```python
import torch

def _softmax(x, axis=-1):
    return torch.softmax(x, dim=axis)

def _gelu(x):
    return torch.nn.functional.gelu(x, approximate='tanh')

def _silu(x):
    return torch.nn.functional.silu(x)

def _sigmoid(x):
    return torch.sigmoid(x)

def _layernorm(x, axis=-1, eps=1e-05):
    m = x.mean(dim=axis, keepdim=True)
    v = x.var(dim=axis, keepdim=True, unbiased=False)
    return (x - m) / torch.sqrt(v + eps)

def _scatter_add(tgt, idx, src, axis=0):
    return tgt.clone().index_add_(axis, idx, src)

def _segment_sum(src, seg, n):
    out = torch.zeros((n,) + src.shape[1:], dtype=src.dtype)
    return out.index_add_(0, seg, src)

def _pad(x, pw):
    flat = tuple((v for pair in reversed(pw) for v in pair))
    return torch.nn.functional.pad(x, flat)
kernel_name = 'recurrent_scan__softmax_full_mha__mixer_gmlp__prompt'

def setup_inputs():

    _w = lambda a: (lambda t: t.to(torch.bfloat16) if t.is_floating_point() else t)(torch.as_tensor(a))

    def _A_setup():
        B, S, D = (1, 2048, 1024)
        return {'x': _w((lambda *s: torch.randn(*s, dtype=torch.bfloat16) * 0.05)(B, S, D)), 'wqkv': _w((lambda *s: torch.randn(*s, dtype=torch.bfloat16) * 0.05)(D, 3 * D)), 'wo': _w((lambda *s: torch.randn(*s, dtype=torch.bfloat16) * 0.05)(D, D))}
    _A_in = _A_setup()

    def _B_setup():
        B, S, D, F = (1, 2048, 1024, 3584)
        Fh = F // 2
        return {'x': _w((lambda *s: torch.randn(*s, dtype=torch.bfloat16) * 0.05)(B, S, D)), 'w_in': _w((lambda *s: torch.randn(*s, dtype=torch.bfloat16) * 0.8)(D, 2 * Fh)), 'w_sp': _w(0.01 * (lambda *s: torch.randn(*s, dtype=torch.bfloat16) * 0.8)(S, S)), 'b_sp': _w(1.0 + 0.01 * (lambda *s: torch.randn(*s, dtype=torch.bfloat16) * 0.05)(S)), 'w_out': _w((lambda *s: torch.randn(*s, dtype=torch.bfloat16) * 0.05)(Fh, D))}
    _B_in = _B_setup()
    return {'A_x': _A_in['x'], 'A_wqkv': _A_in['wqkv'], 'A_wo': _A_in['wo'], 'B_x': _B_in['x'], 'B_w_in': _B_in['w_in'], 'B_w_sp': _B_in['w_sp'], 'B_b_sp': _B_in['b_sp'], 'B_w_out': _B_in['w_out']}

def reference(A_x, A_wqkv, A_wo, B_x, B_w_in, B_w_sp, B_b_sp, B_w_out):

    def _A_ref(x, wqkv, wo):
        B, S, D = x.shape
        H = 32
        Dh = D // H
        qkv = (lambda x, *d: x.permute(*d))((x @ wqkv).reshape(B, S, 3, H, Dh), 2, 0, 3, 1, 4)
        q, k, v = (qkv[0], qkv[1], qkv[2])
        scale = Dh ** (-0.5)
        scores = torch.einsum('bhqd,bhkd->bhqk', q, k) * scale
        p = _softmax(scores, axis=-1)
        o = torch.einsum('bhqk,bhkd->bhqd', p, v)
        return (lambda x, *d: x.permute(*d))(o, 0, 2, 1, 3).reshape(B, S, D) @ wo

    def _B_ref(x, w_in, w_sp, b_sp, w_out):
        B, S, D = x.shape
        F = w_in.shape[-1]
        Fh = F // 2
        z = _gelu(torch.einsum('bsd,df->bsf', x, w_in))
        z1 = z[..., :Fh].clone()
        z2 = _layernorm(z[..., Fh:], axis=-1)
        g = torch.einsum('ts,bsf->btf', w_sp, z2) + b_sp[None, :, None]
        return torch.einsum('bsf,fd->bsd', z1 * g, w_out)
    x = A_x
    xn = _layernorm(x, axis=-1)
    s = _A_ref(xn, A_wqkv, A_wo)
    g = _silu(_B_ref(xn, B_w_in, B_w_sp, B_b_sp, B_w_out))
    return x + s * g
```

```asm
; @launch grid=(256,1,1) block=(512,1,1) lds=163840
.amdgcn_target "amdgcn-amd-amdhsa--gfx950"
.text
.globl recurrent_scan__softmax_full_mha__mixer_gmlp__prompt_kernel
.p2align 8
.type recurrent_scan__softmax_full_mha__mixer_gmlp__prompt_kernel,@function
recurrent_scan__softmax_full_mha__mixer_gmlp__prompt_kernel:
s_cmp_ge_u32 s2, 256
s_cbranch_scc1 L_end
s_load_dwordx2 s[72:73], s[0:1], 0
s_load_dwordx2 s[6:7], s[0:1], 8
s_load_dwordx2 s[36:37], s[0:1], 32
s_load_dwordx4 s[44:47], s[0:1], 72
s_load_dwordx4 s[60:63], s[0:1], 40
s_load_dwordx2 s[66:67], s[0:1], 16
s_load_dwordx4 s[68:71], s[0:1], 56
v_lshrrev_b32 v1, 6, v0
v_and_b32 v0, 63, v0
s_nop 0
v_readfirstlane_b32 s25, v1
s_and_b32 s23, s2, 1
s_lshl_b32 s23, s23, 2
s_bfe_u32 s24, s2, 0x20003
s_add_u32 s23, s23, s24
s_bfe_u32 s32, s2, 0x20001
s_lshr_b32 s30, s2, 5
s_lshl_b32 s24, s32, 3
s_add_u32 s24, s24, s30
s_lshl_b32 s26, s24, 14
s_lshl_b32 s27, s25, 11
s_add_u32 s21, s26, s27
v_lshlrev_b32 v24, 4, v0
v_lshrrev_b32 v25, 3, v0
v_lshrrev_b32 v26, 4, v0
v_and_b32 v27, 7, v0
s_lshl_b32 s26, s25, 16
v_lshlrev_b32 v25, 11, v25
v_add_u32 v25, s26, v25
v_xor_b32 v27, v27, v26
v_xor_b32 v26, 4, v27
v_lshl_add_u32 v27, v27, 4, v25
v_lshl_add_u32 v26, v26, 4, v25
v_add_u32 v5, 0, v27
v_add_u32 v6, 15360, v26
v_add_u32 v7, 30720, v27
v_add_u32 v8, 46080, v26
s_cmp_ge_u32 s30, 3
s_cselect_b32 s58, 1, 0
s_cselect_b32 s26, 3, 0
s_cselect_b32 s27, 14, 24
s_cselect_b32 s34, 0, 16
s_cselect_b32 s89, 1024, s58
s_cselect_b32 s88, 3584, s58
s_sub_u32 s33, s30, s26
s_mul_i32 s35, s33, 3
s_sub_u32 s35, s35, 1
s_max_i32 s35, s35, 0
s_mul_i32 s27, s27, s32
s_add_u32 s34, s34, s27
s_add_u32 s34, s34, s35
s_mul_i32 s22, s32, 24
s_lshl_b32 s26, s30, 1
s_add_u32 s22, s22, s26
s_add_u32 s89, s89, 6144
v_bfe_u32 v28, v0, 3, 1
v_bfe_u32 v25, v0, 1, 2
v_lshl_add_u32 v28, v28, 3, v25
s_lshr_b32 s26, s25, 2
s_lshl_b32 s26, s26, 5
s_and_b32 s27, s25, 1
s_lshl_b32 s27, s27, 4
s_add_u32 s26, s26, s27
s_and_b32 s27, s25, 2
s_lshl_b32 s27, s27, 1
s_add_u32 s26, s26, s27
v_add_u32 v28, s26, v28
v_lshrrev_b32 v25, 4, v0
v_and_b32 v26, 1, v0
v_lshlrev_b32 v25, 5, v25
v_lshl_add_u32 v25, v26, 4, v25
s_lshl_b32 s26, s22, 6
s_movk_i32 s27, 6144
v_add_u32 v26, s26, v25
v_mad_u32_u24 v1, v28, s27, v26
s_lshl_b32 s26, s34, 6
s_add_u32 s26, s26, s88
s_sub_u32 s26, s26, 1024
v_add_u32 v26, s26, v25
v_mad_u32_u24 v2, v28, s89, v26
s_cmp_lg_u32 s33, 0
s_cselect_b32 s26, 32, 0
v_cmp_gt_u32 vcc, s26, v0
v_add_u32 v25, 4294966400, v2
v_mov_b32 v26, 0x7fff0000
v_cndmask_b32 v3, v26, v25, vcc
s_and_b32 s42, s25, 3
s_mul_i32 s28, s42, 3072
s_add_u32 s28, s28, 98304
s_lshr_b32 s26, s25, 2
s_lshl_b32 s26, s26, 14
s_add_u32 s40, s28, s26
s_lshl_b32 s29, s25, 12
s_lshl_b32 s26, s23, 19
s_add_u32 m0, s29, 65536
s_cmp_lg_u32 s58, 0
s_waitcnt lgkmcnt(0)
s_cselect_b32 s84, s36, s6
s_cselect_b32 s85, s37, s7
s_add_u32 s12, s72, s26
s_addc_u32 s13, s73, 0
s_mov_b32 s14, 0x80000
s_mov_b32 s15, 0x20000
L_cw0:
s_getpc_b64 s[16:17]
s_mov_b32 s18, L_cw1-L_cw0
s_mov_b32 s19, 0x20000
s_lshr_b32 s27, s2, 3
s_lshl_b32 s27, s27, 3
s_add_u32 s27, s27, s25
s_lshl_b32 s27, s27, 9
v_lshlrev_b32 v22, 6, v0
v_cmp_gt_u32 vcc, 8, v0
v_add_u32 v22, s27, v22
v_mov_b32 v23, 0x7fff0000
v_cndmask_b32 v22, v23, v22, vcc
buffer_load_dword v14, v22, s[16:19], 0 offen
buffer_load_dwordx4 v[128:131], v24, s[12:15], s21 offen offset:0
buffer_load_dwordx4 v[132:135], v24, s[12:15], s21 offen offset:1024
buffer_load_dwordx4 v5, s[12:15], 0 offen offset:0 lds
buffer_load_dwordx4 v6, s[12:15], 0 offen offset:1024 lds
buffer_load_dwordx4 v7, s[12:15], 0 offen offset:2048 lds
buffer_load_dwordx4 v8, s[12:15], 0 offen offset:3072 lds
s_mov_b32 m0, s40
s_lshl_b32 s86, s89, 10
s_mov_b32 s87, 0x20000
s_mov_b32 s8, s6
s_mov_b32 s9, s7
s_mov_b32 s10, 0x600000
s_mov_b32 s11, 0x20000
buffer_load_dwordx4 v1, s[8:11], 0 offen offset:0 lds
buffer_load_dwordx4 v2, s[84:87], 0 offen offset:1024 lds
buffer_load_dwordx4 v3, s[84:87], 0 offen offset:2048 lds
s_mov_b32 s4, s46
s_mov_b32 s5, s47
s_mov_b32 s16, s4
s_mov_b32 s17, s5
s_mov_b32 s18, 0x2800000
s_mov_b32 s19, 0x20000
s_mov_b32 s92, s4
s_mov_b32 s93, s5
s_mov_b32 s94, 0x8000
s_mov_b32 s95, 0x20000
s_mov_b32 s52, s44
s_mov_b32 s53, s45
s_mov_b32 s54, 0x100
s_mov_b32 s55, 0x20000
s_add_u32 s48, s4, 0x3400000
s_addc_u32 s49, s5, 0
s_mov_b32 s50, 0x10000
s_mov_b32 s51, 0x20000
s_lshl_b32 s26, s23, 5
s_add_u32 s26, s26, s24
s_lshl_b32 s26, s26, 7
s_lshl_b32 s27, s25, 3
s_add_u32 s26, s26, s27
v_mov_b32 v22, s26
v_cmp_eq_u32 vcc, 0, v0
v_mov_b32 v29, 0x7fff0000
s_nop 0
v_cndmask_b32 v30, v29, v22, vcc
s_lshl_b32 s26, s2, 8
s_cmp_lg_u32 s25, 0
s_cselect_b32 s26, 0x7fff0000, s26
v_and_b32 v22, 7, v0
v_lshl_add_u32 v22, v22, 2, s26
v_lshrrev_b32 v23, 3, v0
v_lshl_add_u32 v22, v23, 7, v22
v_cmp_gt_u32 vcc, 16, v0
s_nop 1
v_cndmask_b32 v29, v29, v22, vcc
v_mov_b32 v31, 0
s_lshl_b32 s47, s23, 5
s_lshl_b32 s89, s89, 6
s_mov_b32 s88, s89
s_mov_b32 s20, 393216
s_mov_b32 s21, 128
s_mov_b32 s57, 32768
s_mov_b32 s59, 0xffff0000
s_mov_b32 s40, 2
s_lshl_b32 s26, s24, 1
s_lshr_b32 s27, s25, 2
s_add_u32 s26, s26, s27
s_lshl_b32 s74, s26, 9
s_lshl_b32 s31, s23, 14
s_lshl_b32 s26, s42, 12
s_add_u32 s31, s31, s26
s_lshl_b32 s64, s23, 1
s_bfe_u32 s26, s2, 0x10001
s_add_u32 s64, s64, s26
s_cmp_ge_u32 s25, 4
s_cbranch_scc1 L_k1_g
s_cmp_lg_u32 s58, 0
s_cbranch_scc1 L_k1_z
s_cmp_lg_u32 s33, 0
s_cbranch_scc1 L_k1_q3
s_branch L_k1_q2
L_k1_z:
s_cmp_lg_u32 s33, 0
s_cbranch_scc1 L_k1_z3
s_branch L_k1_z2
L_k1_q3:
s_lshl_b32 s26, s34, 17
s_add_u32 s31, s31, s26
s_add_u32 s31, s31, 0x400000
s_mov_b32 s35, 2
s_cmp_lt_u32 s34, 32
s_cselect_b32 s56, 0x3e8293ee, 1.0
v_and_b32 v24, 15, v0
v_lshrrev_b32 v25, 4, v0
v_bfe_u32 v26, v0, 1, 3
s_lshl_b32 s26, s42, 13
s_add_u32 s26, s26, 65536
v_lshlrev_b32 v24, 7, v24
v_add_u32 v24, s26, v24
v_xor_b32 v27, v25, v26
v_lshl_add_u32 v9, v27, 4, v24
v_xor_b32 v10, 64, v9
v_lshrrev_b32 v24, 5, v0
v_mul_u32_u24 v24, 3072, v24
v_and_b32 v25, 31, v0
v_lshl_add_u32 v24, v25, 3, v24
s_cmp_ge_u32 s42, 3
s_cselect_b32 s27, 3, 0
s_sub_u32 s46, s42, s27
s_add_u32 s26, s46, 0
s_cmp_ge_u32 s26, 3
s_cselect_b32 s27, 3, 0
s_sub_u32 s26, s26, s27
s_lshl_b32 s26, s26, 9
s_add_u32 s26, s26, 99328
v_add_u32 v11, s26, v24
s_add_u32 s26, s46, 1
s_cmp_ge_u32 s26, 3
s_cselect_b32 s27, 3, 0
s_sub_u32 s26, s26, s27
s_lshl_b32 s26, s26, 9
s_add_u32 s26, s26, 99328
v_add_u32 v12, s26, v24
s_add_u32 s26, s46, 2
s_cmp_ge_u32 s26, 3
s_cselect_b32 s27, 3, 0
s_sub_u32 s26, s26, s27
s_lshl_b32 s26, s26, 9
s_add_u32 s26, s26, 99328
v_add_u32 v13, s26, v24
v_bfe_u32 v24, v0, 1, 1
v_lshrrev_b32 v25, 5, v0
v_cmp_eq_u32 vcc, v24, v25
v_mov_b32 v24, 0x3f803f80
s_nop 0
v_cndmask_b32 v96, 0, v24, vcc
v_mov_b32 v97, v96
v_mov_b32 v98, v96
v_mov_b32 v99, v96
v_and_b32 v24, 1, v0
v_mul_u32_u24 v24, 0xaaaa, v24
v_add_u32 v15, 0x4444, v24
v_mov_b32 v100, 0
v_mov_b32 v101, 0
v_mov_b32 v102, 0
v_mov_b32 v103, 0
s_waitcnt vmcnt(7)
s_mov_b32 m0, s29
s_nop 0
buffer_load_dwordx4 v5, s[12:15], s21 offen offset:0 lds
v_lshlrev_b32 v144, 16, v128
v_and_b32 v145, 0xffff0000, v128
v_lshlrev_b32 v146, 16, v129
v_and_b32 v147, 0xffff0000, v129
v_lshlrev_b32 v148, 16, v130
v_and_b32 v149, 0xffff0000, v130
v_lshlrev_b32 v150, 16, v131
v_and_b32 v151, 0xffff0000, v131
v_lshlrev_b32 v152, 16, v132
buffer_load_dwordx4 v6, s[12:15], s21 offen offset:1024 lds
v_and_b32 v153, 0xffff0000, v132
v_lshlrev_b32 v154, 16, v133
v_and_b32 v155, 0xffff0000, v133
v_lshlrev_b32 v156, 16, v134
v_and_b32 v157, 0xffff0000, v134
v_lshlrev_b32 v158, 16, v135
v_and_b32 v159, 0xffff0000, v135
v_pk_add_f32 v[128:129], v[144:145], v[152:153]
v_pk_add_f32 v[130:131], v[146:147], v[154:155]
v_pk_add_f32 v[132:133], v[148:149], v[156:157]
buffer_load_dwordx4 v7, s[12:15], s21 offen offset:2048 lds
v_pk_add_f32 v[134:135], v[150:151], v[158:159]
v_pk_add_f32 v[128:129], v[128:129], v[130:131]
v_pk_add_f32 v[132:133], v[132:133], v[134:135]
v_pk_add_f32 v[128:129], v[128:129], v[132:133]
v_add_f32 v128, v128, v129
s_nop 1
v_add_f32_dpp v128, v128, v128 quad_perm:[1,0,3,2] row_mask:0xf bank_mask:0xf
s_nop 1
v_add_f32_dpp v128, v128, v128 quad_perm:[2,3,0,1] row_mask:0xf bank_mask:0xf
s_nop 1
v_add_f32_dpp v128, v128, v128 row_half_mirror row_mask:0xf bank_mask:0xf
s_nop 1
v_add_f32_dpp v128, v128, v128 row_mirror row_mask:0xf bank_mask:0xf
v_mov_b32 v129, v128
buffer_load_dwordx4 v8, s[12:15], s21 offen offset:3072 lds
s_add_u32 s21, s21, 128
s_add_u32 s29, s29, 32768
s_cmp_ge_u32 s29, 98304
s_cselect_b32 s26, 98304, 0
s_sub_u32 s29, s29, s26
v_permlane16_swap_b32 v128, v129
v_add_f32 v128, v128, v129
v_mov_b32 v129, v128
s_nop 1
v_permlane32_swap_b32 v128, v129
v_add_f32 v128, v128, v129
v_mul_f32 v16, 0xba800000, v128
v_pk_add_f32 v[144:145], v[144:145], v[16:17] op_sel_hi:[1,0]
v_pk_add_f32 v[146:147], v[146:147], v[16:17] op_sel_hi:[1,0]
v_pk_add_f32 v[148:149], v[148:149], v[16:17] op_sel_hi:[1,0]
v_pk_add_f32 v[150:151], v[150:151], v[16:17] op_sel_hi:[1,0]
s_add_u32 m0, s28, 32768
s_nop 0
buffer_load_dwordx4 v1, s[8:11], s20 offen offset:0 lds
v_pk_add_f32 v[152:153], v[152:153], v[16:17] op_sel_hi:[1,0]
v_pk_add_f32 v[154:155], v[154:155], v[16:17] op_sel_hi:[1,0]
v_pk_add_f32 v[156:157], v[156:157], v[16:17] op_sel_hi:[1,0]
v_pk_add_f32 v[158:159], v[158:159], v[16:17] op_sel_hi:[1,0]
v_pk_mul_f32 v[128:129], v[144:145], v[144:145]
v_pk_mul_f32 v[130:131], v[146:147], v[146:147]
v_pk_mul_f32 v[132:133], v[148:149], v[148:149]
v_pk_mul_f32 v[134:135], v[150:151], v[150:151]
v_pk_fma_f32 v[128:129], v[152:153], v[152:153], v[128:129]
v_pk_fma_f32 v[130:131], v[154:155], v[154:155], v[130:131]
buffer_load_dwordx4 v2, s[84:87], s88 offen offset:1024 lds
v_pk_fma_f32 v[132:133], v[156:157], v[156:157], v[132:133]
v_pk_fma_f32 v[134:135], v[158:159], v[158:159], v[134:135]
v_pk_add_f32 v[128:129], v[128:129], v[130:131]
v_pk_add_f32 v[132:133], v[132:133], v[134:135]
v_pk_add_f32 v[128:129], v[128:129], v[132:133]
v_add_f32 v128, v128, v129
s_nop 1
v_add_f32_dpp v128, v128, v128 quad_perm:[1,0,3,2] row_mask:0xf bank_mask:0xf
s_nop 1
v_add_f32_dpp v128, v128, v128 quad_perm:[2,3,0,1] row_mask:0xf bank_mask:0xf
s_nop 1
v_add_f32_dpp v128, v128, v128 row_half_mirror row_mask:0xf bank_mask:0xf
s_nop 1
v_add_f32_dpp v128, v128, v128 row_mirror row_mask:0xf bank_mask:0xf
buffer_load_dwordx4 v3, s[84:87], s88 offen offset:2048 lds
s_add_u32 s20, s20, 393216
s_add_u32 s88, s88, s89
v_mov_b32 v129, v128
s_nop 1
v_permlane16_swap_b32 v128, v129
v_add_f32 v128, v128, v129
v_mov_b32 v129, v128
s_nop 1
v_permlane32_swap_b32 v128, v129
v_add_f32 v128, v128, v129
v_mov_b32 v129, 0x3727c5ac
v_fmac_f32 v129, 0x3a800000, v128
v_rsq_f32 v17, v129
s_nop 0
buffer_store_dwordx2 v[16:17], v30, s[92:95], 0 offen sc0 sc1
buffer_store_dword v31, v29, s[48:51], 0 offen sc0 sc1
s_waitcnt vmcnt(9)
s_barrier
ds_read_b64_tr_b16 v[224:225], v11 offset:0
ds_read_b64_tr_b16 v[226:227], v11 offset:6144
ds_read_b128 v[32:35], v9 offset:0
ds_read_b64_tr_b16 v[232:233], v11 offset:16384
ds_read_b64_tr_b16 v[234:235], v11 offset:22528
ds_read_b128 v[48:51], v10 offset:0
ds_read_b128 v[52:55], v10 offset:2048
ds_read_b128 v[36:39], v9 offset:2048
ds_read_b64_tr_b16 v[228:229], v11 offset:256
ds_read_b64_tr_b16 v[230:231], v11 offset:6400
ds_read_b64_tr_b16 v[236:237], v11 offset:16640
ds_read_b64_tr_b16 v[238:239], v11 offset:22784
ds_read_b64_tr_b16 v[64:65], v12 offset:0
ds_read_b64_tr_b16 v[66:67], v12 offset:6144
ds_read_b64_tr_b16 v[72:73], v12 offset:16384
s_waitcnt lgkmcnt(14)
ds_read_b64_tr_b16 v[74:75], v12 offset:22528
s_waitcnt lgkmcnt(14)
ds_read_b64_tr_b16 v[68:69], v12 offset:256
s_waitcnt lgkmcnt(14)
ds_read_b64_tr_b16 v[70:71], v12 offset:6400
s_waitcnt lgkmcnt(14)
ds_read_b64_tr_b16 v[76:77], v12 offset:16640
s_waitcnt lgkmcnt(14)
ds_read_b64_tr_b16 v[78:79], v12 offset:22784
s_waitcnt lgkmcnt(14)
ds_read_b64_tr_b16 v[80:81], v13 offset:0
s_waitcnt lgkmcnt(14)
ds_read_b64_tr_b16 v[82:83], v13 offset:6144
s_waitcnt lgkmcnt(14)
ds_read_b64_tr_b16 v[88:89], v13 offset:16384
s_waitcnt lgkmcnt(14)
ds_read_b64_tr_b16 v[90:91], v13 offset:22528
s_mov_b32 s22, 6
s_mov_b32 m0, s29
v_mfma_f32_16x16x32_bf16 v[128:131], v[224:227], v[32:35], 0
s_setprio 1
s_waitcnt lgkmcnt(14)
ds_read_b64_tr_b16 v[84:85], v13 offset:256
v_mfma_f32_16x16x32_bf16 v[128:131], v[232:235], v[48:51], v[128:131]
buffer_load_dwordx4 v5, s[12:15], s21 offen offset:0 lds
s_waitcnt lgkmcnt(14)
ds_read_b64_tr_b16 v[86:87], v13 offset:6400
v_mfma_f32_16x16x32_bf16 v[132:135], v[232:235], v[52:55], 0
s_waitcnt lgkmcnt(14)
ds_read_b64_tr_b16 v[92:93], v13 offset:16640
v_mfma_f32_16x16x32_bf16 v[132:135], v[224:227], v[36:39], v[132:135]
s_waitcnt lgkmcnt(14)
ds_read_b64_tr_b16 v[94:95], v13 offset:22784
v_mfma_f32_16x16x32_bf16 v[148:151], v[228:231], v[36:39], 0
buffer_load_dwordx4 v6, s[12:15], s21 offen offset:1024 lds
s_waitcnt lgkmcnt(14)
ds_read_b128 v[40:43], v9 offset:4096
v_mfma_f32_16x16x32_bf16 v[148:151], v[236:239], v[52:55], v[148:151]
s_waitcnt lgkmcnt(14)
ds_read_b128 v[56:59], v10 offset:4096
v_mfma_f32_16x16x32_bf16 v[144:147], v[236:239], v[48:51], 0
buffer_load_dwordx4 v7, s[12:15], s21 offen offset:2048 lds
s_waitcnt lgkmcnt(14)
ds_read_b128 v[44:47], v9 offset:6144
v_mfma_f32_16x16x32_bf16 v[144:147], v[228:231], v[32:35], v[144:147]
s_waitcnt lgkmcnt(14)
ds_read_b128 v[60:63], v10 offset:6144
v_add_u32 v9, s59, v9
v_add_u32 v10, s59, v10
s_add_u32 s40, s40, 1
s_cmp_eq_u32 s40, 3
s_cselect_b32 s40, 0, s40
s_cmp_eq_u32 s40, 2
s_cselect_b32 s59, 0xffff0000, s57
v_smfmac_f32_16x16x64_bf16 v[100:103], v[96:99], v[224:231], v15
v_mfma_f32_16x16x32_bf16 v[160:163], v[64:67], v[32:35], 0
v_mfma_f32_16x16x32_bf16 v[160:163], v[72:75], v[48:51], v[160:163]
buffer_load_dwordx4 v8, s[12:15], s21 offen offset:3072 lds
s_add_u32 s21, s21, 128
s_add_u32 s29, s29, 32768
s_cmp_ge_u32 s29, 98304
s_cselect_b32 s26, 98304, 0
s_sub_u32 s29, s29, s26
v_mfma_f32_16x16x32_bf16 v[164:167], v[72:75], v[52:55], 0
v_mfma_f32_16x16x32_bf16 v[164:167], v[64:67], v[36:39], v[164:167]
s_setprio 0
s_waitcnt lgkmcnt(14)
v_mfma_f32_16x16x32_bf16 v[180:183], v[68:71], v[36:39], 0
s_setprio 1
s_waitcnt lgkmcnt(12)
v_mfma_f32_16x16x32_bf16 v[180:183], v[76:79], v[52:55], v[180:183]
s_waitcnt lgkmcnt(0)
s_barrier
s_add_u32 m0, s28, 0
v_mfma_f32_16x16x32_bf16 v[176:179], v[76:79], v[48:51], 0
buffer_load_dwordx4 v1, s[8:11], s20 offen offset:0 lds
v_mfma_f32_16x16x32_bf16 v[176:179], v[68:71], v[32:35], v[176:179]
v_smfmac_f32_16x16x64_bf16 v[100:103], v[96:99], v[232:239], v15
v_mfma_f32_16x16x32_bf16 v[192:195], v[80:83], v[32:35], 0
v_mfma_f32_16x16x32_bf16 v[192:195], v[88:91], v[48:51], v[192:195]
v_mfma_f32_16x16x32_bf16 v[196:199], v[88:91], v[52:55], 0
v_mfma_f32_16x16x32_bf16 v[196:199], v[80:83], v[36:39], v[196:199]
v_mfma_f32_16x16x32_bf16 v[212:215], v[84:87], v[36:39], 0
buffer_load_dwordx4 v2, s[84:87], s88 offen offset:1024 lds
v_mfma_f32_16x16x32_bf16 v[212:215], v[92:95], v[52:55], v[212:215]
v_mfma_f32_16x16x32_bf16 v[208:211], v[92:95], v[48:51], 0
v_mfma_f32_16x16x32_bf16 v[208:211], v[84:87], v[32:35], v[208:211]
s_setprio 0
s_waitcnt vmcnt(6)
s_barrier
v_mfma_f32_16x16x32_bf16 v[136:139], v[224:227], v[40:43], 0
s_setprio 1
ds_read_b128 v[36:39], v9 offset:2048
s_cmp_lg_u32 s25, 0
s_cbranch_scc1 L_k1_np_q3
v_mov_b32 v28, 1
v_mov_b32 v29, 0
s_mov_b64 exec, 1
buffer_atomic_add v28, v29, s[52:55], s47 offen sc1
s_mov_b64 exec, -1
v_lshlrev_b32 v27, 5, v0
L_k1_np_q3:
v_mfma_f32_16x16x32_bf16 v[136:139], v[232:235], v[56:59], v[136:139]
ds_read_b128 v[52:55], v10 offset:2048
v_mfma_f32_16x16x32_bf16 v[140:143], v[232:235], v[60:63], 0
buffer_load_dwordx4 v3, s[84:87], s88 offen offset:2048 lds
s_add_u32 s20, s20, 393216
s_add_u32 s88, s88, s89
s_mov_b32 m0, s29
ds_read_b128 v[32:35], v9 offset:0
v_mfma_f32_16x16x32_bf16 v[140:143], v[224:227], v[44:47], v[140:143]
buffer_load_dwordx4 v5, s[12:15], s21 offen offset:0 lds
ds_read_b128 v[48:51], v10 offset:0
v_mfma_f32_16x16x32_bf16 v[156:159], v[228:231], v[44:47], 0
ds_read_b64_tr_b16 v[224:225], v11 offset:32768
v_mfma_f32_16x16x32_bf16 v[156:159], v[236:239], v[60:63], v[156:159]
ds_read_b64_tr_b16 v[226:227], v11 offset:38912
v_mfma_f32_16x16x32_bf16 v[152:155], v[236:239], v[56:59], 0
ds_read_b64_tr_b16 v[232:233], v11 offset:49152
v_mfma_f32_16x16x32_bf16 v[152:155], v[228:231], v[40:43], v[152:155]
ds_read_b64_tr_b16 v[234:235], v11 offset:55296
v_mfma_f32_16x16x32_bf16 v[168:171], v[64:67], v[40:43], 0
ds_read_b64_tr_b16 v[228:229], v11 offset:33024
v_mfma_f32_16x16x32_bf16 v[168:171], v[72:75], v[56:59], v[168:171]
buffer_load_dwordx4 v6, s[12:15], s21 offen offset:1024 lds
ds_read_b64_tr_b16 v[230:231], v11 offset:39168
v_mfma_f32_16x16x32_bf16 v[172:175], v[72:75], v[60:63], 0
ds_read_b64_tr_b16 v[236:237], v11 offset:49408
v_mfma_f32_16x16x32_bf16 v[172:175], v[64:67], v[44:47], v[172:175]
s_setprio 0
ds_read_b64_tr_b16 v[238:239], v11 offset:55552
v_mfma_f32_16x16x32_bf16 v[188:191], v[68:71], v[44:47], 0
s_setprio 1
ds_read_b64_tr_b16 v[64:65], v12 offset:32768
v_mfma_f32_16x16x32_bf16 v[188:191], v[76:79], v[60:63], v[188:191]
ds_read_b64_tr_b16 v[66:67], v12 offset:38912
v_mfma_f32_16x16x32_bf16 v[184:187], v[76:79], v[56:59], 0
ds_read_b64_tr_b16 v[72:73], v12 offset:49152
v_mfma_f32_16x16x32_bf16 v[184:187], v[68:71], v[40:43], v[184:187]
buffer_load_dwordx4 v7, s[12:15], s21 offen offset:2048 lds
s_waitcnt lgkmcnt(14)
ds_read_b64_tr_b16 v[74:75], v12 offset:55296
v_mfma_f32_16x16x32_bf16 v[200:203], v[80:83], v[40:43], 0
s_waitcnt lgkmcnt(14)
ds_read_b64_tr_b16 v[68:69], v12 offset:33024
v_mfma_f32_16x16x32_bf16 v[200:203], v[88:91], v[56:59], v[200:203]
s_waitcnt lgkmcnt(14)
ds_read_b64_tr_b16 v[70:71], v12 offset:39168
v_mfma_f32_16x16x32_bf16 v[204:207], v[88:91], v[60:63], 0
s_waitcnt lgkmcnt(14)
ds_read_b64_tr_b16 v[76:77], v12 offset:49408
v_mfma_f32_16x16x32_bf16 v[204:207], v[80:83], v[44:47], v[204:207]
s_waitcnt lgkmcnt(14)
ds_read_b64_tr_b16 v[78:79], v12 offset:55552
v_mfma_f32_16x16x32_bf16 v[220:223], v[84:87], v[44:47], 0
s_waitcnt lgkmcnt(14)
ds_read_b64_tr_b16 v[80:81], v13 offset:32768
v_mfma_f32_16x16x32_bf16 v[220:223], v[92:95], v[60:63], v[220:223]
buffer_load_dwordx4 v8, s[12:15], s21 offen offset:3072 lds
s_add_u32 s21, s21, 128
s_add_u32 s29, s29, 32768
s_cmp_ge_u32 s29, 98304
s_cselect_b32 s26, 98304, 0
s_sub_u32 s29, s29, s26
s_waitcnt lgkmcnt(14)
ds_read_b64_tr_b16 v[82:83], v13 offset:38912
v_mfma_f32_16x16x32_bf16 v[216:219], v[92:95], v[56:59], 0
s_waitcnt lgkmcnt(14)
ds_read_b64_tr_b16 v[88:89], v13 offset:49152
v_mfma_f32_16x16x32_bf16 v[216:219], v[84:87], v[40:43], v[216:219]
s_setprio 0
s_waitcnt lgkmcnt(14)
ds_read_b64_tr_b16 v[90:91], v13 offset:55296
L_k1_loop_q3:
v_mfma_f32_16x16x32_bf16 v[128:131], v[224:227], v[32:35], v[128:131]
s_setprio 1
s_waitcnt lgkmcnt(14)
ds_read_b64_tr_b16 v[84:85], v13 offset:33024
v_mfma_f32_16x16x32_bf16 v[128:131], v[232:235], v[48:51], v[128:131]
s_waitcnt lgkmcnt(14)
ds_read_b64_tr_b16 v[86:87], v13 offset:39168
v_mfma_f32_16x16x32_bf16 v[132:135], v[232:235], v[52:55], v[132:135]
s_waitcnt lgkmcnt(14)
ds_read_b64_tr_b16 v[92:93], v13 offset:49408
v_mfma_f32_16x16x32_bf16 v[132:135], v[224:227], v[36:39], v[132:135]
s_waitcnt lgkmcnt(14)
ds_read_b64_tr_b16 v[94:95], v13 offset:55552
v_mfma_f32_16x16x32_bf16 v[148:151], v[228:231], v[36:39], v[148:151]
s_waitcnt lgkmcnt(14)
ds_read_b128 v[40:43], v9 offset:4096
v_mfma_f32_16x16x32_bf16 v[148:151], v[236:239], v[52:55], v[148:151]
s_waitcnt lgkmcnt(14)
ds_read_b128 v[56:59], v10 offset:4096
v_mfma_f32_16x16x32_bf16 v[144:147], v[236:239], v[48:51], v[144:147]
s_waitcnt lgkmcnt(14)
ds_read_b128 v[44:47], v9 offset:6144
v_mfma_f32_16x16x32_bf16 v[144:147], v[228:231], v[32:35], v[144:147]
s_waitcnt lgkmcnt(14)
ds_read_b128 v[60:63], v10 offset:6144
v_add_u32 v9, s59, v9
v_add_u32 v10, s59, v10
s_add_u32 s40, s40, 1
s_cmp_eq_u32 s40, 3
s_cselect_b32 s40, 0, s40
s_cmp_eq_u32 s40, 2
s_cselect_b32 s59, 0xffff0000, s57
v_smfmac_f32_16x16x64_bf16 v[100:103], v[96:99], v[224:231], v15
v_mfma_f32_16x16x32_bf16 v[160:163], v[64:67], v[32:35], v[160:163]
v_mfma_f32_16x16x32_bf16 v[160:163], v[72:75], v[48:51], v[160:163]
v_mfma_f32_16x16x32_bf16 v[164:167], v[72:75], v[52:55], v[164:167]
v_mfma_f32_16x16x32_bf16 v[164:167], v[64:67], v[36:39], v[164:167]
s_setprio 0
s_waitcnt lgkmcnt(14)
v_mfma_f32_16x16x32_bf16 v[180:183], v[68:71], v[36:39], v[180:183]
s_setprio 1
s_waitcnt lgkmcnt(12)
v_mfma_f32_16x16x32_bf16 v[180:183], v[76:79], v[52:55], v[180:183]
s_waitcnt lgkmcnt(0)
s_barrier
s_add_u32 m0, s28, 32768
v_mfma_f32_16x16x32_bf16 v[176:179], v[76:79], v[48:51], v[176:179]
buffer_load_dwordx4 v1, s[8:11], s20 offen offset:0 lds
v_mfma_f32_16x16x32_bf16 v[176:179], v[68:71], v[32:35], v[176:179]
v_smfmac_f32_16x16x64_bf16 v[100:103], v[96:99], v[232:239], v15
v_mfma_f32_16x16x32_bf16 v[192:195], v[80:83], v[32:35], v[192:195]
v_mfma_f32_16x16x32_bf16 v[192:195], v[88:91], v[48:51], v[192:195]
v_mfma_f32_16x16x32_bf16 v[196:199], v[88:91], v[52:55], v[196:199]
v_mfma_f32_16x16x32_bf16 v[196:199], v[80:83], v[36:39], v[196:199]
v_mfma_f32_16x16x32_bf16 v[212:215], v[84:87], v[36:39], v[212:215]
buffer_load_dwordx4 v2, s[84:87], s88 offen offset:1024 lds
v_mfma_f32_16x16x32_bf16 v[212:215], v[92:95], v[52:55], v[212:215]
v_mfma_f32_16x16x32_bf16 v[208:211], v[92:95], v[48:51], v[208:211]
v_mfma_f32_16x16x32_bf16 v[208:211], v[84:87], v[32:35], v[208:211]
s_setprio 0
s_waitcnt vmcnt(6)
s_barrier
v_mfma_f32_16x16x32_bf16 v[136:139], v[224:227], v[40:43], v[136:139]
s_setprio 1
ds_read_b128 v[36:39], v9 offset:2048
v_mfma_f32_16x16x32_bf16 v[136:139], v[232:235], v[56:59], v[136:139]
ds_read_b128 v[52:55], v10 offset:2048
v_mfma_f32_16x16x32_bf16 v[140:143], v[232:235], v[60:63], v[140:143]
buffer_load_dwordx4 v3, s[84:87], s88 offen offset:2048 lds
s_add_u32 s20, s20, 393216
s_add_u32 s88, s88, s89
s_mov_b32 m0, s29
ds_read_b128 v[32:35], v9 offset:0
v_mfma_f32_16x16x32_bf16 v[140:143], v[224:227], v[44:47], v[140:143]
buffer_load_dwordx4 v5, s[12:15], s21 offen offset:0 lds
ds_read_b128 v[48:51], v10 offset:0
v_mfma_f32_16x16x32_bf16 v[156:159], v[228:231], v[44:47], v[156:159]
ds_read_b64_tr_b16 v[224:225], v11 offset:0
v_mfma_f32_16x16x32_bf16 v[156:159], v[236:239], v[60:63], v[156:159]
ds_read_b64_tr_b16 v[226:227], v11 offset:6144
v_mfma_f32_16x16x32_bf16 v[152:155], v[236:239], v[56:59], v[152:155]
ds_read_b64_tr_b16 v[232:233], v11 offset:16384
v_mfma_f32_16x16x32_bf16 v[152:155], v[228:231], v[40:43], v[152:155]
ds_read_b64_tr_b16 v[234:235], v11 offset:22528
v_mfma_f32_16x16x32_bf16 v[168:171], v[64:67], v[40:43], v[168:171]
ds_read_b64_tr_b16 v[228:229], v11 offset:256
v_mfma_f32_16x16x32_bf16 v[168:171], v[72:75], v[56:59], v[168:171]
buffer_load_dwordx4 v6, s[12:15], s21 offen offset:1024 lds
ds_read_b64_tr_b16 v[230:231], v11 offset:6400
v_mfma_f32_16x16x32_bf16 v[172:175], v[72:75], v[60:63], v[172:175]
ds_read_b64_tr_b16 v[236:237], v11 offset:16640
v_mfma_f32_16x16x32_bf16 v[172:175], v[64:67], v[44:47], v[172:175]
s_setprio 0
ds_read_b64_tr_b16 v[238:239], v11 offset:22784
v_mfma_f32_16x16x32_bf16 v[188:191], v[68:71], v[44:47], v[188:191]
s_setprio 1
ds_read_b64_tr_b16 v[64:65], v12 offset:0
v_mfma_f32_16x16x32_bf16 v[188:191], v[76:79], v[60:63], v[188:191]
ds_read_b64_tr_b16 v[66:67], v12 offset:6144
v_mfma_f32_16x16x32_bf16 v[184:187], v[76:79], v[56:59], v[184:187]
ds_read_b64_tr_b16 v[72:73], v12 offset:16384
v_mfma_f32_16x16x32_bf16 v[184:187], v[68:71], v[40:43], v[184:187]
buffer_load_dwordx4 v7, s[12:15], s21 offen offset:2048 lds
s_waitcnt lgkmcnt(14)
ds_read_b64_tr_b16 v[74:75], v12 offset:22528
v_mfma_f32_16x16x32_bf16 v[200:203], v[80:83], v[40:43], v[200:203]
s_waitcnt lgkmcnt(14)
ds_read_b64_tr_b16 v[68:69], v12 offset:256
v_mfma_f32_16x16x32_bf16 v[200:203], v[88:91], v[56:59], v[200:203]
s_waitcnt lgkmcnt(14)
ds_read_b64_tr_b16 v[70:71], v12 offset:6400
v_mfma_f32_16x16x32_bf16 v[204:207], v[88:91], v[60:63], v[204:207]
s_waitcnt lgkmcnt(14)
ds_read_b64_tr_b16 v[76:77], v12 offset:16640
v_mfma_f32_16x16x32_bf16 v[204:207], v[80:83], v[44:47], v[204:207]
s_waitcnt lgkmcnt(14)
ds_read_b64_tr_b16 v[78:79], v12 offset:22784
v_mfma_f32_16x16x32_bf16 v[220:223], v[84:87], v[44:47], v[220:223]
s_waitcnt lgkmcnt(14)
ds_read_b64_tr_b16 v[80:81], v13 offset:0
v_mfma_f32_16x16x32_bf16 v[220:223], v[92:95], v[60:63], v[220:223]
buffer_load_dwordx4 v8, s[12:15], s21 offen offset:3072 lds
s_add_u32 s21, s21, 128
s_add_u32 s29, s29, 32768
s_cmp_ge_u32 s29, 98304
s_cselect_b32 s26, 98304, 0
s_sub_u32 s29, s29, s26
s_waitcnt lgkmcnt(14)
ds_read_b64_tr_b16 v[82:83], v13 offset:6144
v_mfma_f32_16x16x32_bf16 v[216:219], v[92:95], v[56:59], v[216:219]
s_waitcnt lgkmcnt(14)
ds_read_b64_tr_b16 v[88:89], v13 offset:16384
v_mfma_f32_16x16x32_bf16 v[216:219], v[84:87], v[40:43], v[216:219]
s_setprio 0
s_waitcnt lgkmcnt(14)
ds_read_b64_tr_b16 v[90:91], v13 offset:22528
v_mfma_f32_16x16x32_bf16 v[128:131], v[224:227], v[32:35], v[128:131]
s_setprio 1
s_waitcnt lgkmcnt(14)
ds_read_b64_tr_b16 v[84:85], v13 offset:256
v_mfma_f32_16x16x32_bf16 v[128:131], v[232:235], v[48:51], v[128:131]
s_waitcnt lgkmcnt(14)
ds_read_b64_tr_b16 v[86:87], v13 offset:6400
v_mfma_f32_16x16x32_bf16 v[132:135], v[232:235], v[52:55], v[132:135]
s_waitcnt lgkmcnt(14)
ds_read_b64_tr_b16 v[92:93], v13 offset:16640
v_mfma_f32_16x16x32_bf16 v[132:135], v[224:227], v[36:39], v[132:135]
s_waitcnt lgkmcnt(14)
ds_read_b64_tr_b16 v[94:95], v13 offset:22784
v_mfma_f32_16x16x32_bf16 v[148:151], v[228:231], v[36:39], v[148:151]
s_waitcnt lgkmcnt(14)
ds_read_b128 v[40:43], v9 offset:4096
v_mfma_f32_16x16x32_bf16 v[148:151], v[236:239], v[52:55], v[148:151]
s_waitcnt lgkmcnt(14)
ds_read_b128 v[56:59], v10 offset:4096
v_mfma_f32_16x16x32_bf16 v[144:147], v[236:239], v[48:51], v[144:147]
s_waitcnt lgkmcnt(14)
ds_read_b128 v[44:47], v9 offset:6144
v_mfma_f32_16x16x32_bf16 v[144:147], v[228:231], v[32:35], v[144:147]
s_waitcnt lgkmcnt(14)
ds_read_b128 v[60:63], v10 offset:6144
v_add_u32 v9, s59, v9
v_add_u32 v10, s59, v10
s_add_u32 s40, s40, 1
s_cmp_eq_u32 s40, 3
s_cselect_b32 s40, 0, s40
s_cmp_eq_u32 s40, 2
s_cselect_b32 s59, 0xffff0000, s57
v_smfmac_f32_16x16x64_bf16 v[100:103], v[96:99], v[224:231], v15
v_mfma_f32_16x16x32_bf16 v[160:163], v[64:67], v[32:35], v[160:163]
v_mfma_f32_16x16x32_bf16 v[160:163], v[72:75], v[48:51], v[160:163]
v_mfma_f32_16x16x32_bf16 v[164:167], v[72:75], v[52:55], v[164:167]
v_mfma_f32_16x16x32_bf16 v[164:167], v[64:67], v[36:39], v[164:167]
s_setprio 0
s_waitcnt lgkmcnt(14)
v_mfma_f32_16x16x32_bf16 v[180:183], v[68:71], v[36:39], v[180:183]
s_setprio 1
s_waitcnt lgkmcnt(12)
v_mfma_f32_16x16x32_bf16 v[180:183], v[76:79], v[52:55], v[180:183]
s_waitcnt lgkmcnt(0)
s_barrier
s_add_u32 m0, s28, 0
v_mfma_f32_16x16x32_bf16 v[176:179], v[76:79], v[48:51], v[176:179]
buffer_load_dwordx4 v1, s[8:11], s20 offen offset:0 lds
v_mfma_f32_16x16x32_bf16 v[176:179], v[68:71], v[32:35], v[176:179]
v_smfmac_f32_16x16x64_bf16 v[100:103], v[96:99], v[232:239], v15
v_mfma_f32_16x16x32_bf16 v[192:195], v[80:83], v[32:35], v[192:195]
v_mfma_f32_16x16x32_bf16 v[192:195], v[88:91], v[48:51], v[192:195]
v_mfma_f32_16x16x32_bf16 v[196:199], v[88:91], v[52:55], v[196:199]
v_mfma_f32_16x16x32_bf16 v[196:199], v[80:83], v[36:39], v[196:199]
v_mfma_f32_16x16x32_bf16 v[212:215], v[84:87], v[36:39], v[212:215]
buffer_load_dwordx4 v2, s[84:87], s88 offen offset:1024 lds
v_mfma_f32_16x16x32_bf16 v[212:215], v[92:95], v[52:55], v[212:215]
v_mfma_f32_16x16x32_bf16 v[208:211], v[92:95], v[48:51], v[208:211]
v_mfma_f32_16x16x32_bf16 v[208:211], v[84:87], v[32:35], v[208:211]
s_setprio 0
s_waitcnt vmcnt(6)
s_barrier
v_mfma_f32_16x16x32_bf16 v[136:139], v[224:227], v[40:43], v[136:139]
s_setprio 1
ds_read_b128 v[36:39], v9 offset:2048
v_mfma_f32_16x16x32_bf16 v[136:139], v[232:235], v[56:59], v[136:139]
ds_read_b128 v[52:55], v10 offset:2048
v_mfma_f32_16x16x32_bf16 v[140:143], v[232:235], v[60:63], v[140:143]
buffer_load_dwordx4 v3, s[84:87], s88 offen offset:2048 lds
s_add_u32 s20, s20, 393216
s_add_u32 s88, s88, s89
s_mov_b32 m0, s29
ds_read_b128 v[32:35], v9 offset:0
v_mfma_f32_16x16x32_bf16 v[140:143], v[224:227], v[44:47], v[140:143]
buffer_load_dwordx4 v5, s[12:15], s21 offen offset:0 lds
ds_read_b128 v[48:51], v10 offset:0
v_mfma_f32_16x16x32_bf16 v[156:159], v[228:231], v[44:47], v[156:159]
ds_read_b64_tr_b16 v[224:225], v11 offset:32768
v_mfma_f32_16x16x32_bf16 v[156:159], v[236:239], v[60:63], v[156:159]
ds_read_b64_tr_b16 v[226:227], v11 offset:38912
v_mfma_f32_16x16x32_bf16 v[152:155], v[236:239], v[56:59], v[152:155]
ds_read_b64_tr_b16 v[232:233], v11 offset:49152
v_mfma_f32_16x16x32_bf16 v[152:155], v[228:231], v[40:43], v[152:155]
ds_read_b64_tr_b16 v[234:235], v11 offset:55296
v_mfma_f32_16x16x32_bf16 v[168:171], v[64:67], v[40:43], v[168:171]
ds_read_b64_tr_b16 v[228:229], v11 offset:33024
v_mfma_f32_16x16x32_bf16 v[168:171], v[72:75], v[56:59], v[168:171]
buffer_load_dwordx4 v6, s[12:15], s21 offen offset:1024 lds
ds_read_b64_tr_b16 v[230:231], v11 offset:39168
v_mfma_f32_16x16x32_bf16 v[172:175], v[72:75], v[60:63], v[172:175]
ds_read_b64_tr_b16 v[236:237], v11 offset:49408
v_mfma_f32_16x16x32_bf16 v[172:175], v[64:67], v[44:47], v[172:175]
s_setprio 0
ds_read_b64_tr_b16 v[238:239], v11 offset:55552
v_mfma_f32_16x16x32_bf16 v[188:191], v[68:71], v[44:47], v[188:191]
s_setprio 1
ds_read_b64_tr_b16 v[64:65], v12 offset:32768
v_mfma_f32_16x16x32_bf16 v[188:191], v[76:79], v[60:63], v[188:191]
ds_read_b64_tr_b16 v[66:67], v12 offset:38912
v_mfma_f32_16x16x32_bf16 v[184:187], v[76:79], v[56:59], v[184:187]
ds_read_b64_tr_b16 v[72:73], v12 offset:49152
v_mfma_f32_16x16x32_bf16 v[184:187], v[68:71], v[40:43], v[184:187]
buffer_load_dwordx4 v7, s[12:15], s21 offen offset:2048 lds
s_waitcnt lgkmcnt(14)
ds_read_b64_tr_b16 v[74:75], v12 offset:55296
v_mfma_f32_16x16x32_bf16 v[200:203], v[80:83], v[40:43], v[200:203]
s_waitcnt lgkmcnt(14)
ds_read_b64_tr_b16 v[68:69], v12 offset:33024
v_mfma_f32_16x16x32_bf16 v[200:203], v[88:91], v[56:59], v[200:203]
s_waitcnt lgkmcnt(14)
ds_read_b64_tr_b16 v[70:71], v12 offset:39168
v_mfma_f32_16x16x32_bf16 v[204:207], v[88:91], v[60:63], v[204:207]
s_waitcnt lgkmcnt(14)
ds_read_b64_tr_b16 v[76:77], v12 offset:49408
v_mfma_f32_16x16x32_bf16 v[204:207], v[80:83], v[44:47], v[204:207]
s_waitcnt lgkmcnt(14)
ds_read_b64_tr_b16 v[78:79], v12 offset:55552
v_mfma_f32_16x16x32_bf16 v[220:223], v[84:87], v[44:47], v[220:223]
s_waitcnt lgkmcnt(14)
ds_read_b64_tr_b16 v[80:81], v13 offset:32768
v_mfma_f32_16x16x32_bf16 v[220:223], v[92:95], v[60:63], v[220:223]
buffer_load_dwordx4 v8, s[12:15], s21 offen offset:3072 lds
s_add_u32 s21, s21, 128
s_add_u32 s29, s29, 32768
s_cmp_ge_u32 s29, 98304
s_cselect_b32 s26, 98304, 0
s_sub_u32 s29, s29, s26
s_waitcnt lgkmcnt(14)
ds_read_b64_tr_b16 v[82:83], v13 offset:38912
v_mfma_f32_16x16x32_bf16 v[216:219], v[92:95], v[56:59], v[216:219]
s_waitcnt lgkmcnt(14)
ds_read_b64_tr_b16 v[88:89], v13 offset:49152
v_mfma_f32_16x16x32_bf16 v[216:219], v[84:87], v[40:43], v[216:219]
s_setprio 0
s_waitcnt lgkmcnt(14)
ds_read_b64_tr_b16 v[90:91], v13 offset:55296
s_sub_u32 s22, s22, 1
s_cmp_lg_u32 s22, 0
s_cbranch_scc1 L_k1_loop_q3
v_mfma_f32_16x16x32_bf16 v[128:131], v[224:227], v[32:35], v[128:131]
s_setprio 1
s_waitcnt lgkmcnt(14)
ds_read_b64_tr_b16 v[84:85], v13 offset:33024
s_cmp_lg_u32 s25, 0
s_cbranch_scc1 L_k1_ak_q3
s_mov_b64 exec, 0xff
buffer_load_dword v28, v27, s[52:55], 0 offen sc1
s_mov_b64 exec, -1
L_k1_ak_q3:
v_mfma_f32_16x16x32_bf16 v[128:131], v[232:235], v[48:51], v[128:131]
s_waitcnt lgkmcnt(14)
ds_read_b64_tr_b16 v[86:87], v13 offset:39168
v_mfma_f32_16x16x32_bf16 v[132:135], v[232:235], v[52:55], v[132:135]
s_waitcnt lgkmcnt(14)
ds_read_b64_tr_b16 v[92:93], v13 offset:49408
v_mfma_f32_16x16x32_bf16 v[132:135], v[224:227], v[36:39], v[132:135]
s_waitcnt lgkmcnt(14)
ds_read_b64_tr_b16 v[94:95], v13 offset:55552
v_mfma_f32_16x16x32_bf16 v[148:151], v[228:231], v[36:39], v[148:151]
s_waitcnt lgkmcnt(14)
ds_read_b128 v[40:43], v9 offset:4096
v_mfma_f32_16x16x32_bf16 v[148:151], v[236:239], v[52:55], v[148:151]
s_waitcnt lgkmcnt(14)
ds_read_b128 v[56:59], v10 offset:4096
v_mfma_f32_16x16x32_bf16 v[144:147], v[236:239], v[48:51], v[144:147]
s_waitcnt lgkmcnt(14)
ds_read_b128 v[44:47], v9 offset:6144
v_mfma_f32_16x16x32_bf16 v[144:147], v[228:231], v[32:35], v[144:147]
s_waitcnt lgkmcnt(14)
ds_read_b128 v[60:63], v10 offset:6144
v_add_u32 v9, s59, v9
v_add_u32 v10, s59, v10
s_add_u32 s40, s40, 1
s_cmp_eq_u32 s40, 3
s_cselect_b32 s40, 0, s40
s_cmp_eq_u32 s40, 2
s_cselect_b32 s59, 0xffff0000, s57
v_smfmac_f32_16x16x64_bf16 v[100:103], v[96:99], v[224:231], v15
v_mfma_f32_16x16x32_bf16 v[160:163], v[64:67], v[32:35], v[160:163]
v_mfma_f32_16x16x32_bf16 v[160:163], v[72:75], v[48:51], v[160:163]
v_mfma_f32_16x16x32_bf16 v[164:167], v[72:75], v[52:55], v[164:167]
v_mfma_f32_16x16x32_bf16 v[164:167], v[64:67], v[36:39], v[164:167]
s_setprio 0
s_waitcnt lgkmcnt(14)
v_mfma_f32_16x16x32_bf16 v[180:183], v[68:71], v[36:39], v[180:183]
s_setprio 1
s_waitcnt lgkmcnt(12)
v_mfma_f32_16x16x32_bf16 v[180:183], v[76:79], v[52:55], v[180:183]
s_waitcnt lgkmcnt(0)
s_barrier
s_add_u32 m0, s28, 32768
v_mfma_f32_16x16x32_bf16 v[176:179], v[76:79], v[48:51], v[176:179]
buffer_load_dwordx4 v1, s[8:11], s20 offen offset:0 lds
v_mfma_f32_16x16x32_bf16 v[176:179], v[68:71], v[32:35], v[176:179]
v_smfmac_f32_16x16x64_bf16 v[100:103], v[96:99], v[232:239], v15
v_mfma_f32_16x16x32_bf16 v[192:195], v[80:83], v[32:35], v[192:195]
v_mfma_f32_16x16x32_bf16 v[192:195], v[88:91], v[48:51], v[192:195]
v_mfma_f32_16x16x32_bf16 v[196:199], v[88:91], v[52:55], v[196:199]
v_mfma_f32_16x16x32_bf16 v[196:199], v[80:83], v[36:39], v[196:199]
v_mfma_f32_16x16x32_bf16 v[212:215], v[84:87], v[36:39], v[212:215]
buffer_load_dwordx4 v2, s[84:87], s88 offen offset:1024 lds
v_mfma_f32_16x16x32_bf16 v[212:215], v[92:95], v[52:55], v[212:215]
v_mfma_f32_16x16x32_bf16 v[208:211], v[92:95], v[48:51], v[208:211]
v_mfma_f32_16x16x32_bf16 v[208:211], v[84:87], v[32:35], v[208:211]
s_setprio 0
s_waitcnt vmcnt(6)
s_barrier
v_mfma_f32_16x16x32_bf16 v[136:139], v[224:227], v[40:43], v[136:139]
s_setprio 1
ds_read_b128 v[36:39], v9 offset:2048
v_mfma_f32_16x16x32_bf16 v[136:139], v[232:235], v[56:59], v[136:139]
ds_read_b128 v[52:55], v10 offset:2048
v_mfma_f32_16x16x32_bf16 v[140:143], v[232:235], v[60:63], v[140:143]
buffer_load_dwordx4 v3, s[84:87], s88 offen offset:2048 lds
s_add_u32 s20, s20, 393216
s_add_u32 s88, s88, s89
ds_read_b128 v[32:35], v9 offset:0
v_mfma_f32_16x16x32_bf16 v[140:143], v[224:227], v[44:47], v[140:143]
ds_read_b128 v[48:51], v10 offset:0
v_mfma_f32_16x16x32_bf16 v[156:159], v[228:231], v[44:47], v[156:159]
ds_read_b64_tr_b16 v[224:225], v11 offset:0
v_mfma_f32_16x16x32_bf16 v[156:159], v[236:239], v[60:63], v[156:159]
ds_read_b64_tr_b16 v[226:227], v11 offset:6144
v_mfma_f32_16x16x32_bf16 v[152:155], v[236:239], v[56:59], v[152:155]
ds_read_b64_tr_b16 v[232:233], v11 offset:16384
v_mfma_f32_16x16x32_bf16 v[152:155], v[228:231], v[40:43], v[152:155]
ds_read_b64_tr_b16 v[234:235], v11 offset:22528
v_mfma_f32_16x16x32_bf16 v[168:171], v[64:67], v[40:43], v[168:171]
ds_read_b64_tr_b16 v[228:229], v11 offset:256
v_mfma_f32_16x16x32_bf16 v[168:171], v[72:75], v[56:59], v[168:171]
ds_read_b64_tr_b16 v[230:231], v11 offset:6400
v_mfma_f32_16x16x32_bf16 v[172:175], v[72:75], v[60:63], v[172:175]
ds_read_b64_tr_b16 v[236:237], v11 offset:16640
v_mfma_f32_16x16x32_bf16 v[172:175], v[64:67], v[44:47], v[172:175]
s_setprio 0
ds_read_b64_tr_b16 v[238:239], v11 offset:22784
v_mfma_f32_16x16x32_bf16 v[188:191], v[68:71], v[44:47], v[188:191]
s_setprio 1
ds_read_b64_tr_b16 v[64:65], v12 offset:0
v_mfma_f32_16x16x32_bf16 v[188:191], v[76:79], v[60:63], v[188:191]
ds_read_b64_tr_b16 v[66:67], v12 offset:6144
v_mfma_f32_16x16x32_bf16 v[184:187], v[76:79], v[56:59], v[184:187]
ds_read_b64_tr_b16 v[72:73], v12 offset:16384
v_mfma_f32_16x16x32_bf16 v[184:187], v[68:71], v[40:43], v[184:187]
s_waitcnt lgkmcnt(14)
ds_read_b64_tr_b16 v[74:75], v12 offset:22528
v_mfma_f32_16x16x32_bf16 v[200:203], v[80:83], v[40:43], v[200:203]
s_waitcnt lgkmcnt(14)
ds_read_b64_tr_b16 v[68:69], v12 offset:256
v_mfma_f32_16x16x32_bf16 v[200:203], v[88:91], v[56:59], v[200:203]
s_waitcnt lgkmcnt(14)
ds_read_b64_tr_b16 v[70:71], v12 offset:6400
v_mfma_f32_16x16x32_bf16 v[204:207], v[88:91], v[60:63], v[204:207]
s_waitcnt lgkmcnt(14)
ds_read_b64_tr_b16 v[76:77], v12 offset:16640
v_mfma_f32_16x16x32_bf16 v[204:207], v[80:83], v[44:47], v[204:207]
s_waitcnt lgkmcnt(14)
ds_read_b64_tr_b16 v[78:79], v12 offset:22784
v_mfma_f32_16x16x32_bf16 v[220:223], v[84:87], v[44:47], v[220:223]
s_waitcnt lgkmcnt(14)
ds_read_b64_tr_b16 v[80:81], v13 offset:0
v_mfma_f32_16x16x32_bf16 v[220:223], v[92:95], v[60:63], v[220:223]
s_waitcnt lgkmcnt(14)
ds_read_b64_tr_b16 v[82:83], v13 offset:6144
v_mfma_f32_16x16x32_bf16 v[216:219], v[92:95], v[56:59], v[216:219]
s_waitcnt lgkmcnt(14)
ds_read_b64_tr_b16 v[88:89], v13 offset:16384
v_mfma_f32_16x16x32_bf16 v[216:219], v[84:87], v[40:43], v[216:219]
s_setprio 0
s_waitcnt lgkmcnt(14)
ds_read_b64_tr_b16 v[90:91], v13 offset:22528
v_mfma_f32_16x16x32_bf16 v[128:131], v[224:227], v[32:35], v[128:131]
s_setprio 1
s_waitcnt lgkmcnt(14)
ds_read_b64_tr_b16 v[84:85], v13 offset:256
v_and_b32 v2, 31, v0
s_add_u32 s26, s35, s46
s_lshl_b32 s26, s26, 7
s_add_u32 s26, s26, 143360
v_mfma_f32_16x16x32_bf16 v[128:131], v[232:235], v[48:51], v[128:131]
s_waitcnt lgkmcnt(14)
ds_read_b64_tr_b16 v[86:87], v13 offset:6400
v_lshl_add_u32 v2, v2, 2, s26
v_lshrrev_b32 v3, 4, v0
v_mfma_f32_16x16x32_bf16 v[132:135], v[232:235], v[52:55], v[132:135]
s_waitcnt lgkmcnt(14)
ds_read_b64_tr_b16 v[92:93], v13 offset:16640
v_lshlrev_b32 v3, 4, v3
v_lshlrev_b32 v4, 4, v0
v_mfma_f32_16x16x32_bf16 v[132:135], v[224:227], v[36:39], v[132:135]
s_waitcnt lgkmcnt(14)
ds_read_b64_tr_b16 v[94:95], v13 offset:22784
v_mfma_f32_16x16x32_bf16 v[148:151], v[228:231], v[36:39], v[148:151]
s_waitcnt lgkmcnt(14)
ds_read_b128 v[40:43], v9 offset:4096
v_mfma_f32_16x16x32_bf16 v[148:151], v[236:239], v[52:55], v[148:151]
s_waitcnt lgkmcnt(14)
ds_read_b128 v[56:59], v10 offset:4096
v_mfma_f32_16x16x32_bf16 v[144:147], v[236:239], v[48:51], v[144:147]
s_waitcnt lgkmcnt(14)
ds_read_b128 v[44:47], v9 offset:6144
v_mov_b32 v6, 159744
v_mov_b32 v7, 0
v_mfma_f32_16x16x32_bf16 v[144:147], v[228:231], v[32:35], v[144:147]
s_waitcnt lgkmcnt(14)
ds_read_b128 v[60:63], v10 offset:6144
v_add_u32 v9, s59, v9
v_add_u32 v10, s59, v10
s_add_u32 s40, s40, 1
s_cmp_eq_u32 s40, 3
s_cselect_b32 s40, 0, s40
s_cmp_eq_u32 s40, 2
s_cselect_b32 s59, 0xffff0000, s57
v_smfmac_f32_16x16x64_bf16 v[100:103], v[96:99], v[224:231], v15
s_waitcnt lgkmcnt(14)
ds_write_b32 v6, v7
v_mfma_f32_16x16x32_bf16 v[160:163], v[64:67], v[32:35], v[160:163]
v_mfma_f32_16x16x32_bf16 v[160:163], v[72:75], v[48:51], v[160:163]
v_mfma_f32_16x16x32_bf16 v[164:167], v[72:75], v[52:55], v[164:167]
v_mfma_f32_16x16x32_bf16 v[164:167], v[64:67], v[36:39], v[164:167]
s_setprio 0
v_mfma_f32_16x16x32_bf16 v[180:183], v[68:71], v[36:39], v[180:183]
s_setprio 1
s_waitcnt lgkmcnt(13)
v_mfma_f32_16x16x32_bf16 v[180:183], v[76:79], v[52:55], v[180:183]
s_waitcnt lgkmcnt(0)
s_barrier
v_mfma_f32_16x16x32_bf16 v[176:179], v[76:79], v[48:51], v[176:179]
v_mfma_f32_16x16x32_bf16 v[176:179], v[68:71], v[32:35], v[176:179]
v_smfmac_f32_16x16x64_bf16 v[100:103], v[96:99], v[232:239], v15
v_mfma_f32_16x16x32_bf16 v[192:195], v[80:83], v[32:35], v[192:195]
v_mfma_f32_16x16x32_bf16 v[192:195], v[88:91], v[48:51], v[192:195]
v_mfma_f32_16x16x32_bf16 v[196:199], v[88:91], v[52:55], v[196:199]
v_mfma_f32_16x16x32_bf16 v[196:199], v[80:83], v[36:39], v[196:199]
v_mfma_f32_16x16x32_bf16 v[212:215], v[84:87], v[36:39], v[212:215]
v_bfe_u32 v1, v0, 3, 1
v_and_b32 v24, 7, v0
s_lshl_b32 s26, s23, 12
v_mfma_f32_16x16x32_bf16 v[212:215], v[92:95], v[52:55], v[212:215]
v_lshlrev_b32 v1, 7, v1
s_lshl_b32 s27, s42, 10
v_mfma_f32_16x16x32_bf16 v[208:211], v[92:95], v[48:51], v[208:211]
v_lshl_add_u32 v1, v24, 3, v1
s_add_u32 s43, s26, s27
v_mfma_f32_16x16x32_bf16 v[208:211], v[84:87], v[32:35], v[208:211]
s_setprio 0
s_waitcnt vmcnt(0)
s_cmp_lg_u32 s25, 0
s_cbranch_scc1 L_k1_ck_q3
s_mov_b32 s27, 0x40000
L_k1_chl_q3:
v_cmp_le_u32 vcc, 32, v28
s_nop 1
s_and_b32 s26, vcc_lo, 0xff
s_cmp_eq_u32 s26, 0xff
s_cbranch_scc1 L_k1_ck_q3
s_sleep 2
s_mov_b64 exec, 0xff
buffer_load_dword v28, v27, s[52:55], 0 offen sc1
s_mov_b64 exec, -1
s_waitcnt vmcnt(0)
s_sub_u32 s27, s27, 1
s_cmp_lg_u32 s27, 0
s_cbranch_scc1 L_k1_chl_q3
L_k1_ck_q3:
s_barrier
v_mfma_f32_16x16x32_bf16 v[136:139], v[224:227], v[40:43], v[136:139]
s_setprio 1
ds_read_b128 v[36:39], v9 offset:2048
buffer_load_dwordx2 v[16:17], v1, s[92:95], s43 offen offset:0 sc1
v_mfma_f32_16x16x32_bf16 v[136:139], v[232:235], v[56:59], v[136:139]
ds_read_b128 v[52:55], v10 offset:2048
buffer_load_dwordx2 v[18:19], v1, s[92:95], s43 offen offset:256 sc1
v_mfma_f32_16x16x32_bf16 v[140:143], v[232:235], v[60:63], v[140:143]
ds_read_b128 v[32:35], v9 offset:0
buffer_load_dwordx2 v[20:21], v1, s[92:95], s43 offen offset:512 sc1
v_mfma_f32_16x16x32_bf16 v[140:143], v[224:227], v[44:47], v[140:143]
ds_read_b128 v[48:51], v10 offset:0
buffer_load_dwordx2 v[22:23], v1, s[92:95], s43 offen offset:768 sc1
v_mfma_f32_16x16x32_bf16 v[156:159], v[228:231], v[44:47], v[156:159]
ds_read_b64_tr_b16 v[224:225], v11 offset:32768
v_mfma_f32_16x16x32_bf16 v[156:159], v[236:239], v[60:63], v[156:159]
ds_read_b64_tr_b16 v[226:227], v11 offset:38912
v_mfma_f32_16x16x32_bf16 v[152:155], v[236:239], v[56:59], v[152:155]
ds_read_b64_tr_b16 v[232:233], v11 offset:49152
v_mfma_f32_16x16x32_bf16 v[152:155], v[228:231], v[40:43], v[152:155]
ds_read_b64_tr_b16 v[234:235], v11 offset:55296
v_mfma_f32_16x16x32_bf16 v[168:171], v[64:67], v[40:43], v[168:171]
ds_read_b64_tr_b16 v[228:229], v11 offset:33024
v_mfma_f32_16x16x32_bf16 v[168:171], v[72:75], v[56:59], v[168:171]
ds_read_b64_tr_b16 v[230:231], v11 offset:39168
v_mfma_f32_16x16x32_bf16 v[172:175], v[72:75], v[60:63], v[172:175]
ds_read_b64_tr_b16 v[236:237], v11 offset:49408
v_mfma_f32_16x16x32_bf16 v[172:175], v[64:67], v[44:47], v[172:175]
s_setprio 0
ds_read_b64_tr_b16 v[238:239], v11 offset:55552
v_mfma_f32_16x16x32_bf16 v[188:191], v[68:71], v[44:47], v[188:191]
s_setprio 1
ds_read_b64_tr_b16 v[64:65], v12 offset:32768
v_mfma_f32_16x16x32_bf16 v[188:191], v[76:79], v[60:63], v[188:191]
ds_read_b64_tr_b16 v[66:67], v12 offset:38912
v_mfma_f32_16x16x32_bf16 v[184:187], v[76:79], v[56:59], v[184:187]
ds_read_b64_tr_b16 v[72:73], v12 offset:49152
v_mfma_f32_16x16x32_bf16 v[184:187], v[68:71], v[40:43], v[184:187]
s_waitcnt lgkmcnt(14)
ds_read_b64_tr_b16 v[74:75], v12 offset:55296
v_mfma_f32_16x16x32_bf16 v[200:203], v[80:83], v[40:43], v[200:203]
s_waitcnt lgkmcnt(14)
ds_read_b64_tr_b16 v[68:69], v12 offset:33024
v_mfma_f32_16x16x32_bf16 v[200:203], v[88:91], v[56:59], v[200:203]
s_waitcnt lgkmcnt(14)
ds_read_b64_tr_b16 v[70:71], v12 offset:39168
v_mfma_f32_16x16x32_bf16 v[204:207], v[88:91], v[60:63], v[204:207]
s_waitcnt lgkmcnt(14)
ds_read_b64_tr_b16 v[76:77], v12 offset:49408
v_mfma_f32_16x16x32_bf16 v[204:207], v[80:83], v[44:47], v[204:207]
s_waitcnt lgkmcnt(14)
ds_read_b64_tr_b16 v[78:79], v12 offset:55552
v_mfma_f32_16x16x32_bf16 v[220:223], v[84:87], v[44:47], v[220:223]
s_waitcnt lgkmcnt(14)
ds_read_b64_tr_b16 v[80:81], v13 offset:32768
v_mfma_f32_16x16x32_bf16 v[220:223], v[92:95], v[60:63], v[220:223]
s_waitcnt lgkmcnt(14)
ds_read_b64_tr_b16 v[82:83], v13 offset:38912
s_waitcnt lgkmcnt(12)
v_smfmac_f32_16x16x64_bf16 v[100:103], v[96:99], v[224:231], v15
v_mfma_f32_16x16x32_bf16 v[216:219], v[92:95], v[56:59], v[216:219]
ds_read_b64_tr_b16 v[88:89], v13 offset:49152
v_mfma_f32_16x16x32_bf16 v[216:219], v[84:87], v[40:43], v[216:219]
s_setprio 0
ds_read_b64_tr_b16 v[90:91], v13 offset:55296
s_waitcnt lgkmcnt(12)
v_smfmac_f32_16x16x64_bf16 v[100:103], v[96:99], v[232:239], v15
s_setprio 1
v_mfma_f32_16x16x32_bf16 v[128:131], v[224:227], v[32:35], v[128:131]
ds_read_b128 v[40:43], v9 offset:4096
v_mfma_f32_16x16x32_bf16 v[128:131], v[232:235], v[48:51], v[128:131]
ds_read_b128 v[56:59], v10 offset:4096
v_bfe_u32 v5, v0, 4, 1
v_mfma_f32_16x16x32_bf16 v[132:135], v[232:235], v[52:55], v[132:135]
ds_read_b128 v[44:47], v9 offset:6144
v_cmp_eq_u32 vcc, 0, v5
v_mfma_f32_16x16x32_bf16 v[132:135], v[224:227], v[36:39], v[132:135]
s_waitcnt lgkmcnt(14)
ds_read_b128 v[60:63], v10 offset:6144
v_mfma_f32_16x16x32_bf16 v[148:151], v[228:231], v[36:39], v[148:151]
v_add_f32 v100, v100, v101
v_add_f32 v102, v102, v103
v_mfma_f32_16x16x32_bf16 v[148:151], v[236:239], v[52:55], v[148:151]
v_cndmask_b32 v100, v102, v100, vcc
s_waitcnt lgkmcnt(14)
ds_write_b32 v2, v100
v_mfma_f32_16x16x32_bf16 v[144:147], v[236:239], v[48:51], v[144:147]
v_mfma_f32_16x16x32_bf16 v[144:147], v[228:231], v[32:35], v[144:147]
s_waitcnt lgkmcnt(0)
s_barrier
s_add_u32 s26, s46, 0
s_cmp_ge_u32 s26, 3
s_cselect_b32 s27, 3, 0
s_sub_u32 s26, s26, s27
s_lshl_b32 s26, s26, 7
s_add_u32 s26, s26, 143616
v_add_u32 v5, s26, v3
ds_read_b128 v[112:115], v5 offset:0
ds_read_b128 v[116:119], v5 offset:64
v_mfma_f32_16x16x32_bf16 v[152:155], v[228:231], v[40:43], v[152:155]
ds_read_b64_tr_b16 v[84:85], v13 offset:33024
v_mfma_f32_16x16x32_bf16 v[152:155], v[236:239], v[56:59], v[152:155]
ds_read_b64_tr_b16 v[86:87], v13 offset:39168
v_mfma_f32_16x16x32_bf16 v[156:159], v[236:239], v[60:63], v[156:159]
ds_read_b64_tr_b16 v[92:93], v13 offset:49408
v_mfma_f32_16x16x32_bf16 v[156:159], v[228:231], v[44:47], v[156:159]
ds_read_b64_tr_b16 v[94:95], v13 offset:55552
s_waitcnt vmcnt(0)
v_mfma_f32_16x16x32_bf16 v[140:143], v[224:227], v[44:47], v[140:143]
v_mul_f32 v24, s56, v17
v_mfma_f32_16x16x32_bf16 v[140:143], v[232:235], v[60:63], v[140:143]
v_mul_f32 v26, s56, v19
v_mfma_f32_16x16x32_bf16 v[136:139], v[232:235], v[56:59], v[136:139]
v_mul_f32 v28, s56, v21
v_mfma_f32_16x16x32_bf16 v[136:139], v[224:227], v[40:43], v[136:139]
v_mul_f32 v30, s56, v23
v_mfma_f32_16x16x32_bf16 v[160:163], v[64:67], v[32:35], v[160:163]
s_add_u32 s26, s46, 1
s_cmp_ge_u32 s26, 3
s_cselect_b32 s27, 3, 0
s_sub_u32 s26, s26, s27
s_lshl_b32 s26, s26, 7
s_add_u32 s26, s26, 143616
v_add_u32 v5, s26, v3
v_mfma_f32_16x16x32_bf16 v[160:163], v[72:75], v[48:51], v[160:163]
ds_read_b128 v[120:123], v5 offset:0
ds_read_b128 v[124:127], v5 offset:64
s_waitcnt lgkmcnt(7)
v_fmac_f32 v128, v112, v16
v_fmac_f32 v129, v113, v16
v_fmac_f32 v130, v114, v16
v_fmac_f32 v131, v115, v16
v_mfma_f32_16x16x32_bf16 v[164:167], v[72:75], v[52:55], v[164:167]
v_fmac_f32 v132, v112, v18
v_fmac_f32 v133, v113, v18
v_fmac_f32 v134, v114, v18
v_fmac_f32 v135, v115, v18
v_fmac_f32 v136, v112, v20
v_fmac_f32 v137, v113, v20
v_mfma_f32_16x16x32_bf16 v[164:167], v[64:67], v[36:39], v[164:167]
v_fmac_f32 v138, v114, v20
v_fmac_f32 v139, v115, v20
v_fmac_f32 v140, v112, v22
v_fmac_f32 v141, v113, v22
v_fmac_f32 v142, v114, v22
v_fmac_f32 v143, v115, v22
v_mfma_f32_16x16x32_bf16 v[180:183], v[68:71], v[36:39], v[180:183]
v_mul_f32 v128, v128, v24
v_mul_f32 v129, v129, v24
v_mul_f32 v130, v130, v24
v_mul_f32 v131, v131, v24
v_mul_f32 v132, v132, v26
v_mul_f32 v133, v133, v26
v_mfma_f32_16x16x32_bf16 v[180:183], v[76:79], v[52:55], v[180:183]
v_mul_f32 v134, v134, v26
v_mul_f32 v135, v135, v26
v_mul_f32 v136, v136, v28
v_mul_f32 v137, v137, v28
v_mul_f32 v138, v138, v28
v_mul_f32 v139, v139, v28
v_mul_f32 v140, v140, v30
v_mfma_f32_16x16x32_bf16 v[176:179], v[76:79], v[48:51], v[176:179]
v_mul_f32 v141, v141, v30
v_mul_f32 v142, v142, v30
v_mul_f32 v143, v143, v30
s_waitcnt lgkmcnt(6)
v_fmac_f32 v144, v116, v16
v_fmac_f32 v145, v117, v16
v_fmac_f32 v146, v118, v16
v_mfma_f32_16x16x32_bf16 v[176:179], v[68:71], v[32:35], v[176:179]
v_fmac_f32 v147, v119, v16
v_fmac_f32 v148, v116, v18
v_fmac_f32 v149, v117, v18
v_fmac_f32 v150, v118, v18
v_fmac_f32 v151, v119, v18
v_fmac_f32 v152, v116, v20
v_mfma_f32_16x16x32_bf16 v[184:187], v[68:71], v[40:43], v[184:187]
v_fmac_f32 v153, v117, v20
v_fmac_f32 v154, v118, v20
v_fmac_f32 v155, v119, v20
v_fmac_f32 v156, v116, v22
v_fmac_f32 v157, v117, v22
v_fmac_f32 v158, v118, v22
v_mfma_f32_16x16x32_bf16 v[184:187], v[76:79], v[56:59], v[184:187]
v_fmac_f32 v159, v119, v22
v_mul_f32 v144, v144, v24
v_mul_f32 v145, v145, v24
v_mul_f32 v146, v146, v24
v_mul_f32 v147, v147, v24
v_mul_f32 v148, v148, v26
v_mfma_f32_16x16x32_bf16 v[188:191], v[76:79], v[60:63], v[188:191]
v_mul_f32 v149, v149, v26
v_mul_f32 v150, v150, v26
v_mul_f32 v151, v151, v26
v_mul_f32 v152, v152, v28
v_mul_f32 v153, v153, v28
v_mul_f32 v154, v154, v28
v_mul_f32 v155, v155, v28
v_mfma_f32_16x16x32_bf16 v[188:191], v[68:71], v[44:47], v[188:191]
v_mul_f32 v156, v156, v30
v_mul_f32 v157, v157, v30
v_mul_f32 v158, v158, v30
v_mul_f32 v159, v159, v30
s_add_u32 s26, s46, 0
s_cmp_ge_u32 s26, 3
v_mfma_f32_16x16x32_bf16 v[172:175], v[64:67], v[44:47], v[172:175]
s_cselect_b32 s27, 3, 0
s_sub_u32 s26, s26, s27
s_lshl_b32 s26, s26, 17
s_add_u32 s27, s26, s31
v_cvt_pk_bf16_f32 v128, v128, v129
v_cvt_pk_bf16_f32 v129, v130, v131
v_mfma_f32_16x16x32_bf16 v[172:175], v[72:75], v[60:63], v[172:175]
v_cvt_pk_bf16_f32 v130, v144, v145
v_cvt_pk_bf16_f32 v131, v146, v147
buffer_store_dwordx4 v[128:131], v4, s[16:19], s27 offen offset:0 sc0 sc1
v_cvt_pk_bf16_f32 v132, v132, v133
v_cvt_pk_bf16_f32 v133, v134, v135
v_cvt_pk_bf16_f32 v134, v148, v149
v_mfma_f32_16x16x32_bf16 v[168:171], v[72:75], v[56:59], v[168:171]
v_cvt_pk_bf16_f32 v135, v150, v151
buffer_store_dwordx4 v[132:135], v4, s[16:19], s27 offen offset:1024 sc0 sc1
v_cvt_pk_bf16_f32 v136, v136, v137
v_cvt_pk_bf16_f32 v137, v138, v139
v_cvt_pk_bf16_f32 v138, v152, v153
v_cvt_pk_bf16_f32 v139, v154, v155
v_mfma_f32_16x16x32_bf16 v[168:171], v[64:67], v[40:43], v[168:171]
buffer_store_dwordx4 v[136:139], v4, s[16:19], s27 offen offset:2048 sc0 sc1
v_cvt_pk_bf16_f32 v140, v140, v141
v_cvt_pk_bf16_f32 v141, v142, v143
v_cvt_pk_bf16_f32 v142, v156, v157
v_cvt_pk_bf16_f32 v143, v158, v159
buffer_store_dwordx4 v[140:143], v4, s[16:19], s27 offen offset:3072 sc0 sc1
v_mfma_f32_16x16x32_bf16 v[192:195], v[80:83], v[32:35], v[192:195]
s_add_u32 s26, s46, 2
s_cmp_ge_u32 s26, 3
s_cselect_b32 s27, 3, 0
s_sub_u32 s26, s26, s27
s_lshl_b32 s26, s26, 7
s_add_u32 s26, s26, 143616
v_add_u32 v5, s26, v3
v_mfma_f32_16x16x32_bf16 v[192:195], v[88:91], v[48:51], v[192:195]
ds_read_b128 v[112:115], v5 offset:0
ds_read_b128 v[116:119], v5 offset:64
s_waitcnt lgkmcnt(3)
v_fmac_f32 v160, v120, v16
v_fmac_f32 v161, v121, v16
v_fmac_f32 v162, v122, v16
v_fmac_f32 v163, v123, v16
v_mfma_f32_16x16x32_bf16 v[196:199], v[88:91], v[52:55], v[196:199]
v_fmac_f32 v164, v120, v18
v_fmac_f32 v165, v121, v18
v_fmac_f32 v166, v122, v18
v_fmac_f32 v167, v123, v18
v_fmac_f32 v168, v120, v20
v_fmac_f32 v169, v121, v20
v_mfma_f32_16x16x32_bf16 v[196:199], v[80:83], v[36:39], v[196:199]
v_fmac_f32 v170, v122, v20
v_fmac_f32 v171, v123, v20
v_fmac_f32 v172, v120, v22
v_fmac_f32 v173, v121, v22
v_fmac_f32 v174, v122, v22
v_fmac_f32 v175, v123, v22
v_mfma_f32_16x16x32_bf16 v[212:215], v[84:87], v[36:39], v[212:215]
v_mul_f32 v160, v160, v24
v_mul_f32 v161, v161, v24
v_mul_f32 v162, v162, v24
v_mul_f32 v163, v163, v24
v_mul_f32 v164, v164, v26
v_mul_f32 v165, v165, v26
v_mfma_f32_16x16x32_bf16 v[212:215], v[92:95], v[52:55], v[212:215]
v_mul_f32 v166, v166, v26
v_mul_f32 v167, v167, v26
v_mul_f32 v168, v168, v28
v_mul_f32 v169, v169, v28
v_mul_f32 v170, v170, v28
v_mul_f32 v171, v171, v28
v_mul_f32 v172, v172, v30
v_mfma_f32_16x16x32_bf16 v[208:211], v[92:95], v[48:51], v[208:211]
v_mul_f32 v173, v173, v30
v_mul_f32 v174, v174, v30
v_mul_f32 v175, v175, v30
s_waitcnt lgkmcnt(2)
v_fmac_f32 v176, v124, v16
v_fmac_f32 v177, v125, v16
v_fmac_f32 v178, v126, v16
v_mfma_f32_16x16x32_bf16 v[208:211], v[84:87], v[32:35], v[208:211]
v_fmac_f32 v179, v127, v16
v_fmac_f32 v180, v124, v18
v_fmac_f32 v181, v125, v18
v_fmac_f32 v182, v126, v18
v_fmac_f32 v183, v127, v18
v_fmac_f32 v184, v124, v20
v_mfma_f32_16x16x32_bf16 v[216:219], v[84:87], v[40:43], v[216:219]
v_fmac_f32 v185, v125, v20
v_fmac_f32 v186, v126, v20
v_fmac_f32 v187, v127, v20
v_fmac_f32 v188, v124, v22
v_fmac_f32 v189, v125, v22
v_fmac_f32 v190, v126, v22
v_mfma_f32_16x16x32_bf16 v[216:219], v[92:95], v[56:59], v[216:219]
v_fmac_f32 v191, v127, v22
v_mul_f32 v176, v176, v24
v_mul_f32 v177, v177, v24
v_mul_f32 v178, v178, v24
v_mul_f32 v179, v179, v24
v_mul_f32 v180, v180, v26
v_mfma_f32_16x16x32_bf16 v[220:223], v[92:95], v[60:63], v[220:223]
v_mul_f32 v181, v181, v26
v_mul_f32 v182, v182, v26
v_mul_f32 v183, v183, v26
v_mul_f32 v184, v184, v28
v_mul_f32 v185, v185, v28
v_mul_f32 v186, v186, v28
v_mul_f32 v187, v187, v28
v_mfma_f32_16x16x32_bf16 v[220:223], v[84:87], v[44:47], v[220:223]
v_mul_f32 v188, v188, v30
v_mul_f32 v189, v189, v30
v_mul_f32 v190, v190, v30
v_mul_f32 v191, v191, v30
s_add_u32 s26, s46, 1
s_cmp_ge_u32 s26, 3
v_mfma_f32_16x16x32_bf16 v[204:207], v[80:83], v[44:47], v[204:207]
s_cselect_b32 s27, 3, 0
s_sub_u32 s26, s26, s27
s_lshl_b32 s26, s26, 17
s_add_u32 s27, s26, s31
v_cvt_pk_bf16_f32 v160, v160, v161
v_cvt_pk_bf16_f32 v161, v162, v163
v_mfma_f32_16x16x32_bf16 v[204:207], v[88:91], v[60:63], v[204:207]
v_cvt_pk_bf16_f32 v162, v176, v177
v_cvt_pk_bf16_f32 v163, v178, v179
buffer_store_dwordx4 v[160:163], v4, s[16:19], s27 offen offset:0 sc0 sc1
v_cvt_pk_bf16_f32 v164, v164, v165
v_cvt_pk_bf16_f32 v165, v166, v167
v_cvt_pk_bf16_f32 v166, v180, v181
v_mfma_f32_16x16x32_bf16 v[200:203], v[88:91], v[56:59], v[200:203]
v_cvt_pk_bf16_f32 v167, v182, v183
buffer_store_dwordx4 v[164:167], v4, s[16:19], s27 offen offset:1024 sc0 sc1
v_cvt_pk_bf16_f32 v168, v168, v169
v_cvt_pk_bf16_f32 v169, v170, v171
v_cvt_pk_bf16_f32 v170, v184, v185
v_cvt_pk_bf16_f32 v171, v186, v187
v_mfma_f32_16x16x32_bf16 v[200:203], v[80:83], v[40:43], v[200:203]
buffer_store_dwordx4 v[168:171], v4, s[16:19], s27 offen offset:2048 sc0 sc1
v_cvt_pk_bf16_f32 v172, v172, v173
v_cvt_pk_bf16_f32 v173, v174, v175
v_cvt_pk_bf16_f32 v174, v188, v189
v_cvt_pk_bf16_f32 v175, v190, v191
buffer_store_dwordx4 v[172:175], v4, s[16:19], s27 offen offset:3072 sc0 sc1
s_waitcnt lgkmcnt(1)
v_pk_fma_f32 v[192:193], v[112:113], v[16:17], v[192:193] op_sel_hi:[1,0,1]
v_pk_fma_f32 v[194:195], v[114:115], v[16:17], v[194:195] op_sel_hi:[1,0,1]
v_pk_fma_f32 v[196:197], v[112:113], v[18:19], v[196:197] op_sel_hi:[1,0,1]
v_pk_fma_f32 v[198:199], v[114:115], v[18:19], v[198:199] op_sel_hi:[1,0,1]
v_pk_fma_f32 v[200:201], v[112:113], v[20:21], v[200:201] op_sel_hi:[1,0,1]
v_pk_fma_f32 v[202:203], v[114:115], v[20:21], v[202:203] op_sel_hi:[1,0,1]
v_pk_fma_f32 v[204:205], v[112:113], v[22:23], v[204:205] op_sel_hi:[1,0,1]
v_pk_fma_f32 v[206:207], v[114:115], v[22:23], v[206:207] op_sel_hi:[1,0,1]
v_pk_mul_f32 v[192:193], v[192:193], v[24:25] op_sel_hi:[1,0]
v_pk_mul_f32 v[194:195], v[194:195], v[24:25] op_sel_hi:[1,0]
v_pk_mul_f32 v[196:197], v[196:197], v[26:27] op_sel_hi:[1,0]
v_pk_mul_f32 v[198:199], v[198:199], v[26:27] op_sel_hi:[1,0]
v_pk_mul_f32 v[200:201], v[200:201], v[28:29] op_sel_hi:[1,0]
v_pk_mul_f32 v[202:203], v[202:203], v[28:29] op_sel_hi:[1,0]
v_pk_mul_f32 v[204:205], v[204:205], v[30:31] op_sel_hi:[1,0]
v_pk_mul_f32 v[206:207], v[206:207], v[30:31] op_sel_hi:[1,0]
s_waitcnt lgkmcnt(0)
v_pk_fma_f32 v[208:209], v[116:117], v[16:17], v[208:209] op_sel_hi:[1,0,1]
v_pk_fma_f32 v[210:211], v[118:119], v[16:17], v[210:211] op_sel_hi:[1,0,1]
v_pk_fma_f32 v[212:213], v[116:117], v[18:19], v[212:213] op_sel_hi:[1,0,1]
v_pk_fma_f32 v[214:215], v[118:119], v[18:19], v[214:215] op_sel_hi:[1,0,1]
v_pk_fma_f32 v[216:217], v[116:117], v[20:21], v[216:217] op_sel_hi:[1,0,1]
v_pk_fma_f32 v[218:219], v[118:119], v[20:21], v[218:219] op_sel_hi:[1,0,1]
v_pk_fma_f32 v[220:221], v[116:117], v[22:23], v[220:221] op_sel_hi:[1,0,1]
v_pk_fma_f32 v[222:223], v[118:119], v[22:23], v[222:223] op_sel_hi:[1,0,1]
v_pk_mul_f32 v[208:209], v[208:209], v[24:25] op_sel_hi:[1,0]
v_pk_mul_f32 v[210:211], v[210:211], v[24:25] op_sel_hi:[1,0]
v_pk_mul_f32 v[212:213], v[212:213], v[26:27] op_sel_hi:[1,0]
v_pk_mul_f32 v[214:215], v[214:215], v[26:27] op_sel_hi:[1,0]
v_pk_mul_f32 v[216:217], v[216:217], v[28:29] op_sel_hi:[1,0]
v_pk_mul_f32 v[218:219], v[218:219], v[28:29] op_sel_hi:[1,0]
v_pk_mul_f32 v[220:221], v[220:221], v[30:31] op_sel_hi:[1,0]
v_pk_mul_f32 v[222:223], v[222:223], v[30:31] op_sel_hi:[1,0]
s_add_u32 s26, s46, 2
s_cmp_ge_u32 s26, 3
s_cselect_b32 s27, 3, 0
s_sub_u32 s26, s26, s27
s_lshl_b32 s26, s26, 17
s_add_u32 s27, s26, s31
v_cvt_pk_bf16_f32 v192, v192, v193
v_cvt_pk_bf16_f32 v193, v194, v195
v_cvt_pk_bf16_f32 v194, v208, v209
v_cvt_pk_bf16_f32 v195, v210, v211
buffer_store_dwordx4 v[192:195], v4, s[16:19], s27 offen offset:0 sc0 sc1
v_cvt_pk_bf16_f32 v196, v196, v197
v_cvt_pk_bf16_f32 v197, v198, v199
v_cvt_pk_bf16_f32 v198, v212, v213
v_cvt_pk_bf16_f32 v199, v214, v215
buffer_store_dwordx4 v[196:199], v4, s[16:19], s27 offen offset:1024 sc0 sc1
v_cvt_pk_bf16_f32 v200, v200, v201
v_cvt_pk_bf16_f32 v201, v202, v203
v_cvt_pk_bf16_f32 v202, v216, v217
v_cvt_pk_bf16_f32 v203, v218, v219
buffer_store_dwordx4 v[200:203], v4, s[16:19], s27 offen offset:2048 sc0 sc1
v_cvt_pk_bf16_f32 v204, v204, v205
v_cvt_pk_bf16_f32 v205, v206, v207
v_cvt_pk_bf16_f32 v206, v220, v221
v_cvt_pk_bf16_f32 v207, v222, v223
buffer_store_dwordx4 v[204:207], v4, s[16:19], s27 offen offset:3072 sc0 sc1
s_setprio 0
s_bfe_u32 s27, s2, 0x20003
s_lshr_b32 s34, s2, 5
v_lshlrev_b32 v11, 4, v0
s_add_u32 s34, s34, s2
s_and_b32 s34, s34, 7
s_and_b32 s26, s2, 7
s_lshl_b32 s33, s26, 2
s_add_u32 s33, s33, s27
s_lshl_b32 s30, s34, 14
s_lshl_b32 s27, s42, 12
s_add_u32 s30, s30, s27
s_and_b32 s26, s42, 1
s_lshl_b32 s40, s26, 10
s_lshl_b32 s41, s42, 10
s_add_u32 s41, s41, 131072
v_bfe_u32 v12, v0, 4, 1
v_lshlrev_b32 v12, 7, v12
s_cmp_ge_u32 s42, 2
s_cselect_b32 s26, -1, 0
v_and_b32 v12, s26, v12
v_xor_b32 v7, v11, v12
s_lshl_b32 s26, s33, 17
s_add_u32 s27, s26, 0x400000
s_lshr_b32 s35, s42, 1
s_add_u32 s35, s35, 1
s_lshl_b32 s35, s35, 22
s_add_u32 s35, s35, s27
s_add_u32 s12, s4, s27
s_addc_u32 s13, s5, 0
s_mov_b32 s14, 0x20000
s_mov_b32 s15, 0x20000
s_add_u32 s8, s4, s35
s_addc_u32 s9, s5, 0
s_mov_b32 s10, 0x20000
s_mov_b32 s11, 0x20000
v_lshl_add_u32 v12, v0, 5, s33
v_mul_u32_u24 v13, 43, v12
v_lshrrev_b32 v13, 10, v13
v_mul_u32_u24 v14, 24, v13
v_sub_u32 v12, v12, v14
v_or_b32 v14, 1, v12
v_cmp_gt_u32 vcc, 16, v12
v_subrev_u32 v12, 15, v12
v_mul_u32_u24 v12, 11, v12
v_lshrrev_b32 v12, 5, v12
v_lshlrev_b32 v12, 1, v12
v_cndmask_b32 v12, v12, v14, vcc
v_lshl_add_u32 v12, v13, 4, v12
s_and_b32 s26, s34, 3
v_lshl_add_u32 v12, v12, 2, s26
v_lshlrev_b32 v12, 7, v12
s_barrier
v_mov_b32 v13, 159744
v_mov_b32 v14, 1
v_lshlrev_b32 v15, 7, v0
s_mov_b64 exec, 1
s_waitcnt vmcnt(0)
ds_add_rtn_u32 v13, v13, v14
s_waitcnt lgkmcnt(0)
v_readfirstlane_b32 s26, v13
s_mov_b64 exec, 15
s_cmp_lg_u32 s26, 3
s_cbranch_scc1 L_t_pq3
buffer_atomic_add v14, v15, s[48:51], s74 offen sc1
L_t_pq3:
s_mov_b64 exec, -1
s_barrier
s_barrier
s_barrier
s_barrier
s_mov_b64 exec, 7
buffer_load_dword v9, v12, s[48:51], 0 offen sc1
s_mov_b64 exec, -1
s_barrier
s_mov_b64 exec, 7
s_mov_b32 s47, 0x40000
s_waitcnt vmcnt(0)
s_branch L_t_wq3_k
L_t_wq3_l:
s_waitcnt vmcnt(0)
L_t_wq3_k:
v_cmp_le_u32 s[26:27], 8, v9
s_sub_u32 s47, s47, 1
s_nop 0
s_cmp_eq_u32 s26, 7
s_cbranch_scc1 L_t_wq3_g
s_sleep 1
buffer_load_dword v9, v12, s[48:51], 0 offen sc1
s_cmp_lg_u32 s47, 0
s_cbranch_scc1 L_t_wq3_l
L_t_wq3_g:
s_mov_b64 exec, -1
s_add_u32 m0, s41, 0
s_nop 0
buffer_load_dwordx4 v7, s[8:11], s40 offen lds
s_add_u32 s40, s40, 2048
buffer_load_dwordx4 v[240:243], v11, s[12:15], s30 offen offset:0
buffer_load_dwordx4 v[244:247], v11, s[12:15], s30 offen offset:1024
buffer_load_dwordx4 v[248:251], v11, s[12:15], s30 offen offset:2048
buffer_load_dwordx4 v[252:255], v11, s[12:15], s30 offen offset:3072
s_add_u32 m0, s41, 4096
s_nop 0
buffer_load_dwordx4 v7, s[8:11], s40 offen lds
s_add_u32 s40, s40, 2048
s_add_u32 m0, s41, 8192
s_nop 0
buffer_load_dwordx4 v7, s[8:11], s40 offen lds
s_add_u32 s40, s40, 2048
s_add_u32 m0, s41, 12288
s_nop 0
buffer_load_dwordx4 v7, s[8:11], s40 offen lds
s_add_u32 s40, s40, 2048
s_add_u32 m0, s41, 16384
s_nop 0
buffer_load_dwordx4 v7, s[8:11], s40 offen lds
s_add_u32 s40, s40, 2048
s_add_u32 m0, s41, 20480
s_nop 0
buffer_load_dwordx4 v7, s[8:11], s40 offen lds
s_add_u32 s40, s40, 2048
s_add_u32 m0, s41, 24576
s_nop 0
buffer_load_dwordx4 v7, s[8:11], s40 offen lds
s_add_u32 s40, s40, 2048
s_branch L_att
L_k1_q2:
s_lshl_b32 s26, s34, 17
s_add_u32 s31, s31, s26
s_add_u32 s31, s31, 0x400000
s_mov_b32 s35, 2
s_cmp_lt_u32 s34, 32
s_cselect_b32 s56, 0x3e8293ee, 1.0
v_and_b32 v24, 15, v0
v_lshrrev_b32 v25, 4, v0
v_bfe_u32 v26, v0, 1, 3
s_lshl_b32 s26, s42, 13
s_add_u32 s26, s26, 65536
v_lshlrev_b32 v24, 7, v24
v_add_u32 v24, s26, v24
v_xor_b32 v27, v25, v26
v_lshl_add_u32 v9, v27, 4, v24
v_xor_b32 v10, 64, v9
v_lshrrev_b32 v24, 5, v0
v_mul_u32_u24 v24, 3072, v24
v_and_b32 v25, 31, v0
v_lshl_add_u32 v24, v25, 3, v24
s_cmp_ge_u32 s42, 2
s_cselect_b32 s27, 2, 0
s_sub_u32 s46, s42, s27
s_add_u32 s26, s46, 0
s_cmp_ge_u32 s26, 2
s_cselect_b32 s27, 2, 0
s_sub_u32 s26, s26, s27
s_lshl_b32 s26, s26, 9
s_add_u32 s26, s26, 99328
v_add_u32 v11, s26, v24
s_add_u32 s26, s46, 1
s_cmp_ge_u32 s26, 2
s_cselect_b32 s27, 2, 0
s_sub_u32 s26, s26, s27
s_lshl_b32 s26, s26, 9
s_add_u32 s26, s26, 99328
v_add_u32 v12, s26, v24
v_bfe_u32 v24, v0, 1, 1
v_lshrrev_b32 v25, 5, v0
v_cmp_eq_u32 vcc, v24, v25
v_mov_b32 v24, 0x3f803f80
s_nop 0
v_cndmask_b32 v96, 0, v24, vcc
v_mov_b32 v97, v96
v_mov_b32 v98, v96
v_mov_b32 v99, v96
v_and_b32 v24, 1, v0
v_mul_u32_u24 v24, 0xaaaa, v24
v_add_u32 v15, 0x4444, v24
v_mov_b32 v100, 0
v_mov_b32 v101, 0
v_mov_b32 v102, 0
v_mov_b32 v103, 0
s_waitcnt vmcnt(7)
s_mov_b32 m0, s29
s_nop 0
buffer_load_dwordx4 v5, s[12:15], s21 offen offset:0 lds
v_lshlrev_b32 v144, 16, v128
v_and_b32 v145, 0xffff0000, v128
v_lshlrev_b32 v146, 16, v129
v_and_b32 v147, 0xffff0000, v129
v_lshlrev_b32 v148, 16, v130
v_and_b32 v149, 0xffff0000, v130
v_lshlrev_b32 v150, 16, v131
v_and_b32 v151, 0xffff0000, v131
v_lshlrev_b32 v152, 16, v132
buffer_load_dwordx4 v6, s[12:15], s21 offen offset:1024 lds
v_and_b32 v153, 0xffff0000, v132
v_lshlrev_b32 v154, 16, v133
v_and_b32 v155, 0xffff0000, v133
v_lshlrev_b32 v156, 16, v134
v_and_b32 v157, 0xffff0000, v134
v_lshlrev_b32 v158, 16, v135
v_and_b32 v159, 0xffff0000, v135
v_pk_add_f32 v[128:129], v[144:145], v[152:153]
v_pk_add_f32 v[130:131], v[146:147], v[154:155]
v_pk_add_f32 v[132:133], v[148:149], v[156:157]
buffer_load_dwordx4 v7, s[12:15], s21 offen offset:2048 lds
v_pk_add_f32 v[134:135], v[150:151], v[158:159]
v_pk_add_f32 v[128:129], v[128:129], v[130:131]
v_pk_add_f32 v[132:133], v[132:133], v[134:135]
v_pk_add_f32 v[128:129], v[128:129], v[132:133]
v_add_f32 v128, v128, v129
s_nop 1
v_add_f32_dpp v128, v128, v128 quad_perm:[1,0,3,2] row_mask:0xf bank_mask:0xf
s_nop 1
v_add_f32_dpp v128, v128, v128 quad_perm:[2,3,0,1] row_mask:0xf bank_mask:0xf
s_nop 1
v_add_f32_dpp v128, v128, v128 row_half_mirror row_mask:0xf bank_mask:0xf
s_nop 1
v_add_f32_dpp v128, v128, v128 row_mirror row_mask:0xf bank_mask:0xf
v_mov_b32 v129, v128
buffer_load_dwordx4 v8, s[12:15], s21 offen offset:3072 lds
s_add_u32 s21, s21, 128
s_add_u32 s29, s29, 32768
s_cmp_ge_u32 s29, 98304
s_cselect_b32 s26, 98304, 0
s_sub_u32 s29, s29, s26
v_permlane16_swap_b32 v128, v129
v_add_f32 v128, v128, v129
v_mov_b32 v129, v128
s_nop 1
v_permlane32_swap_b32 v128, v129
v_add_f32 v128, v128, v129
v_mul_f32 v16, 0xba800000, v128
v_pk_add_f32 v[144:145], v[144:145], v[16:17] op_sel_hi:[1,0]
v_pk_add_f32 v[146:147], v[146:147], v[16:17] op_sel_hi:[1,0]
v_pk_add_f32 v[148:149], v[148:149], v[16:17] op_sel_hi:[1,0]
v_pk_add_f32 v[150:151], v[150:151], v[16:17] op_sel_hi:[1,0]
s_add_u32 m0, s28, 32768
s_nop 0
buffer_load_dwordx4 v1, s[8:11], s20 offen offset:0 lds
v_pk_add_f32 v[152:153], v[152:153], v[16:17] op_sel_hi:[1,0]
v_pk_add_f32 v[154:155], v[154:155], v[16:17] op_sel_hi:[1,0]
v_pk_add_f32 v[156:157], v[156:157], v[16:17] op_sel_hi:[1,0]
v_pk_add_f32 v[158:159], v[158:159], v[16:17] op_sel_hi:[1,0]
v_pk_mul_f32 v[128:129], v[144:145], v[144:145]
v_pk_mul_f32 v[130:131], v[146:147], v[146:147]
v_pk_mul_f32 v[132:133], v[148:149], v[148:149]
v_pk_mul_f32 v[134:135], v[150:151], v[150:151]
v_pk_fma_f32 v[128:129], v[152:153], v[152:153], v[128:129]
v_pk_fma_f32 v[130:131], v[154:155], v[154:155], v[130:131]
buffer_load_dwordx4 v2, s[84:87], s88 offen offset:1024 lds
v_pk_fma_f32 v[132:133], v[156:157], v[156:157], v[132:133]
v_pk_fma_f32 v[134:135], v[158:159], v[158:159], v[134:135]
v_pk_add_f32 v[128:129], v[128:129], v[130:131]
v_pk_add_f32 v[132:133], v[132:133], v[134:135]
v_pk_add_f32 v[128:129], v[128:129], v[132:133]
v_add_f32 v128, v128, v129
s_nop 1
v_add_f32_dpp v128, v128, v128 quad_perm:[1,0,3,2] row_mask:0xf bank_mask:0xf
s_nop 1
v_add_f32_dpp v128, v128, v128 quad_perm:[2,3,0,1] row_mask:0xf bank_mask:0xf
s_nop 1
v_add_f32_dpp v128, v128, v128 row_half_mirror row_mask:0xf bank_mask:0xf
s_nop 1
v_add_f32_dpp v128, v128, v128 row_mirror row_mask:0xf bank_mask:0xf
buffer_load_dwordx4 v3, s[84:87], s88 offen offset:2048 lds
s_add_u32 s20, s20, 393216
s_add_u32 s88, s88, s89
v_mov_b32 v129, v128
s_nop 1
v_permlane16_swap_b32 v128, v129
v_add_f32 v128, v128, v129
v_mov_b32 v129, v128
s_nop 1
v_permlane32_swap_b32 v128, v129
v_add_f32 v128, v128, v129
v_mov_b32 v129, 0x3727c5ac
v_fmac_f32 v129, 0x3a800000, v128
v_rsq_f32 v17, v129
s_nop 0
buffer_store_dwordx2 v[16:17], v30, s[92:95], 0 offen sc0 sc1
buffer_store_dword v31, v29, s[48:51], 0 offen sc0 sc1
s_waitcnt vmcnt(9)
s_barrier
ds_read_b64_tr_b16 v[64:65], v11 offset:0
ds_read_b64_tr_b16 v[66:67], v11 offset:6144
ds_read_b128 v[32:35], v9 offset:0
ds_read_b64_tr_b16 v[72:73], v11 offset:16384
ds_read_b64_tr_b16 v[74:75], v11 offset:22528
ds_read_b128 v[48:51], v10 offset:0
ds_read_b128 v[52:55], v10 offset:2048
ds_read_b128 v[36:39], v9 offset:2048
ds_read_b64_tr_b16 v[68:69], v11 offset:256
ds_read_b64_tr_b16 v[70:71], v11 offset:6400
ds_read_b64_tr_b16 v[76:77], v11 offset:16640
ds_read_b64_tr_b16 v[78:79], v11 offset:22784
ds_read_b64_tr_b16 v[80:81], v12 offset:0
ds_read_b64_tr_b16 v[82:83], v12 offset:6144
ds_read_b64_tr_b16 v[88:89], v12 offset:16384
s_waitcnt lgkmcnt(14)
ds_read_b64_tr_b16 v[90:91], v12 offset:22528
s_mov_b32 s22, 6
s_mov_b32 m0, s29
s_waitcnt lgkmcnt(13)
v_mfma_f32_16x16x32_bf16 v[128:131], v[64:67], v[32:35], 0
s_setprio 1
buffer_load_dwordx4 v5, s[12:15], s21 offen offset:0 lds
ds_read_b64_tr_b16 v[84:85], v12 offset:256
s_waitcnt lgkmcnt(11)
v_mfma_f32_16x16x32_bf16 v[128:131], v[72:75], v[48:51], v[128:131]
ds_read_b64_tr_b16 v[86:87], v12 offset:6400
s_waitcnt lgkmcnt(11)
v_mfma_f32_16x16x32_bf16 v[132:135], v[72:75], v[52:55], 0
buffer_load_dwordx4 v6, s[12:15], s21 offen offset:1024 lds
ds_read_b64_tr_b16 v[92:93], v12 offset:16640
s_waitcnt lgkmcnt(11)
v_mfma_f32_16x16x32_bf16 v[132:135], v[64:67], v[36:39], v[132:135]
ds_read_b64_tr_b16 v[94:95], v12 offset:22784
s_waitcnt lgkmcnt(10)
v_mfma_f32_16x16x32_bf16 v[148:151], v[68:71], v[36:39], 0
buffer_load_dwordx4 v7, s[12:15], s21 offen offset:2048 lds
ds_read_b128 v[40:43], v9 offset:4096
s_waitcnt lgkmcnt(9)
v_mfma_f32_16x16x32_bf16 v[148:151], v[76:79], v[52:55], v[148:151]
ds_read_b128 v[56:59], v10 offset:4096
v_mfma_f32_16x16x32_bf16 v[144:147], v[76:79], v[48:51], 0
buffer_load_dwordx4 v8, s[12:15], s21 offen offset:3072 lds
s_add_u32 s21, s21, 128
s_add_u32 s29, s29, 32768
s_cmp_ge_u32 s29, 98304
s_cselect_b32 s26, 98304, 0
s_sub_u32 s29, s29, s26
ds_read_b128 v[44:47], v9 offset:6144
v_mfma_f32_16x16x32_bf16 v[144:147], v[68:71], v[32:35], v[144:147]
s_setprio 0
ds_read_b128 v[60:63], v10 offset:6144
v_add_u32 v9, s59, v9
v_add_u32 v10, s59, v10
s_add_u32 s40, s40, 1
s_cmp_eq_u32 s40, 3
s_cselect_b32 s40, 0, s40
s_cmp_eq_u32 s40, 2
s_cselect_b32 s59, 0xffff0000, s57
v_smfmac_f32_16x16x64_bf16 v[100:103], v[96:99], v[64:71], v15
s_waitcnt lgkmcnt(10)
v_mfma_f32_16x16x32_bf16 v[160:163], v[80:83], v[32:35], 0
s_setprio 1
s_waitcnt lgkmcnt(8)
v_mfma_f32_16x16x32_bf16 v[160:163], v[88:91], v[48:51], v[160:163]
s_waitcnt lgkmcnt(0)
s_barrier
s_add_u32 m0, s28, 0
v_mfma_f32_16x16x32_bf16 v[164:167], v[88:91], v[52:55], 0
buffer_load_dwordx4 v1, s[8:11], s20 offen offset:0 lds
v_mfma_f32_16x16x32_bf16 v[164:167], v[80:83], v[36:39], v[164:167]
v_mfma_f32_16x16x32_bf16 v[180:183], v[84:87], v[36:39], 0
v_mfma_f32_16x16x32_bf16 v[180:183], v[92:95], v[52:55], v[180:183]
v_mfma_f32_16x16x32_bf16 v[176:179], v[92:95], v[48:51], 0
buffer_load_dwordx4 v2, s[84:87], s88 offen offset:1024 lds
v_mfma_f32_16x16x32_bf16 v[176:179], v[84:87], v[32:35], v[176:179]
s_setprio 0
v_smfmac_f32_16x16x64_bf16 v[100:103], v[96:99], v[72:79], v15
s_waitcnt vmcnt(6)
s_barrier
v_mfma_f32_16x16x32_bf16 v[136:139], v[64:67], v[40:43], 0
s_setprio 1
ds_read_b128 v[36:39], v9 offset:2048
s_cmp_lg_u32 s25, 0
s_cbranch_scc1 L_k1_np_q2
v_mov_b32 v28, 1
v_mov_b32 v29, 0
s_mov_b64 exec, 1
buffer_atomic_add v28, v29, s[52:55], s47 offen sc1
s_mov_b64 exec, -1
v_lshlrev_b32 v27, 5, v0
L_k1_np_q2:
v_mfma_f32_16x16x32_bf16 v[136:139], v[72:75], v[56:59], v[136:139]
ds_read_b128 v[52:55], v10 offset:2048
v_mfma_f32_16x16x32_bf16 v[140:143], v[72:75], v[60:63], 0
buffer_load_dwordx4 v3, s[84:87], s88 offen offset:2048 lds
s_add_u32 s20, s20, 393216
s_add_u32 s88, s88, s89
s_mov_b32 m0, s29
ds_read_b128 v[32:35], v9 offset:0
v_mfma_f32_16x16x32_bf16 v[140:143], v[64:67], v[44:47], v[140:143]
buffer_load_dwordx4 v5, s[12:15], s21 offen offset:0 lds
ds_read_b128 v[48:51], v10 offset:0
v_mfma_f32_16x16x32_bf16 v[156:159], v[68:71], v[44:47], 0
ds_read_b64_tr_b16 v[64:65], v11 offset:32768
v_mfma_f32_16x16x32_bf16 v[156:159], v[76:79], v[60:63], v[156:159]
ds_read_b64_tr_b16 v[66:67], v11 offset:38912
v_mfma_f32_16x16x32_bf16 v[152:155], v[76:79], v[56:59], 0
ds_read_b64_tr_b16 v[72:73], v11 offset:49152
v_mfma_f32_16x16x32_bf16 v[152:155], v[68:71], v[40:43], v[152:155]
s_setprio 0
buffer_load_dwordx4 v6, s[12:15], s21 offen offset:1024 lds
ds_read_b64_tr_b16 v[74:75], v11 offset:55296
v_mfma_f32_16x16x32_bf16 v[168:171], v[80:83], v[40:43], 0
s_setprio 1
ds_read_b64_tr_b16 v[68:69], v11 offset:33024
v_mfma_f32_16x16x32_bf16 v[168:171], v[88:91], v[56:59], v[168:171]
ds_read_b64_tr_b16 v[70:71], v11 offset:39168
v_mfma_f32_16x16x32_bf16 v[172:175], v[88:91], v[60:63], 0
ds_read_b64_tr_b16 v[76:77], v11 offset:49408
v_mfma_f32_16x16x32_bf16 v[172:175], v[80:83], v[44:47], v[172:175]
buffer_load_dwordx4 v7, s[12:15], s21 offen offset:2048 lds
ds_read_b64_tr_b16 v[78:79], v11 offset:55552
v_mfma_f32_16x16x32_bf16 v[188:191], v[84:87], v[44:47], 0
ds_read_b64_tr_b16 v[80:81], v12 offset:32768
v_mfma_f32_16x16x32_bf16 v[188:191], v[92:95], v[60:63], v[188:191]
ds_read_b64_tr_b16 v[82:83], v12 offset:38912
v_mfma_f32_16x16x32_bf16 v[184:187], v[92:95], v[56:59], 0
ds_read_b64_tr_b16 v[88:89], v12 offset:49152
v_mfma_f32_16x16x32_bf16 v[184:187], v[84:87], v[40:43], v[184:187]
s_setprio 0
buffer_load_dwordx4 v8, s[12:15], s21 offen offset:3072 lds
s_add_u32 s21, s21, 128
s_add_u32 s29, s29, 32768
s_cmp_ge_u32 s29, 98304
s_cselect_b32 s26, 98304, 0
s_sub_u32 s29, s29, s26
s_waitcnt lgkmcnt(14)
ds_read_b64_tr_b16 v[90:91], v12 offset:55296
L_k1_loop_q2:
s_waitcnt lgkmcnt(10)
v_mfma_f32_16x16x32_bf16 v[128:131], v[64:67], v[32:35], v[128:131]
s_setprio 1
ds_read_b64_tr_b16 v[84:85], v12 offset:33024
s_waitcnt lgkmcnt(9)
v_mfma_f32_16x16x32_bf16 v[128:131], v[72:75], v[48:51], v[128:131]
ds_read_b64_tr_b16 v[86:87], v12 offset:39168
v_mfma_f32_16x16x32_bf16 v[132:135], v[72:75], v[52:55], v[132:135]
ds_read_b64_tr_b16 v[92:93], v12 offset:49408
v_mfma_f32_16x16x32_bf16 v[132:135], v[64:67], v[36:39], v[132:135]
ds_read_b64_tr_b16 v[94:95], v12 offset:55552
s_waitcnt lgkmcnt(10)
v_mfma_f32_16x16x32_bf16 v[148:151], v[68:71], v[36:39], v[148:151]
ds_read_b128 v[40:43], v9 offset:4096
s_waitcnt lgkmcnt(9)
v_mfma_f32_16x16x32_bf16 v[148:151], v[76:79], v[52:55], v[148:151]
ds_read_b128 v[56:59], v10 offset:4096
v_mfma_f32_16x16x32_bf16 v[144:147], v[76:79], v[48:51], v[144:147]
ds_read_b128 v[44:47], v9 offset:6144
v_mfma_f32_16x16x32_bf16 v[144:147], v[68:71], v[32:35], v[144:147]
s_setprio 0
ds_read_b128 v[60:63], v10 offset:6144
v_add_u32 v9, s59, v9
v_add_u32 v10, s59, v10
s_add_u32 s40, s40, 1
s_cmp_eq_u32 s40, 3
s_cselect_b32 s40, 0, s40
s_cmp_eq_u32 s40, 2
s_cselect_b32 s59, 0xffff0000, s57
v_smfmac_f32_16x16x64_bf16 v[100:103], v[96:99], v[64:71], v15
s_waitcnt lgkmcnt(10)
v_mfma_f32_16x16x32_bf16 v[160:163], v[80:83], v[32:35], v[160:163]
s_setprio 1
s_waitcnt lgkmcnt(8)
v_mfma_f32_16x16x32_bf16 v[160:163], v[88:91], v[48:51], v[160:163]
s_waitcnt lgkmcnt(0)
s_barrier
s_add_u32 m0, s28, 32768
v_mfma_f32_16x16x32_bf16 v[164:167], v[88:91], v[52:55], v[164:167]
buffer_load_dwordx4 v1, s[8:11], s20 offen offset:0 lds
v_mfma_f32_16x16x32_bf16 v[164:167], v[80:83], v[36:39], v[164:167]
v_mfma_f32_16x16x32_bf16 v[180:183], v[84:87], v[36:39], v[180:183]
v_mfma_f32_16x16x32_bf16 v[180:183], v[92:95], v[52:55], v[180:183]
v_mfma_f32_16x16x32_bf16 v[176:179], v[92:95], v[48:51], v[176:179]
buffer_load_dwordx4 v2, s[84:87], s88 offen offset:1024 lds
v_mfma_f32_16x16x32_bf16 v[176:179], v[84:87], v[32:35], v[176:179]
s_setprio 0
v_smfmac_f32_16x16x64_bf16 v[100:103], v[96:99], v[72:79], v15
s_waitcnt vmcnt(6)
s_barrier
v_mfma_f32_16x16x32_bf16 v[136:139], v[64:67], v[40:43], v[136:139]
s_setprio 1
ds_read_b128 v[36:39], v9 offset:2048
v_mfma_f32_16x16x32_bf16 v[136:139], v[72:75], v[56:59], v[136:139]
ds_read_b128 v[52:55], v10 offset:2048
v_mfma_f32_16x16x32_bf16 v[140:143], v[72:75], v[60:63], v[140:143]
buffer_load_dwordx4 v3, s[84:87], s88 offen offset:2048 lds
s_add_u32 s20, s20, 393216
s_add_u32 s88, s88, s89
s_mov_b32 m0, s29
ds_read_b128 v[32:35], v9 offset:0
v_mfma_f32_16x16x32_bf16 v[140:143], v[64:67], v[44:47], v[140:143]
buffer_load_dwordx4 v5, s[12:15], s21 offen offset:0 lds
ds_read_b128 v[48:51], v10 offset:0
v_mfma_f32_16x16x32_bf16 v[156:159], v[68:71], v[44:47], v[156:159]
ds_read_b64_tr_b16 v[64:65], v11 offset:0
v_mfma_f32_16x16x32_bf16 v[156:159], v[76:79], v[60:63], v[156:159]
ds_read_b64_tr_b16 v[66:67], v11 offset:6144
v_mfma_f32_16x16x32_bf16 v[152:155], v[76:79], v[56:59], v[152:155]
ds_read_b64_tr_b16 v[72:73], v11 offset:16384
v_mfma_f32_16x16x32_bf16 v[152:155], v[68:71], v[40:43], v[152:155]
s_setprio 0
buffer_load_dwordx4 v6, s[12:15], s21 offen offset:1024 lds
ds_read_b64_tr_b16 v[74:75], v11 offset:22528
v_mfma_f32_16x16x32_bf16 v[168:171], v[80:83], v[40:43], v[168:171]
s_setprio 1
ds_read_b64_tr_b16 v[68:69], v11 offset:256
v_mfma_f32_16x16x32_bf16 v[168:171], v[88:91], v[56:59], v[168:171]
ds_read_b64_tr_b16 v[70:71], v11 offset:6400
v_mfma_f32_16x16x32_bf16 v[172:175], v[88:91], v[60:63], v[172:175]
ds_read_b64_tr_b16 v[76:77], v11 offset:16640
v_mfma_f32_16x16x32_bf16 v[172:175], v[80:83], v[44:47], v[172:175]
buffer_load_dwordx4 v7, s[12:15], s21 offen offset:2048 lds
ds_read_b64_tr_b16 v[78:79], v11 offset:22784
v_mfma_f32_16x16x32_bf16 v[188:191], v[84:87], v[44:47], v[188:191]
ds_read_b64_tr_b16 v[80:81], v12 offset:0
v_mfma_f32_16x16x32_bf16 v[188:191], v[92:95], v[60:63], v[188:191]
ds_read_b64_tr_b16 v[82:83], v12 offset:6144
v_mfma_f32_16x16x32_bf16 v[184:187], v[92:95], v[56:59], v[184:187]
ds_read_b64_tr_b16 v[88:89], v12 offset:16384
v_mfma_f32_16x16x32_bf16 v[184:187], v[84:87], v[40:43], v[184:187]
s_setprio 0
buffer_load_dwordx4 v8, s[12:15], s21 offen offset:3072 lds
s_add_u32 s21, s21, 128
s_add_u32 s29, s29, 32768
s_cmp_ge_u32 s29, 98304
s_cselect_b32 s26, 98304, 0
s_sub_u32 s29, s29, s26
s_waitcnt lgkmcnt(14)
ds_read_b64_tr_b16 v[90:91], v12 offset:22528
s_waitcnt lgkmcnt(10)
v_mfma_f32_16x16x32_bf16 v[128:131], v[64:67], v[32:35], v[128:131]
s_setprio 1
ds_read_b64_tr_b16 v[84:85], v12 offset:256
s_waitcnt lgkmcnt(9)
v_mfma_f32_16x16x32_bf16 v[128:131], v[72:75], v[48:51], v[128:131]
ds_read_b64_tr_b16 v[86:87], v12 offset:6400
v_mfma_f32_16x16x32_bf16 v[132:135], v[72:75], v[52:55], v[132:135]
ds_read_b64_tr_b16 v[92:93], v12 offset:16640
v_mfma_f32_16x16x32_bf16 v[132:135], v[64:67], v[36:39], v[132:135]
ds_read_b64_tr_b16 v[94:95], v12 offset:22784
s_waitcnt lgkmcnt(10)
v_mfma_f32_16x16x32_bf16 v[148:151], v[68:71], v[36:39], v[148:151]
ds_read_b128 v[40:43], v9 offset:4096
s_waitcnt lgkmcnt(9)
v_mfma_f32_16x16x32_bf16 v[148:151], v[76:79], v[52:55], v[148:151]
ds_read_b128 v[56:59], v10 offset:4096
v_mfma_f32_16x16x32_bf16 v[144:147], v[76:79], v[48:51], v[144:147]
ds_read_b128 v[44:47], v9 offset:6144
v_mfma_f32_16x16x32_bf16 v[144:147], v[68:71], v[32:35], v[144:147]
s_setprio 0
ds_read_b128 v[60:63], v10 offset:6144
v_add_u32 v9, s59, v9
v_add_u32 v10, s59, v10
s_add_u32 s40, s40, 1
s_cmp_eq_u32 s40, 3
s_cselect_b32 s40, 0, s40
s_cmp_eq_u32 s40, 2
s_cselect_b32 s59, 0xffff0000, s57
v_smfmac_f32_16x16x64_bf16 v[100:103], v[96:99], v[64:71], v15
s_waitcnt lgkmcnt(10)
v_mfma_f32_16x16x32_bf16 v[160:163], v[80:83], v[32:35], v[160:163]
s_setprio 1
s_waitcnt lgkmcnt(8)
v_mfma_f32_16x16x32_bf16 v[160:163], v[88:91], v[48:51], v[160:163]
s_waitcnt lgkmcnt(0)
s_barrier
s_add_u32 m0, s28, 0
v_mfma_f32_16x16x32_bf16 v[164:167], v[88:91], v[52:55], v[164:167]
buffer_load_dwordx4 v1, s[8:11], s20 offen offset:0 lds
v_mfma_f32_16x16x32_bf16 v[164:167], v[80:83], v[36:39], v[164:167]
v_mfma_f32_16x16x32_bf16 v[180:183], v[84:87], v[36:39], v[180:183]
v_mfma_f32_16x16x32_bf16 v[180:183], v[92:95], v[52:55], v[180:183]
v_mfma_f32_16x16x32_bf16 v[176:179], v[92:95], v[48:51], v[176:179]
buffer_load_dwordx4 v2, s[84:87], s88 offen offset:1024 lds
v_mfma_f32_16x16x32_bf16 v[176:179], v[84:87], v[32:35], v[176:179]
s_setprio 0
v_smfmac_f32_16x16x64_bf16 v[100:103], v[96:99], v[72:79], v15
s_waitcnt vmcnt(6)
s_barrier
v_mfma_f32_16x16x32_bf16 v[136:139], v[64:67], v[40:43], v[136:139]
s_setprio 1
ds_read_b128 v[36:39], v9 offset:2048
v_mfma_f32_16x16x32_bf16 v[136:139], v[72:75], v[56:59], v[136:139]
ds_read_b128 v[52:55], v10 offset:2048
v_mfma_f32_16x16x32_bf16 v[140:143], v[72:75], v[60:63], v[140:143]
buffer_load_dwordx4 v3, s[84:87], s88 offen offset:2048 lds
s_add_u32 s20, s20, 393216
s_add_u32 s88, s88, s89
s_mov_b32 m0, s29
ds_read_b128 v[32:35], v9 offset:0
v_mfma_f32_16x16x32_bf16 v[140:143], v[64:67], v[44:47], v[140:143]
buffer_load_dwordx4 v5, s[12:15], s21 offen offset:0 lds
ds_read_b128 v[48:51], v10 offset:0
v_mfma_f32_16x16x32_bf16 v[156:159], v[68:71], v[44:47], v[156:159]
ds_read_b64_tr_b16 v[64:65], v11 offset:32768
v_mfma_f32_16x16x32_bf16 v[156:159], v[76:79], v[60:63], v[156:159]
ds_read_b64_tr_b16 v[66:67], v11 offset:38912
v_mfma_f32_16x16x32_bf16 v[152:155], v[76:79], v[56:59], v[152:155]
ds_read_b64_tr_b16 v[72:73], v11 offset:49152
v_mfma_f32_16x16x32_bf16 v[152:155], v[68:71], v[40:43], v[152:155]
s_setprio 0
buffer_load_dwordx4 v6, s[12:15], s21 offen offset:1024 lds
ds_read_b64_tr_b16 v[74:75], v11 offset:55296
v_mfma_f32_16x16x32_bf16 v[168:171], v[80:83], v[40:43], v[168:171]
s_setprio 1
ds_read_b64_tr_b16 v[68:69], v11 offset:33024
v_mfma_f32_16x16x32_bf16 v[168:171], v[88:91], v[56:59], v[168:171]
ds_read_b64_tr_b16 v[70:71], v11 offset:39168
v_mfma_f32_16x16x32_bf16 v[172:175], v[88:91], v[60:63], v[172:175]
ds_read_b64_tr_b16 v[76:77], v11 offset:49408
v_mfma_f32_16x16x32_bf16 v[172:175], v[80:83], v[44:47], v[172:175]
buffer_load_dwordx4 v7, s[12:15], s21 offen offset:2048 lds
ds_read_b64_tr_b16 v[78:79], v11 offset:55552
v_mfma_f32_16x16x32_bf16 v[188:191], v[84:87], v[44:47], v[188:191]
ds_read_b64_tr_b16 v[80:81], v12 offset:32768
v_mfma_f32_16x16x32_bf16 v[188:191], v[92:95], v[60:63], v[188:191]
ds_read_b64_tr_b16 v[82:83], v12 offset:38912
v_mfma_f32_16x16x32_bf16 v[184:187], v[92:95], v[56:59], v[184:187]
ds_read_b64_tr_b16 v[88:89], v12 offset:49152
v_mfma_f32_16x16x32_bf16 v[184:187], v[84:87], v[40:43], v[184:187]
s_setprio 0
buffer_load_dwordx4 v8, s[12:15], s21 offen offset:3072 lds
s_add_u32 s21, s21, 128
s_add_u32 s29, s29, 32768
s_cmp_ge_u32 s29, 98304
s_cselect_b32 s26, 98304, 0
s_sub_u32 s29, s29, s26
s_waitcnt lgkmcnt(14)
ds_read_b64_tr_b16 v[90:91], v12 offset:55296
s_sub_u32 s22, s22, 1
s_cmp_lg_u32 s22, 0
s_cbranch_scc1 L_k1_loop_q2
s_waitcnt lgkmcnt(10)
v_mfma_f32_16x16x32_bf16 v[128:131], v[64:67], v[32:35], v[128:131]
s_setprio 1
ds_read_b64_tr_b16 v[84:85], v12 offset:33024
s_cmp_lg_u32 s25, 0
s_cbranch_scc1 L_k1_ak_q2
s_mov_b64 exec, 0xff
buffer_load_dword v28, v27, s[52:55], 0 offen sc1
s_mov_b64 exec, -1
L_k1_ak_q2:
s_waitcnt lgkmcnt(9)
v_mfma_f32_16x16x32_bf16 v[128:131], v[72:75], v[48:51], v[128:131]
ds_read_b64_tr_b16 v[86:87], v12 offset:39168
v_mfma_f32_16x16x32_bf16 v[132:135], v[72:75], v[52:55], v[132:135]
ds_read_b64_tr_b16 v[92:93], v12 offset:49408
v_mfma_f32_16x16x32_bf16 v[132:135], v[64:67], v[36:39], v[132:135]
ds_read_b64_tr_b16 v[94:95], v12 offset:55552
s_waitcnt lgkmcnt(10)
v_mfma_f32_16x16x32_bf16 v[148:151], v[68:71], v[36:39], v[148:151]
ds_read_b128 v[40:43], v9 offset:4096
s_waitcnt lgkmcnt(9)
v_mfma_f32_16x16x32_bf16 v[148:151], v[76:79], v[52:55], v[148:151]
ds_read_b128 v[56:59], v10 offset:4096
v_mfma_f32_16x16x32_bf16 v[144:147], v[76:79], v[48:51], v[144:147]
ds_read_b128 v[44:47], v9 offset:6144
v_mfma_f32_16x16x32_bf16 v[144:147], v[68:71], v[32:35], v[144:147]
s_setprio 0
ds_read_b128 v[60:63], v10 offset:6144
v_add_u32 v9, s59, v9
v_add_u32 v10, s59, v10
s_add_u32 s40, s40, 1
s_cmp_eq_u32 s40, 3
s_cselect_b32 s40, 0, s40
s_cmp_eq_u32 s40, 2
s_cselect_b32 s59, 0xffff0000, s57
v_smfmac_f32_16x16x64_bf16 v[100:103], v[96:99], v[64:71], v15
s_waitcnt lgkmcnt(10)
v_mfma_f32_16x16x32_bf16 v[160:163], v[80:83], v[32:35], v[160:163]
s_setprio 1
s_waitcnt lgkmcnt(8)
v_mfma_f32_16x16x32_bf16 v[160:163], v[88:91], v[48:51], v[160:163]
s_waitcnt lgkmcnt(0)
s_barrier
s_add_u32 m0, s28, 32768
v_mfma_f32_16x16x32_bf16 v[164:167], v[88:91], v[52:55], v[164:167]
buffer_load_dwordx4 v1, s[8:11], s20 offen offset:0 lds
v_mfma_f32_16x16x32_bf16 v[164:167], v[80:83], v[36:39], v[164:167]
v_mfma_f32_16x16x32_bf16 v[180:183], v[84:87], v[36:39], v[180:183]
v_mfma_f32_16x16x32_bf16 v[180:183], v[92:95], v[52:55], v[180:183]
v_mfma_f32_16x16x32_bf16 v[176:179], v[92:95], v[48:51], v[176:179]
buffer_load_dwordx4 v2, s[84:87], s88 offen offset:1024 lds
v_mfma_f32_16x16x32_bf16 v[176:179], v[84:87], v[32:35], v[176:179]
s_setprio 0
v_smfmac_f32_16x16x64_bf16 v[100:103], v[96:99], v[72:79], v15
s_waitcnt vmcnt(6)
s_barrier
v_mfma_f32_16x16x32_bf16 v[136:139], v[64:67], v[40:43], v[136:139]
s_setprio 1
ds_read_b128 v[36:39], v9 offset:2048
v_mfma_f32_16x16x32_bf16 v[136:139], v[72:75], v[56:59], v[136:139]
ds_read_b128 v[52:55], v10 offset:2048
v_mfma_f32_16x16x32_bf16 v[140:143], v[72:75], v[60:63], v[140:143]
buffer_load_dwordx4 v3, s[84:87], s88 offen offset:2048 lds
s_add_u32 s20, s20, 393216
s_add_u32 s88, s88, s89
ds_read_b128 v[32:35], v9 offset:0
v_mfma_f32_16x16x32_bf16 v[140:143], v[64:67], v[44:47], v[140:143]
ds_read_b128 v[48:51], v10 offset:0
v_mfma_f32_16x16x32_bf16 v[156:159], v[68:71], v[44:47], v[156:159]
ds_read_b64_tr_b16 v[64:65], v11 offset:0
v_mfma_f32_16x16x32_bf16 v[156:159], v[76:79], v[60:63], v[156:159]
ds_read_b64_tr_b16 v[66:67], v11 offset:6144
v_mfma_f32_16x16x32_bf16 v[152:155], v[76:79], v[56:59], v[152:155]
ds_read_b64_tr_b16 v[72:73], v11 offset:16384
v_mfma_f32_16x16x32_bf16 v[152:155], v[68:71], v[40:43], v[152:155]
s_setprio 0
ds_read_b64_tr_b16 v[74:75], v11 offset:22528
v_mfma_f32_16x16x32_bf16 v[168:171], v[80:83], v[40:43], v[168:171]
s_setprio 1
ds_read_b64_tr_b16 v[68:69], v11 offset:256
v_mfma_f32_16x16x32_bf16 v[168:171], v[88:91], v[56:59], v[168:171]
ds_read_b64_tr_b16 v[70:71], v11 offset:6400
v_mfma_f32_16x16x32_bf16 v[172:175], v[88:91], v[60:63], v[172:175]
ds_read_b64_tr_b16 v[76:77], v11 offset:16640
v_mfma_f32_16x16x32_bf16 v[172:175], v[80:83], v[44:47], v[172:175]
ds_read_b64_tr_b16 v[78:79], v11 offset:22784
v_mfma_f32_16x16x32_bf16 v[188:191], v[84:87], v[44:47], v[188:191]
ds_read_b64_tr_b16 v[80:81], v12 offset:0
v_mfma_f32_16x16x32_bf16 v[188:191], v[92:95], v[60:63], v[188:191]
ds_read_b64_tr_b16 v[82:83], v12 offset:6144
v_mfma_f32_16x16x32_bf16 v[184:187], v[92:95], v[56:59], v[184:187]
ds_read_b64_tr_b16 v[88:89], v12 offset:16384
v_mfma_f32_16x16x32_bf16 v[184:187], v[84:87], v[40:43], v[184:187]
s_setprio 0
s_waitcnt lgkmcnt(14)
ds_read_b64_tr_b16 v[90:91], v12 offset:22528
s_waitcnt lgkmcnt(10)
v_mfma_f32_16x16x32_bf16 v[128:131], v[64:67], v[32:35], v[128:131]
s_setprio 1
ds_read_b64_tr_b16 v[84:85], v12 offset:256
v_and_b32 v2, 31, v0
s_add_u32 s26, s35, s46
s_lshl_b32 s26, s26, 7
s_add_u32 s26, s26, 143360
s_waitcnt lgkmcnt(9)
v_mfma_f32_16x16x32_bf16 v[128:131], v[72:75], v[48:51], v[128:131]
ds_read_b64_tr_b16 v[86:87], v12 offset:6400
v_lshl_add_u32 v2, v2, 2, s26
v_lshrrev_b32 v3, 4, v0
v_mfma_f32_16x16x32_bf16 v[132:135], v[72:75], v[52:55], v[132:135]
ds_read_b64_tr_b16 v[92:93], v12 offset:16640
v_lshlrev_b32 v3, 4, v3
v_lshlrev_b32 v4, 4, v0
v_mfma_f32_16x16x32_bf16 v[132:135], v[64:67], v[36:39], v[132:135]
ds_read_b64_tr_b16 v[94:95], v12 offset:22784
s_waitcnt lgkmcnt(10)
v_mfma_f32_16x16x32_bf16 v[148:151], v[68:71], v[36:39], v[148:151]
ds_read_b128 v[40:43], v9 offset:4096
s_waitcnt lgkmcnt(9)
v_mfma_f32_16x16x32_bf16 v[148:151], v[76:79], v[52:55], v[148:151]
ds_read_b128 v[56:59], v10 offset:4096
v_mfma_f32_16x16x32_bf16 v[144:147], v[76:79], v[48:51], v[144:147]
ds_read_b128 v[44:47], v9 offset:6144
v_mov_b32 v6, 159744
v_mov_b32 v7, 0
v_mfma_f32_16x16x32_bf16 v[144:147], v[68:71], v[32:35], v[144:147]
s_setprio 0
ds_read_b128 v[60:63], v10 offset:6144
v_add_u32 v9, s59, v9
v_add_u32 v10, s59, v10
s_add_u32 s40, s40, 1
s_cmp_eq_u32 s40, 3
s_cselect_b32 s40, 0, s40
s_cmp_eq_u32 s40, 2
s_cselect_b32 s59, 0xffff0000, s57
v_smfmac_f32_16x16x64_bf16 v[100:103], v[96:99], v[64:71], v15
ds_write_b32 v6, v7
s_waitcnt lgkmcnt(11)
v_mfma_f32_16x16x32_bf16 v[160:163], v[80:83], v[32:35], v[160:163]
s_setprio 1
s_waitcnt lgkmcnt(9)
v_mfma_f32_16x16x32_bf16 v[160:163], v[88:91], v[48:51], v[160:163]
s_waitcnt lgkmcnt(0)
s_barrier
v_mfma_f32_16x16x32_bf16 v[164:167], v[88:91], v[52:55], v[164:167]
v_mfma_f32_16x16x32_bf16 v[164:167], v[80:83], v[36:39], v[164:167]
v_mfma_f32_16x16x32_bf16 v[180:183], v[84:87], v[36:39], v[180:183]
v_bfe_u32 v1, v0, 3, 1
v_and_b32 v24, 7, v0
s_lshl_b32 s26, s23, 12
v_mfma_f32_16x16x32_bf16 v[180:183], v[92:95], v[52:55], v[180:183]
v_lshlrev_b32 v1, 7, v1
s_lshl_b32 s27, s42, 10
v_mfma_f32_16x16x32_bf16 v[176:179], v[92:95], v[48:51], v[176:179]
v_lshl_add_u32 v1, v24, 3, v1
s_add_u32 s43, s26, s27
v_mfma_f32_16x16x32_bf16 v[176:179], v[84:87], v[32:35], v[176:179]
s_setprio 0
v_smfmac_f32_16x16x64_bf16 v[100:103], v[96:99], v[72:79], v15
s_waitcnt vmcnt(0)
s_cmp_lg_u32 s25, 0
s_cbranch_scc1 L_k1_ck_q2
s_mov_b32 s27, 0x40000
L_k1_chl_q2:
v_cmp_le_u32 vcc, 32, v28
s_nop 1
s_and_b32 s26, vcc_lo, 0xff
s_cmp_eq_u32 s26, 0xff
s_cbranch_scc1 L_k1_ck_q2
s_sleep 2
s_mov_b64 exec, 0xff
buffer_load_dword v28, v27, s[52:55], 0 offen sc1
s_mov_b64 exec, -1
s_waitcnt vmcnt(0)
s_sub_u32 s27, s27, 1
s_cmp_lg_u32 s27, 0
s_cbranch_scc1 L_k1_chl_q2
L_k1_ck_q2:
s_barrier
v_mfma_f32_16x16x32_bf16 v[136:139], v[64:67], v[40:43], v[136:139]
s_setprio 1
ds_read_b128 v[36:39], v9 offset:2048
buffer_load_dwordx2 v[16:17], v1, s[92:95], s43 offen offset:0 sc1
v_mfma_f32_16x16x32_bf16 v[136:139], v[72:75], v[56:59], v[136:139]
ds_read_b128 v[52:55], v10 offset:2048
buffer_load_dwordx2 v[18:19], v1, s[92:95], s43 offen offset:256 sc1
v_mfma_f32_16x16x32_bf16 v[140:143], v[72:75], v[60:63], v[140:143]
ds_read_b128 v[32:35], v9 offset:0
buffer_load_dwordx2 v[20:21], v1, s[92:95], s43 offen offset:512 sc1
v_mfma_f32_16x16x32_bf16 v[140:143], v[64:67], v[44:47], v[140:143]
ds_read_b128 v[48:51], v10 offset:0
buffer_load_dwordx2 v[22:23], v1, s[92:95], s43 offen offset:768 sc1
v_mfma_f32_16x16x32_bf16 v[156:159], v[68:71], v[44:47], v[156:159]
ds_read_b64_tr_b16 v[64:65], v11 offset:32768
v_mfma_f32_16x16x32_bf16 v[156:159], v[76:79], v[60:63], v[156:159]
ds_read_b64_tr_b16 v[66:67], v11 offset:38912
v_mfma_f32_16x16x32_bf16 v[152:155], v[76:79], v[56:59], v[152:155]
ds_read_b64_tr_b16 v[72:73], v11 offset:49152
v_mfma_f32_16x16x32_bf16 v[152:155], v[68:71], v[40:43], v[152:155]
s_setprio 0
ds_read_b64_tr_b16 v[74:75], v11 offset:55296
v_mfma_f32_16x16x32_bf16 v[168:171], v[80:83], v[40:43], v[168:171]
s_setprio 1
ds_read_b64_tr_b16 v[68:69], v11 offset:33024
v_mfma_f32_16x16x32_bf16 v[168:171], v[88:91], v[56:59], v[168:171]
ds_read_b64_tr_b16 v[70:71], v11 offset:39168
v_mfma_f32_16x16x32_bf16 v[172:175], v[88:91], v[60:63], v[172:175]
ds_read_b64_tr_b16 v[76:77], v11 offset:49408
v_mfma_f32_16x16x32_bf16 v[172:175], v[80:83], v[44:47], v[172:175]
ds_read_b64_tr_b16 v[78:79], v11 offset:55552
v_mfma_f32_16x16x32_bf16 v[188:191], v[84:87], v[44:47], v[188:191]
ds_read_b64_tr_b16 v[80:81], v12 offset:32768
v_mfma_f32_16x16x32_bf16 v[188:191], v[92:95], v[60:63], v[188:191]
ds_read_b64_tr_b16 v[82:83], v12 offset:38912
s_waitcnt lgkmcnt(4)
v_smfmac_f32_16x16x64_bf16 v[100:103], v[96:99], v[64:71], v15
v_mfma_f32_16x16x32_bf16 v[184:187], v[92:95], v[56:59], v[184:187]
ds_read_b64_tr_b16 v[88:89], v12 offset:49152
v_mfma_f32_16x16x32_bf16 v[184:187], v[84:87], v[40:43], v[184:187]
s_setprio 0
ds_read_b64_tr_b16 v[90:91], v12 offset:55296
s_waitcnt lgkmcnt(4)
v_smfmac_f32_16x16x64_bf16 v[100:103], v[96:99], v[72:79], v15
s_setprio 1
v_mfma_f32_16x16x32_bf16 v[128:131], v[64:67], v[32:35], v[128:131]
ds_read_b128 v[40:43], v9 offset:4096
v_mfma_f32_16x16x32_bf16 v[128:131], v[72:75], v[48:51], v[128:131]
ds_read_b128 v[56:59], v10 offset:4096
v_bfe_u32 v5, v0, 4, 1
v_mfma_f32_16x16x32_bf16 v[132:135], v[72:75], v[52:55], v[132:135]
ds_read_b128 v[44:47], v9 offset:6144
v_cmp_eq_u32 vcc, 0, v5
v_mfma_f32_16x16x32_bf16 v[132:135], v[64:67], v[36:39], v[132:135]
ds_read_b128 v[60:63], v10 offset:6144
v_mfma_f32_16x16x32_bf16 v[148:151], v[68:71], v[36:39], v[148:151]
v_add_f32 v100, v100, v101
v_add_f32 v102, v102, v103
v_mfma_f32_16x16x32_bf16 v[148:151], v[76:79], v[52:55], v[148:151]
v_cndmask_b32 v100, v102, v100, vcc
ds_write_b32 v2, v100
v_mfma_f32_16x16x32_bf16 v[144:147], v[76:79], v[48:51], v[144:147]
v_mfma_f32_16x16x32_bf16 v[144:147], v[68:71], v[32:35], v[144:147]
s_waitcnt lgkmcnt(0)
s_barrier
s_add_u32 s26, s46, 0
s_cmp_ge_u32 s26, 2
s_cselect_b32 s27, 2, 0
s_sub_u32 s26, s26, s27
s_lshl_b32 s26, s26, 7
s_add_u32 s26, s26, 143616
v_add_u32 v5, s26, v3
ds_read_b128 v[112:115], v5 offset:0
ds_read_b128 v[116:119], v5 offset:64
v_mfma_f32_16x16x32_bf16 v[152:155], v[68:71], v[40:43], v[152:155]
ds_read_b64_tr_b16 v[84:85], v12 offset:33024
v_mfma_f32_16x16x32_bf16 v[152:155], v[76:79], v[56:59], v[152:155]
ds_read_b64_tr_b16 v[86:87], v12 offset:39168
v_mfma_f32_16x16x32_bf16 v[156:159], v[76:79], v[60:63], v[156:159]
ds_read_b64_tr_b16 v[92:93], v12 offset:49408
v_mfma_f32_16x16x32_bf16 v[156:159], v[68:71], v[44:47], v[156:159]
ds_read_b64_tr_b16 v[94:95], v12 offset:55552
s_waitcnt vmcnt(0)
v_mfma_f32_16x16x32_bf16 v[140:143], v[64:67], v[44:47], v[140:143]
v_mul_f32 v24, s56, v17
v_mfma_f32_16x16x32_bf16 v[140:143], v[72:75], v[60:63], v[140:143]
v_mul_f32 v26, s56, v19
v_mfma_f32_16x16x32_bf16 v[136:139], v[72:75], v[56:59], v[136:139]
v_mul_f32 v28, s56, v21
v_mfma_f32_16x16x32_bf16 v[136:139], v[64:67], v[40:43], v[136:139]
v_mul_f32 v30, s56, v23
v_mfma_f32_16x16x32_bf16 v[160:163], v[80:83], v[32:35], v[160:163]
s_add_u32 s26, s46, 1
s_cmp_ge_u32 s26, 2
s_cselect_b32 s27, 2, 0
s_sub_u32 s26, s26, s27
s_lshl_b32 s26, s26, 7
s_add_u32 s26, s26, 143616
v_add_u32 v5, s26, v3
v_mfma_f32_16x16x32_bf16 v[160:163], v[88:91], v[48:51], v[160:163]
ds_read_b128 v[120:123], v5 offset:0
ds_read_b128 v[124:127], v5 offset:64
s_waitcnt lgkmcnt(7)
v_fmac_f32 v128, v112, v16
v_fmac_f32 v129, v113, v16
v_fmac_f32 v130, v114, v16
v_fmac_f32 v131, v115, v16
v_mfma_f32_16x16x32_bf16 v[164:167], v[88:91], v[52:55], v[164:167]
v_fmac_f32 v132, v112, v18
v_fmac_f32 v133, v113, v18
v_fmac_f32 v134, v114, v18
v_fmac_f32 v135, v115, v18
v_fmac_f32 v136, v112, v20
v_fmac_f32 v137, v113, v20
v_mfma_f32_16x16x32_bf16 v[164:167], v[80:83], v[36:39], v[164:167]
v_fmac_f32 v138, v114, v20
v_fmac_f32 v139, v115, v20
v_fmac_f32 v140, v112, v22
v_fmac_f32 v141, v113, v22
v_fmac_f32 v142, v114, v22
v_fmac_f32 v143, v115, v22
s_waitcnt lgkmcnt(4)
v_mfma_f32_16x16x32_bf16 v[180:183], v[84:87], v[36:39], v[180:183]
v_mul_f32 v128, v128, v24
v_mul_f32 v129, v129, v24
v_mul_f32 v130, v130, v24
v_mul_f32 v131, v131, v24
v_mul_f32 v132, v132, v26
v_mul_f32 v133, v133, v26
s_waitcnt lgkmcnt(2)
v_mfma_f32_16x16x32_bf16 v[180:183], v[92:95], v[52:55], v[180:183]
v_mul_f32 v134, v134, v26
v_mul_f32 v135, v135, v26
v_mul_f32 v136, v136, v28
v_mul_f32 v137, v137, v28
v_mul_f32 v138, v138, v28
v_mul_f32 v139, v139, v28
v_mul_f32 v140, v140, v30
v_mfma_f32_16x16x32_bf16 v[176:179], v[92:95], v[48:51], v[176:179]
v_mul_f32 v141, v141, v30
v_mul_f32 v142, v142, v30
v_mul_f32 v143, v143, v30
v_fmac_f32 v144, v116, v16
v_fmac_f32 v145, v117, v16
v_fmac_f32 v146, v118, v16
v_mfma_f32_16x16x32_bf16 v[176:179], v[84:87], v[32:35], v[176:179]
v_fmac_f32 v147, v119, v16
v_fmac_f32 v148, v116, v18
v_fmac_f32 v149, v117, v18
v_fmac_f32 v150, v118, v18
v_fmac_f32 v151, v119, v18
v_fmac_f32 v152, v116, v20
v_mfma_f32_16x16x32_bf16 v[184:187], v[84:87], v[40:43], v[184:187]
v_fmac_f32 v153, v117, v20
v_fmac_f32 v154, v118, v20
v_fmac_f32 v155, v119, v20
v_fmac_f32 v156, v116, v22
v_fmac_f32 v157, v117, v22
v_fmac_f32 v158, v118, v22
v_mfma_f32_16x16x32_bf16 v[184:187], v[92:95], v[56:59], v[184:187]
v_fmac_f32 v159, v119, v22
v_mul_f32 v144, v144, v24
v_mul_f32 v145, v145, v24
v_mul_f32 v146, v146, v24
v_mul_f32 v147, v147, v24
v_mul_f32 v148, v148, v26
v_mfma_f32_16x16x32_bf16 v[188:191], v[92:95], v[60:63], v[188:191]
v_mul_f32 v149, v149, v26
v_mul_f32 v150, v150, v26
v_mul_f32 v151, v151, v26
v_mul_f32 v152, v152, v28
v_mul_f32 v153, v153, v28
v_mul_f32 v154, v154, v28
v_mul_f32 v155, v155, v28
v_mfma_f32_16x16x32_bf16 v[188:191], v[84:87], v[44:47], v[188:191]
v_mul_f32 v156, v156, v30
v_mul_f32 v157, v157, v30
v_mul_f32 v158, v158, v30
v_mul_f32 v159, v159, v30
s_add_u32 s26, s46, 0
s_cmp_ge_u32 s26, 2
v_mfma_f32_16x16x32_bf16 v[172:175], v[80:83], v[44:47], v[172:175]
s_cselect_b32 s27, 2, 0
s_sub_u32 s26, s26, s27
s_lshl_b32 s26, s26, 17
s_add_u32 s27, s26, s31
v_cvt_pk_bf16_f32 v128, v128, v129
v_cvt_pk_bf16_f32 v129, v130, v131
v_mfma_f32_16x16x32_bf16 v[172:175], v[88:91], v[60:63], v[172:175]
v_cvt_pk_bf16_f32 v130, v144, v145
v_cvt_pk_bf16_f32 v131, v146, v147
buffer_store_dwordx4 v[128:131], v4, s[16:19], s27 offen offset:0 sc0 sc1
v_cvt_pk_bf16_f32 v132, v132, v133
v_cvt_pk_bf16_f32 v133, v134, v135
v_cvt_pk_bf16_f32 v134, v148, v149
v_mfma_f32_16x16x32_bf16 v[168:171], v[88:91], v[56:59], v[168:171]
v_cvt_pk_bf16_f32 v135, v150, v151
buffer_store_dwordx4 v[132:135], v4, s[16:19], s27 offen offset:1024 sc0 sc1
v_cvt_pk_bf16_f32 v136, v136, v137
v_cvt_pk_bf16_f32 v137, v138, v139
v_cvt_pk_bf16_f32 v138, v152, v153
v_cvt_pk_bf16_f32 v139, v154, v155
v_mfma_f32_16x16x32_bf16 v[168:171], v[80:83], v[40:43], v[168:171]
buffer_store_dwordx4 v[136:139], v4, s[16:19], s27 offen offset:2048 sc0 sc1
v_cvt_pk_bf16_f32 v140, v140, v141
v_cvt_pk_bf16_f32 v141, v142, v143
v_cvt_pk_bf16_f32 v142, v156, v157
v_cvt_pk_bf16_f32 v143, v158, v159
buffer_store_dwordx4 v[140:143], v4, s[16:19], s27 offen offset:3072 sc0 sc1
s_waitcnt lgkmcnt(1)
v_pk_fma_f32 v[160:161], v[120:121], v[16:17], v[160:161] op_sel_hi:[1,0,1]
v_pk_fma_f32 v[162:163], v[122:123], v[16:17], v[162:163] op_sel_hi:[1,0,1]
v_pk_fma_f32 v[164:165], v[120:121], v[18:19], v[164:165] op_sel_hi:[1,0,1]
v_pk_fma_f32 v[166:167], v[122:123], v[18:19], v[166:167] op_sel_hi:[1,0,1]
v_pk_fma_f32 v[168:169], v[120:121], v[20:21], v[168:169] op_sel_hi:[1,0,1]
v_pk_fma_f32 v[170:171], v[122:123], v[20:21], v[170:171] op_sel_hi:[1,0,1]
v_pk_fma_f32 v[172:173], v[120:121], v[22:23], v[172:173] op_sel_hi:[1,0,1]
v_pk_fma_f32 v[174:175], v[122:123], v[22:23], v[174:175] op_sel_hi:[1,0,1]
v_pk_mul_f32 v[160:161], v[160:161], v[24:25] op_sel_hi:[1,0]
v_pk_mul_f32 v[162:163], v[162:163], v[24:25] op_sel_hi:[1,0]
v_pk_mul_f32 v[164:165], v[164:165], v[26:27] op_sel_hi:[1,0]
v_pk_mul_f32 v[166:167], v[166:167], v[26:27] op_sel_hi:[1,0]
v_pk_mul_f32 v[168:169], v[168:169], v[28:29] op_sel_hi:[1,0]
v_pk_mul_f32 v[170:171], v[170:171], v[28:29] op_sel_hi:[1,0]
v_pk_mul_f32 v[172:173], v[172:173], v[30:31] op_sel_hi:[1,0]
v_pk_mul_f32 v[174:175], v[174:175], v[30:31] op_sel_hi:[1,0]
s_waitcnt lgkmcnt(0)
v_pk_fma_f32 v[176:177], v[124:125], v[16:17], v[176:177] op_sel_hi:[1,0,1]
v_pk_fma_f32 v[178:179], v[126:127], v[16:17], v[178:179] op_sel_hi:[1,0,1]
v_pk_fma_f32 v[180:181], v[124:125], v[18:19], v[180:181] op_sel_hi:[1,0,1]
v_pk_fma_f32 v[182:183], v[126:127], v[18:19], v[182:183] op_sel_hi:[1,0,1]
v_pk_fma_f32 v[184:185], v[124:125], v[20:21], v[184:185] op_sel_hi:[1,0,1]
v_pk_fma_f32 v[186:187], v[126:127], v[20:21], v[186:187] op_sel_hi:[1,0,1]
v_pk_fma_f32 v[188:189], v[124:125], v[22:23], v[188:189] op_sel_hi:[1,0,1]
v_pk_fma_f32 v[190:191], v[126:127], v[22:23], v[190:191] op_sel_hi:[1,0,1]
v_pk_mul_f32 v[176:177], v[176:177], v[24:25] op_sel_hi:[1,0]
v_pk_mul_f32 v[178:179], v[178:179], v[24:25] op_sel_hi:[1,0]
v_pk_mul_f32 v[180:181], v[180:181], v[26:27] op_sel_hi:[1,0]
v_pk_mul_f32 v[182:183], v[182:183], v[26:27] op_sel_hi:[1,0]
v_pk_mul_f32 v[184:185], v[184:185], v[28:29] op_sel_hi:[1,0]
v_pk_mul_f32 v[186:187], v[186:187], v[28:29] op_sel_hi:[1,0]
v_pk_mul_f32 v[188:189], v[188:189], v[30:31] op_sel_hi:[1,0]
v_pk_mul_f32 v[190:191], v[190:191], v[30:31] op_sel_hi:[1,0]
s_add_u32 s26, s46, 1
s_cmp_ge_u32 s26, 2
s_cselect_b32 s27, 2, 0
s_sub_u32 s26, s26, s27
s_lshl_b32 s26, s26, 17
s_add_u32 s27, s26, s31
v_cvt_pk_bf16_f32 v160, v160, v161
v_cvt_pk_bf16_f32 v161, v162, v163
v_cvt_pk_bf16_f32 v162, v176, v177
v_cvt_pk_bf16_f32 v163, v178, v179
buffer_store_dwordx4 v[160:163], v4, s[16:19], s27 offen offset:0 sc0 sc1
v_cvt_pk_bf16_f32 v164, v164, v165
v_cvt_pk_bf16_f32 v165, v166, v167
v_cvt_pk_bf16_f32 v166, v180, v181
v_cvt_pk_bf16_f32 v167, v182, v183
buffer_store_dwordx4 v[164:167], v4, s[16:19], s27 offen offset:1024 sc0 sc1
v_cvt_pk_bf16_f32 v168, v168, v169
v_cvt_pk_bf16_f32 v169, v170, v171
v_cvt_pk_bf16_f32 v170, v184, v185
v_cvt_pk_bf16_f32 v171, v186, v187
buffer_store_dwordx4 v[168:171], v4, s[16:19], s27 offen offset:2048 sc0 sc1
v_cvt_pk_bf16_f32 v172, v172, v173
v_cvt_pk_bf16_f32 v173, v174, v175
v_cvt_pk_bf16_f32 v174, v188, v189
v_cvt_pk_bf16_f32 v175, v190, v191
buffer_store_dwordx4 v[172:175], v4, s[16:19], s27 offen offset:3072 sc0 sc1
s_setprio 0
s_bfe_u32 s27, s2, 0x20003
s_lshr_b32 s34, s2, 5
v_lshlrev_b32 v11, 4, v0
s_add_u32 s34, s34, s2
s_and_b32 s34, s34, 7
s_and_b32 s26, s2, 7
s_lshl_b32 s33, s26, 2
s_add_u32 s33, s33, s27
s_lshl_b32 s30, s34, 14
s_lshl_b32 s27, s42, 12
s_add_u32 s30, s30, s27
s_and_b32 s26, s42, 1
s_lshl_b32 s40, s26, 10
s_lshl_b32 s41, s42, 10
s_add_u32 s41, s41, 131072
v_bfe_u32 v12, v0, 4, 1
v_lshlrev_b32 v12, 7, v12
s_cmp_ge_u32 s42, 2
s_cselect_b32 s26, -1, 0
v_and_b32 v12, s26, v12
v_xor_b32 v7, v11, v12
s_lshl_b32 s26, s33, 17
s_add_u32 s27, s26, 0x400000
s_lshr_b32 s35, s42, 1
s_add_u32 s35, s35, 1
s_lshl_b32 s35, s35, 22
s_add_u32 s35, s35, s27
s_add_u32 s12, s4, s27
s_addc_u32 s13, s5, 0
s_mov_b32 s14, 0x20000
s_mov_b32 s15, 0x20000
s_add_u32 s8, s4, s35
s_addc_u32 s9, s5, 0
s_mov_b32 s10, 0x20000
s_mov_b32 s11, 0x20000
v_lshl_add_u32 v12, v0, 5, s33
v_mul_u32_u24 v13, 43, v12
v_lshrrev_b32 v13, 10, v13
v_mul_u32_u24 v14, 24, v13
v_sub_u32 v12, v12, v14
v_or_b32 v14, 1, v12
v_cmp_gt_u32 vcc, 16, v12
v_subrev_u32 v12, 15, v12
v_mul_u32_u24 v12, 11, v12
v_lshrrev_b32 v12, 5, v12
v_lshlrev_b32 v12, 1, v12
v_cndmask_b32 v12, v12, v14, vcc
v_lshl_add_u32 v12, v13, 4, v12
s_and_b32 s26, s34, 3
v_lshl_add_u32 v12, v12, 2, s26
v_lshlrev_b32 v12, 7, v12
s_barrier
v_mov_b32 v13, 159744
v_mov_b32 v14, 1
v_lshlrev_b32 v15, 7, v0
s_mov_b64 exec, 1
s_waitcnt vmcnt(0)
ds_add_rtn_u32 v13, v13, v14
s_waitcnt lgkmcnt(0)
v_readfirstlane_b32 s26, v13
s_mov_b64 exec, 15
s_cmp_lg_u32 s26, 3
s_cbranch_scc1 L_t_pq2
buffer_atomic_add v14, v15, s[48:51], s74 offen sc1
L_t_pq2:
s_mov_b64 exec, -1
s_barrier
s_barrier
s_barrier
s_barrier
s_barrier
s_barrier
s_barrier
s_mov_b64 exec, 7
buffer_load_dword v9, v12, s[48:51], 0 offen sc1
s_mov_b64 exec, -1
s_barrier
s_mov_b64 exec, 7
s_mov_b32 s47, 0x40000
s_waitcnt vmcnt(0)
s_branch L_t_wq2_k
L_t_wq2_l:
s_waitcnt vmcnt(0)
L_t_wq2_k:
v_cmp_le_u32 s[26:27], 8, v9
s_sub_u32 s47, s47, 1
s_nop 0
s_cmp_eq_u32 s26, 7
s_cbranch_scc1 L_t_wq2_g
s_sleep 1
buffer_load_dword v9, v12, s[48:51], 0 offen sc1
s_cmp_lg_u32 s47, 0
s_cbranch_scc1 L_t_wq2_l
L_t_wq2_g:
s_mov_b64 exec, -1
s_add_u32 m0, s41, 0
s_nop 0
buffer_load_dwordx4 v7, s[8:11], s40 offen lds
s_add_u32 s40, s40, 2048
buffer_load_dwordx4 v[240:243], v11, s[12:15], s30 offen offset:0
buffer_load_dwordx4 v[244:247], v11, s[12:15], s30 offen offset:1024
buffer_load_dwordx4 v[248:251], v11, s[12:15], s30 offen offset:2048
buffer_load_dwordx4 v[252:255], v11, s[12:15], s30 offen offset:3072
s_add_u32 m0, s41, 4096
s_nop 0
buffer_load_dwordx4 v7, s[8:11], s40 offen lds
s_add_u32 s40, s40, 2048
s_add_u32 m0, s41, 8192
s_nop 0
buffer_load_dwordx4 v7, s[8:11], s40 offen lds
s_add_u32 s40, s40, 2048
s_add_u32 m0, s41, 12288
s_nop 0
buffer_load_dwordx4 v7, s[8:11], s40 offen lds
s_add_u32 s40, s40, 2048
s_add_u32 m0, s41, 16384
s_nop 0
buffer_load_dwordx4 v7, s[8:11], s40 offen lds
s_add_u32 s40, s40, 2048
s_add_u32 m0, s41, 20480
s_nop 0
buffer_load_dwordx4 v7, s[8:11], s40 offen lds
s_add_u32 s40, s40, 2048
s_add_u32 m0, s41, 24576
s_nop 0
buffer_load_dwordx4 v7, s[8:11], s40 offen lds
s_add_u32 s40, s40, 2048
s_branch L_att
L_k1_z3:
s_lshl_b32 s26, s34, 17
s_add_u32 s31, s31, s26
s_add_u32 s31, s31, 0x2000000
s_mov_b32 s35, 2
v_and_b32 v24, 15, v0
v_lshrrev_b32 v25, 4, v0
v_bfe_u32 v26, v0, 1, 3
s_lshl_b32 s26, s42, 13
s_add_u32 s26, s26, 65536
v_lshlrev_b32 v24, 7, v24
v_add_u32 v24, s26, v24
v_xor_b32 v27, v25, v26
v_lshl_add_u32 v9, v27, 4, v24
v_xor_b32 v10, 64, v9
v_lshrrev_b32 v24, 5, v0
v_mul_u32_u24 v24, 3072, v24
v_and_b32 v25, 31, v0
v_lshl_add_u32 v24, v25, 3, v24
s_cmp_ge_u32 s42, 3
s_cselect_b32 s27, 3, 0
s_sub_u32 s46, s42, s27
s_add_u32 s26, s46, 0
s_cmp_ge_u32 s26, 3
s_cselect_b32 s27, 3, 0
s_sub_u32 s26, s26, s27
s_lshl_b32 s26, s26, 9
s_add_u32 s26, s26, 99328
v_add_u32 v11, s26, v24
s_add_u32 s26, s46, 1
s_cmp_ge_u32 s26, 3
s_cselect_b32 s27, 3, 0
s_sub_u32 s26, s26, s27
s_lshl_b32 s26, s26, 9
s_add_u32 s26, s26, 99328
v_add_u32 v12, s26, v24
s_add_u32 s26, s46, 2
s_cmp_ge_u32 s26, 3
s_cselect_b32 s27, 3, 0
s_sub_u32 s26, s26, s27
s_lshl_b32 s26, s26, 9
s_add_u32 s26, s26, 99328
v_add_u32 v13, s26, v24
v_bfe_u32 v24, v0, 1, 1
v_lshrrev_b32 v25, 5, v0
v_cmp_eq_u32 vcc, v24, v25
v_mov_b32 v24, 0x3f803f80
s_nop 0
v_cndmask_b32 v96, 0, v24, vcc
v_mov_b32 v97, v96
v_mov_b32 v98, v96
v_mov_b32 v99, v96
v_and_b32 v24, 1, v0
v_mul_u32_u24 v24, 0xaaaa, v24
v_add_u32 v15, 0x4444, v24
v_mov_b32 v100, 0
v_mov_b32 v101, 0
v_mov_b32 v102, 0
v_mov_b32 v103, 0
s_waitcnt vmcnt(7)
s_mov_b32 m0, s29
s_nop 0
buffer_load_dwordx4 v5, s[12:15], s21 offen offset:0 lds
v_lshlrev_b32 v144, 16, v128
v_and_b32 v145, 0xffff0000, v128
v_lshlrev_b32 v146, 16, v129
v_and_b32 v147, 0xffff0000, v129
v_lshlrev_b32 v148, 16, v130
v_and_b32 v149, 0xffff0000, v130
v_lshlrev_b32 v150, 16, v131
v_and_b32 v151, 0xffff0000, v131
v_lshlrev_b32 v152, 16, v132
buffer_load_dwordx4 v6, s[12:15], s21 offen offset:1024 lds
v_and_b32 v153, 0xffff0000, v132
v_lshlrev_b32 v154, 16, v133
v_and_b32 v155, 0xffff0000, v133
v_lshlrev_b32 v156, 16, v134
v_and_b32 v157, 0xffff0000, v134
v_lshlrev_b32 v158, 16, v135
v_and_b32 v159, 0xffff0000, v135
v_pk_add_f32 v[128:129], v[144:145], v[152:153]
v_pk_add_f32 v[130:131], v[146:147], v[154:155]
v_pk_add_f32 v[132:133], v[148:149], v[156:157]
buffer_load_dwordx4 v7, s[12:15], s21 offen offset:2048 lds
v_pk_add_f32 v[134:135], v[150:151], v[158:159]
v_pk_add_f32 v[128:129], v[128:129], v[130:131]
v_pk_add_f32 v[132:133], v[132:133], v[134:135]
v_pk_add_f32 v[128:129], v[128:129], v[132:133]
v_add_f32 v128, v128, v129
s_nop 1
v_add_f32_dpp v128, v128, v128 quad_perm:[1,0,3,2] row_mask:0xf bank_mask:0xf
s_nop 1
v_add_f32_dpp v128, v128, v128 quad_perm:[2,3,0,1] row_mask:0xf bank_mask:0xf
s_nop 1
v_add_f32_dpp v128, v128, v128 row_half_mirror row_mask:0xf bank_mask:0xf
s_nop 1
v_add_f32_dpp v128, v128, v128 row_mirror row_mask:0xf bank_mask:0xf
v_mov_b32 v129, v128
buffer_load_dwordx4 v8, s[12:15], s21 offen offset:3072 lds
s_add_u32 s21, s21, 128
s_add_u32 s29, s29, 32768
s_cmp_ge_u32 s29, 98304
s_cselect_b32 s26, 98304, 0
s_sub_u32 s29, s29, s26
v_permlane16_swap_b32 v128, v129
v_add_f32 v128, v128, v129
v_mov_b32 v129, v128
s_nop 1
v_permlane32_swap_b32 v128, v129
v_add_f32 v128, v128, v129
v_mul_f32 v16, 0xba800000, v128
v_pk_add_f32 v[144:145], v[144:145], v[16:17] op_sel_hi:[1,0]
v_pk_add_f32 v[146:147], v[146:147], v[16:17] op_sel_hi:[1,0]
v_pk_add_f32 v[148:149], v[148:149], v[16:17] op_sel_hi:[1,0]
v_pk_add_f32 v[150:151], v[150:151], v[16:17] op_sel_hi:[1,0]
s_add_u32 m0, s28, 32768
s_nop 0
buffer_load_dwordx4 v1, s[8:11], s20 offen offset:0 lds
v_pk_add_f32 v[152:153], v[152:153], v[16:17] op_sel_hi:[1,0]
v_pk_add_f32 v[154:155], v[154:155], v[16:17] op_sel_hi:[1,0]
v_pk_add_f32 v[156:157], v[156:157], v[16:17] op_sel_hi:[1,0]
v_pk_add_f32 v[158:159], v[158:159], v[16:17] op_sel_hi:[1,0]
v_pk_mul_f32 v[128:129], v[144:145], v[144:145]
v_pk_mul_f32 v[130:131], v[146:147], v[146:147]
v_pk_mul_f32 v[132:133], v[148:149], v[148:149]
v_pk_mul_f32 v[134:135], v[150:151], v[150:151]
v_pk_fma_f32 v[128:129], v[152:153], v[152:153], v[128:129]
v_pk_fma_f32 v[130:131], v[154:155], v[154:155], v[130:131]
buffer_load_dwordx4 v2, s[84:87], s88 offen offset:1024 lds
v_pk_fma_f32 v[132:133], v[156:157], v[156:157], v[132:133]
v_pk_fma_f32 v[134:135], v[158:159], v[158:159], v[134:135]
v_pk_add_f32 v[128:129], v[128:129], v[130:131]
v_pk_add_f32 v[132:133], v[132:133], v[134:135]
v_pk_add_f32 v[128:129], v[128:129], v[132:133]
v_add_f32 v128, v128, v129
s_nop 1
v_add_f32_dpp v128, v128, v128 quad_perm:[1,0,3,2] row_mask:0xf bank_mask:0xf
s_nop 1
v_add_f32_dpp v128, v128, v128 quad_perm:[2,3,0,1] row_mask:0xf bank_mask:0xf
s_nop 1
v_add_f32_dpp v128, v128, v128 row_half_mirror row_mask:0xf bank_mask:0xf
s_nop 1
v_add_f32_dpp v128, v128, v128 row_mirror row_mask:0xf bank_mask:0xf
buffer_load_dwordx4 v3, s[84:87], s88 offen offset:2048 lds
s_add_u32 s20, s20, 393216
s_add_u32 s88, s88, s89
v_mov_b32 v129, v128
s_nop 1
v_permlane16_swap_b32 v128, v129
v_add_f32 v128, v128, v129
v_mov_b32 v129, v128
s_nop 1
v_permlane32_swap_b32 v128, v129
v_add_f32 v128, v128, v129
v_mov_b32 v129, 0x3727c5ac
v_fmac_f32 v129, 0x3a800000, v128
v_rsq_f32 v17, v129
s_nop 0
buffer_store_dwordx2 v[16:17], v30, s[92:95], 0 offen sc0 sc1
buffer_store_dword v31, v29, s[48:51], 0 offen sc0 sc1
s_mul_i32 s26, s23, 40960
s_mul_i32 s27, s42, 10240
s_add_u32 s38, s26, s27
s_add_u32 s38, s38, 0x100000
s_mul_i32 s26, s32, 5
s_add_u32 s26, s26, s33
s_and_b32 s27, s26, 1
s_lshr_b32 s26, s26, 1
s_lshl_b32 s26, s26, 10
s_lshl_b32 s27, s27, 3
s_add_u32 s39, s26, s38
s_add_u32 s39, s39, s27
v_lshlrev_b32 v24, 4, v0
v_mov_b32 v26, -1
v_mov_b32 v27, -1
buffer_store_dwordx2 v[26:27], v24, s[16:19], s39 offen sc0 sc1
s_waitcnt vmcnt(10)
s_barrier
ds_read_b64_tr_b16 v[224:225], v11 offset:0
ds_read_b64_tr_b16 v[226:227], v11 offset:6144
ds_read_b128 v[32:35], v9 offset:0
ds_read_b64_tr_b16 v[232:233], v11 offset:16384
ds_read_b64_tr_b16 v[234:235], v11 offset:22528
ds_read_b128 v[48:51], v10 offset:0
ds_read_b128 v[52:55], v10 offset:2048
ds_read_b128 v[36:39], v9 offset:2048
ds_read_b64_tr_b16 v[228:229], v11 offset:256
ds_read_b64_tr_b16 v[230:231], v11 offset:6400
ds_read_b64_tr_b16 v[236:237], v11 offset:16640
ds_read_b64_tr_b16 v[238:239], v11 offset:22784
ds_read_b64_tr_b16 v[64:65], v12 offset:0
ds_read_b64_tr_b16 v[66:67], v12 offset:6144
ds_read_b64_tr_b16 v[72:73], v12 offset:16384
s_waitcnt lgkmcnt(14)
ds_read_b64_tr_b16 v[74:75], v12 offset:22528
s_waitcnt lgkmcnt(14)
ds_read_b64_tr_b16 v[68:69], v12 offset:256
s_waitcnt lgkmcnt(14)
ds_read_b64_tr_b16 v[70:71], v12 offset:6400
s_waitcnt lgkmcnt(14)
ds_read_b64_tr_b16 v[76:77], v12 offset:16640
s_waitcnt lgkmcnt(14)
ds_read_b64_tr_b16 v[78:79], v12 offset:22784
s_waitcnt lgkmcnt(14)
ds_read_b64_tr_b16 v[80:81], v13 offset:0
s_waitcnt lgkmcnt(14)
ds_read_b64_tr_b16 v[82:83], v13 offset:6144
s_waitcnt lgkmcnt(14)
ds_read_b64_tr_b16 v[88:89], v13 offset:16384
s_waitcnt lgkmcnt(14)
ds_read_b64_tr_b16 v[90:91], v13 offset:22528
s_mov_b32 s22, 6
s_mov_b32 m0, s29
v_mfma_f32_16x16x32_bf16 v[128:131], v[224:227], v[32:35], 0
s_setprio 1
s_waitcnt lgkmcnt(14)
ds_read_b64_tr_b16 v[84:85], v13 offset:256
v_mfma_f32_16x16x32_bf16 v[128:131], v[232:235], v[48:51], v[128:131]
buffer_load_dwordx4 v5, s[12:15], s21 offen offset:0 lds
s_waitcnt lgkmcnt(14)
ds_read_b64_tr_b16 v[86:87], v13 offset:6400
v_mfma_f32_16x16x32_bf16 v[132:135], v[232:235], v[52:55], 0
s_waitcnt lgkmcnt(14)
ds_read_b64_tr_b16 v[92:93], v13 offset:16640
v_mfma_f32_16x16x32_bf16 v[132:135], v[224:227], v[36:39], v[132:135]
s_waitcnt lgkmcnt(14)
ds_read_b64_tr_b16 v[94:95], v13 offset:22784
v_mfma_f32_16x16x32_bf16 v[148:151], v[228:231], v[36:39], 0
buffer_load_dwordx4 v6, s[12:15], s21 offen offset:1024 lds
s_waitcnt lgkmcnt(14)
ds_read_b128 v[40:43], v9 offset:4096
v_mfma_f32_16x16x32_bf16 v[148:151], v[236:239], v[52:55], v[148:151]
s_waitcnt lgkmcnt(14)
ds_read_b128 v[56:59], v10 offset:4096
v_mfma_f32_16x16x32_bf16 v[144:147], v[236:239], v[48:51], 0
buffer_load_dwordx4 v7, s[12:15], s21 offen offset:2048 lds
s_waitcnt lgkmcnt(14)
ds_read_b128 v[44:47], v9 offset:6144
v_mfma_f32_16x16x32_bf16 v[144:147], v[228:231], v[32:35], v[144:147]
s_waitcnt lgkmcnt(14)
ds_read_b128 v[60:63], v10 offset:6144
v_add_u32 v9, s59, v9
v_add_u32 v10, s59, v10
s_add_u32 s40, s40, 1
s_cmp_eq_u32 s40, 3
s_cselect_b32 s40, 0, s40
s_cmp_eq_u32 s40, 2
s_cselect_b32 s59, 0xffff0000, s57
v_smfmac_f32_16x16x64_bf16 v[100:103], v[96:99], v[224:231], v15
v_mfma_f32_16x16x32_bf16 v[160:163], v[64:67], v[32:35], 0
v_mfma_f32_16x16x32_bf16 v[160:163], v[72:75], v[48:51], v[160:163]
buffer_load_dwordx4 v8, s[12:15], s21 offen offset:3072 lds
s_add_u32 s21, s21, 128
s_add_u32 s29, s29, 32768
s_cmp_ge_u32 s29, 98304
s_cselect_b32 s26, 98304, 0
s_sub_u32 s29, s29, s26
v_mfma_f32_16x16x32_bf16 v[164:167], v[72:75], v[52:55], 0
v_mfma_f32_16x16x32_bf16 v[164:167], v[64:67], v[36:39], v[164:167]
s_setprio 0
s_waitcnt lgkmcnt(14)
v_mfma_f32_16x16x32_bf16 v[180:183], v[68:71], v[36:39], 0
s_setprio 1
s_waitcnt lgkmcnt(12)
v_mfma_f32_16x16x32_bf16 v[180:183], v[76:79], v[52:55], v[180:183]
s_waitcnt lgkmcnt(0)
s_barrier
s_add_u32 m0, s28, 0
v_mfma_f32_16x16x32_bf16 v[176:179], v[76:79], v[48:51], 0
buffer_load_dwordx4 v1, s[8:11], s20 offen offset:0 lds
v_mfma_f32_16x16x32_bf16 v[176:179], v[68:71], v[32:35], v[176:179]
v_smfmac_f32_16x16x64_bf16 v[100:103], v[96:99], v[232:239], v15
v_mfma_f32_16x16x32_bf16 v[192:195], v[80:83], v[32:35], 0
v_mfma_f32_16x16x32_bf16 v[192:195], v[88:91], v[48:51], v[192:195]
v_mfma_f32_16x16x32_bf16 v[196:199], v[88:91], v[52:55], 0
v_mfma_f32_16x16x32_bf16 v[196:199], v[80:83], v[36:39], v[196:199]
v_mfma_f32_16x16x32_bf16 v[212:215], v[84:87], v[36:39], 0
buffer_load_dwordx4 v2, s[84:87], s88 offen offset:1024 lds
v_mfma_f32_16x16x32_bf16 v[212:215], v[92:95], v[52:55], v[212:215]
v_mfma_f32_16x16x32_bf16 v[208:211], v[92:95], v[48:51], 0
v_mfma_f32_16x16x32_bf16 v[208:211], v[84:87], v[32:35], v[208:211]
s_setprio 0
s_waitcnt vmcnt(6)
s_barrier
v_mfma_f32_16x16x32_bf16 v[136:139], v[224:227], v[40:43], 0
s_setprio 1
ds_read_b128 v[36:39], v9 offset:2048
s_cmp_lg_u32 s25, 0
s_cbranch_scc1 L_k1_np_z3
v_mov_b32 v28, 1
v_mov_b32 v29, 0
s_mov_b64 exec, 1
buffer_atomic_add v28, v29, s[52:55], s47 offen sc1
s_mov_b64 exec, -1
v_lshlrev_b32 v27, 5, v0
L_k1_np_z3:
v_mfma_f32_16x16x32_bf16 v[136:139], v[232:235], v[56:59], v[136:139]
ds_read_b128 v[52:55], v10 offset:2048
v_mfma_f32_16x16x32_bf16 v[140:143], v[232:235], v[60:63], 0
buffer_load_dwordx4 v3, s[84:87], s88 offen offset:2048 lds
s_add_u32 s20, s20, 393216
s_add_u32 s88, s88, s89
s_mov_b32 m0, s29
ds_read_b128 v[32:35], v9 offset:0
v_mfma_f32_16x16x32_bf16 v[140:143], v[224:227], v[44:47], v[140:143]
buffer_load_dwordx4 v5, s[12:15], s21 offen offset:0 lds
ds_read_b128 v[48:51], v10 offset:0
v_mfma_f32_16x16x32_bf16 v[156:159], v[228:231], v[44:47], 0
ds_read_b64_tr_b16 v[224:225], v11 offset:32768
v_mfma_f32_16x16x32_bf16 v[156:159], v[236:239], v[60:63], v[156:159]
ds_read_b64_tr_b16 v[226:227], v11 offset:38912
v_mfma_f32_16x16x32_bf16 v[152:155], v[236:239], v[56:59], 0
ds_read_b64_tr_b16 v[232:233], v11 offset:49152
v_mfma_f32_16x16x32_bf16 v[152:155], v[228:231], v[40:43], v[152:155]
ds_read_b64_tr_b16 v[234:235], v11 offset:55296
v_mfma_f32_16x16x32_bf16 v[168:171], v[64:67], v[40:43], 0
ds_read_b64_tr_b16 v[228:229], v11 offset:33024
v_mfma_f32_16x16x32_bf16 v[168:171], v[72:75], v[56:59], v[168:171]
buffer_load_dwordx4 v6, s[12:15], s21 offen offset:1024 lds
ds_read_b64_tr_b16 v[230:231], v11 offset:39168
v_mfma_f32_16x16x32_bf16 v[172:175], v[72:75], v[60:63], 0
ds_read_b64_tr_b16 v[236:237], v11 offset:49408
v_mfma_f32_16x16x32_bf16 v[172:175], v[64:67], v[44:47], v[172:175]
s_setprio 0
ds_read_b64_tr_b16 v[238:239], v11 offset:55552
v_mfma_f32_16x16x32_bf16 v[188:191], v[68:71], v[44:47], 0
s_setprio 1
ds_read_b64_tr_b16 v[64:65], v12 offset:32768
v_mfma_f32_16x16x32_bf16 v[188:191], v[76:79], v[60:63], v[188:191]
ds_read_b64_tr_b16 v[66:67], v12 offset:38912
v_mfma_f32_16x16x32_bf16 v[184:187], v[76:79], v[56:59], 0
ds_read_b64_tr_b16 v[72:73], v12 offset:49152
v_mfma_f32_16x16x32_bf16 v[184:187], v[68:71], v[40:43], v[184:187]
buffer_load_dwordx4 v7, s[12:15], s21 offen offset:2048 lds
s_waitcnt lgkmcnt(14)
ds_read_b64_tr_b16 v[74:75], v12 offset:55296
v_mfma_f32_16x16x32_bf16 v[200:203], v[80:83], v[40:43], 0
s_waitcnt lgkmcnt(14)
ds_read_b64_tr_b16 v[68:69], v12 offset:33024
v_mfma_f32_16x16x32_bf16 v[200:203], v[88:91], v[56:59], v[200:203]
s_waitcnt lgkmcnt(14)
ds_read_b64_tr_b16 v[70:71], v12 offset:39168
v_mfma_f32_16x16x32_bf16 v[204:207], v[88:91], v[60:63], 0
s_waitcnt lgkmcnt(14)
ds_read_b64_tr_b16 v[76:77], v12 offset:49408
v_mfma_f32_16x16x32_bf16 v[204:207], v[80:83], v[44:47], v[204:207]
s_waitcnt lgkmcnt(14)
ds_read_b64_tr_b16 v[78:79], v12 offset:55552
v_mfma_f32_16x16x32_bf16 v[220:223], v[84:87], v[44:47], 0
s_waitcnt lgkmcnt(14)
ds_read_b64_tr_b16 v[80:81], v13 offset:32768
v_mfma_f32_16x16x32_bf16 v[220:223], v[92:95], v[60:63], v[220:223]
buffer_load_dwordx4 v8, s[12:15], s21 offen offset:3072 lds
s_add_u32 s21, s21, 128
s_add_u32 s29, s29, 32768
s_cmp_ge_u32 s29, 98304
s_cselect_b32 s26, 98304, 0
s_sub_u32 s29, s29, s26
s_waitcnt lgkmcnt(14)
ds_read_b64_tr_b16 v[82:83], v13 offset:38912
v_mfma_f32_16x16x32_bf16 v[216:219], v[92:95], v[56:59], 0
s_waitcnt lgkmcnt(14)
ds_read_b64_tr_b16 v[88:89], v13 offset:49152
v_mfma_f32_16x16x32_bf16 v[216:219], v[84:87], v[40:43], v[216:219]
s_setprio 0
s_waitcnt lgkmcnt(14)
ds_read_b64_tr_b16 v[90:91], v13 offset:55296
L_k1_loop_z3:
v_mfma_f32_16x16x32_bf16 v[128:131], v[224:227], v[32:35], v[128:131]
s_setprio 1
s_waitcnt lgkmcnt(14)
ds_read_b64_tr_b16 v[84:85], v13 offset:33024
v_mfma_f32_16x16x32_bf16 v[128:131], v[232:235], v[48:51], v[128:131]
s_waitcnt lgkmcnt(14)
ds_read_b64_tr_b16 v[86:87], v13 offset:39168
v_mfma_f32_16x16x32_bf16 v[132:135], v[232:235], v[52:55], v[132:135]
s_waitcnt lgkmcnt(14)
ds_read_b64_tr_b16 v[92:93], v13 offset:49408
v_mfma_f32_16x16x32_bf16 v[132:135], v[224:227], v[36:39], v[132:135]
s_waitcnt lgkmcnt(14)
ds_read_b64_tr_b16 v[94:95], v13 offset:55552
v_mfma_f32_16x16x32_bf16 v[148:151], v[228:231], v[36:39], v[148:151]
s_waitcnt lgkmcnt(14)
ds_read_b128 v[40:43], v9 offset:4096
v_mfma_f32_16x16x32_bf16 v[148:151], v[236:239], v[52:55], v[148:151]
s_waitcnt lgkmcnt(14)
ds_read_b128 v[56:59], v10 offset:4096
v_mfma_f32_16x16x32_bf16 v[144:147], v[236:239], v[48:51], v[144:147]
s_waitcnt lgkmcnt(14)
ds_read_b128 v[44:47], v9 offset:6144
v_mfma_f32_16x16x32_bf16 v[144:147], v[228:231], v[32:35], v[144:147]
s_waitcnt lgkmcnt(14)
ds_read_b128 v[60:63], v10 offset:6144
v_add_u32 v9, s59, v9
v_add_u32 v10, s59, v10
s_add_u32 s40, s40, 1
s_cmp_eq_u32 s40, 3
s_cselect_b32 s40, 0, s40
s_cmp_eq_u32 s40, 2
s_cselect_b32 s59, 0xffff0000, s57
v_smfmac_f32_16x16x64_bf16 v[100:103], v[96:99], v[224:231], v15
v_mfma_f32_16x16x32_bf16 v[160:163], v[64:67], v[32:35], v[160:163]
v_mfma_f32_16x16x32_bf16 v[160:163], v[72:75], v[48:51], v[160:163]
v_mfma_f32_16x16x32_bf16 v[164:167], v[72:75], v[52:55], v[164:167]
v_mfma_f32_16x16x32_bf16 v[164:167], v[64:67], v[36:39], v[164:167]
s_setprio 0
s_waitcnt lgkmcnt(14)
v_mfma_f32_16x16x32_bf16 v[180:183], v[68:71], v[36:39], v[180:183]
s_setprio 1
s_waitcnt lgkmcnt(12)
v_mfma_f32_16x16x32_bf16 v[180:183], v[76:79], v[52:55], v[180:183]
s_waitcnt lgkmcnt(0)
s_barrier
s_add_u32 m0, s28, 32768
v_mfma_f32_16x16x32_bf16 v[176:179], v[76:79], v[48:51], v[176:179]
buffer_load_dwordx4 v1, s[8:11], s20 offen offset:0 lds
v_mfma_f32_16x16x32_bf16 v[176:179], v[68:71], v[32:35], v[176:179]
v_smfmac_f32_16x16x64_bf16 v[100:103], v[96:99], v[232:239], v15
v_mfma_f32_16x16x32_bf16 v[192:195], v[80:83], v[32:35], v[192:195]
v_mfma_f32_16x16x32_bf16 v[192:195], v[88:91], v[48:51], v[192:195]
v_mfma_f32_16x16x32_bf16 v[196:199], v[88:91], v[52:55], v[196:199]
v_mfma_f32_16x16x32_bf16 v[196:199], v[80:83], v[36:39], v[196:199]
v_mfma_f32_16x16x32_bf16 v[212:215], v[84:87], v[36:39], v[212:215]
buffer_load_dwordx4 v2, s[84:87], s88 offen offset:1024 lds
v_mfma_f32_16x16x32_bf16 v[212:215], v[92:95], v[52:55], v[212:215]
v_mfma_f32_16x16x32_bf16 v[208:211], v[92:95], v[48:51], v[208:211]
v_mfma_f32_16x16x32_bf16 v[208:211], v[84:87], v[32:35], v[208:211]
s_setprio 0
s_waitcnt vmcnt(6)
s_barrier
v_mfma_f32_16x16x32_bf16 v[136:139], v[224:227], v[40:43], v[136:139]
s_setprio 1
ds_read_b128 v[36:39], v9 offset:2048
v_mfma_f32_16x16x32_bf16 v[136:139], v[232:235], v[56:59], v[136:139]
ds_read_b128 v[52:55], v10 offset:2048
v_mfma_f32_16x16x32_bf16 v[140:143], v[232:235], v[60:63], v[140:143]
buffer_load_dwordx4 v3, s[84:87], s88 offen offset:2048 lds
s_add_u32 s20, s20, 393216
s_add_u32 s88, s88, s89
s_mov_b32 m0, s29
ds_read_b128 v[32:35], v9 offset:0
v_mfma_f32_16x16x32_bf16 v[140:143], v[224:227], v[44:47], v[140:143]
buffer_load_dwordx4 v5, s[12:15], s21 offen offset:0 lds
ds_read_b128 v[48:51], v10 offset:0
v_mfma_f32_16x16x32_bf16 v[156:159], v[228:231], v[44:47], v[156:159]
ds_read_b64_tr_b16 v[224:225], v11 offset:0
v_mfma_f32_16x16x32_bf16 v[156:159], v[236:239], v[60:63], v[156:159]
ds_read_b64_tr_b16 v[226:227], v11 offset:6144
v_mfma_f32_16x16x32_bf16 v[152:155], v[236:239], v[56:59], v[152:155]
ds_read_b64_tr_b16 v[232:233], v11 offset:16384
v_mfma_f32_16x16x32_bf16 v[152:155], v[228:231], v[40:43], v[152:155]
ds_read_b64_tr_b16 v[234:235], v11 offset:22528
v_mfma_f32_16x16x32_bf16 v[168:171], v[64:67], v[40:43], v[168:171]
ds_read_b64_tr_b16 v[228:229], v11 offset:256
v_mfma_f32_16x16x32_bf16 v[168:171], v[72:75], v[56:59], v[168:171]
buffer_load_dwordx4 v6, s[12:15], s21 offen offset:1024 lds
ds_read_b64_tr_b16 v[230:231], v11 offset:6400
v_mfma_f32_16x16x32_bf16 v[172:175], v[72:75], v[60:63], v[172:175]
ds_read_b64_tr_b16 v[236:237], v11 offset:16640
v_mfma_f32_16x16x32_bf16 v[172:175], v[64:67], v[44:47], v[172:175]
s_setprio 0
ds_read_b64_tr_b16 v[238:239], v11 offset:22784
v_mfma_f32_16x16x32_bf16 v[188:191], v[68:71], v[44:47], v[188:191]
s_setprio 1
ds_read_b64_tr_b16 v[64:65], v12 offset:0
v_mfma_f32_16x16x32_bf16 v[188:191], v[76:79], v[60:63], v[188:191]
ds_read_b64_tr_b16 v[66:67], v12 offset:6144
v_mfma_f32_16x16x32_bf16 v[184:187], v[76:79], v[56:59], v[184:187]
ds_read_b64_tr_b16 v[72:73], v12 offset:16384
v_mfma_f32_16x16x32_bf16 v[184:187], v[68:71], v[40:43], v[184:187]
buffer_load_dwordx4 v7, s[12:15], s21 offen offset:2048 lds
s_waitcnt lgkmcnt(14)
ds_read_b64_tr_b16 v[74:75], v12 offset:22528
v_mfma_f32_16x16x32_bf16 v[200:203], v[80:83], v[40:43], v[200:203]
s_waitcnt lgkmcnt(14)
ds_read_b64_tr_b16 v[68:69], v12 offset:256
v_mfma_f32_16x16x32_bf16 v[200:203], v[88:91], v[56:59], v[200:203]
s_waitcnt lgkmcnt(14)
ds_read_b64_tr_b16 v[70:71], v12 offset:6400
v_mfma_f32_16x16x32_bf16 v[204:207], v[88:91], v[60:63], v[204:207]
s_waitcnt lgkmcnt(14)
ds_read_b64_tr_b16 v[76:77], v12 offset:16640
v_mfma_f32_16x16x32_bf16 v[204:207], v[80:83], v[44:47], v[204:207]
s_waitcnt lgkmcnt(14)
ds_read_b64_tr_b16 v[78:79], v12 offset:22784
v_mfma_f32_16x16x32_bf16 v[220:223], v[84:87], v[44:47], v[220:223]
s_waitcnt lgkmcnt(14)
ds_read_b64_tr_b16 v[80:81], v13 offset:0
v_mfma_f32_16x16x32_bf16 v[220:223], v[92:95], v[60:63], v[220:223]
buffer_load_dwordx4 v8, s[12:15], s21 offen offset:3072 lds
s_add_u32 s21, s21, 128
s_add_u32 s29, s29, 32768
s_cmp_ge_u32 s29, 98304
s_cselect_b32 s26, 98304, 0
s_sub_u32 s29, s29, s26
s_waitcnt lgkmcnt(14)
ds_read_b64_tr_b16 v[82:83], v13 offset:6144
v_mfma_f32_16x16x32_bf16 v[216:219], v[92:95], v[56:59], v[216:219]
s_waitcnt lgkmcnt(14)
ds_read_b64_tr_b16 v[88:89], v13 offset:16384
v_mfma_f32_16x16x32_bf16 v[216:219], v[84:87], v[40:43], v[216:219]
s_setprio 0
s_waitcnt lgkmcnt(14)
ds_read_b64_tr_b16 v[90:91], v13 offset:22528
v_mfma_f32_16x16x32_bf16 v[128:131], v[224:227], v[32:35], v[128:131]
s_setprio 1
s_waitcnt lgkmcnt(14)
ds_read_b64_tr_b16 v[84:85], v13 offset:256
v_mfma_f32_16x16x32_bf16 v[128:131], v[232:235], v[48:51], v[128:131]
s_waitcnt lgkmcnt(14)
ds_read_b64_tr_b16 v[86:87], v13 offset:6400
v_mfma_f32_16x16x32_bf16 v[132:135], v[232:235], v[52:55], v[132:135]
s_waitcnt lgkmcnt(14)
ds_read_b64_tr_b16 v[92:93], v13 offset:16640
v_mfma_f32_16x16x32_bf16 v[132:135], v[224:227], v[36:39], v[132:135]
s_waitcnt lgkmcnt(14)
ds_read_b64_tr_b16 v[94:95], v13 offset:22784
v_mfma_f32_16x16x32_bf16 v[148:151], v[228:231], v[36:39], v[148:151]
s_waitcnt lgkmcnt(14)
ds_read_b128 v[40:43], v9 offset:4096
v_mfma_f32_16x16x32_bf16 v[148:151], v[236:239], v[52:55], v[148:151]
s_waitcnt lgkmcnt(14)
ds_read_b128 v[56:59], v10 offset:4096
v_mfma_f32_16x16x32_bf16 v[144:147], v[236:239], v[48:51], v[144:147]
s_waitcnt lgkmcnt(14)
ds_read_b128 v[44:47], v9 offset:6144
v_mfma_f32_16x16x32_bf16 v[144:147], v[228:231], v[32:35], v[144:147]
s_waitcnt lgkmcnt(14)
ds_read_b128 v[60:63], v10 offset:6144
v_add_u32 v9, s59, v9
v_add_u32 v10, s59, v10
s_add_u32 s40, s40, 1
s_cmp_eq_u32 s40, 3
s_cselect_b32 s40, 0, s40
s_cmp_eq_u32 s40, 2
s_cselect_b32 s59, 0xffff0000, s57
v_smfmac_f32_16x16x64_bf16 v[100:103], v[96:99], v[224:231], v15
v_mfma_f32_16x16x32_bf16 v[160:163], v[64:67], v[32:35], v[160:163]
v_mfma_f32_16x16x32_bf16 v[160:163], v[72:75], v[48:51], v[160:163]
v_mfma_f32_16x16x32_bf16 v[164:167], v[72:75], v[52:55], v[164:167]
v_mfma_f32_16x16x32_bf16 v[164:167], v[64:67], v[36:39], v[164:167]
s_setprio 0
s_waitcnt lgkmcnt(14)
v_mfma_f32_16x16x32_bf16 v[180:183], v[68:71], v[36:39], v[180:183]
s_setprio 1
s_waitcnt lgkmcnt(12)
v_mfma_f32_16x16x32_bf16 v[180:183], v[76:79], v[52:55], v[180:183]
s_waitcnt lgkmcnt(0)
s_barrier
s_add_u32 m0, s28, 0
v_mfma_f32_16x16x32_bf16 v[176:179], v[76:79], v[48:51], v[176:179]
buffer_load_dwordx4 v1, s[8:11], s20 offen offset:0 lds
v_mfma_f32_16x16x32_bf16 v[176:179], v[68:71], v[32:35], v[176:179]
v_smfmac_f32_16x16x64_bf16 v[100:103], v[96:99], v[232:239], v15
v_mfma_f32_16x16x32_bf16 v[192:195], v[80:83], v[32:35], v[192:195]
v_mfma_f32_16x16x32_bf16 v[192:195], v[88:91], v[48:51], v[192:195]
v_mfma_f32_16x16x32_bf16 v[196:199], v[88:91], v[52:55], v[196:199]
v_mfma_f32_16x16x32_bf16 v[196:199], v[80:83], v[36:39], v[196:199]
v_mfma_f32_16x16x32_bf16 v[212:215], v[84:87], v[36:39], v[212:215]
buffer_load_dwordx4 v2, s[84:87], s88 offen offset:1024 lds
v_mfma_f32_16x16x32_bf16 v[212:215], v[92:95], v[52:55], v[212:215]
v_mfma_f32_16x16x32_bf16 v[208:211], v[92:95], v[48:51], v[208:211]
v_mfma_f32_16x16x32_bf16 v[208:211], v[84:87], v[32:35], v[208:211]
s_setprio 0
s_waitcnt vmcnt(6)
s_barrier
v_mfma_f32_16x16x32_bf16 v[136:139], v[224:227], v[40:43], v[136:139]
s_setprio 1
ds_read_b128 v[36:39], v9 offset:2048
v_mfma_f32_16x16x32_bf16 v[136:139], v[232:235], v[56:59], v[136:139]
ds_read_b128 v[52:55], v10 offset:2048
v_mfma_f32_16x16x32_bf16 v[140:143], v[232:235], v[60:63], v[140:143]
buffer_load_dwordx4 v3, s[84:87], s88 offen offset:2048 lds
s_add_u32 s20, s20, 393216
s_add_u32 s88, s88, s89
s_mov_b32 m0, s29
ds_read_b128 v[32:35], v9 offset:0
v_mfma_f32_16x16x32_bf16 v[140:143], v[224:227], v[44:47], v[140:143]
buffer_load_dwordx4 v5, s[12:15], s21 offen offset:0 lds
ds_read_b128 v[48:51], v10 offset:0
v_mfma_f32_16x16x32_bf16 v[156:159], v[228:231], v[44:47], v[156:159]
ds_read_b64_tr_b16 v[224:225], v11 offset:32768
v_mfma_f32_16x16x32_bf16 v[156:159], v[236:239], v[60:63], v[156:159]
ds_read_b64_tr_b16 v[226:227], v11 offset:38912
v_mfma_f32_16x16x32_bf16 v[152:155], v[236:239], v[56:59], v[152:155]
ds_read_b64_tr_b16 v[232:233], v11 offset:49152
v_mfma_f32_16x16x32_bf16 v[152:155], v[228:231], v[40:43], v[152:155]
ds_read_b64_tr_b16 v[234:235], v11 offset:55296
v_mfma_f32_16x16x32_bf16 v[168:171], v[64:67], v[40:43], v[168:171]
ds_read_b64_tr_b16 v[228:229], v11 offset:33024
v_mfma_f32_16x16x32_bf16 v[168:171], v[72:75], v[56:59], v[168:171]
buffer_load_dwordx4 v6, s[12:15], s21 offen offset:1024 lds
ds_read_b64_tr_b16 v[230:231], v11 offset:39168
v_mfma_f32_16x16x32_bf16 v[172:175], v[72:75], v[60:63], v[172:175]
ds_read_b64_tr_b16 v[236:237], v11 offset:49408
v_mfma_f32_16x16x32_bf16 v[172:175], v[64:67], v[44:47], v[172:175]
s_setprio 0
ds_read_b64_tr_b16 v[238:239], v11 offset:55552
v_mfma_f32_16x16x32_bf16 v[188:191], v[68:71], v[44:47], v[188:191]
s_setprio 1
ds_read_b64_tr_b16 v[64:65], v12 offset:32768
v_mfma_f32_16x16x32_bf16 v[188:191], v[76:79], v[60:63], v[188:191]
ds_read_b64_tr_b16 v[66:67], v12 offset:38912
v_mfma_f32_16x16x32_bf16 v[184:187], v[76:79], v[56:59], v[184:187]
ds_read_b64_tr_b16 v[72:73], v12 offset:49152
v_mfma_f32_16x16x32_bf16 v[184:187], v[68:71], v[40:43], v[184:187]
buffer_load_dwordx4 v7, s[12:15], s21 offen offset:2048 lds
s_waitcnt lgkmcnt(14)
ds_read_b64_tr_b16 v[74:75], v12 offset:55296
v_mfma_f32_16x16x32_bf16 v[200:203], v[80:83], v[40:43], v[200:203]
s_waitcnt lgkmcnt(14)
ds_read_b64_tr_b16 v[68:69], v12 offset:33024
v_mfma_f32_16x16x32_bf16 v[200:203], v[88:91], v[56:59], v[200:203]
s_waitcnt lgkmcnt(14)
ds_read_b64_tr_b16 v[70:71], v12 offset:39168
v_mfma_f32_16x16x32_bf16 v[204:207], v[88:91], v[60:63], v[204:207]
s_waitcnt lgkmcnt(14)
ds_read_b64_tr_b16 v[76:77], v12 offset:49408
v_mfma_f32_16x16x32_bf16 v[204:207], v[80:83], v[44:47], v[204:207]
s_waitcnt lgkmcnt(14)
ds_read_b64_tr_b16 v[78:79], v12 offset:55552
v_mfma_f32_16x16x32_bf16 v[220:223], v[84:87], v[44:47], v[220:223]
s_waitcnt lgkmcnt(14)
ds_read_b64_tr_b16 v[80:81], v13 offset:32768
v_mfma_f32_16x16x32_bf16 v[220:223], v[92:95], v[60:63], v[220:223]
buffer_load_dwordx4 v8, s[12:15], s21 offen offset:3072 lds
s_add_u32 s21, s21, 128
s_add_u32 s29, s29, 32768
s_cmp_ge_u32 s29, 98304
s_cselect_b32 s26, 98304, 0
s_sub_u32 s29, s29, s26
s_waitcnt lgkmcnt(14)
ds_read_b64_tr_b16 v[82:83], v13 offset:38912
v_mfma_f32_16x16x32_bf16 v[216:219], v[92:95], v[56:59], v[216:219]
s_waitcnt lgkmcnt(14)
ds_read_b64_tr_b16 v[88:89], v13 offset:49152
v_mfma_f32_16x16x32_bf16 v[216:219], v[84:87], v[40:43], v[216:219]
s_setprio 0
s_waitcnt lgkmcnt(14)
ds_read_b64_tr_b16 v[90:91], v13 offset:55296
s_sub_u32 s22, s22, 1
s_cmp_lg_u32 s22, 0
s_cbranch_scc1 L_k1_loop_z3
v_mfma_f32_16x16x32_bf16 v[128:131], v[224:227], v[32:35], v[128:131]
s_setprio 1
s_waitcnt lgkmcnt(14)
ds_read_b64_tr_b16 v[84:85], v13 offset:33024
s_cmp_lg_u32 s25, 0
s_cbranch_scc1 L_k1_ak_z3
s_mov_b64 exec, 0xff
buffer_load_dword v28, v27, s[52:55], 0 offen sc1
s_mov_b64 exec, -1
L_k1_ak_z3:
v_mfma_f32_16x16x32_bf16 v[128:131], v[232:235], v[48:51], v[128:131]
s_waitcnt lgkmcnt(14)
ds_read_b64_tr_b16 v[86:87], v13 offset:39168
v_mfma_f32_16x16x32_bf16 v[132:135], v[232:235], v[52:55], v[132:135]
s_waitcnt lgkmcnt(14)
ds_read_b64_tr_b16 v[92:93], v13 offset:49408
v_mfma_f32_16x16x32_bf16 v[132:135], v[224:227], v[36:39], v[132:135]
s_waitcnt lgkmcnt(14)
ds_read_b64_tr_b16 v[94:95], v13 offset:55552
v_mfma_f32_16x16x32_bf16 v[148:151], v[228:231], v[36:39], v[148:151]
s_waitcnt lgkmcnt(14)
ds_read_b128 v[40:43], v9 offset:4096
v_mfma_f32_16x16x32_bf16 v[148:151], v[236:239], v[52:55], v[148:151]
s_waitcnt lgkmcnt(14)
ds_read_b128 v[56:59], v10 offset:4096
v_mfma_f32_16x16x32_bf16 v[144:147], v[236:239], v[48:51], v[144:147]
s_waitcnt lgkmcnt(14)
ds_read_b128 v[44:47], v9 offset:6144
v_mfma_f32_16x16x32_bf16 v[144:147], v[228:231], v[32:35], v[144:147]
s_waitcnt lgkmcnt(14)
ds_read_b128 v[60:63], v10 offset:6144
v_add_u32 v9, s59, v9
v_add_u32 v10, s59, v10
s_add_u32 s40, s40, 1
s_cmp_eq_u32 s40, 3
s_cselect_b32 s40, 0, s40
s_cmp_eq_u32 s40, 2
s_cselect_b32 s59, 0xffff0000, s57
v_smfmac_f32_16x16x64_bf16 v[100:103], v[96:99], v[224:231], v15
v_mfma_f32_16x16x32_bf16 v[160:163], v[64:67], v[32:35], v[160:163]
v_mfma_f32_16x16x32_bf16 v[160:163], v[72:75], v[48:51], v[160:163]
v_mfma_f32_16x16x32_bf16 v[164:167], v[72:75], v[52:55], v[164:167]
v_mfma_f32_16x16x32_bf16 v[164:167], v[64:67], v[36:39], v[164:167]
s_setprio 0
s_waitcnt lgkmcnt(14)
v_mfma_f32_16x16x32_bf16 v[180:183], v[68:71], v[36:39], v[180:183]
s_setprio 1
s_waitcnt lgkmcnt(12)
v_mfma_f32_16x16x32_bf16 v[180:183], v[76:79], v[52:55], v[180:183]
s_waitcnt lgkmcnt(0)
s_barrier
s_add_u32 m0, s28, 32768
v_mfma_f32_16x16x32_bf16 v[176:179], v[76:79], v[48:51], v[176:179]
buffer_load_dwordx4 v1, s[8:11], s20 offen offset:0 lds
v_mfma_f32_16x16x32_bf16 v[176:179], v[68:71], v[32:35], v[176:179]
v_smfmac_f32_16x16x64_bf16 v[100:103], v[96:99], v[232:239], v15
v_mfma_f32_16x16x32_bf16 v[192:195], v[80:83], v[32:35], v[192:195]
v_mfma_f32_16x16x32_bf16 v[192:195], v[88:91], v[48:51], v[192:195]
v_mfma_f32_16x16x32_bf16 v[196:199], v[88:91], v[52:55], v[196:199]
v_mfma_f32_16x16x32_bf16 v[196:199], v[80:83], v[36:39], v[196:199]
v_mfma_f32_16x16x32_bf16 v[212:215], v[84:87], v[36:39], v[212:215]
buffer_load_dwordx4 v2, s[84:87], s88 offen offset:1024 lds
v_mfma_f32_16x16x32_bf16 v[212:215], v[92:95], v[52:55], v[212:215]
v_mfma_f32_16x16x32_bf16 v[208:211], v[92:95], v[48:51], v[208:211]
v_mfma_f32_16x16x32_bf16 v[208:211], v[84:87], v[32:35], v[208:211]
s_setprio 0
s_waitcnt vmcnt(6)
s_barrier
v_mfma_f32_16x16x32_bf16 v[136:139], v[224:227], v[40:43], v[136:139]
s_setprio 1
ds_read_b128 v[36:39], v9 offset:2048
v_mfma_f32_16x16x32_bf16 v[136:139], v[232:235], v[56:59], v[136:139]
ds_read_b128 v[52:55], v10 offset:2048
v_mfma_f32_16x16x32_bf16 v[140:143], v[232:235], v[60:63], v[140:143]
buffer_load_dwordx4 v3, s[84:87], s88 offen offset:2048 lds
s_add_u32 s20, s20, 393216
s_add_u32 s88, s88, s89
ds_read_b128 v[32:35], v9 offset:0
v_mfma_f32_16x16x32_bf16 v[140:143], v[224:227], v[44:47], v[140:143]
ds_read_b128 v[48:51], v10 offset:0
v_mfma_f32_16x16x32_bf16 v[156:159], v[228:231], v[44:47], v[156:159]
ds_read_b64_tr_b16 v[224:225], v11 offset:0
v_mfma_f32_16x16x32_bf16 v[156:159], v[236:239], v[60:63], v[156:159]
ds_read_b64_tr_b16 v[226:227], v11 offset:6144
v_mfma_f32_16x16x32_bf16 v[152:155], v[236:239], v[56:59], v[152:155]
ds_read_b64_tr_b16 v[232:233], v11 offset:16384
v_mfma_f32_16x16x32_bf16 v[152:155], v[228:231], v[40:43], v[152:155]
ds_read_b64_tr_b16 v[234:235], v11 offset:22528
v_mfma_f32_16x16x32_bf16 v[168:171], v[64:67], v[40:43], v[168:171]
ds_read_b64_tr_b16 v[228:229], v11 offset:256
v_mfma_f32_16x16x32_bf16 v[168:171], v[72:75], v[56:59], v[168:171]
ds_read_b64_tr_b16 v[230:231], v11 offset:6400
v_mfma_f32_16x16x32_bf16 v[172:175], v[72:75], v[60:63], v[172:175]
ds_read_b64_tr_b16 v[236:237], v11 offset:16640
v_mfma_f32_16x16x32_bf16 v[172:175], v[64:67], v[44:47], v[172:175]
s_setprio 0
ds_read_b64_tr_b16 v[238:239], v11 offset:22784
v_mfma_f32_16x16x32_bf16 v[188:191], v[68:71], v[44:47], v[188:191]
s_setprio 1
ds_read_b64_tr_b16 v[64:65], v12 offset:0
v_mfma_f32_16x16x32_bf16 v[188:191], v[76:79], v[60:63], v[188:191]
ds_read_b64_tr_b16 v[66:67], v12 offset:6144
v_mfma_f32_16x16x32_bf16 v[184:187], v[76:79], v[56:59], v[184:187]
ds_read_b64_tr_b16 v[72:73], v12 offset:16384
v_mfma_f32_16x16x32_bf16 v[184:187], v[68:71], v[40:43], v[184:187]
s_waitcnt lgkmcnt(14)
ds_read_b64_tr_b16 v[74:75], v12 offset:22528
v_mfma_f32_16x16x32_bf16 v[200:203], v[80:83], v[40:43], v[200:203]
s_waitcnt lgkmcnt(14)
ds_read_b64_tr_b16 v[68:69], v12 offset:256
v_mfma_f32_16x16x32_bf16 v[200:203], v[88:91], v[56:59], v[200:203]
s_waitcnt lgkmcnt(14)
ds_read_b64_tr_b16 v[70:71], v12 offset:6400
v_mfma_f32_16x16x32_bf16 v[204:207], v[88:91], v[60:63], v[204:207]
s_waitcnt lgkmcnt(14)
ds_read_b64_tr_b16 v[76:77], v12 offset:16640
v_mfma_f32_16x16x32_bf16 v[204:207], v[80:83], v[44:47], v[204:207]
s_waitcnt lgkmcnt(14)
ds_read_b64_tr_b16 v[78:79], v12 offset:22784
v_mfma_f32_16x16x32_bf16 v[220:223], v[84:87], v[44:47], v[220:223]
s_waitcnt lgkmcnt(14)
ds_read_b64_tr_b16 v[80:81], v13 offset:0
v_mfma_f32_16x16x32_bf16 v[220:223], v[92:95], v[60:63], v[220:223]
s_waitcnt lgkmcnt(14)
ds_read_b64_tr_b16 v[82:83], v13 offset:6144
v_mfma_f32_16x16x32_bf16 v[216:219], v[92:95], v[56:59], v[216:219]
s_waitcnt lgkmcnt(14)
ds_read_b64_tr_b16 v[88:89], v13 offset:16384
v_mfma_f32_16x16x32_bf16 v[216:219], v[84:87], v[40:43], v[216:219]
s_setprio 0
s_waitcnt lgkmcnt(14)
ds_read_b64_tr_b16 v[90:91], v13 offset:22528
v_mfma_f32_16x16x32_bf16 v[128:131], v[224:227], v[32:35], v[128:131]
s_setprio 1
s_waitcnt lgkmcnt(14)
ds_read_b64_tr_b16 v[84:85], v13 offset:256
v_and_b32 v2, 31, v0
s_add_u32 s26, s35, s46
s_lshl_b32 s26, s26, 7
s_add_u32 s26, s26, 143360
v_mfma_f32_16x16x32_bf16 v[128:131], v[232:235], v[48:51], v[128:131]
s_waitcnt lgkmcnt(14)
ds_read_b64_tr_b16 v[86:87], v13 offset:6400
v_lshl_add_u32 v2, v2, 2, s26
v_lshrrev_b32 v3, 4, v0
v_mfma_f32_16x16x32_bf16 v[132:135], v[232:235], v[52:55], v[132:135]
s_waitcnt lgkmcnt(14)
ds_read_b64_tr_b16 v[92:93], v13 offset:16640
v_lshlrev_b32 v3, 4, v3
v_lshlrev_b32 v4, 4, v0
v_mfma_f32_16x16x32_bf16 v[132:135], v[224:227], v[36:39], v[132:135]
s_waitcnt lgkmcnt(14)
ds_read_b64_tr_b16 v[94:95], v13 offset:22784
v_mfma_f32_16x16x32_bf16 v[148:151], v[228:231], v[36:39], v[148:151]
s_waitcnt lgkmcnt(14)
ds_read_b128 v[40:43], v9 offset:4096
v_mfma_f32_16x16x32_bf16 v[148:151], v[236:239], v[52:55], v[148:151]
s_waitcnt lgkmcnt(14)
ds_read_b128 v[56:59], v10 offset:4096
v_mfma_f32_16x16x32_bf16 v[144:147], v[236:239], v[48:51], v[144:147]
s_waitcnt lgkmcnt(14)
ds_read_b128 v[44:47], v9 offset:6144
v_mov_b32 v6, 159744
v_mov_b32 v7, 0
v_mfma_f32_16x16x32_bf16 v[144:147], v[228:231], v[32:35], v[144:147]
s_waitcnt lgkmcnt(14)
ds_read_b128 v[60:63], v10 offset:6144
v_add_u32 v9, s59, v9
v_add_u32 v10, s59, v10
s_add_u32 s40, s40, 1
s_cmp_eq_u32 s40, 3
s_cselect_b32 s40, 0, s40
s_cmp_eq_u32 s40, 2
s_cselect_b32 s59, 0xffff0000, s57
v_smfmac_f32_16x16x64_bf16 v[100:103], v[96:99], v[224:231], v15
s_waitcnt lgkmcnt(14)
ds_write_b32 v6, v7
v_mfma_f32_16x16x32_bf16 v[160:163], v[64:67], v[32:35], v[160:163]
v_mfma_f32_16x16x32_bf16 v[160:163], v[72:75], v[48:51], v[160:163]
v_mfma_f32_16x16x32_bf16 v[164:167], v[72:75], v[52:55], v[164:167]
v_mfma_f32_16x16x32_bf16 v[164:167], v[64:67], v[36:39], v[164:167]
s_setprio 0
v_mfma_f32_16x16x32_bf16 v[180:183], v[68:71], v[36:39], v[180:183]
s_setprio 1
s_waitcnt lgkmcnt(13)
v_mfma_f32_16x16x32_bf16 v[180:183], v[76:79], v[52:55], v[180:183]
s_waitcnt lgkmcnt(0)
s_barrier
v_mfma_f32_16x16x32_bf16 v[176:179], v[76:79], v[48:51], v[176:179]
v_mfma_f32_16x16x32_bf16 v[176:179], v[68:71], v[32:35], v[176:179]
v_smfmac_f32_16x16x64_bf16 v[100:103], v[96:99], v[232:239], v15
v_mfma_f32_16x16x32_bf16 v[192:195], v[80:83], v[32:35], v[192:195]
v_mfma_f32_16x16x32_bf16 v[192:195], v[88:91], v[48:51], v[192:195]
v_mfma_f32_16x16x32_bf16 v[196:199], v[88:91], v[52:55], v[196:199]
v_mfma_f32_16x16x32_bf16 v[196:199], v[80:83], v[36:39], v[196:199]
v_mfma_f32_16x16x32_bf16 v[212:215], v[84:87], v[36:39], v[212:215]
v_bfe_u32 v1, v0, 3, 1
v_and_b32 v24, 7, v0
s_lshl_b32 s26, s23, 12
v_mfma_f32_16x16x32_bf16 v[212:215], v[92:95], v[52:55], v[212:215]
v_lshlrev_b32 v1, 7, v1
s_lshl_b32 s27, s42, 10
v_mfma_f32_16x16x32_bf16 v[208:211], v[92:95], v[48:51], v[208:211]
v_lshl_add_u32 v1, v24, 3, v1
s_add_u32 s43, s26, s27
v_mfma_f32_16x16x32_bf16 v[208:211], v[84:87], v[32:35], v[208:211]
s_setprio 0
s_waitcnt vmcnt(0)
s_cmp_lg_u32 s25, 0
s_cbranch_scc1 L_k1_ck_z3
s_mov_b32 s27, 0x40000
L_k1_chl_z3:
v_cmp_le_u32 vcc, 32, v28
s_nop 1
s_and_b32 s26, vcc_lo, 0xff
s_cmp_eq_u32 s26, 0xff
s_cbranch_scc1 L_k1_ck_z3
s_sleep 2
s_mov_b64 exec, 0xff
buffer_load_dword v28, v27, s[52:55], 0 offen sc1
s_mov_b64 exec, -1
s_waitcnt vmcnt(0)
s_sub_u32 s27, s27, 1
s_cmp_lg_u32 s27, 0
s_cbranch_scc1 L_k1_chl_z3
L_k1_ck_z3:
s_barrier
v_mfma_f32_16x16x32_bf16 v[136:139], v[224:227], v[40:43], v[136:139]
s_setprio 1
ds_read_b128 v[36:39], v9 offset:2048
buffer_load_dwordx2 v[16:17], v1, s[92:95], s43 offen offset:0 sc1
v_mfma_f32_16x16x32_bf16 v[136:139], v[232:235], v[56:59], v[136:139]
ds_read_b128 v[52:55], v10 offset:2048
buffer_load_dwordx2 v[18:19], v1, s[92:95], s43 offen offset:256 sc1
v_mfma_f32_16x16x32_bf16 v[140:143], v[232:235], v[60:63], v[140:143]
ds_read_b128 v[32:35], v9 offset:0
buffer_load_dwordx2 v[20:21], v1, s[92:95], s43 offen offset:512 sc1
v_mfma_f32_16x16x32_bf16 v[140:143], v[224:227], v[44:47], v[140:143]
ds_read_b128 v[48:51], v10 offset:0
buffer_load_dwordx2 v[22:23], v1, s[92:95], s43 offen offset:768 sc1
v_mfma_f32_16x16x32_bf16 v[156:159], v[228:231], v[44:47], v[156:159]
ds_read_b64_tr_b16 v[224:225], v11 offset:32768
v_mfma_f32_16x16x32_bf16 v[156:159], v[236:239], v[60:63], v[156:159]
ds_read_b64_tr_b16 v[226:227], v11 offset:38912
v_mfma_f32_16x16x32_bf16 v[152:155], v[236:239], v[56:59], v[152:155]
ds_read_b64_tr_b16 v[232:233], v11 offset:49152
v_mfma_f32_16x16x32_bf16 v[152:155], v[228:231], v[40:43], v[152:155]
ds_read_b64_tr_b16 v[234:235], v11 offset:55296
v_mfma_f32_16x16x32_bf16 v[168:171], v[64:67], v[40:43], v[168:171]
ds_read_b64_tr_b16 v[228:229], v11 offset:33024
v_mfma_f32_16x16x32_bf16 v[168:171], v[72:75], v[56:59], v[168:171]
ds_read_b64_tr_b16 v[230:231], v11 offset:39168
v_mfma_f32_16x16x32_bf16 v[172:175], v[72:75], v[60:63], v[172:175]
ds_read_b64_tr_b16 v[236:237], v11 offset:49408
v_mfma_f32_16x16x32_bf16 v[172:175], v[64:67], v[44:47], v[172:175]
s_setprio 0
ds_read_b64_tr_b16 v[238:239], v11 offset:55552
v_mfma_f32_16x16x32_bf16 v[188:191], v[68:71], v[44:47], v[188:191]
s_setprio 1
ds_read_b64_tr_b16 v[64:65], v12 offset:32768
v_mfma_f32_16x16x32_bf16 v[188:191], v[76:79], v[60:63], v[188:191]
ds_read_b64_tr_b16 v[66:67], v12 offset:38912
v_mfma_f32_16x16x32_bf16 v[184:187], v[76:79], v[56:59], v[184:187]
ds_read_b64_tr_b16 v[72:73], v12 offset:49152
v_mfma_f32_16x16x32_bf16 v[184:187], v[68:71], v[40:43], v[184:187]
s_waitcnt lgkmcnt(14)
ds_read_b64_tr_b16 v[74:75], v12 offset:55296
v_mfma_f32_16x16x32_bf16 v[200:203], v[80:83], v[40:43], v[200:203]
s_waitcnt lgkmcnt(14)
ds_read_b64_tr_b16 v[68:69], v12 offset:33024
v_mfma_f32_16x16x32_bf16 v[200:203], v[88:91], v[56:59], v[200:203]
s_waitcnt lgkmcnt(14)
ds_read_b64_tr_b16 v[70:71], v12 offset:39168
v_mfma_f32_16x16x32_bf16 v[204:207], v[88:91], v[60:63], v[204:207]
s_waitcnt lgkmcnt(14)
ds_read_b64_tr_b16 v[76:77], v12 offset:49408
v_mfma_f32_16x16x32_bf16 v[204:207], v[80:83], v[44:47], v[204:207]
s_waitcnt lgkmcnt(14)
ds_read_b64_tr_b16 v[78:79], v12 offset:55552
v_mfma_f32_16x16x32_bf16 v[220:223], v[84:87], v[44:47], v[220:223]
s_waitcnt lgkmcnt(14)
ds_read_b64_tr_b16 v[80:81], v13 offset:32768
v_mfma_f32_16x16x32_bf16 v[220:223], v[92:95], v[60:63], v[220:223]
s_waitcnt lgkmcnt(14)
ds_read_b64_tr_b16 v[82:83], v13 offset:38912
s_waitcnt lgkmcnt(12)
v_smfmac_f32_16x16x64_bf16 v[100:103], v[96:99], v[224:231], v15
v_mfma_f32_16x16x32_bf16 v[216:219], v[92:95], v[56:59], v[216:219]
ds_read_b64_tr_b16 v[88:89], v13 offset:49152
v_mfma_f32_16x16x32_bf16 v[216:219], v[84:87], v[40:43], v[216:219]
s_setprio 0
ds_read_b64_tr_b16 v[90:91], v13 offset:55296
s_waitcnt lgkmcnt(12)
v_smfmac_f32_16x16x64_bf16 v[100:103], v[96:99], v[232:239], v15
s_setprio 2
v_mfma_f32_16x16x32_bf16 v[128:131], v[224:227], v[32:35], v[128:131]
ds_read_b128 v[40:43], v9 offset:4096
v_mfma_f32_16x16x32_bf16 v[128:131], v[232:235], v[48:51], v[128:131]
ds_read_b128 v[56:59], v10 offset:4096
v_bfe_u32 v5, v0, 4, 1
v_mfma_f32_16x16x32_bf16 v[132:135], v[232:235], v[52:55], v[132:135]
ds_read_b128 v[44:47], v9 offset:6144
v_cmp_eq_u32 vcc, 0, v5
v_mfma_f32_16x16x32_bf16 v[132:135], v[224:227], v[36:39], v[132:135]
s_waitcnt lgkmcnt(14)
ds_read_b128 v[60:63], v10 offset:6144
v_mfma_f32_16x16x32_bf16 v[148:151], v[228:231], v[36:39], v[148:151]
v_add_f32 v100, v100, v101
v_add_f32 v102, v102, v103
v_mfma_f32_16x16x32_bf16 v[148:151], v[236:239], v[52:55], v[148:151]
v_cndmask_b32 v100, v102, v100, vcc
s_waitcnt lgkmcnt(14)
ds_write_b32 v2, v100
v_mfma_f32_16x16x32_bf16 v[144:147], v[236:239], v[48:51], v[144:147]
v_mfma_f32_16x16x32_bf16 v[144:147], v[228:231], v[32:35], v[144:147]
s_waitcnt lgkmcnt(0)
s_barrier
s_add_u32 s26, s46, 0
s_cmp_ge_u32 s26, 3
s_cselect_b32 s27, 3, 0
s_sub_u32 s26, s26, s27
s_lshl_b32 s26, s26, 7
s_add_u32 s26, s26, 143616
v_add_u32 v5, s26, v3
ds_read_b128 v[112:115], v5 offset:0
ds_read_b128 v[116:119], v5 offset:64
v_mfma_f32_16x16x32_bf16 v[152:155], v[228:231], v[40:43], v[152:155]
ds_read_b64_tr_b16 v[84:85], v13 offset:33024
v_mfma_f32_16x16x32_bf16 v[152:155], v[236:239], v[56:59], v[152:155]
ds_read_b64_tr_b16 v[86:87], v13 offset:39168
v_mfma_f32_16x16x32_bf16 v[156:159], v[236:239], v[60:63], v[156:159]
ds_read_b64_tr_b16 v[92:93], v13 offset:49408
v_mfma_f32_16x16x32_bf16 v[156:159], v[228:231], v[44:47], v[156:159]
ds_read_b64_tr_b16 v[94:95], v13 offset:55552
s_waitcnt vmcnt(0)
v_mfma_f32_16x16x32_bf16 v[140:143], v[224:227], v[44:47], v[140:143]
v_mul_f32 v96, 0xc0135761, v17
v_mul_f32 v98, 0xc0135761, v19
v_mul_f32 v100, 0xc0135761, v21
v_mul_f32 v102, 0xc0135761, v23
v_mul_f32 v120, v17, v17
v_mfma_f32_16x16x32_bf16 v[140:143], v[232:235], v[60:63], v[140:143]
v_mul_f32 v122, v19, v19
v_mul_f32 v124, v21, v21
v_mul_f32 v126, v23, v23
v_mov_b32 v24, v17
v_mov_b32 v25, v19
v_mfma_f32_16x16x32_bf16 v[136:139], v[232:235], v[56:59], v[136:139]
v_mov_b32 v26, v21
v_mov_b32 v27, v23
v_mul_f32 v120, v120, v96
v_mul_f32 v122, v122, v98
v_mul_f32 v124, v124, v100
v_mfma_f32_16x16x32_bf16 v[136:139], v[224:227], v[40:43], v[136:139]
v_mul_f32 v126, v126, v102
v_mul_f32 v120, 0x3d372713, v120
v_mul_f32 v122, 0x3d372713, v122
v_mul_f32 v124, 0x3d372713, v124
v_mul_f32 v126, 0x3d372713, v126
v_mfma_f32_16x16x32_bf16 v[160:163], v[64:67], v[32:35], v[160:163]
s_waitcnt lgkmcnt(5)
v_fmac_f32 v128, v112, v16
s_add_u32 s26, s46, 1
s_cmp_ge_u32 s26, 3
s_cselect_b32 s27, 3, 0
s_sub_u32 s26, s26, s27
s_lshl_b32 s26, s26, 7
s_add_u32 s26, s26, 143616
v_add_u32 v5, s26, v3
ds_read_b128 v[104:107], v5 offset:0
ds_read_b128 v[108:111], v5 offset:64
v_fmac_f32 v132, v112, v18
v_mfma_f32_16x16x32_bf16 v[160:163], v[72:75], v[48:51], v[160:163]
v_mul_f32 v240, v128, v128
v_fmac_f32 v136, v112, v20
v_mul_f32 v241, v132, v132
v_fma_f32 v240, v240, v120, v96
v_fmac_f32 v140, v112, v22
v_mul_f32 v242, v136, v136
v_fma_f32 v241, v241, v122, v98
v_mul_f32 v240, v240, v128
v_fmac_f32 v129, v113, v16
v_mul_f32 v243, v140, v140
v_mfma_f32_16x16x32_bf16 v[164:167], v[72:75], v[52:55], v[164:167]
v_exp_f32 v240, v240
v_fma_f32 v242, v242, v124, v100
v_mul_f32 v241, v241, v132
v_fmac_f32 v133, v113, v18
v_mul_f32 v244, v129, v129
v_exp_f32 v241, v241
v_fma_f32 v243, v243, v126, v102
v_mul_f32 v242, v242, v136
v_fmac_f32 v137, v113, v20
v_mul_f32 v245, v133, v133
v_mfma_f32_16x16x32_bf16 v[164:167], v[64:67], v[36:39], v[164:167]
v_exp_f32 v242, v242
v_fma_f32 v244, v244, v120, v96
v_mul_f32 v243, v243, v140
v_add_f32 v240, 1.0, v240
v_fmac_f32 v141, v113, v22
v_mul_f32 v246, v137, v137
v_exp_f32 v243, v243
v_fma_f32 v245, v245, v122, v98
v_mul_f32 v244, v244, v129
v_add_f32 v241, 1.0, v241
v_rcp_f32 v240, v240
v_mfma_f32_16x16x32_bf16 v[180:183], v[68:71], v[36:39], v[180:183]
v_fmac_f32 v130, v114, v16
v_mul_f32 v247, v141, v141
v_exp_f32 v244, v244
v_fma_f32 v246, v246, v124, v100
v_mul_f32 v245, v245, v133
v_add_f32 v242, 1.0, v242
v_rcp_f32 v241, v241
v_fmac_f32 v134, v114, v18
v_mul_f32 v248, v130, v130
v_exp_f32 v245, v245
v_mfma_f32_16x16x32_bf16 v[180:183], v[76:79], v[52:55], v[180:183]
v_fma_f32 v247, v247, v126, v102
v_mul_f32 v246, v246, v137
v_add_f32 v243, 1.0, v243
v_rcp_f32 v242, v242
v_mul_f32 v128, v128, v240
v_fmac_f32 v138, v114, v20
v_mul_f32 v249, v134, v134
v_exp_f32 v246, v246
v_fma_f32 v248, v248, v120, v96
v_mul_f32 v247, v247, v141
v_mfma_f32_16x16x32_bf16 v[176:179], v[76:79], v[48:51], v[176:179]
v_add_f32 v244, 1.0, v244
v_rcp_f32 v243, v243
v_mul_f32 v132, v132, v241
v_mov_b32 v224, v128
v_mul_f32 v232, v128, v128
v_fmac_f32 v142, v114, v22
v_mul_f32 v250, v138, v138
v_exp_f32 v247, v247
v_fma_f32 v249, v249, v122, v98
v_mul_f32 v248, v248, v130
v_mfma_f32_16x16x32_bf16 v[176:179], v[68:71], v[32:35], v[176:179]
v_add_f32 v245, 1.0, v245
v_rcp_f32 v244, v244
v_mul_f32 v136, v136, v242
v_mov_b32 v226, v132
v_mul_f32 v234, v132, v132
v_fmac_f32 v131, v115, v16
v_mul_f32 v251, v142, v142
v_exp_f32 v248, v248
v_fma_f32 v250, v250, v124, v100
v_mul_f32 v249, v249, v134
v_add_f32 v246, 1.0, v246
v_mfma_f32_16x16x32_bf16 v[184:187], v[68:71], v[40:43], v[184:187]
v_rcp_f32 v245, v245
v_mul_f32 v140, v140, v243
v_mov_b32 v228, v136
v_mul_f32 v236, v136, v136
v_fmac_f32 v135, v115, v18
v_mul_f32 v252, v131, v131
v_exp_f32 v249, v249
v_fma_f32 v251, v251, v126, v102
v_mul_f32 v250, v250, v138
v_add_f32 v247, 1.0, v247
v_mfma_f32_16x16x32_bf16 v[184:187], v[76:79], v[56:59], v[184:187]
v_rcp_f32 v246, v246
v_mul_f32 v129, v129, v244
v_mov_b32 v230, v140
v_mul_f32 v238, v140, v140
v_fmac_f32 v139, v115, v20
v_mul_f32 v253, v135, v135
v_exp_f32 v250, v250
v_fma_f32 v252, v252, v120, v96
v_mul_f32 v251, v251, v142
v_add_f32 v248, 1.0, v248
v_mfma_f32_16x16x32_bf16 v[188:191], v[76:79], v[60:63], v[188:191]
v_rcp_f32 v247, v247
v_mul_f32 v133, v133, v245
v_mov_b32 v225, v129
v_mul_f32 v233, v129, v129
v_fmac_f32 v143, v115, v22
v_mul_f32 v254, v139, v139
v_exp_f32 v251, v251
v_fma_f32 v253, v253, v122, v98
v_mul_f32 v252, v252, v131
v_add_f32 v249, 1.0, v249
v_rcp_f32 v248, v248
v_mfma_f32_16x16x32_bf16 v[188:191], v[68:71], v[44:47], v[188:191]
v_mul_f32 v137, v137, v246
v_mov_b32 v227, v133
v_mul_f32 v235, v133, v133
s_waitcnt lgkmcnt(6)
v_fmac_f32 v144, v116, v16
v_mul_f32 v255, v143, v143
v_exp_f32 v252, v252
v_fma_f32 v254, v254, v124, v100
v_mul_f32 v253, v253, v135
v_add_f32 v250, 1.0, v250
v_rcp_f32 v249, v249
v_mfma_f32_16x16x32_bf16 v[172:175], v[64:67], v[44:47], v[172:175]
v_mul_f32 v141, v141, v247
v_mov_b32 v229, v137
v_mul_f32 v237, v137, v137
v_fmac_f32 v148, v116, v18
v_mul_f32 v240, v144, v144
v_exp_f32 v253, v253
v_fma_f32 v255, v255, v126, v102
v_mul_f32 v254, v254, v139
v_add_f32 v251, 1.0, v251
v_rcp_f32 v250, v250
v_mfma_f32_16x16x32_bf16 v[172:175], v[72:75], v[60:63], v[172:175]
v_mul_f32 v130, v130, v248
v_mov_b32 v231, v141
v_mul_f32 v239, v141, v141
v_fmac_f32 v152, v116, v20
v_mul_f32 v241, v148, v148
v_exp_f32 v254, v254
v_fma_f32 v240, v240, v120, v96
v_mul_f32 v255, v255, v143
v_add_f32 v252, 1.0, v252
v_rcp_f32 v251, v251
v_mfma_f32_16x16x32_bf16 v[168:171], v[72:75], v[56:59], v[168:171]
v_mul_f32 v134, v134, v249
v_add_f32 v224, v224, v130
v_fmac_f32 v232, v130, v130
v_fmac_f32 v156, v116, v22
v_mul_f32 v242, v152, v152
v_exp_f32 v255, v255
v_fma_f32 v241, v241, v122, v98
v_mul_f32 v240, v240, v144
v_add_f32 v253, 1.0, v253
v_rcp_f32 v252, v252
v_mul_f32 v138, v138, v250
v_mfma_f32_16x16x32_bf16 v[168:171], v[64:67], v[40:43], v[168:171]
v_add_f32 v226, v226, v134
v_fmac_f32 v234, v134, v134
v_fmac_f32 v145, v117, v16
v_mul_f32 v243, v156, v156
v_exp_f32 v240, v240
v_fma_f32 v242, v242, v124, v100
v_mul_f32 v241, v241, v148
v_add_f32 v254, 1.0, v254
v_rcp_f32 v253, v253
v_mul_f32 v142, v142, v251
v_mfma_f32_16x16x32_bf16 v[192:195], v[80:83], v[32:35], v[192:195]
v_add_f32 v228, v228, v138
v_fmac_f32 v236, v138, v138
v_fmac_f32 v149, v117, v18
v_mul_f32 v244, v145, v145
v_exp_f32 v241, v241
v_fma_f32 v243, v243, v126, v102
v_mul_f32 v242, v242, v152
v_add_f32 v255, 1.0, v255
v_rcp_f32 v254, v254
v_mul_f32 v131, v131, v252
v_mfma_f32_16x16x32_bf16 v[192:195], v[88:91], v[48:51], v[192:195]
v_add_f32 v230, v230, v142
v_fmac_f32 v238, v142, v142
v_fmac_f32 v153, v117, v20
v_mul_f32 v245, v149, v149
v_exp_f32 v242, v242
v_fma_f32 v244, v244, v120, v96
v_mul_f32 v243, v243, v156
v_add_f32 v240, 1.0, v240
v_rcp_f32 v255, v255
v_mul_f32 v135, v135, v253
v_add_f32 v225, v225, v131
v_mfma_f32_16x16x32_bf16 v[196:199], v[88:91], v[52:55], v[196:199]
v_fmac_f32 v233, v131, v131
v_fmac_f32 v157, v117, v22
v_mul_f32 v246, v153, v153
v_exp_f32 v243, v243
v_fma_f32 v245, v245, v122, v98
v_mul_f32 v244, v244, v145
v_add_f32 v241, 1.0, v241
v_rcp_f32 v240, v240
v_mul_f32 v139, v139, v254
v_add_f32 v227, v227, v135
v_mfma_f32_16x16x32_bf16 v[196:199], v[80:83], v[36:39], v[196:199]
v_fmac_f32 v235, v135, v135
v_fmac_f32 v146, v118, v16
v_mul_f32 v247, v157, v157
v_exp_f32 v244, v244
v_fma_f32 v246, v246, v124, v100
v_mul_f32 v245, v245, v149
v_add_f32 v242, 1.0, v242
v_rcp_f32 v241, v241
v_mul_f32 v143, v143, v255
v_add_f32 v229, v229, v139
s_waitcnt lgkmcnt(4)
v_mfma_f32_16x16x32_bf16 v[212:215], v[84:87], v[36:39], v[212:215]
v_fmac_f32 v237, v139, v139
v_fmac_f32 v150, v118, v18
v_mul_f32 v248, v146, v146
v_exp_f32 v245, v245
v_fma_f32 v247, v247, v126, v102
v_mul_f32 v246, v246, v153
v_add_f32 v243, 1.0, v243
v_rcp_f32 v242, v242
v_mul_f32 v144, v144, v240
v_add_f32 v231, v231, v143
s_waitcnt lgkmcnt(2)
v_mfma_f32_16x16x32_bf16 v[212:215], v[92:95], v[52:55], v[212:215]
v_fmac_f32 v239, v143, v143
v_fmac_f32 v154, v118, v20
v_mul_f32 v249, v150, v150
v_exp_f32 v246, v246
v_fma_f32 v248, v248, v120, v96
v_mul_f32 v247, v247, v157
v_add_f32 v244, 1.0, v244
v_rcp_f32 v243, v243
v_mul_f32 v148, v148, v241
v_add_f32 v224, v224, v144
v_fmac_f32 v232, v144, v144
v_mfma_f32_16x16x32_bf16 v[208:211], v[92:95], v[48:51], v[208:211]
v_fmac_f32 v158, v118, v22
v_mul_f32 v250, v154, v154
v_exp_f32 v247, v247
v_fma_f32 v249, v249, v122, v98
v_mul_f32 v248, v248, v146
v_add_f32 v245, 1.0, v245
v_rcp_f32 v244, v244
v_mul_f32 v152, v152, v242
v_add_f32 v226, v226, v148
v_fmac_f32 v234, v148, v148
v_mfma_f32_16x16x32_bf16 v[208:211], v[84:87], v[32:35], v[208:211]
v_fmac_f32 v147, v119, v16
v_mul_f32 v251, v158, v158
v_exp_f32 v248, v248
v_fma_f32 v250, v250, v124, v100
v_mul_f32 v249, v249, v150
v_add_f32 v246, 1.0, v246
v_rcp_f32 v245, v245
v_mul_f32 v156, v156, v243
v_add_f32 v228, v228, v152
v_fmac_f32 v236, v152, v152
v_mfma_f32_16x16x32_bf16 v[216:219], v[84:87], v[40:43], v[216:219]
v_fmac_f32 v151, v119, v18
v_mul_f32 v252, v147, v147
v_exp_f32 v249, v249
v_fma_f32 v251, v251, v126, v102
v_mul_f32 v250, v250, v154
v_add_f32 v247, 1.0, v247
v_rcp_f32 v246, v246
v_mul_f32 v145, v145, v244
v_add_f32 v230, v230, v156
v_fmac_f32 v238, v156, v156
v_fmac_f32 v155, v119, v20
v_mfma_f32_16x16x32_bf16 v[216:219], v[92:95], v[56:59], v[216:219]
v_mul_f32 v253, v151, v151
v_exp_f32 v250, v250
v_fma_f32 v252, v252, v120, v96
v_mul_f32 v251, v251, v158
v_add_f32 v248, 1.0, v248
v_rcp_f32 v247, v247
v_mul_f32 v149, v149, v245
v_add_f32 v225, v225, v145
v_fmac_f32 v233, v145, v145
v_fmac_f32 v159, v119, v22
v_mfma_f32_16x16x32_bf16 v[220:223], v[92:95], v[60:63], v[220:223]
v_mul_f32 v254, v155, v155
v_exp_f32 v251, v251
v_fma_f32 v253, v253, v122, v98
v_mul_f32 v252, v252, v147
v_add_f32 v249, 1.0, v249
v_rcp_f32 v248, v248
v_mul_f32 v153, v153, v246
v_add_f32 v227, v227, v149
v_fmac_f32 v235, v149, v149
v_mul_f32 v255, v159, v159
v_mfma_f32_16x16x32_bf16 v[220:223], v[84:87], v[44:47], v[220:223]
v_exp_f32 v252, v252
v_fma_f32 v254, v254, v124, v100
v_mul_f32 v253, v253, v151
v_add_f32 v250, 1.0, v250
v_rcp_f32 v249, v249
v_mul_f32 v157, v157, v247
v_add_f32 v229, v229, v153
v_fmac_f32 v237, v153, v153
v_exp_f32 v253, v253
v_fma_f32 v255, v255, v126, v102
v_mfma_f32_16x16x32_bf16 v[204:207], v[80:83], v[44:47], v[204:207]
v_mul_f32 v254, v254, v155
v_add_f32 v251, 1.0, v251
v_rcp_f32 v250, v250
v_mul_f32 v146, v146, v248
v_add_f32 v231, v231, v157
v_fmac_f32 v239, v157, v157
v_exp_f32 v254, v254
v_mul_f32 v255, v255, v159
v_add_f32 v252, 1.0, v252
v_rcp_f32 v251, v251
v_mul_f32 v150, v150, v249
v_mfma_f32_16x16x32_bf16 v[204:207], v[88:91], v[60:63], v[204:207]
v_add_f32 v224, v224, v146
v_fmac_f32 v232, v146, v146
v_exp_f32 v255, v255
v_add_f32 v253, 1.0, v253
v_rcp_f32 v252, v252
v_mul_f32 v154, v154, v250
v_add_f32 v226, v226, v150
v_fmac_f32 v234, v150, v150
v_add_f32 v254, 1.0, v254
v_rcp_f32 v253, v253
v_mfma_f32_16x16x32_bf16 v[200:203], v[88:91], v[56:59], v[200:203]
v_mul_f32 v158, v158, v251
v_add_f32 v228, v228, v154
v_fmac_f32 v236, v154, v154
v_add_f32 v255, 1.0, v255
v_rcp_f32 v254, v254
v_mul_f32 v147, v147, v252
v_add_f32 v230, v230, v158
v_fmac_f32 v238, v158, v158
v_rcp_f32 v255, v255
v_mul_f32 v151, v151, v253
v_mfma_f32_16x16x32_bf16 v[200:203], v[80:83], v[40:43], v[200:203]
v_add_f32 v225, v225, v147
v_fmac_f32 v233, v147, v147
v_mul_f32 v155, v155, v254
v_add_f32 v227, v227, v151
v_fmac_f32 v235, v151, v151
v_mul_f32 v159, v159, v255
v_add_f32 v229, v229, v155
v_fmac_f32 v237, v155, v155
v_add_f32 v231, v231, v159
v_fmac_f32 v239, v159, v159
s_setprio 2
s_waitcnt lgkmcnt(1)
v_pk_fma_f32 v[160:161], v[104:105], v[16:17], v[160:161] op_sel_hi:[1,0,1]
s_add_u32 s26, s46, 2
s_cmp_ge_u32 s26, 3
s_cselect_b32 s27, 3, 0
s_sub_u32 s26, s26, s27
s_lshl_b32 s26, s26, 7
s_add_u32 s26, s26, 143616
v_add_u32 v5, s26, v3
ds_read_b128 v[112:115], v5 offset:0
ds_read_b128 v[116:119], v5 offset:64
v_pk_fma_f32 v[164:165], v[104:105], v[18:19], v[164:165] op_sel_hi:[1,0,1]
v_pk_mul_f32 v[240:241], v[160:161], v[160:161]
v_pk_fma_f32 v[168:169], v[104:105], v[20:21], v[168:169] op_sel_hi:[1,0,1]
v_pk_mul_f32 v[242:243], v[164:165], v[164:165]
v_pk_fma_f32 v[240:241], v[240:241], v[120:121], v[96:97] op_sel_hi:[1,0,0]
v_pk_fma_f32 v[172:173], v[104:105], v[22:23], v[172:173] op_sel_hi:[1,0,1]
v_pk_mul_f32 v[244:245], v[168:169], v[168:169]
v_pk_fma_f32 v[242:243], v[242:243], v[122:123], v[98:99] op_sel_hi:[1,0,0]
v_pk_mul_f32 v[240:241], v[240:241], v[160:161]
v_exp_f32 v240, v240
v_pk_fma_f32 v[162:163], v[106:107], v[16:17], v[162:163] op_sel_hi:[1,0,1]
v_pk_mul_f32 v[246:247], v[172:173], v[172:173]
v_exp_f32 v241, v241
v_pk_fma_f32 v[244:245], v[244:245], v[124:125], v[100:101] op_sel_hi:[1,0,0]
v_pk_mul_f32 v[242:243], v[242:243], v[164:165]
v_exp_f32 v242, v242
v_pk_fma_f32 v[166:167], v[106:107], v[18:19], v[166:167] op_sel_hi:[1,0,1]
v_pk_mul_f32 v[248:249], v[162:163], v[162:163]
v_exp_f32 v243, v243
v_pk_fma_f32 v[246:247], v[246:247], v[126:127], v[102:103] op_sel_hi:[1,0,0]
v_pk_mul_f32 v[244:245], v[244:245], v[168:169]
v_pk_add_f32 v[240:241], v[240:241], 1.0 op_sel_hi:[1,0]
v_exp_f32 v244, v244
v_pk_fma_f32 v[170:171], v[106:107], v[20:21], v[170:171] op_sel_hi:[1,0,1]
v_pk_mul_f32 v[250:251], v[166:167], v[166:167]
v_exp_f32 v245, v245
v_pk_fma_f32 v[248:249], v[248:249], v[120:121], v[96:97] op_sel_hi:[1,0,0]
v_pk_mul_f32 v[246:247], v[246:247], v[172:173]
v_rcp_f32 v240, v240
v_pk_add_f32 v[242:243], v[242:243], 1.0 op_sel_hi:[1,0]
v_rcp_f32 v241, v241
v_exp_f32 v246, v246
v_pk_fma_f32 v[174:175], v[106:107], v[22:23], v[174:175] op_sel_hi:[1,0,1]
v_pk_mul_f32 v[252:253], v[170:171], v[170:171]
v_exp_f32 v247, v247
v_pk_fma_f32 v[250:251], v[250:251], v[122:123], v[98:99] op_sel_hi:[1,0,0]
v_pk_mul_f32 v[248:249], v[248:249], v[162:163]
v_rcp_f32 v242, v242
v_pk_add_f32 v[244:245], v[244:245], 1.0 op_sel_hi:[1,0]
v_pk_mul_f32 v[160:161], v[160:161], v[240:241]
v_rcp_f32 v243, v243
v_exp_f32 v248, v248
s_waitcnt lgkmcnt(2)
v_pk_fma_f32 v[176:177], v[108:109], v[16:17], v[176:177] op_sel_hi:[1,0,1]
v_pk_mul_f32 v[254:255], v[174:175], v[174:175]
v_exp_f32 v249, v249
v_pk_fma_f32 v[252:253], v[252:253], v[124:125], v[100:101] op_sel_hi:[1,0,0]
v_pk_mul_f32 v[250:251], v[250:251], v[166:167]
v_rcp_f32 v244, v244
v_pk_add_f32 v[246:247], v[246:247], 1.0 op_sel_hi:[1,0]
v_pk_mul_f32 v[164:165], v[164:165], v[242:243]
v_rcp_f32 v245, v245
v_pk_add_f32 v[224:225], v[224:225], v[160:161]
v_pk_fma_f32 v[232:233], v[160:161], v[160:161], v[232:233]
v_exp_f32 v250, v250
v_pk_fma_f32 v[180:181], v[108:109], v[18:19], v[180:181] op_sel_hi:[1,0,1]
v_pk_mul_f32 v[240:241], v[176:177], v[176:177]
v_exp_f32 v251, v251
v_pk_fma_f32 v[254:255], v[254:255], v[126:127], v[102:103] op_sel_hi:[1,0,0]
v_pk_mul_f32 v[252:253], v[252:253], v[170:171]
v_rcp_f32 v246, v246
v_pk_add_f32 v[248:249], v[248:249], 1.0 op_sel_hi:[1,0]
v_pk_mul_f32 v[168:169], v[168:169], v[244:245]
v_rcp_f32 v247, v247
v_pk_add_f32 v[226:227], v[226:227], v[164:165]
v_pk_fma_f32 v[234:235], v[164:165], v[164:165], v[234:235]
v_exp_f32 v252, v252
v_pk_fma_f32 v[184:185], v[108:109], v[20:21], v[184:185] op_sel_hi:[1,0,1]
v_pk_mul_f32 v[242:243], v[180:181], v[180:181]
v_exp_f32 v253, v253
v_pk_fma_f32 v[240:241], v[240:241], v[120:121], v[96:97] op_sel_hi:[1,0,0]
v_pk_mul_f32 v[254:255], v[254:255], v[174:175]
v_rcp_f32 v248, v248
v_pk_add_f32 v[250:251], v[250:251], 1.0 op_sel_hi:[1,0]
v_pk_mul_f32 v[172:173], v[172:173], v[246:247]
v_rcp_f32 v249, v249
v_pk_add_f32 v[228:229], v[228:229], v[168:169]
v_pk_fma_f32 v[236:237], v[168:169], v[168:169], v[236:237]
v_exp_f32 v254, v254
v_pk_fma_f32 v[188:189], v[108:109], v[22:23], v[188:189] op_sel_hi:[1,0,1]
v_pk_mul_f32 v[244:245], v[184:185], v[184:185]
v_exp_f32 v255, v255
v_pk_fma_f32 v[242:243], v[242:243], v[122:123], v[98:99] op_sel_hi:[1,0,0]
v_pk_mul_f32 v[240:241], v[240:241], v[176:177]
v_rcp_f32 v250, v250
v_pk_add_f32 v[252:253], v[252:253], 1.0 op_sel_hi:[1,0]
v_pk_mul_f32 v[162:163], v[162:163], v[248:249]
v_rcp_f32 v251, v251
v_pk_add_f32 v[230:231], v[230:231], v[172:173]
v_pk_fma_f32 v[238:239], v[172:173], v[172:173], v[238:239]
v_exp_f32 v240, v240
v_pk_fma_f32 v[178:179], v[110:111], v[16:17], v[178:179] op_sel_hi:[1,0,1]
v_pk_mul_f32 v[246:247], v[188:189], v[188:189]
v_exp_f32 v241, v241
v_pk_fma_f32 v[244:245], v[244:245], v[124:125], v[100:101] op_sel_hi:[1,0,0]
v_pk_mul_f32 v[242:243], v[242:243], v[180:181]
v_rcp_f32 v252, v252
v_pk_add_f32 v[254:255], v[254:255], 1.0 op_sel_hi:[1,0]
v_pk_mul_f32 v[166:167], v[166:167], v[250:251]
v_rcp_f32 v253, v253
v_pk_add_f32 v[224:225], v[224:225], v[162:163]
v_pk_fma_f32 v[232:233], v[162:163], v[162:163], v[232:233]
v_exp_f32 v242, v242
v_pk_fma_f32 v[182:183], v[110:111], v[18:19], v[182:183] op_sel_hi:[1,0,1]
v_pk_mul_f32 v[248:249], v[178:179], v[178:179]
v_exp_f32 v243, v243
v_pk_fma_f32 v[246:247], v[246:247], v[126:127], v[102:103] op_sel_hi:[1,0,0]
v_pk_mul_f32 v[244:245], v[244:245], v[184:185]
v_rcp_f32 v254, v254
v_pk_add_f32 v[240:241], v[240:241], 1.0 op_sel_hi:[1,0]
v_pk_mul_f32 v[170:171], v[170:171], v[252:253]
v_rcp_f32 v255, v255
v_pk_add_f32 v[226:227], v[226:227], v[166:167]
v_pk_fma_f32 v[234:235], v[166:167], v[166:167], v[234:235]
v_exp_f32 v244, v244
v_pk_fma_f32 v[186:187], v[110:111], v[20:21], v[186:187] op_sel_hi:[1,0,1]
v_pk_mul_f32 v[250:251], v[182:183], v[182:183]
v_exp_f32 v245, v245
v_pk_fma_f32 v[248:249], v[248:249], v[120:121], v[96:97] op_sel_hi:[1,0,0]
v_pk_mul_f32 v[246:247], v[246:247], v[188:189]
v_rcp_f32 v240, v240
v_pk_add_f32 v[242:243], v[242:243], 1.0 op_sel_hi:[1,0]
v_pk_mul_f32 v[174:175], v[174:175], v[254:255]
v_rcp_f32 v241, v241
v_pk_add_f32 v[228:229], v[228:229], v[170:171]
v_pk_fma_f32 v[236:237], v[170:171], v[170:171], v[236:237]
v_exp_f32 v246, v246
v_pk_fma_f32 v[190:191], v[110:111], v[22:23], v[190:191] op_sel_hi:[1,0,1]
v_pk_mul_f32 v[252:253], v[186:187], v[186:187]
v_exp_f32 v247, v247
v_pk_fma_f32 v[250:251], v[250:251], v[122:123], v[98:99] op_sel_hi:[1,0,0]
v_pk_mul_f32 v[248:249], v[248:249], v[178:179]
v_rcp_f32 v242, v242
v_pk_add_f32 v[244:245], v[244:245], 1.0 op_sel_hi:[1,0]
v_pk_mul_f32 v[176:177], v[176:177], v[240:241]
v_rcp_f32 v243, v243
v_pk_add_f32 v[230:231], v[230:231], v[174:175]
v_pk_fma_f32 v[238:239], v[174:175], v[174:175], v[238:239]
v_exp_f32 v248, v248
s_waitcnt lgkmcnt(1)
v_pk_fma_f32 v[192:193], v[112:113], v[16:17], v[192:193] op_sel_hi:[1,0,1]
v_pk_mul_f32 v[254:255], v[190:191], v[190:191]
v_exp_f32 v249, v249
v_pk_fma_f32 v[252:253], v[252:253], v[124:125], v[100:101] op_sel_hi:[1,0,0]
v_pk_mul_f32 v[250:251], v[250:251], v[182:183]
v_rcp_f32 v244, v244
v_pk_add_f32 v[246:247], v[246:247], 1.0 op_sel_hi:[1,0]
v_pk_mul_f32 v[180:181], v[180:181], v[242:243]
v_rcp_f32 v245, v245
v_pk_add_f32 v[224:225], v[224:225], v[176:177]
v_pk_fma_f32 v[232:233], v[176:177], v[176:177], v[232:233]
v_exp_f32 v250, v250
v_pk_fma_f32 v[196:197], v[112:113], v[18:19], v[196:197] op_sel_hi:[1,0,1]
v_pk_mul_f32 v[240:241], v[192:193], v[192:193]
v_exp_f32 v251, v251
v_pk_fma_f32 v[254:255], v[254:255], v[126:127], v[102:103] op_sel_hi:[1,0,0]
v_pk_mul_f32 v[252:253], v[252:253], v[186:187]
v_rcp_f32 v246, v246
v_pk_add_f32 v[248:249], v[248:249], 1.0 op_sel_hi:[1,0]
v_pk_mul_f32 v[184:185], v[184:185], v[244:245]
v_rcp_f32 v247, v247
v_pk_add_f32 v[226:227], v[226:227], v[180:181]
v_pk_fma_f32 v[234:235], v[180:181], v[180:181], v[234:235]
v_exp_f32 v252, v252
v_pk_fma_f32 v[200:201], v[112:113], v[20:21], v[200:201] op_sel_hi:[1,0,1]
v_pk_mul_f32 v[242:243], v[196:197], v[196:197]
v_exp_f32 v253, v253
v_pk_fma_f32 v[240:241], v[240:241], v[120:121], v[96:97] op_sel_hi:[1,0,0]
v_pk_mul_f32 v[254:255], v[254:255], v[190:191]
v_rcp_f32 v248, v248
v_pk_add_f32 v[250:251], v[250:251], 1.0 op_sel_hi:[1,0]
v_pk_mul_f32 v[188:189], v[188:189], v[246:247]
v_rcp_f32 v249, v249
v_pk_add_f32 v[228:229], v[228:229], v[184:185]
v_pk_fma_f32 v[236:237], v[184:185], v[184:185], v[236:237]
v_exp_f32 v254, v254
v_pk_fma_f32 v[204:205], v[112:113], v[22:23], v[204:205] op_sel_hi:[1,0,1]
v_pk_mul_f32 v[244:245], v[200:201], v[200:201]
v_exp_f32 v255, v255
v_pk_fma_f32 v[242:243], v[242:243], v[122:123], v[98:99] op_sel_hi:[1,0,0]
v_pk_mul_f32 v[240:241], v[240:241], v[192:193]
v_rcp_f32 v250, v250
v_pk_add_f32 v[252:253], v[252:253], 1.0 op_sel_hi:[1,0]
v_pk_mul_f32 v[178:179], v[178:179], v[248:249]
v_rcp_f32 v251, v251
v_pk_add_f32 v[230:231], v[230:231], v[188:189]
v_pk_fma_f32 v[238:239], v[188:189], v[188:189], v[238:239]
v_exp_f32 v240, v240
v_pk_fma_f32 v[194:195], v[114:115], v[16:17], v[194:195] op_sel_hi:[1,0,1]
v_pk_mul_f32 v[246:247], v[204:205], v[204:205]
v_exp_f32 v241, v241
v_pk_fma_f32 v[244:245], v[244:245], v[124:125], v[100:101] op_sel_hi:[1,0,0]
v_pk_mul_f32 v[242:243], v[242:243], v[196:197]
v_rcp_f32 v252, v252
v_pk_add_f32 v[254:255], v[254:255], 1.0 op_sel_hi:[1,0]
v_pk_mul_f32 v[182:183], v[182:183], v[250:251]
v_rcp_f32 v253, v253
v_pk_add_f32 v[224:225], v[224:225], v[178:179]
v_pk_fma_f32 v[232:233], v[178:179], v[178:179], v[232:233]
v_exp_f32 v242, v242
v_pk_fma_f32 v[198:199], v[114:115], v[18:19], v[198:199] op_sel_hi:[1,0,1]
v_pk_mul_f32 v[248:249], v[194:195], v[194:195]
v_exp_f32 v243, v243
v_pk_fma_f32 v[246:247], v[246:247], v[126:127], v[102:103] op_sel_hi:[1,0,0]
v_pk_mul_f32 v[244:245], v[244:245], v[200:201]
v_rcp_f32 v254, v254
v_pk_add_f32 v[240:241], v[240:241], 1.0 op_sel_hi:[1,0]
v_pk_mul_f32 v[186:187], v[186:187], v[252:253]
v_rcp_f32 v255, v255
v_pk_add_f32 v[226:227], v[226:227], v[182:183]
v_pk_fma_f32 v[234:235], v[182:183], v[182:183], v[234:235]
v_exp_f32 v244, v244
v_pk_fma_f32 v[202:203], v[114:115], v[20:21], v[202:203] op_sel_hi:[1,0,1]
v_pk_mul_f32 v[250:251], v[198:199], v[198:199]
v_exp_f32 v245, v245
v_pk_fma_f32 v[248:249], v[248:249], v[120:121], v[96:97] op_sel_hi:[1,0,0]
v_pk_mul_f32 v[246:247], v[246:247], v[204:205]
v_rcp_f32 v240, v240
v_pk_add_f32 v[242:243], v[242:243], 1.0 op_sel_hi:[1,0]
v_pk_mul_f32 v[190:191], v[190:191], v[254:255]
v_rcp_f32 v241, v241
v_pk_add_f32 v[228:229], v[228:229], v[186:187]
v_pk_fma_f32 v[236:237], v[186:187], v[186:187], v[236:237]
v_exp_f32 v246, v246
v_pk_fma_f32 v[206:207], v[114:115], v[22:23], v[206:207] op_sel_hi:[1,0,1]
v_pk_mul_f32 v[252:253], v[202:203], v[202:203]
v_exp_f32 v247, v247
v_pk_fma_f32 v[250:251], v[250:251], v[122:123], v[98:99] op_sel_hi:[1,0,0]
v_pk_mul_f32 v[248:249], v[248:249], v[194:195]
v_rcp_f32 v242, v242
v_pk_add_f32 v[244:245], v[244:245], 1.0 op_sel_hi:[1,0]
v_pk_mul_f32 v[192:193], v[192:193], v[240:241]
v_rcp_f32 v243, v243
v_pk_add_f32 v[230:231], v[230:231], v[190:191]
v_pk_fma_f32 v[238:239], v[190:191], v[190:191], v[238:239]
v_exp_f32 v248, v248
s_waitcnt lgkmcnt(0)
v_pk_fma_f32 v[208:209], v[116:117], v[16:17], v[208:209] op_sel_hi:[1,0,1]
v_pk_mul_f32 v[254:255], v[206:207], v[206:207]
v_exp_f32 v249, v249
v_pk_fma_f32 v[252:253], v[252:253], v[124:125], v[100:101] op_sel_hi:[1,0,0]
v_pk_mul_f32 v[250:251], v[250:251], v[198:199]
v_rcp_f32 v244, v244
v_pk_add_f32 v[246:247], v[246:247], 1.0 op_sel_hi:[1,0]
v_pk_mul_f32 v[196:197], v[196:197], v[242:243]
v_rcp_f32 v245, v245
v_pk_add_f32 v[224:225], v[224:225], v[192:193]
v_pk_fma_f32 v[232:233], v[192:193], v[192:193], v[232:233]
v_exp_f32 v250, v250
v_pk_fma_f32 v[212:213], v[116:117], v[18:19], v[212:213] op_sel_hi:[1,0,1]
v_pk_mul_f32 v[240:241], v[208:209], v[208:209]
v_exp_f32 v251, v251
v_pk_fma_f32 v[254:255], v[254:255], v[126:127], v[102:103] op_sel_hi:[1,0,0]
v_pk_mul_f32 v[252:253], v[252:253], v[202:203]
v_rcp_f32 v246, v246
v_pk_add_f32 v[248:249], v[248:249], 1.0 op_sel_hi:[1,0]
v_pk_mul_f32 v[200:201], v[200:201], v[244:245]
v_rcp_f32 v247, v247
v_pk_add_f32 v[226:227], v[226:227], v[196:197]
v_pk_fma_f32 v[234:235], v[196:197], v[196:197], v[234:235]
v_exp_f32 v252, v252
v_pk_fma_f32 v[216:217], v[116:117], v[20:21], v[216:217] op_sel_hi:[1,0,1]
v_pk_mul_f32 v[242:243], v[212:213], v[212:213]
v_exp_f32 v253, v253
v_pk_fma_f32 v[240:241], v[240:241], v[120:121], v[96:97] op_sel_hi:[1,0,0]
v_pk_mul_f32 v[254:255], v[254:255], v[206:207]
v_rcp_f32 v248, v248
v_pk_add_f32 v[250:251], v[250:251], 1.0 op_sel_hi:[1,0]
v_pk_mul_f32 v[204:205], v[204:205], v[246:247]
v_rcp_f32 v249, v249
v_pk_add_f32 v[228:229], v[228:229], v[200:201]
v_pk_fma_f32 v[236:237], v[200:201], v[200:201], v[236:237]
v_exp_f32 v254, v254
v_pk_fma_f32 v[220:221], v[116:117], v[22:23], v[220:221] op_sel_hi:[1,0,1]
v_pk_mul_f32 v[244:245], v[216:217], v[216:217]
v_exp_f32 v255, v255
v_pk_fma_f32 v[242:243], v[242:243], v[122:123], v[98:99] op_sel_hi:[1,0,0]
v_pk_mul_f32 v[240:241], v[240:241], v[208:209]
v_rcp_f32 v250, v250
v_pk_add_f32 v[252:253], v[252:253], 1.0 op_sel_hi:[1,0]
v_pk_mul_f32 v[194:195], v[194:195], v[248:249]
v_rcp_f32 v251, v251
v_pk_add_f32 v[230:231], v[230:231], v[204:205]
v_pk_fma_f32 v[238:239], v[204:205], v[204:205], v[238:239]
v_exp_f32 v240, v240
v_pk_fma_f32 v[210:211], v[118:119], v[16:17], v[210:211] op_sel_hi:[1,0,1]
v_pk_mul_f32 v[246:247], v[220:221], v[220:221]
v_exp_f32 v241, v241
v_pk_fma_f32 v[244:245], v[244:245], v[124:125], v[100:101] op_sel_hi:[1,0,0]
v_pk_mul_f32 v[242:243], v[242:243], v[212:213]
v_rcp_f32 v252, v252
v_pk_add_f32 v[254:255], v[254:255], 1.0 op_sel_hi:[1,0]
v_pk_mul_f32 v[198:199], v[198:199], v[250:251]
v_rcp_f32 v253, v253
v_pk_add_f32 v[224:225], v[224:225], v[194:195]
v_pk_fma_f32 v[232:233], v[194:195], v[194:195], v[232:233]
v_exp_f32 v242, v242
v_pk_fma_f32 v[214:215], v[118:119], v[18:19], v[214:215] op_sel_hi:[1,0,1]
v_pk_mul_f32 v[248:249], v[210:211], v[210:211]
v_exp_f32 v243, v243
v_pk_fma_f32 v[246:247], v[246:247], v[126:127], v[102:103] op_sel_hi:[1,0,0]
v_pk_mul_f32 v[244:245], v[244:245], v[216:217]
v_rcp_f32 v254, v254
v_pk_add_f32 v[240:241], v[240:241], 1.0 op_sel_hi:[1,0]
v_pk_mul_f32 v[202:203], v[202:203], v[252:253]
v_rcp_f32 v255, v255
v_pk_add_f32 v[226:227], v[226:227], v[198:199]
v_pk_fma_f32 v[234:235], v[198:199], v[198:199], v[234:235]
v_exp_f32 v244, v244
v_pk_fma_f32 v[218:219], v[118:119], v[20:21], v[218:219] op_sel_hi:[1,0,1]
v_pk_mul_f32 v[250:251], v[214:215], v[214:215]
v_exp_f32 v245, v245
v_pk_fma_f32 v[248:249], v[248:249], v[120:121], v[96:97] op_sel_hi:[1,0,0]
v_pk_mul_f32 v[246:247], v[246:247], v[220:221]
v_rcp_f32 v240, v240
v_pk_add_f32 v[242:243], v[242:243], 1.0 op_sel_hi:[1,0]
v_pk_mul_f32 v[206:207], v[206:207], v[254:255]
v_rcp_f32 v241, v241
v_pk_add_f32 v[228:229], v[228:229], v[202:203]
v_pk_fma_f32 v[236:237], v[202:203], v[202:203], v[236:237]
v_exp_f32 v246, v246
v_pk_fma_f32 v[222:223], v[118:119], v[22:23], v[222:223] op_sel_hi:[1,0,1]
v_pk_mul_f32 v[252:253], v[218:219], v[218:219]
v_exp_f32 v247, v247
v_pk_fma_f32 v[250:251], v[250:251], v[122:123], v[98:99] op_sel_hi:[1,0,0]
v_pk_mul_f32 v[248:249], v[248:249], v[210:211]
v_rcp_f32 v242, v242
v_pk_add_f32 v[244:245], v[244:245], 1.0 op_sel_hi:[1,0]
v_pk_mul_f32 v[208:209], v[208:209], v[240:241]
v_rcp_f32 v243, v243
v_pk_add_f32 v[230:231], v[230:231], v[206:207]
v_pk_fma_f32 v[238:239], v[206:207], v[206:207], v[238:239]
v_exp_f32 v248, v248
v_pk_mul_f32 v[254:255], v[222:223], v[222:223]
v_exp_f32 v249, v249
v_pk_fma_f32 v[252:253], v[252:253], v[124:125], v[100:101] op_sel_hi:[1,0,0]
v_pk_mul_f32 v[250:251], v[250:251], v[214:215]
v_rcp_f32 v244, v244
v_pk_add_f32 v[246:247], v[246:247], 1.0 op_sel_hi:[1,0]
v_pk_mul_f32 v[212:213], v[212:213], v[242:243]
v_rcp_f32 v245, v245
v_pk_add_f32 v[224:225], v[224:225], v[208:209]
v_pk_fma_f32 v[232:233], v[208:209], v[208:209], v[232:233]
v_exp_f32 v250, v250
v_exp_f32 v251, v251
v_pk_fma_f32 v[254:255], v[254:255], v[126:127], v[102:103] op_sel_hi:[1,0,0]
v_pk_mul_f32 v[252:253], v[252:253], v[218:219]
v_rcp_f32 v246, v246
v_pk_add_f32 v[248:249], v[248:249], 1.0 op_sel_hi:[1,0]
v_pk_mul_f32 v[216:217], v[216:217], v[244:245]
v_rcp_f32 v247, v247
v_pk_add_f32 v[226:227], v[226:227], v[212:213]
v_pk_fma_f32 v[234:235], v[212:213], v[212:213], v[234:235]
v_exp_f32 v252, v252
v_exp_f32 v253, v253
v_pk_mul_f32 v[254:255], v[254:255], v[222:223]
v_rcp_f32 v248, v248
v_pk_add_f32 v[250:251], v[250:251], 1.0 op_sel_hi:[1,0]
v_pk_mul_f32 v[220:221], v[220:221], v[246:247]
v_rcp_f32 v249, v249
v_pk_add_f32 v[228:229], v[228:229], v[216:217]
v_pk_fma_f32 v[236:237], v[216:217], v[216:217], v[236:237]
v_exp_f32 v254, v254
v_exp_f32 v255, v255
v_rcp_f32 v250, v250
v_pk_add_f32 v[252:253], v[252:253], 1.0 op_sel_hi:[1,0]
v_pk_mul_f32 v[210:211], v[210:211], v[248:249]
v_rcp_f32 v251, v251
v_pk_add_f32 v[230:231], v[230:231], v[220:221]
v_pk_fma_f32 v[238:239], v[220:221], v[220:221], v[238:239]
v_rcp_f32 v252, v252
v_pk_add_f32 v[254:255], v[254:255], 1.0 op_sel_hi:[1,0]
v_pk_mul_f32 v[214:215], v[214:215], v[250:251]
v_rcp_f32 v253, v253
v_pk_add_f32 v[224:225], v[224:225], v[210:211]
v_pk_fma_f32 v[232:233], v[210:211], v[210:211], v[232:233]
v_rcp_f32 v254, v254
v_pk_mul_f32 v[218:219], v[218:219], v[252:253]
v_rcp_f32 v255, v255
v_pk_add_f32 v[226:227], v[226:227], v[214:215]
v_pk_fma_f32 v[234:235], v[214:215], v[214:215], v[234:235]
v_pk_mul_f32 v[222:223], v[222:223], v[254:255]
v_pk_add_f32 v[228:229], v[228:229], v[218:219]
v_pk_fma_f32 v[236:237], v[218:219], v[218:219], v[236:237]
v_pk_add_f32 v[230:231], v[230:231], v[222:223]
v_pk_fma_f32 v[238:239], v[222:223], v[222:223], v[238:239]
v_add_f32 v224, v224, v225
v_add_f32 v226, v226, v227
v_add_f32 v228, v228, v229
v_add_f32 v230, v230, v231
v_add_f32 v232, v232, v233
v_add_f32 v234, v234, v235
v_add_f32 v236, v236, v237
v_add_f32 v238, v238, v239
v_mul_f32 v224, v224, v24
v_mul_f32 v226, v226, v25
v_mul_f32 v228, v228, v26
v_mul_f32 v230, v230, v27
v_mul_f32 v232, v232, v24
v_mul_f32 v234, v234, v25
v_mul_f32 v236, v236, v26
v_mul_f32 v238, v238, v27
v_mul_f32 v232, v232, v24
v_mul_f32 v234, v234, v25
v_mul_f32 v236, v236, v26
v_mul_f32 v238, v238, v27
v_permlane16_swap_b32 v224, v226
v_permlane16_swap_b32 v228, v230
v_permlane16_swap_b32 v232, v234
v_permlane16_swap_b32 v236, v238
v_add_f32 v224, v224, v226
v_add_f32 v228, v228, v230
v_add_f32 v232, v232, v234
v_add_f32 v236, v236, v238
v_permlane32_swap_b32 v224, v228
s_nop 0
v_permlane32_swap_b32 v232, v236
v_add_f32 v28, v224, v228
v_add_f32 v29, v232, v236
v_lshlrev_b32 v5, 4, v0
v_min_f32 v29, 0x7f800000, v29
buffer_store_dwordx2 v[28:29], v5, s[16:19], s39 offen sc0 sc1
s_setprio 0
s_bfe_u32 s27, s2, 0x20003
s_lshr_b32 s34, s2, 5
v_lshlrev_b32 v11, 4, v0
s_add_u32 s34, s34, s2
s_and_b32 s34, s34, 7
s_and_b32 s26, s2, 7
s_lshl_b32 s33, s26, 2
s_add_u32 s33, s33, s27
s_lshl_b32 s30, s34, 14
s_lshl_b32 s27, s42, 12
s_add_u32 s30, s30, s27
s_and_b32 s26, s42, 1
s_lshl_b32 s40, s26, 10
s_lshl_b32 s41, s42, 10
s_add_u32 s41, s41, 131072
v_bfe_u32 v12, v0, 4, 1
v_lshlrev_b32 v12, 7, v12
s_cmp_ge_u32 s42, 2
s_cselect_b32 s26, -1, 0
v_and_b32 v12, s26, v12
v_xor_b32 v7, v11, v12
s_lshl_b32 s26, s33, 17
s_add_u32 s27, s26, 0x400000
s_lshr_b32 s35, s42, 1
s_add_u32 s35, s35, 1
s_lshl_b32 s35, s35, 22
s_add_u32 s35, s35, s27
s_add_u32 s12, s4, s27
s_addc_u32 s13, s5, 0
s_mov_b32 s14, 0x20000
s_mov_b32 s15, 0x20000
s_add_u32 s8, s4, s35
s_addc_u32 s9, s5, 0
s_mov_b32 s10, 0x20000
s_mov_b32 s11, 0x20000
v_lshl_add_u32 v12, v0, 5, s33
v_mul_u32_u24 v13, 43, v12
v_lshrrev_b32 v13, 10, v13
v_mul_u32_u24 v14, 24, v13
v_sub_u32 v12, v12, v14
v_or_b32 v14, 1, v12
v_cmp_gt_u32 vcc, 16, v12
v_subrev_u32 v12, 15, v12
v_mul_u32_u24 v12, 11, v12
v_lshrrev_b32 v12, 5, v12
v_lshlrev_b32 v12, 1, v12
v_cndmask_b32 v12, v12, v14, vcc
v_lshl_add_u32 v12, v13, 4, v12
s_and_b32 s26, s34, 3
v_lshl_add_u32 v12, v12, 2, s26
v_lshlrev_b32 v12, 7, v12
s_barrier
s_barrier
s_barrier
s_barrier
s_mov_b32 s47, 0x4000
L_t_zz3_l:
s_mov_b32 s26, s38
buffer_load_dwordx4 v[64:67], v5, s[16:19], s26 offen offset:0 sc1
buffer_load_dwordx4 v[68:71], v5, s[16:19], s26 offen offset:1024 sc1
buffer_load_dwordx4 v[72:75], v5, s[16:19], s26 offen offset:2048 sc1
buffer_load_dwordx4 v[76:79], v5, s[16:19], s26 offen offset:3072 sc1
s_add_u32 s26, s26, 4096
buffer_load_dwordx4 v[80:83], v5, s[16:19], s26 offen offset:0 sc1
buffer_load_dwordx4 v[84:87], v5, s[16:19], s26 offen offset:1024 sc1
buffer_load_dwordx4 v[88:91], v5, s[16:19], s26 offen offset:2048 sc1
buffer_load_dwordx4 v[92:95], v5, s[16:19], s26 offen offset:3072 sc1
s_add_u32 s26, s26, 4096
buffer_load_dwordx4 v[96:99], v5, s[16:19], s26 offen offset:0 sc1
buffer_load_dwordx4 v[100:103], v5, s[16:19], s26 offen offset:1024 sc1
L_t_zz3_w:
s_waitcnt vmcnt(5)
v_pk_add_f32 v[64:65], v[64:65], v[74:75]
v_pk_add_f32 v[66:67], v[66:67], v[76:77]
v_pk_add_f32 v[68:69], v[68:69], v[78:79]
v_pk_add_f32 v[70:71], v[70:71], v[80:81]
v_pk_add_f32 v[72:73], v[72:73], v[82:83]
s_waitcnt vmcnt(0)
v_pk_add_f32 v[84:85], v[84:85], v[94:95]
v_pk_add_f32 v[86:87], v[86:87], v[96:97]
v_pk_add_f32 v[88:89], v[88:89], v[98:99]
v_pk_add_f32 v[90:91], v[90:91], v[100:101]
v_pk_add_f32 v[92:93], v[92:93], v[102:103]
v_pk_add_f32 v[64:65], v[64:65], v[84:85]
v_pk_add_f32 v[66:67], v[66:67], v[86:87]
v_pk_add_f32 v[68:69], v[68:69], v[88:89]
v_pk_add_f32 v[70:71], v[70:71], v[90:91]
v_pk_add_f32 v[72:73], v[72:73], v[92:93]
v_pk_add_f32 v[64:65], v[64:65], v[66:67]
v_pk_add_f32 v[68:69], v[68:69], v[70:71]
v_pk_add_f32 v[64:65], v[64:65], v[72:73]
v_pk_add_f32 v[64:65], v[64:65], v[68:69]
s_nop 0
v_cmp_u_f32 vcc, v65, v65
s_sub_u32 s47, s47, 1
s_cbranch_scc1 L_t_zz3_g
s_cbranch_vccz L_t_zz3_g
s_sleep 2
s_branch L_t_zz3_l
L_t_zz3_g:
s_mov_b64 exec, 7
buffer_load_dword v9, v12, s[48:51], 0 offen sc1
s_mov_b64 exec, -1
v_mul_f32 v28, 0x3a124925, v64
v_mul_f32 v29, 0x3a124925, v65
v_fma_f32 v29, -v28, v28, v29
v_max_f32 v29, 0, v29
v_add_f32 v29, 0x3727c5ac, v29
v_rsq_f32 v16, v29
s_nop 0
v_mul_f32 v17, -v28, v16
v_mov_b32 v20, v16
v_mov_b32 v21, v17
s_nop 0
v_permlane32_swap_b32 v16, v20
v_permlane32_swap_b32 v17, v21
v_mov_b32 v18, v16
v_mov_b32 v19, v17
v_mov_b32 v22, v20
v_mov_b32 v23, v21
v_permlane16_swap_b32 v16, v18
v_permlane16_swap_b32 v17, v19
v_permlane16_swap_b32 v20, v22
v_permlane16_swap_b32 v21, v23
v_mov_b32 v40, v17
v_mov_b32 v42, v19
v_mov_b32 v44, v21
v_mov_b32 v46, v23
v_mul_f32 v16, v16, v24
v_mul_f32 v18, v18, v25
v_mul_f32 v20, v20, v26
v_mul_f32 v22, v22, v27
v_pk_fma_f32 v[128:129], v[128:129], v[16:17], v[40:41] op_sel_hi:[1,0,0]
v_pk_fma_f32 v[130:131], v[130:131], v[16:17], v[40:41] op_sel_hi:[1,0,0]
v_pk_fma_f32 v[132:133], v[132:133], v[18:19], v[42:43] op_sel_hi:[1,0,0]
v_pk_fma_f32 v[134:135], v[134:135], v[18:19], v[42:43] op_sel_hi:[1,0,0]
v_pk_fma_f32 v[136:137], v[136:137], v[20:21], v[44:45] op_sel_hi:[1,0,0]
v_pk_fma_f32 v[138:139], v[138:139], v[20:21], v[44:45] op_sel_hi:[1,0,0]
v_pk_fma_f32 v[140:141], v[140:141], v[22:23], v[46:47] op_sel_hi:[1,0,0]
v_pk_fma_f32 v[142:143], v[142:143], v[22:23], v[46:47] op_sel_hi:[1,0,0]
v_pk_fma_f32 v[144:145], v[144:145], v[16:17], v[40:41] op_sel_hi:[1,0,0]
v_pk_fma_f32 v[146:147], v[146:147], v[16:17], v[40:41] op_sel_hi:[1,0,0]
v_pk_fma_f32 v[148:149], v[148:149], v[18:19], v[42:43] op_sel_hi:[1,0,0]
v_pk_fma_f32 v[150:151], v[150:151], v[18:19], v[42:43] op_sel_hi:[1,0,0]
v_pk_fma_f32 v[152:153], v[152:153], v[20:21], v[44:45] op_sel_hi:[1,0,0]
v_pk_fma_f32 v[154:155], v[154:155], v[20:21], v[44:45] op_sel_hi:[1,0,0]
v_pk_fma_f32 v[156:157], v[156:157], v[22:23], v[46:47] op_sel_hi:[1,0,0]
v_pk_fma_f32 v[158:159], v[158:159], v[22:23], v[46:47] op_sel_hi:[1,0,0]
s_add_u32 s26, s46, 0
s_cmp_ge_u32 s26, 3
s_cselect_b32 s27, 3, 0
s_sub_u32 s26, s26, s27
s_lshl_b32 s26, s26, 17
s_add_u32 s27, s26, s31
v_cvt_pk_bf16_f32 v128, v128, v129
v_cvt_pk_bf16_f32 v129, v130, v131
v_cvt_pk_bf16_f32 v130, v144, v145
v_cvt_pk_bf16_f32 v131, v146, v147
buffer_store_dwordx4 v[128:131], v4, s[16:19], s27 offen offset:0 sc0 sc1
v_cvt_pk_bf16_f32 v132, v132, v133
v_cvt_pk_bf16_f32 v133, v134, v135
v_cvt_pk_bf16_f32 v134, v148, v149
v_cvt_pk_bf16_f32 v135, v150, v151
buffer_store_dwordx4 v[132:135], v4, s[16:19], s27 offen offset:1024 sc0 sc1
v_cvt_pk_bf16_f32 v136, v136, v137
v_cvt_pk_bf16_f32 v137, v138, v139
v_cvt_pk_bf16_f32 v138, v152, v153
v_cvt_pk_bf16_f32 v139, v154, v155
buffer_store_dwordx4 v[136:139], v4, s[16:19], s27 offen offset:2048 sc0 sc1
v_cvt_pk_bf16_f32 v140, v140, v141
v_cvt_pk_bf16_f32 v141, v142, v143
v_cvt_pk_bf16_f32 v142, v156, v157
v_cvt_pk_bf16_f32 v143, v158, v159
buffer_store_dwordx4 v[140:143], v4, s[16:19], s27 offen offset:3072 sc0 sc1
v_pk_fma_f32 v[160:161], v[160:161], v[16:17], v[40:41] op_sel_hi:[1,0,0]
v_pk_fma_f32 v[162:163], v[162:163], v[16:17], v[40:41] op_sel_hi:[1,0,0]
v_pk_fma_f32 v[164:165], v[164:165], v[18:19], v[42:43] op_sel_hi:[1,0,0]
v_pk_fma_f32 v[166:167], v[166:167], v[18:19], v[42:43] op_sel_hi:[1,0,0]
v_pk_fma_f32 v[168:169], v[168:169], v[20:21], v[44:45] op_sel_hi:[1,0,0]
v_pk_fma_f32 v[170:171], v[170:171], v[20:21], v[44:45] op_sel_hi:[1,0,0]
v_pk_fma_f32 v[172:173], v[172:173], v[22:23], v[46:47] op_sel_hi:[1,0,0]
v_pk_fma_f32 v[174:175], v[174:175], v[22:23], v[46:47] op_sel_hi:[1,0,0]
v_pk_fma_f32 v[176:177], v[176:177], v[16:17], v[40:41] op_sel_hi:[1,0,0]
v_pk_fma_f32 v[178:179], v[178:179], v[16:17], v[40:41] op_sel_hi:[1,0,0]
v_pk_fma_f32 v[180:181], v[180:181], v[18:19], v[42:43] op_sel_hi:[1,0,0]
v_pk_fma_f32 v[182:183], v[182:183], v[18:19], v[42:43] op_sel_hi:[1,0,0]
v_pk_fma_f32 v[184:185], v[184:185], v[20:21], v[44:45] op_sel_hi:[1,0,0]
v_pk_fma_f32 v[186:187], v[186:187], v[20:21], v[44:45] op_sel_hi:[1,0,0]
v_pk_fma_f32 v[188:189], v[188:189], v[22:23], v[46:47] op_sel_hi:[1,0,0]
v_pk_fma_f32 v[190:191], v[190:191], v[22:23], v[46:47] op_sel_hi:[1,0,0]
s_add_u32 s26, s46, 1
s_cmp_ge_u32 s26, 3
s_cselect_b32 s27, 3, 0
s_sub_u32 s26, s26, s27
s_lshl_b32 s26, s26, 17
s_add_u32 s27, s26, s31
v_cvt_pk_bf16_f32 v160, v160, v161
v_cvt_pk_bf16_f32 v161, v162, v163
v_cvt_pk_bf16_f32 v162, v176, v177
v_cvt_pk_bf16_f32 v163, v178, v179
buffer_store_dwordx4 v[160:163], v4, s[16:19], s27 offen offset:0 sc0 sc1
v_cvt_pk_bf16_f32 v164, v164, v165
v_cvt_pk_bf16_f32 v165, v166, v167
v_cvt_pk_bf16_f32 v166, v180, v181
v_cvt_pk_bf16_f32 v167, v182, v183
buffer_store_dwordx4 v[164:167], v4, s[16:19], s27 offen offset:1024 sc0 sc1
v_cvt_pk_bf16_f32 v168, v168, v169
v_cvt_pk_bf16_f32 v169, v170, v171
v_cvt_pk_bf16_f32 v170, v184, v185
v_cvt_pk_bf16_f32 v171, v186, v187
buffer_store_dwordx4 v[168:171], v4, s[16:19], s27 offen offset:2048 sc0 sc1
v_cvt_pk_bf16_f32 v172, v172, v173
v_cvt_pk_bf16_f32 v173, v174, v175
v_cvt_pk_bf16_f32 v174, v188, v189
v_cvt_pk_bf16_f32 v175, v190, v191
buffer_store_dwordx4 v[172:175], v4, s[16:19], s27 offen offset:3072 sc0 sc1
v_pk_fma_f32 v[192:193], v[192:193], v[16:17], v[40:41] op_sel_hi:[1,0,0]
v_pk_fma_f32 v[194:195], v[194:195], v[16:17], v[40:41] op_sel_hi:[1,0,0]
v_pk_fma_f32 v[196:197], v[196:197], v[18:19], v[42:43] op_sel_hi:[1,0,0]
v_pk_fma_f32 v[198:199], v[198:199], v[18:19], v[42:43] op_sel_hi:[1,0,0]
v_pk_fma_f32 v[200:201], v[200:201], v[20:21], v[44:45] op_sel_hi:[1,0,0]
v_pk_fma_f32 v[202:203], v[202:203], v[20:21], v[44:45] op_sel_hi:[1,0,0]
v_pk_fma_f32 v[204:205], v[204:205], v[22:23], v[46:47] op_sel_hi:[1,0,0]
v_pk_fma_f32 v[206:207], v[206:207], v[22:23], v[46:47] op_sel_hi:[1,0,0]
v_pk_fma_f32 v[208:209], v[208:209], v[16:17], v[40:41] op_sel_hi:[1,0,0]
v_pk_fma_f32 v[210:211], v[210:211], v[16:17], v[40:41] op_sel_hi:[1,0,0]
v_pk_fma_f32 v[212:213], v[212:213], v[18:19], v[42:43] op_sel_hi:[1,0,0]
v_pk_fma_f32 v[214:215], v[214:215], v[18:19], v[42:43] op_sel_hi:[1,0,0]
v_pk_fma_f32 v[216:217], v[216:217], v[20:21], v[44:45] op_sel_hi:[1,0,0]
v_pk_fma_f32 v[218:219], v[218:219], v[20:21], v[44:45] op_sel_hi:[1,0,0]
v_pk_fma_f32 v[220:221], v[220:221], v[22:23], v[46:47] op_sel_hi:[1,0,0]
v_pk_fma_f32 v[222:223], v[222:223], v[22:23], v[46:47] op_sel_hi:[1,0,0]
s_add_u32 s26, s46, 2
s_cmp_ge_u32 s26, 3
s_cselect_b32 s27, 3, 0
s_sub_u32 s26, s26, s27
s_lshl_b32 s26, s26, 17
s_add_u32 s27, s26, s31
v_cvt_pk_bf16_f32 v192, v192, v193
v_cvt_pk_bf16_f32 v193, v194, v195
v_cvt_pk_bf16_f32 v194, v208, v209
v_cvt_pk_bf16_f32 v195, v210, v211
buffer_store_dwordx4 v[192:195], v4, s[16:19], s27 offen offset:0 sc0 sc1
v_cvt_pk_bf16_f32 v196, v196, v197
v_cvt_pk_bf16_f32 v197, v198, v199
v_cvt_pk_bf16_f32 v198, v212, v213
v_cvt_pk_bf16_f32 v199, v214, v215
buffer_store_dwordx4 v[196:199], v4, s[16:19], s27 offen offset:1024 sc0 sc1
v_cvt_pk_bf16_f32 v200, v200, v201
v_cvt_pk_bf16_f32 v201, v202, v203
v_cvt_pk_bf16_f32 v202, v216, v217
v_cvt_pk_bf16_f32 v203, v218, v219
buffer_store_dwordx4 v[200:203], v4, s[16:19], s27 offen offset:2048 sc0 sc1
v_cvt_pk_bf16_f32 v204, v204, v205
v_cvt_pk_bf16_f32 v205, v206, v207
v_cvt_pk_bf16_f32 v206, v220, v221
v_cvt_pk_bf16_f32 v207, v222, v223
buffer_store_dwordx4 v[204:207], v4, s[16:19], s27 offen offset:3072 sc0 sc1
s_mov_b64 exec, 7
s_mov_b32 s47, 0x40000
s_waitcnt vmcnt(12)
s_branch L_t_wz3_k
L_t_wz3_l:
s_waitcnt vmcnt(0)
L_t_wz3_k:
v_cmp_le_u32 s[26:27], 8, v9
s_sub_u32 s47, s47, 1
s_nop 0
s_cmp_eq_u32 s26, 7
s_cbranch_scc1 L_t_wz3_g
s_sleep 1
buffer_load_dword v9, v12, s[48:51], 0 offen sc1
s_cmp_lg_u32 s47, 0
s_cbranch_scc1 L_t_wz3_l
L_t_wz3_g:
s_mov_b64 exec, -1
s_add_u32 m0, s41, 0
s_nop 0
buffer_load_dwordx4 v7, s[8:11], s40 offen lds
s_add_u32 s40, s40, 2048
buffer_load_dwordx4 v[240:243], v11, s[12:15], s30 offen offset:0
buffer_load_dwordx4 v[244:247], v11, s[12:15], s30 offen offset:1024
buffer_load_dwordx4 v[248:251], v11, s[12:15], s30 offen offset:2048
buffer_load_dwordx4 v[252:255], v11, s[12:15], s30 offen offset:3072
s_add_u32 m0, s41, 4096
s_nop 0
buffer_load_dwordx4 v7, s[8:11], s40 offen lds
s_add_u32 s40, s40, 2048
s_add_u32 m0, s41, 8192
s_nop 0
buffer_load_dwordx4 v7, s[8:11], s40 offen lds
s_add_u32 s40, s40, 2048
s_add_u32 m0, s41, 12288
s_nop 0
buffer_load_dwordx4 v7, s[8:11], s40 offen lds
s_add_u32 s40, s40, 2048
s_add_u32 m0, s41, 16384
s_nop 0
buffer_load_dwordx4 v7, s[8:11], s40 offen lds
s_add_u32 s40, s40, 2048
s_add_u32 m0, s41, 20480
s_nop 0
buffer_load_dwordx4 v7, s[8:11], s40 offen lds
s_add_u32 s40, s40, 2048
s_add_u32 m0, s41, 24576
s_nop 0
buffer_load_dwordx4 v7, s[8:11], s40 offen lds
s_add_u32 s40, s40, 2048
s_barrier
v_mov_b32 v13, 159744
v_mov_b32 v14, 1
v_lshlrev_b32 v15, 7, v0
s_mov_b64 exec, 1
s_waitcnt vmcnt(11)
ds_add_rtn_u32 v13, v13, v14
s_waitcnt lgkmcnt(0)
v_readfirstlane_b32 s26, v13
s_mov_b64 exec, 15
s_cmp_lg_u32 s26, 3
s_cbranch_scc1 L_t_pz3
buffer_atomic_add v14, v15, s[48:51], s74 offen sc1
L_t_pz3:
s_mov_b64 exec, -1
s_branch L_att
L_k1_z2:
s_lshl_b32 s26, s34, 17
s_add_u32 s31, s31, s26
s_add_u32 s31, s31, 0x2000000
s_mov_b32 s35, 2
v_and_b32 v24, 15, v0
v_lshrrev_b32 v25, 4, v0
v_bfe_u32 v26, v0, 1, 3
s_lshl_b32 s26, s42, 13
s_add_u32 s26, s26, 65536
v_lshlrev_b32 v24, 7, v24
v_add_u32 v24, s26, v24
v_xor_b32 v27, v25, v26
v_lshl_add_u32 v9, v27, 4, v24
v_xor_b32 v10, 64, v9
v_lshrrev_b32 v24, 5, v0
v_mul_u32_u24 v24, 3072, v24
v_and_b32 v25, 31, v0
v_lshl_add_u32 v24, v25, 3, v24
s_cmp_ge_u32 s42, 2
s_cselect_b32 s27, 2, 0
s_sub_u32 s46, s42, s27
s_add_u32 s26, s46, 0
s_cmp_ge_u32 s26, 2
s_cselect_b32 s27, 2, 0
s_sub_u32 s26, s26, s27
s_lshl_b32 s26, s26, 9
s_add_u32 s26, s26, 99328
v_add_u32 v11, s26, v24
s_add_u32 s26, s46, 1
s_cmp_ge_u32 s26, 2
s_cselect_b32 s27, 2, 0
s_sub_u32 s26, s26, s27
s_lshl_b32 s26, s26, 9
s_add_u32 s26, s26, 99328
v_add_u32 v12, s26, v24
v_bfe_u32 v24, v0, 1, 1
v_lshrrev_b32 v25, 5, v0
v_cmp_eq_u32 vcc, v24, v25
v_mov_b32 v24, 0x3f803f80
s_nop 0
v_cndmask_b32 v96, 0, v24, vcc
v_mov_b32 v97, v96
v_mov_b32 v98, v96
v_mov_b32 v99, v96
v_and_b32 v24, 1, v0
v_mul_u32_u24 v24, 0xaaaa, v24
v_add_u32 v15, 0x4444, v24
v_mov_b32 v100, 0
v_mov_b32 v101, 0
v_mov_b32 v102, 0
v_mov_b32 v103, 0
s_waitcnt vmcnt(7)
s_mov_b32 m0, s29
s_nop 0
buffer_load_dwordx4 v5, s[12:15], s21 offen offset:0 lds
v_lshlrev_b32 v144, 16, v128
v_and_b32 v145, 0xffff0000, v128
v_lshlrev_b32 v146, 16, v129
v_and_b32 v147, 0xffff0000, v129
v_lshlrev_b32 v148, 16, v130
v_and_b32 v149, 0xffff0000, v130
v_lshlrev_b32 v150, 16, v131
v_and_b32 v151, 0xffff0000, v131
v_lshlrev_b32 v152, 16, v132
buffer_load_dwordx4 v6, s[12:15], s21 offen offset:1024 lds
v_and_b32 v153, 0xffff0000, v132
v_lshlrev_b32 v154, 16, v133
v_and_b32 v155, 0xffff0000, v133
v_lshlrev_b32 v156, 16, v134
v_and_b32 v157, 0xffff0000, v134
v_lshlrev_b32 v158, 16, v135
v_and_b32 v159, 0xffff0000, v135
v_pk_add_f32 v[128:129], v[144:145], v[152:153]
v_pk_add_f32 v[130:131], v[146:147], v[154:155]
v_pk_add_f32 v[132:133], v[148:149], v[156:157]
buffer_load_dwordx4 v7, s[12:15], s21 offen offset:2048 lds
v_pk_add_f32 v[134:135], v[150:151], v[158:159]
v_pk_add_f32 v[128:129], v[128:129], v[130:131]
v_pk_add_f32 v[132:133], v[132:133], v[134:135]
v_pk_add_f32 v[128:129], v[128:129], v[132:133]
v_add_f32 v128, v128, v129
s_nop 1
v_add_f32_dpp v128, v128, v128 quad_perm:[1,0,3,2] row_mask:0xf bank_mask:0xf
s_nop 1
v_add_f32_dpp v128, v128, v128 quad_perm:[2,3,0,1] row_mask:0xf bank_mask:0xf
s_nop 1
v_add_f32_dpp v128, v128, v128 row_half_mirror row_mask:0xf bank_mask:0xf
s_nop 1
v_add_f32_dpp v128, v128, v128 row_mirror row_mask:0xf bank_mask:0xf
v_mov_b32 v129, v128
buffer_load_dwordx4 v8, s[12:15], s21 offen offset:3072 lds
s_add_u32 s21, s21, 128
s_add_u32 s29, s29, 32768
s_cmp_ge_u32 s29, 98304
s_cselect_b32 s26, 98304, 0
s_sub_u32 s29, s29, s26
v_permlane16_swap_b32 v128, v129
v_add_f32 v128, v128, v129
v_mov_b32 v129, v128
s_nop 1
v_permlane32_swap_b32 v128, v129
v_add_f32 v128, v128, v129
v_mul_f32 v16, 0xba800000, v128
v_pk_add_f32 v[144:145], v[144:145], v[16:17] op_sel_hi:[1,0]
v_pk_add_f32 v[146:147], v[146:147], v[16:17] op_sel_hi:[1,0]
v_pk_add_f32 v[148:149], v[148:149], v[16:17] op_sel_hi:[1,0]
v_pk_add_f32 v[150:151], v[150:151], v[16:17] op_sel_hi:[1,0]
s_add_u32 m0, s28, 32768
s_nop 0
buffer_load_dwordx4 v1, s[8:11], s20 offen offset:0 lds
v_pk_add_f32 v[152:153], v[152:153], v[16:17] op_sel_hi:[1,0]
v_pk_add_f32 v[154:155], v[154:155], v[16:17] op_sel_hi:[1,0]
v_pk_add_f32 v[156:157], v[156:157], v[16:17] op_sel_hi:[1,0]
v_pk_add_f32 v[158:159], v[158:159], v[16:17] op_sel_hi:[1,0]
v_pk_mul_f32 v[128:129], v[144:145], v[144:145]
v_pk_mul_f32 v[130:131], v[146:147], v[146:147]
v_pk_mul_f32 v[132:133], v[148:149], v[148:149]
v_pk_mul_f32 v[134:135], v[150:151], v[150:151]
v_pk_fma_f32 v[128:129], v[152:153], v[152:153], v[128:129]
v_pk_fma_f32 v[130:131], v[154:155], v[154:155], v[130:131]
buffer_load_dwordx4 v2, s[84:87], s88 offen offset:1024 lds
v_pk_fma_f32 v[132:133], v[156:157], v[156:157], v[132:133]
v_pk_fma_f32 v[134:135], v[158:159], v[158:159], v[134:135]
v_pk_add_f32 v[128:129], v[128:129], v[130:131]
v_pk_add_f32 v[132:133], v[132:133], v[134:135]
v_pk_add_f32 v[128:129], v[128:129], v[132:133]
v_add_f32 v128, v128, v129
s_nop 1
v_add_f32_dpp v128, v128, v128 quad_perm:[1,0,3,2] row_mask:0xf bank_mask:0xf
s_nop 1
v_add_f32_dpp v128, v128, v128 quad_perm:[2,3,0,1] row_mask:0xf bank_mask:0xf
s_nop 1
v_add_f32_dpp v128, v128, v128 row_half_mirror row_mask:0xf bank_mask:0xf
s_nop 1
v_add_f32_dpp v128, v128, v128 row_mirror row_mask:0xf bank_mask:0xf
buffer_load_dwordx4 v3, s[84:87], s88 offen offset:2048 lds
s_add_u32 s20, s20, 393216
s_add_u32 s88, s88, s89
v_mov_b32 v129, v128
s_nop 1
v_permlane16_swap_b32 v128, v129
v_add_f32 v128, v128, v129
v_mov_b32 v129, v128
s_nop 1
v_permlane32_swap_b32 v128, v129
v_add_f32 v128, v128, v129
v_mov_b32 v129, 0x3727c5ac
v_fmac_f32 v129, 0x3a800000, v128
v_rsq_f32 v17, v129
s_nop 0
buffer_store_dwordx2 v[16:17], v30, s[92:95], 0 offen sc0 sc1
buffer_store_dword v31, v29, s[48:51], 0 offen sc0 sc1
s_mul_i32 s26, s23, 40960
s_mul_i32 s27, s42, 10240
s_add_u32 s38, s26, s27
s_add_u32 s38, s38, 0x100000
s_mul_i32 s26, s32, 5
s_add_u32 s26, s26, s33
s_and_b32 s27, s26, 1
s_lshr_b32 s26, s26, 1
s_lshl_b32 s26, s26, 10
s_lshl_b32 s27, s27, 3
s_add_u32 s39, s26, s38
s_add_u32 s39, s39, s27
v_lshlrev_b32 v24, 4, v0
v_mov_b32 v26, -1
v_mov_b32 v27, -1
buffer_store_dwordx2 v[26:27], v24, s[16:19], s39 offen sc0 sc1
s_waitcnt vmcnt(10)
s_barrier
ds_read_b64_tr_b16 v[64:65], v11 offset:0
ds_read_b64_tr_b16 v[66:67], v11 offset:6144
ds_read_b128 v[32:35], v9 offset:0
ds_read_b64_tr_b16 v[72:73], v11 offset:16384
ds_read_b64_tr_b16 v[74:75], v11 offset:22528
ds_read_b128 v[48:51], v10 offset:0
ds_read_b128 v[52:55], v10 offset:2048
ds_read_b128 v[36:39], v9 offset:2048
ds_read_b64_tr_b16 v[68:69], v11 offset:256
ds_read_b64_tr_b16 v[70:71], v11 offset:6400
ds_read_b64_tr_b16 v[76:77], v11 offset:16640
ds_read_b64_tr_b16 v[78:79], v11 offset:22784
ds_read_b64_tr_b16 v[80:81], v12 offset:0
ds_read_b64_tr_b16 v[82:83], v12 offset:6144
ds_read_b64_tr_b16 v[88:89], v12 offset:16384
s_waitcnt lgkmcnt(14)
ds_read_b64_tr_b16 v[90:91], v12 offset:22528
s_mov_b32 s22, 6
s_mov_b32 m0, s29
s_waitcnt lgkmcnt(13)
v_mfma_f32_16x16x32_bf16 v[128:131], v[64:67], v[32:35], 0
s_setprio 1
buffer_load_dwordx4 v5, s[12:15], s21 offen offset:0 lds
ds_read_b64_tr_b16 v[84:85], v12 offset:256
s_waitcnt lgkmcnt(11)
v_mfma_f32_16x16x32_bf16 v[128:131], v[72:75], v[48:51], v[128:131]
ds_read_b64_tr_b16 v[86:87], v12 offset:6400
s_waitcnt lgkmcnt(11)
v_mfma_f32_16x16x32_bf16 v[132:135], v[72:75], v[52:55], 0
buffer_load_dwordx4 v6, s[12:15], s21 offen offset:1024 lds
ds_read_b64_tr_b16 v[92:93], v12 offset:16640
s_waitcnt lgkmcnt(11)
v_mfma_f32_16x16x32_bf16 v[132:135], v[64:67], v[36:39], v[132:135]
ds_read_b64_tr_b16 v[94:95], v12 offset:22784
s_waitcnt lgkmcnt(10)
v_mfma_f32_16x16x32_bf16 v[148:151], v[68:71], v[36:39], 0
buffer_load_dwordx4 v7, s[12:15], s21 offen offset:2048 lds
ds_read_b128 v[40:43], v9 offset:4096
s_waitcnt lgkmcnt(9)
v_mfma_f32_16x16x32_bf16 v[148:151], v[76:79], v[52:55], v[148:151]
ds_read_b128 v[56:59], v10 offset:4096
v_mfma_f32_16x16x32_bf16 v[144:147], v[76:79], v[48:51], 0
buffer_load_dwordx4 v8, s[12:15], s21 offen offset:3072 lds
s_add_u32 s21, s21, 128
s_add_u32 s29, s29, 32768
s_cmp_ge_u32 s29, 98304
s_cselect_b32 s26, 98304, 0
s_sub_u32 s29, s29, s26
ds_read_b128 v[44:47], v9 offset:6144
v_mfma_f32_16x16x32_bf16 v[144:147], v[68:71], v[32:35], v[144:147]
s_setprio 0
ds_read_b128 v[60:63], v10 offset:6144
v_add_u32 v9, s59, v9
v_add_u32 v10, s59, v10
s_add_u32 s40, s40, 1
s_cmp_eq_u32 s40, 3
s_cselect_b32 s40, 0, s40
s_cmp_eq_u32 s40, 2
s_cselect_b32 s59, 0xffff0000, s57
v_smfmac_f32_16x16x64_bf16 v[100:103], v[96:99], v[64:71], v15
s_waitcnt lgkmcnt(10)
v_mfma_f32_16x16x32_bf16 v[160:163], v[80:83], v[32:35], 0
s_setprio 1
s_waitcnt lgkmcnt(8)
v_mfma_f32_16x16x32_bf16 v[160:163], v[88:91], v[48:51], v[160:163]
s_waitcnt lgkmcnt(0)
s_barrier
s_add_u32 m0, s28, 0
v_mfma_f32_16x16x32_bf16 v[164:167], v[88:91], v[52:55], 0
buffer_load_dwordx4 v1, s[8:11], s20 offen offset:0 lds
v_mfma_f32_16x16x32_bf16 v[164:167], v[80:83], v[36:39], v[164:167]
v_mfma_f32_16x16x32_bf16 v[180:183], v[84:87], v[36:39], 0
v_mfma_f32_16x16x32_bf16 v[180:183], v[92:95], v[52:55], v[180:183]
v_mfma_f32_16x16x32_bf16 v[176:179], v[92:95], v[48:51], 0
buffer_load_dwordx4 v2, s[84:87], s88 offen offset:1024 lds
v_mfma_f32_16x16x32_bf16 v[176:179], v[84:87], v[32:35], v[176:179]
s_setprio 0
v_smfmac_f32_16x16x64_bf16 v[100:103], v[96:99], v[72:79], v15
s_waitcnt vmcnt(6)
s_barrier
v_mfma_f32_16x16x32_bf16 v[136:139], v[64:67], v[40:43], 0
s_setprio 1
ds_read_b128 v[36:39], v9 offset:2048
s_cmp_lg_u32 s25, 0
s_cbranch_scc1 L_k1_np_z2
v_mov_b32 v28, 1
v_mov_b32 v29, 0
s_mov_b64 exec, 1
buffer_atomic_add v28, v29, s[52:55], s47 offen sc1
s_mov_b64 exec, -1
v_lshlrev_b32 v27, 5, v0
L_k1_np_z2:
v_mfma_f32_16x16x32_bf16 v[136:139], v[72:75], v[56:59], v[136:139]
ds_read_b128 v[52:55], v10 offset:2048
v_mfma_f32_16x16x32_bf16 v[140:143], v[72:75], v[60:63], 0
buffer_load_dwordx4 v3, s[84:87], s88 offen offset:2048 lds
s_add_u32 s20, s20, 393216
s_add_u32 s88, s88, s89
s_mov_b32 m0, s29
ds_read_b128 v[32:35], v9 offset:0
v_mfma_f32_16x16x32_bf16 v[140:143], v[64:67], v[44:47], v[140:143]
buffer_load_dwordx4 v5, s[12:15], s21 offen offset:0 lds
ds_read_b128 v[48:51], v10 offset:0
v_mfma_f32_16x16x32_bf16 v[156:159], v[68:71], v[44:47], 0
ds_read_b64_tr_b16 v[64:65], v11 offset:32768
v_mfma_f32_16x16x32_bf16 v[156:159], v[76:79], v[60:63], v[156:159]
ds_read_b64_tr_b16 v[66:67], v11 offset:38912
v_mfma_f32_16x16x32_bf16 v[152:155], v[76:79], v[56:59], 0
ds_read_b64_tr_b16 v[72:73], v11 offset:49152
v_mfma_f32_16x16x32_bf16 v[152:155], v[68:71], v[40:43], v[152:155]
s_setprio 0
buffer_load_dwordx4 v6, s[12:15], s21 offen offset:1024 lds
ds_read_b64_tr_b16 v[74:75], v11 offset:55296
v_mfma_f32_16x16x32_bf16 v[168:171], v[80:83], v[40:43], 0
s_setprio 1
ds_read_b64_tr_b16 v[68:69], v11 offset:33024
v_mfma_f32_16x16x32_bf16 v[168:171], v[88:91], v[56:59], v[168:171]
ds_read_b64_tr_b16 v[70:71], v11 offset:39168
v_mfma_f32_16x16x32_bf16 v[172:175], v[88:91], v[60:63], 0
ds_read_b64_tr_b16 v[76:77], v11 offset:49408
v_mfma_f32_16x16x32_bf16 v[172:175], v[80:83], v[44:47], v[172:175]
buffer_load_dwordx4 v7, s[12:15], s21 offen offset:2048 lds
ds_read_b64_tr_b16 v[78:79], v11 offset:55552
v_mfma_f32_16x16x32_bf16 v[188:191], v[84:87], v[44:47], 0
ds_read_b64_tr_b16 v[80:81], v12 offset:32768
v_mfma_f32_16x16x32_bf16 v[188:191], v[92:95], v[60:63], v[188:191]
ds_read_b64_tr_b16 v[82:83], v12 offset:38912
v_mfma_f32_16x16x32_bf16 v[184:187], v[92:95], v[56:59], 0
ds_read_b64_tr_b16 v[88:89], v12 offset:49152
v_mfma_f32_16x16x32_bf16 v[184:187], v[84:87], v[40:43], v[184:187]
s_setprio 0
buffer_load_dwordx4 v8, s[12:15], s21 offen offset:3072 lds
s_add_u32 s21, s21, 128
s_add_u32 s29, s29, 32768
s_cmp_ge_u32 s29, 98304
s_cselect_b32 s26, 98304, 0
s_sub_u32 s29, s29, s26
s_waitcnt lgkmcnt(14)
ds_read_b64_tr_b16 v[90:91], v12 offset:55296
L_k1_loop_z2:
s_waitcnt lgkmcnt(10)
v_mfma_f32_16x16x32_bf16 v[128:131], v[64:67], v[32:35], v[128:131]
s_setprio 1
ds_read_b64_tr_b16 v[84:85], v12 offset:33024
s_waitcnt lgkmcnt(9)
v_mfma_f32_16x16x32_bf16 v[128:131], v[72:75], v[48:51], v[128:131]
ds_read_b64_tr_b16 v[86:87], v12 offset:39168
v_mfma_f32_16x16x32_bf16 v[132:135], v[72:75], v[52:55], v[132:135]
ds_read_b64_tr_b16 v[92:93], v12 offset:49408
v_mfma_f32_16x16x32_bf16 v[132:135], v[64:67], v[36:39], v[132:135]
ds_read_b64_tr_b16 v[94:95], v12 offset:55552
s_waitcnt lgkmcnt(10)
v_mfma_f32_16x16x32_bf16 v[148:151], v[68:71], v[36:39], v[148:151]
ds_read_b128 v[40:43], v9 offset:4096
s_waitcnt lgkmcnt(9)
v_mfma_f32_16x16x32_bf16 v[148:151], v[76:79], v[52:55], v[148:151]
ds_read_b128 v[56:59], v10 offset:4096
v_mfma_f32_16x16x32_bf16 v[144:147], v[76:79], v[48:51], v[144:147]
ds_read_b128 v[44:47], v9 offset:6144
v_mfma_f32_16x16x32_bf16 v[144:147], v[68:71], v[32:35], v[144:147]
s_setprio 0
ds_read_b128 v[60:63], v10 offset:6144
v_add_u32 v9, s59, v9
v_add_u32 v10, s59, v10
s_add_u32 s40, s40, 1
s_cmp_eq_u32 s40, 3
s_cselect_b32 s40, 0, s40
s_cmp_eq_u32 s40, 2
s_cselect_b32 s59, 0xffff0000, s57
v_smfmac_f32_16x16x64_bf16 v[100:103], v[96:99], v[64:71], v15
s_waitcnt lgkmcnt(10)
v_mfma_f32_16x16x32_bf16 v[160:163], v[80:83], v[32:35], v[160:163]
s_setprio 1
s_waitcnt lgkmcnt(8)
v_mfma_f32_16x16x32_bf16 v[160:163], v[88:91], v[48:51], v[160:163]
s_waitcnt lgkmcnt(0)
s_barrier
s_add_u32 m0, s28, 32768
v_mfma_f32_16x16x32_bf16 v[164:167], v[88:91], v[52:55], v[164:167]
buffer_load_dwordx4 v1, s[8:11], s20 offen offset:0 lds
v_mfma_f32_16x16x32_bf16 v[164:167], v[80:83], v[36:39], v[164:167]
v_mfma_f32_16x16x32_bf16 v[180:183], v[84:87], v[36:39], v[180:183]
v_mfma_f32_16x16x32_bf16 v[180:183], v[92:95], v[52:55], v[180:183]
v_mfma_f32_16x16x32_bf16 v[176:179], v[92:95], v[48:51], v[176:179]
buffer_load_dwordx4 v2, s[84:87], s88 offen offset:1024 lds
v_mfma_f32_16x16x32_bf16 v[176:179], v[84:87], v[32:35], v[176:179]
s_setprio 0
v_smfmac_f32_16x16x64_bf16 v[100:103], v[96:99], v[72:79], v15
s_waitcnt vmcnt(6)
s_barrier
v_mfma_f32_16x16x32_bf16 v[136:139], v[64:67], v[40:43], v[136:139]
s_setprio 1
ds_read_b128 v[36:39], v9 offset:2048
v_mfma_f32_16x16x32_bf16 v[136:139], v[72:75], v[56:59], v[136:139]
ds_read_b128 v[52:55], v10 offset:2048
v_mfma_f32_16x16x32_bf16 v[140:143], v[72:75], v[60:63], v[140:143]
buffer_load_dwordx4 v3, s[84:87], s88 offen offset:2048 lds
s_add_u32 s20, s20, 393216
s_add_u32 s88, s88, s89
s_mov_b32 m0, s29
ds_read_b128 v[32:35], v9 offset:0
v_mfma_f32_16x16x32_bf16 v[140:143], v[64:67], v[44:47], v[140:143]
buffer_load_dwordx4 v5, s[12:15], s21 offen offset:0 lds
ds_read_b128 v[48:51], v10 offset:0
v_mfma_f32_16x16x32_bf16 v[156:159], v[68:71], v[44:47], v[156:159]
ds_read_b64_tr_b16 v[64:65], v11 offset:0
v_mfma_f32_16x16x32_bf16 v[156:159], v[76:79], v[60:63], v[156:159]
ds_read_b64_tr_b16 v[66:67], v11 offset:6144
v_mfma_f32_16x16x32_bf16 v[152:155], v[76:79], v[56:59], v[152:155]
ds_read_b64_tr_b16 v[72:73], v11 offset:16384
v_mfma_f32_16x16x32_bf16 v[152:155], v[68:71], v[40:43], v[152:155]
s_setprio 0
buffer_load_dwordx4 v6, s[12:15], s21 offen offset:1024 lds
ds_read_b64_tr_b16 v[74:75], v11 offset:22528
v_mfma_f32_16x16x32_bf16 v[168:171], v[80:83], v[40:43], v[168:171]
s_setprio 1
ds_read_b64_tr_b16 v[68:69], v11 offset:256
v_mfma_f32_16x16x32_bf16 v[168:171], v[88:91], v[56:59], v[168:171]
ds_read_b64_tr_b16 v[70:71], v11 offset:6400
v_mfma_f32_16x16x32_bf16 v[172:175], v[88:91], v[60:63], v[172:175]
ds_read_b64_tr_b16 v[76:77], v11 offset:16640
v_mfma_f32_16x16x32_bf16 v[172:175], v[80:83], v[44:47], v[172:175]
buffer_load_dwordx4 v7, s[12:15], s21 offen offset:2048 lds
ds_read_b64_tr_b16 v[78:79], v11 offset:22784
v_mfma_f32_16x16x32_bf16 v[188:191], v[84:87], v[44:47], v[188:191]
ds_read_b64_tr_b16 v[80:81], v12 offset:0
v_mfma_f32_16x16x32_bf16 v[188:191], v[92:95], v[60:63], v[188:191]
ds_read_b64_tr_b16 v[82:83], v12 offset:6144
v_mfma_f32_16x16x32_bf16 v[184:187], v[92:95], v[56:59], v[184:187]
ds_read_b64_tr_b16 v[88:89], v12 offset:16384
v_mfma_f32_16x16x32_bf16 v[184:187], v[84:87], v[40:43], v[184:187]
s_setprio 0
buffer_load_dwordx4 v8, s[12:15], s21 offen offset:3072 lds
s_add_u32 s21, s21, 128
s_add_u32 s29, s29, 32768
s_cmp_ge_u32 s29, 98304
s_cselect_b32 s26, 98304, 0
s_sub_u32 s29, s29, s26
s_waitcnt lgkmcnt(14)
ds_read_b64_tr_b16 v[90:91], v12 offset:22528
s_waitcnt lgkmcnt(10)
v_mfma_f32_16x16x32_bf16 v[128:131], v[64:67], v[32:35], v[128:131]
s_setprio 1
ds_read_b64_tr_b16 v[84:85], v12 offset:256
s_waitcnt lgkmcnt(9)
v_mfma_f32_16x16x32_bf16 v[128:131], v[72:75], v[48:51], v[128:131]
ds_read_b64_tr_b16 v[86:87], v12 offset:6400
v_mfma_f32_16x16x32_bf16 v[132:135], v[72:75], v[52:55], v[132:135]
ds_read_b64_tr_b16 v[92:93], v12 offset:16640
v_mfma_f32_16x16x32_bf16 v[132:135], v[64:67], v[36:39], v[132:135]
ds_read_b64_tr_b16 v[94:95], v12 offset:22784
s_waitcnt lgkmcnt(10)
v_mfma_f32_16x16x32_bf16 v[148:151], v[68:71], v[36:39], v[148:151]
ds_read_b128 v[40:43], v9 offset:4096
s_waitcnt lgkmcnt(9)
v_mfma_f32_16x16x32_bf16 v[148:151], v[76:79], v[52:55], v[148:151]
ds_read_b128 v[56:59], v10 offset:4096
v_mfma_f32_16x16x32_bf16 v[144:147], v[76:79], v[48:51], v[144:147]
ds_read_b128 v[44:47], v9 offset:6144
v_mfma_f32_16x16x32_bf16 v[144:147], v[68:71], v[32:35], v[144:147]
s_setprio 0
ds_read_b128 v[60:63], v10 offset:6144
v_add_u32 v9, s59, v9
v_add_u32 v10, s59, v10
s_add_u32 s40, s40, 1
s_cmp_eq_u32 s40, 3
s_cselect_b32 s40, 0, s40
s_cmp_eq_u32 s40, 2
s_cselect_b32 s59, 0xffff0000, s57
v_smfmac_f32_16x16x64_bf16 v[100:103], v[96:99], v[64:71], v15
s_waitcnt lgkmcnt(10)
v_mfma_f32_16x16x32_bf16 v[160:163], v[80:83], v[32:35], v[160:163]
s_setprio 1
s_waitcnt lgkmcnt(8)
v_mfma_f32_16x16x32_bf16 v[160:163], v[88:91], v[48:51], v[160:163]
s_waitcnt lgkmcnt(0)
s_barrier
s_add_u32 m0, s28, 0
v_mfma_f32_16x16x32_bf16 v[164:167], v[88:91], v[52:55], v[164:167]
buffer_load_dwordx4 v1, s[8:11], s20 offen offset:0 lds
v_mfma_f32_16x16x32_bf16 v[164:167], v[80:83], v[36:39], v[164:167]
v_mfma_f32_16x16x32_bf16 v[180:183], v[84:87], v[36:39], v[180:183]
v_mfma_f32_16x16x32_bf16 v[180:183], v[92:95], v[52:55], v[180:183]
v_mfma_f32_16x16x32_bf16 v[176:179], v[92:95], v[48:51], v[176:179]
buffer_load_dwordx4 v2, s[84:87], s88 offen offset:1024 lds
v_mfma_f32_16x16x32_bf16 v[176:179], v[84:87], v[32:35], v[176:179]
s_setprio 0
v_smfmac_f32_16x16x64_bf16 v[100:103], v[96:99], v[72:79], v15
s_waitcnt vmcnt(6)
s_barrier
v_mfma_f32_16x16x32_bf16 v[136:139], v[64:67], v[40:43], v[136:139]
s_setprio 1
ds_read_b128 v[36:39], v9 offset:2048
v_mfma_f32_16x16x32_bf16 v[136:139], v[72:75], v[56:59], v[136:139]
ds_read_b128 v[52:55], v10 offset:2048
v_mfma_f32_16x16x32_bf16 v[140:143], v[72:75], v[60:63], v[140:143]
buffer_load_dwordx4 v3, s[84:87], s88 offen offset:2048 lds
s_add_u32 s20, s20, 393216
s_add_u32 s88, s88, s89
s_mov_b32 m0, s29
ds_read_b128 v[32:35], v9 offset:0
v_mfma_f32_16x16x32_bf16 v[140:143], v[64:67], v[44:47], v[140:143]
buffer_load_dwordx4 v5, s[12:15], s21 offen offset:0 lds
ds_read_b128 v[48:51], v10 offset:0
v_mfma_f32_16x16x32_bf16 v[156:159], v[68:71], v[44:47], v[156:159]
ds_read_b64_tr_b16 v[64:65], v11 offset:32768
v_mfma_f32_16x16x32_bf16 v[156:159], v[76:79], v[60:63], v[156:159]
ds_read_b64_tr_b16 v[66:67], v11 offset:38912
v_mfma_f32_16x16x32_bf16 v[152:155], v[76:79], v[56:59], v[152:155]
ds_read_b64_tr_b16 v[72:73], v11 offset:49152
v_mfma_f32_16x16x32_bf16 v[152:155], v[68:71], v[40:43], v[152:155]
s_setprio 0
buffer_load_dwordx4 v6, s[12:15], s21 offen offset:1024 lds
ds_read_b64_tr_b16 v[74:75], v11 offset:55296
v_mfma_f32_16x16x32_bf16 v[168:171], v[80:83], v[40:43], v[168:171]
s_setprio 1
ds_read_b64_tr_b16 v[68:69], v11 offset:33024
v_mfma_f32_16x16x32_bf16 v[168:171], v[88:91], v[56:59], v[168:171]
ds_read_b64_tr_b16 v[70:71], v11 offset:39168
v_mfma_f32_16x16x32_bf16 v[172:175], v[88:91], v[60:63], v[172:175]
ds_read_b64_tr_b16 v[76:77], v11 offset:49408
v_mfma_f32_16x16x32_bf16 v[172:175], v[80:83], v[44:47], v[172:175]
buffer_load_dwordx4 v7, s[12:15], s21 offen offset:2048 lds
ds_read_b64_tr_b16 v[78:79], v11 offset:55552
v_mfma_f32_16x16x32_bf16 v[188:191], v[84:87], v[44:47], v[188:191]
ds_read_b64_tr_b16 v[80:81], v12 offset:32768
v_mfma_f32_16x16x32_bf16 v[188:191], v[92:95], v[60:63], v[188:191]
ds_read_b64_tr_b16 v[82:83], v12 offset:38912
v_mfma_f32_16x16x32_bf16 v[184:187], v[92:95], v[56:59], v[184:187]
ds_read_b64_tr_b16 v[88:89], v12 offset:49152
v_mfma_f32_16x16x32_bf16 v[184:187], v[84:87], v[40:43], v[184:187]
s_setprio 0
buffer_load_dwordx4 v8, s[12:15], s21 offen offset:3072 lds
s_add_u32 s21, s21, 128
s_add_u32 s29, s29, 32768
s_cmp_ge_u32 s29, 98304
s_cselect_b32 s26, 98304, 0
s_sub_u32 s29, s29, s26
s_waitcnt lgkmcnt(14)
ds_read_b64_tr_b16 v[90:91], v12 offset:55296
s_sub_u32 s22, s22, 1
s_cmp_lg_u32 s22, 0
s_cbranch_scc1 L_k1_loop_z2
s_waitcnt lgkmcnt(10)
v_mfma_f32_16x16x32_bf16 v[128:131], v[64:67], v[32:35], v[128:131]
s_setprio 1
ds_read_b64_tr_b16 v[84:85], v12 offset:33024
s_cmp_lg_u32 s25, 0
s_cbranch_scc1 L_k1_ak_z2
s_mov_b64 exec, 0xff
buffer_load_dword v28, v27, s[52:55], 0 offen sc1
s_mov_b64 exec, -1
L_k1_ak_z2:
s_waitcnt lgkmcnt(9)
v_mfma_f32_16x16x32_bf16 v[128:131], v[72:75], v[48:51], v[128:131]
ds_read_b64_tr_b16 v[86:87], v12 offset:39168
v_mfma_f32_16x16x32_bf16 v[132:135], v[72:75], v[52:55], v[132:135]
ds_read_b64_tr_b16 v[92:93], v12 offset:49408
v_mfma_f32_16x16x32_bf16 v[132:135], v[64:67], v[36:39], v[132:135]
ds_read_b64_tr_b16 v[94:95], v12 offset:55552
s_waitcnt lgkmcnt(10)
v_mfma_f32_16x16x32_bf16 v[148:151], v[68:71], v[36:39], v[148:151]
ds_read_b128 v[40:43], v9 offset:4096
s_waitcnt lgkmcnt(9)
v_mfma_f32_16x16x32_bf16 v[148:151], v[76:79], v[52:55], v[148:151]
ds_read_b128 v[56:59], v10 offset:4096
v_mfma_f32_16x16x32_bf16 v[144:147], v[76:79], v[48:51], v[144:147]
ds_read_b128 v[44:47], v9 offset:6144
v_mfma_f32_16x16x32_bf16 v[144:147], v[68:71], v[32:35], v[144:147]
s_setprio 0
ds_read_b128 v[60:63], v10 offset:6144
v_add_u32 v9, s59, v9
v_add_u32 v10, s59, v10
s_add_u32 s40, s40, 1
s_cmp_eq_u32 s40, 3
s_cselect_b32 s40, 0, s40
s_cmp_eq_u32 s40, 2
s_cselect_b32 s59, 0xffff0000, s57
v_smfmac_f32_16x16x64_bf16 v[100:103], v[96:99], v[64:71], v15
s_waitcnt lgkmcnt(10)
v_mfma_f32_16x16x32_bf16 v[160:163], v[80:83], v[32:35], v[160:163]
s_setprio 1
s_waitcnt lgkmcnt(8)
v_mfma_f32_16x16x32_bf16 v[160:163], v[88:91], v[48:51], v[160:163]
s_waitcnt lgkmcnt(0)
s_barrier
s_add_u32 m0, s28, 32768
v_mfma_f32_16x16x32_bf16 v[164:167], v[88:91], v[52:55], v[164:167]
buffer_load_dwordx4 v1, s[8:11], s20 offen offset:0 lds
v_mfma_f32_16x16x32_bf16 v[164:167], v[80:83], v[36:39], v[164:167]
v_mfma_f32_16x16x32_bf16 v[180:183], v[84:87], v[36:39], v[180:183]
v_mfma_f32_16x16x32_bf16 v[180:183], v[92:95], v[52:55], v[180:183]
v_mfma_f32_16x16x32_bf16 v[176:179], v[92:95], v[48:51], v[176:179]
buffer_load_dwordx4 v2, s[84:87], s88 offen offset:1024 lds
v_mfma_f32_16x16x32_bf16 v[176:179], v[84:87], v[32:35], v[176:179]
s_setprio 0
v_smfmac_f32_16x16x64_bf16 v[100:103], v[96:99], v[72:79], v15
s_waitcnt vmcnt(6)
s_barrier
v_mfma_f32_16x16x32_bf16 v[136:139], v[64:67], v[40:43], v[136:139]
s_setprio 1
ds_read_b128 v[36:39], v9 offset:2048
v_mfma_f32_16x16x32_bf16 v[136:139], v[72:75], v[56:59], v[136:139]
ds_read_b128 v[52:55], v10 offset:2048
v_mfma_f32_16x16x32_bf16 v[140:143], v[72:75], v[60:63], v[140:143]
buffer_load_dwordx4 v3, s[84:87], s88 offen offset:2048 lds
s_add_u32 s20, s20, 393216
s_add_u32 s88, s88, s89
ds_read_b128 v[32:35], v9 offset:0
v_mfma_f32_16x16x32_bf16 v[140:143], v[64:67], v[44:47], v[140:143]
ds_read_b128 v[48:51], v10 offset:0
v_mfma_f32_16x16x32_bf16 v[156:159], v[68:71], v[44:47], v[156:159]
ds_read_b64_tr_b16 v[64:65], v11 offset:0
v_mfma_f32_16x16x32_bf16 v[156:159], v[76:79], v[60:63], v[156:159]
ds_read_b64_tr_b16 v[66:67], v11 offset:6144
v_mfma_f32_16x16x32_bf16 v[152:155], v[76:79], v[56:59], v[152:155]
ds_read_b64_tr_b16 v[72:73], v11 offset:16384
v_mfma_f32_16x16x32_bf16 v[152:155], v[68:71], v[40:43], v[152:155]
s_setprio 0
ds_read_b64_tr_b16 v[74:75], v11 offset:22528
v_mfma_f32_16x16x32_bf16 v[168:171], v[80:83], v[40:43], v[168:171]
s_setprio 1
ds_read_b64_tr_b16 v[68:69], v11 offset:256
v_mfma_f32_16x16x32_bf16 v[168:171], v[88:91], v[56:59], v[168:171]
ds_read_b64_tr_b16 v[70:71], v11 offset:6400
v_mfma_f32_16x16x32_bf16 v[172:175], v[88:91], v[60:63], v[172:175]
ds_read_b64_tr_b16 v[76:77], v11 offset:16640
v_mfma_f32_16x16x32_bf16 v[172:175], v[80:83], v[44:47], v[172:175]
ds_read_b64_tr_b16 v[78:79], v11 offset:22784
v_mfma_f32_16x16x32_bf16 v[188:191], v[84:87], v[44:47], v[188:191]
ds_read_b64_tr_b16 v[80:81], v12 offset:0
v_mfma_f32_16x16x32_bf16 v[188:191], v[92:95], v[60:63], v[188:191]
ds_read_b64_tr_b16 v[82:83], v12 offset:6144
v_mfma_f32_16x16x32_bf16 v[184:187], v[92:95], v[56:59], v[184:187]
ds_read_b64_tr_b16 v[88:89], v12 offset:16384
v_mfma_f32_16x16x32_bf16 v[184:187], v[84:87], v[40:43], v[184:187]
s_setprio 0
s_waitcnt lgkmcnt(14)
ds_read_b64_tr_b16 v[90:91], v12 offset:22528
s_waitcnt lgkmcnt(10)
v_mfma_f32_16x16x32_bf16 v[128:131], v[64:67], v[32:35], v[128:131]
s_setprio 1
ds_read_b64_tr_b16 v[84:85], v12 offset:256
v_and_b32 v2, 31, v0
s_add_u32 s26, s35, s46
s_lshl_b32 s26, s26, 7
s_add_u32 s26, s26, 143360
s_waitcnt lgkmcnt(9)
v_mfma_f32_16x16x32_bf16 v[128:131], v[72:75], v[48:51], v[128:131]
ds_read_b64_tr_b16 v[86:87], v12 offset:6400
v_lshl_add_u32 v2, v2, 2, s26
v_lshrrev_b32 v3, 4, v0
v_mfma_f32_16x16x32_bf16 v[132:135], v[72:75], v[52:55], v[132:135]
ds_read_b64_tr_b16 v[92:93], v12 offset:16640
v_lshlrev_b32 v3, 4, v3
v_lshlrev_b32 v4, 4, v0
v_mfma_f32_16x16x32_bf16 v[132:135], v[64:67], v[36:39], v[132:135]
ds_read_b64_tr_b16 v[94:95], v12 offset:22784
s_waitcnt lgkmcnt(10)
v_mfma_f32_16x16x32_bf16 v[148:151], v[68:71], v[36:39], v[148:151]
ds_read_b128 v[40:43], v9 offset:4096
s_waitcnt lgkmcnt(9)
v_mfma_f32_16x16x32_bf16 v[148:151], v[76:79], v[52:55], v[148:151]
ds_read_b128 v[56:59], v10 offset:4096
v_mfma_f32_16x16x32_bf16 v[144:147], v[76:79], v[48:51], v[144:147]
ds_read_b128 v[44:47], v9 offset:6144
v_mov_b32 v6, 159744
v_mov_b32 v7, 0
v_mfma_f32_16x16x32_bf16 v[144:147], v[68:71], v[32:35], v[144:147]
s_setprio 0
ds_read_b128 v[60:63], v10 offset:6144
v_add_u32 v9, s59, v9
v_add_u32 v10, s59, v10
s_add_u32 s40, s40, 1
s_cmp_eq_u32 s40, 3
s_cselect_b32 s40, 0, s40
s_cmp_eq_u32 s40, 2
s_cselect_b32 s59, 0xffff0000, s57
v_smfmac_f32_16x16x64_bf16 v[100:103], v[96:99], v[64:71], v15
ds_write_b32 v6, v7
s_waitcnt lgkmcnt(11)
v_mfma_f32_16x16x32_bf16 v[160:163], v[80:83], v[32:35], v[160:163]
s_setprio 1
s_waitcnt lgkmcnt(9)
v_mfma_f32_16x16x32_bf16 v[160:163], v[88:91], v[48:51], v[160:163]
s_waitcnt lgkmcnt(0)
s_barrier
v_mfma_f32_16x16x32_bf16 v[164:167], v[88:91], v[52:55], v[164:167]
v_mfma_f32_16x16x32_bf16 v[164:167], v[80:83], v[36:39], v[164:167]
v_mfma_f32_16x16x32_bf16 v[180:183], v[84:87], v[36:39], v[180:183]
v_bfe_u32 v1, v0, 3, 1
v_and_b32 v24, 7, v0
s_lshl_b32 s26, s23, 12
v_mfma_f32_16x16x32_bf16 v[180:183], v[92:95], v[52:55], v[180:183]
v_lshlrev_b32 v1, 7, v1
s_lshl_b32 s27, s42, 10
v_mfma_f32_16x16x32_bf16 v[176:179], v[92:95], v[48:51], v[176:179]
v_lshl_add_u32 v1, v24, 3, v1
s_add_u32 s43, s26, s27
v_mfma_f32_16x16x32_bf16 v[176:179], v[84:87], v[32:35], v[176:179]
s_setprio 0
v_smfmac_f32_16x16x64_bf16 v[100:103], v[96:99], v[72:79], v15
s_waitcnt vmcnt(0)
s_cmp_lg_u32 s25, 0
s_cbranch_scc1 L_k1_ck_z2
s_mov_b32 s27, 0x40000
L_k1_chl_z2:
v_cmp_le_u32 vcc, 32, v28
s_nop 1
s_and_b32 s26, vcc_lo, 0xff
s_cmp_eq_u32 s26, 0xff
s_cbranch_scc1 L_k1_ck_z2
s_sleep 2
s_mov_b64 exec, 0xff
buffer_load_dword v28, v27, s[52:55], 0 offen sc1
s_mov_b64 exec, -1
s_waitcnt vmcnt(0)
s_sub_u32 s27, s27, 1
s_cmp_lg_u32 s27, 0
s_cbranch_scc1 L_k1_chl_z2
L_k1_ck_z2:
s_barrier
v_mfma_f32_16x16x32_bf16 v[136:139], v[64:67], v[40:43], v[136:139]
s_setprio 1
ds_read_b128 v[36:39], v9 offset:2048
buffer_load_dwordx2 v[16:17], v1, s[92:95], s43 offen offset:0 sc1
v_mfma_f32_16x16x32_bf16 v[136:139], v[72:75], v[56:59], v[136:139]
ds_read_b128 v[52:55], v10 offset:2048
buffer_load_dwordx2 v[18:19], v1, s[92:95], s43 offen offset:256 sc1
v_mfma_f32_16x16x32_bf16 v[140:143], v[72:75], v[60:63], v[140:143]
ds_read_b128 v[32:35], v9 offset:0
buffer_load_dwordx2 v[20:21], v1, s[92:95], s43 offen offset:512 sc1
v_mfma_f32_16x16x32_bf16 v[140:143], v[64:67], v[44:47], v[140:143]
ds_read_b128 v[48:51], v10 offset:0
buffer_load_dwordx2 v[22:23], v1, s[92:95], s43 offen offset:768 sc1
v_mfma_f32_16x16x32_bf16 v[156:159], v[68:71], v[44:47], v[156:159]
ds_read_b64_tr_b16 v[64:65], v11 offset:32768
v_mfma_f32_16x16x32_bf16 v[156:159], v[76:79], v[60:63], v[156:159]
ds_read_b64_tr_b16 v[66:67], v11 offset:38912
v_mfma_f32_16x16x32_bf16 v[152:155], v[76:79], v[56:59], v[152:155]
ds_read_b64_tr_b16 v[72:73], v11 offset:49152
v_mfma_f32_16x16x32_bf16 v[152:155], v[68:71], v[40:43], v[152:155]
s_setprio 0
ds_read_b64_tr_b16 v[74:75], v11 offset:55296
v_mfma_f32_16x16x32_bf16 v[168:171], v[80:83], v[40:43], v[168:171]
s_setprio 1
ds_read_b64_tr_b16 v[68:69], v11 offset:33024
v_mfma_f32_16x16x32_bf16 v[168:171], v[88:91], v[56:59], v[168:171]
ds_read_b64_tr_b16 v[70:71], v11 offset:39168
v_mfma_f32_16x16x32_bf16 v[172:175], v[88:91], v[60:63], v[172:175]
ds_read_b64_tr_b16 v[76:77], v11 offset:49408
v_mfma_f32_16x16x32_bf16 v[172:175], v[80:83], v[44:47], v[172:175]
ds_read_b64_tr_b16 v[78:79], v11 offset:55552
v_mfma_f32_16x16x32_bf16 v[188:191], v[84:87], v[44:47], v[188:191]
ds_read_b64_tr_b16 v[80:81], v12 offset:32768
v_mfma_f32_16x16x32_bf16 v[188:191], v[92:95], v[60:63], v[188:191]
ds_read_b64_tr_b16 v[82:83], v12 offset:38912
s_waitcnt lgkmcnt(4)
v_smfmac_f32_16x16x64_bf16 v[100:103], v[96:99], v[64:71], v15
v_mfma_f32_16x16x32_bf16 v[184:187], v[92:95], v[56:59], v[184:187]
ds_read_b64_tr_b16 v[88:89], v12 offset:49152
v_mfma_f32_16x16x32_bf16 v[184:187], v[84:87], v[40:43], v[184:187]
s_setprio 0
ds_read_b64_tr_b16 v[90:91], v12 offset:55296
s_waitcnt lgkmcnt(4)
v_smfmac_f32_16x16x64_bf16 v[100:103], v[96:99], v[72:79], v15
s_setprio 2
v_mfma_f32_16x16x32_bf16 v[128:131], v[64:67], v[32:35], v[128:131]
ds_read_b128 v[40:43], v9 offset:4096
v_mfma_f32_16x16x32_bf16 v[128:131], v[72:75], v[48:51], v[128:131]
ds_read_b128 v[56:59], v10 offset:4096
v_bfe_u32 v5, v0, 4, 1
v_mfma_f32_16x16x32_bf16 v[132:135], v[72:75], v[52:55], v[132:135]
ds_read_b128 v[44:47], v9 offset:6144
v_cmp_eq_u32 vcc, 0, v5
v_mfma_f32_16x16x32_bf16 v[132:135], v[64:67], v[36:39], v[132:135]
ds_read_b128 v[60:63], v10 offset:6144
v_mfma_f32_16x16x32_bf16 v[148:151], v[68:71], v[36:39], v[148:151]
v_add_f32 v100, v100, v101
v_add_f32 v102, v102, v103
v_mfma_f32_16x16x32_bf16 v[148:151], v[76:79], v[52:55], v[148:151]
v_cndmask_b32 v100, v102, v100, vcc
ds_write_b32 v2, v100
v_mfma_f32_16x16x32_bf16 v[144:147], v[76:79], v[48:51], v[144:147]
v_mfma_f32_16x16x32_bf16 v[144:147], v[68:71], v[32:35], v[144:147]
s_waitcnt lgkmcnt(0)
s_barrier
s_add_u32 s26, s46, 0
s_cmp_ge_u32 s26, 2
s_cselect_b32 s27, 2, 0
s_sub_u32 s26, s26, s27
s_lshl_b32 s26, s26, 7
s_add_u32 s26, s26, 143616
v_add_u32 v5, s26, v3
ds_read_b128 v[112:115], v5 offset:0
ds_read_b128 v[116:119], v5 offset:64
v_mfma_f32_16x16x32_bf16 v[152:155], v[68:71], v[40:43], v[152:155]
ds_read_b64_tr_b16 v[84:85], v12 offset:33024
v_mfma_f32_16x16x32_bf16 v[152:155], v[76:79], v[56:59], v[152:155]
ds_read_b64_tr_b16 v[86:87], v12 offset:39168
v_mfma_f32_16x16x32_bf16 v[156:159], v[76:79], v[60:63], v[156:159]
ds_read_b64_tr_b16 v[92:93], v12 offset:49408
v_mfma_f32_16x16x32_bf16 v[156:159], v[68:71], v[44:47], v[156:159]
ds_read_b64_tr_b16 v[94:95], v12 offset:55552
s_waitcnt vmcnt(0)
v_mfma_f32_16x16x32_bf16 v[140:143], v[64:67], v[44:47], v[140:143]
v_mul_f32 v96, 0xc0135761, v17
v_mul_f32 v98, 0xc0135761, v19
v_mul_f32 v100, 0xc0135761, v21
v_mul_f32 v102, 0xc0135761, v23
v_mul_f32 v120, v17, v17
v_mfma_f32_16x16x32_bf16 v[140:143], v[72:75], v[60:63], v[140:143]
v_mul_f32 v122, v19, v19
v_mul_f32 v124, v21, v21
v_mul_f32 v126, v23, v23
v_mov_b32 v24, v17
v_mov_b32 v25, v19
v_mfma_f32_16x16x32_bf16 v[136:139], v[72:75], v[56:59], v[136:139]
v_mov_b32 v26, v21
v_mov_b32 v27, v23
v_mul_f32 v120, v120, v96
v_mul_f32 v122, v122, v98
v_mul_f32 v124, v124, v100
v_mfma_f32_16x16x32_bf16 v[136:139], v[64:67], v[40:43], v[136:139]
v_mul_f32 v126, v126, v102
v_mul_f32 v120, 0x3d372713, v120
v_mul_f32 v122, 0x3d372713, v122
v_mul_f32 v124, 0x3d372713, v124
v_mul_f32 v126, 0x3d372713, v126
v_mfma_f32_16x16x32_bf16 v[160:163], v[80:83], v[32:35], v[160:163]
s_waitcnt lgkmcnt(5)
v_fmac_f32 v128, v112, v16
s_add_u32 s26, s46, 1
s_cmp_ge_u32 s26, 2
s_cselect_b32 s27, 2, 0
s_sub_u32 s26, s26, s27
s_lshl_b32 s26, s26, 7
s_add_u32 s26, s26, 143616
v_add_u32 v5, s26, v3
ds_read_b128 v[104:107], v5 offset:0
ds_read_b128 v[108:111], v5 offset:64
v_fmac_f32 v132, v112, v18
v_mul_f32 v240, v128, v128
v_fmac_f32 v136, v112, v20
v_mul_f32 v241, v132, v132
v_fma_f32 v240, v240, v120, v96
v_fmac_f32 v140, v112, v22
v_mul_f32 v242, v136, v136
v_fma_f32 v241, v241, v122, v98
v_mul_f32 v240, v240, v128
v_fmac_f32 v129, v113, v16
v_mul_f32 v243, v140, v140
v_mfma_f32_16x16x32_bf16 v[160:163], v[88:91], v[48:51], v[160:163]
v_exp_f32 v240, v240
v_fma_f32 v242, v242, v124, v100
v_mul_f32 v241, v241, v132
v_fmac_f32 v133, v113, v18
v_mul_f32 v244, v129, v129
v_exp_f32 v241, v241
v_fma_f32 v243, v243, v126, v102
v_mul_f32 v242, v242, v136
v_fmac_f32 v137, v113, v20
v_mul_f32 v245, v133, v133
v_exp_f32 v242, v242
v_fma_f32 v244, v244, v120, v96
v_mul_f32 v243, v243, v140
v_add_f32 v240, 1.0, v240
v_fmac_f32 v141, v113, v22
v_mul_f32 v246, v137, v137
v_exp_f32 v243, v243
v_fma_f32 v245, v245, v122, v98
v_mul_f32 v244, v244, v129
v_add_f32 v241, 1.0, v241
v_rcp_f32 v240, v240
v_mfma_f32_16x16x32_bf16 v[164:167], v[88:91], v[52:55], v[164:167]
v_fmac_f32 v130, v114, v16
v_mul_f32 v247, v141, v141
v_exp_f32 v244, v244
v_fma_f32 v246, v246, v124, v100
v_mul_f32 v245, v245, v133
v_add_f32 v242, 1.0, v242
v_rcp_f32 v241, v241
v_fmac_f32 v134, v114, v18
v_mul_f32 v248, v130, v130
v_exp_f32 v245, v245
v_fma_f32 v247, v247, v126, v102
v_mul_f32 v246, v246, v137
v_add_f32 v243, 1.0, v243
v_rcp_f32 v242, v242
v_mul_f32 v128, v128, v240
v_fmac_f32 v138, v114, v20
v_mul_f32 v249, v134, v134
v_exp_f32 v246, v246
v_fma_f32 v248, v248, v120, v96
v_mul_f32 v247, v247, v141
v_mfma_f32_16x16x32_bf16 v[164:167], v[80:83], v[36:39], v[164:167]
v_add_f32 v244, 1.0, v244
v_rcp_f32 v243, v243
v_mul_f32 v132, v132, v241
v_mov_b32 v224, v128
v_mul_f32 v232, v128, v128
v_fmac_f32 v142, v114, v22
v_mul_f32 v250, v138, v138
v_exp_f32 v247, v247
v_fma_f32 v249, v249, v122, v98
v_mul_f32 v248, v248, v130
v_add_f32 v245, 1.0, v245
v_rcp_f32 v244, v244
v_mul_f32 v136, v136, v242
v_mov_b32 v226, v132
v_mul_f32 v234, v132, v132
v_fmac_f32 v131, v115, v16
v_mul_f32 v251, v142, v142
v_exp_f32 v248, v248
v_fma_f32 v250, v250, v124, v100
v_mul_f32 v249, v249, v134
v_add_f32 v246, 1.0, v246
s_waitcnt lgkmcnt(4)
v_mfma_f32_16x16x32_bf16 v[180:183], v[84:87], v[36:39], v[180:183]
v_rcp_f32 v245, v245
v_mul_f32 v140, v140, v243
v_mov_b32 v228, v136
v_mul_f32 v236, v136, v136
v_fmac_f32 v135, v115, v18
v_mul_f32 v252, v131, v131
v_exp_f32 v249, v249
v_fma_f32 v251, v251, v126, v102
v_mul_f32 v250, v250, v138
v_add_f32 v247, 1.0, v247
v_rcp_f32 v246, v246
v_mul_f32 v129, v129, v244
v_mov_b32 v230, v140
v_mul_f32 v238, v140, v140
v_fmac_f32 v139, v115, v20
v_mul_f32 v253, v135, v135
v_exp_f32 v250, v250
v_fma_f32 v252, v252, v120, v96
v_mul_f32 v251, v251, v142
v_add_f32 v248, 1.0, v248
s_waitcnt lgkmcnt(2)
v_mfma_f32_16x16x32_bf16 v[180:183], v[92:95], v[52:55], v[180:183]
v_rcp_f32 v247, v247
v_mul_f32 v133, v133, v245
v_mov_b32 v225, v129
v_mul_f32 v233, v129, v129
v_fmac_f32 v143, v115, v22
v_mul_f32 v254, v139, v139
v_exp_f32 v251, v251
v_fma_f32 v253, v253, v122, v98
v_mul_f32 v252, v252, v131
v_add_f32 v249, 1.0, v249
v_rcp_f32 v248, v248
v_mul_f32 v137, v137, v246
v_mov_b32 v227, v133
v_mul_f32 v235, v133, v133
v_fmac_f32 v144, v116, v16
v_mul_f32 v255, v143, v143
v_exp_f32 v252, v252
v_fma_f32 v254, v254, v124, v100
v_mul_f32 v253, v253, v135
v_add_f32 v250, 1.0, v250
v_rcp_f32 v249, v249
v_mfma_f32_16x16x32_bf16 v[176:179], v[92:95], v[48:51], v[176:179]
v_mul_f32 v141, v141, v247
v_mov_b32 v229, v137
v_mul_f32 v237, v137, v137
v_fmac_f32 v148, v116, v18
v_mul_f32 v240, v144, v144
v_exp_f32 v253, v253
v_fma_f32 v255, v255, v126, v102
v_mul_f32 v254, v254, v139
v_add_f32 v251, 1.0, v251
v_rcp_f32 v250, v250
v_mul_f32 v130, v130, v248
v_mov_b32 v231, v141
v_mul_f32 v239, v141, v141
v_fmac_f32 v152, v116, v20
v_mul_f32 v241, v148, v148
v_exp_f32 v254, v254
v_fma_f32 v240, v240, v120, v96
v_mul_f32 v255, v255, v143
v_add_f32 v252, 1.0, v252
v_rcp_f32 v251, v251
v_mfma_f32_16x16x32_bf16 v[176:179], v[84:87], v[32:35], v[176:179]
v_mul_f32 v134, v134, v249
v_add_f32 v224, v224, v130
v_fmac_f32 v232, v130, v130
v_fmac_f32 v156, v116, v22
v_mul_f32 v242, v152, v152
v_exp_f32 v255, v255
v_fma_f32 v241, v241, v122, v98
v_mul_f32 v240, v240, v144
v_add_f32 v253, 1.0, v253
v_rcp_f32 v252, v252
v_mul_f32 v138, v138, v250
v_add_f32 v226, v226, v134
v_fmac_f32 v234, v134, v134
v_fmac_f32 v145, v117, v16
v_mul_f32 v243, v156, v156
v_exp_f32 v240, v240
v_fma_f32 v242, v242, v124, v100
v_mul_f32 v241, v241, v148
v_add_f32 v254, 1.0, v254
v_rcp_f32 v253, v253
v_mul_f32 v142, v142, v251
v_mfma_f32_16x16x32_bf16 v[184:187], v[84:87], v[40:43], v[184:187]
v_add_f32 v228, v228, v138
v_fmac_f32 v236, v138, v138
v_fmac_f32 v149, v117, v18
v_mul_f32 v244, v145, v145
v_exp_f32 v241, v241
v_fma_f32 v243, v243, v126, v102
v_mul_f32 v242, v242, v152
v_add_f32 v255, 1.0, v255
v_rcp_f32 v254, v254
v_mul_f32 v131, v131, v252
v_add_f32 v230, v230, v142
v_fmac_f32 v238, v142, v142
v_fmac_f32 v153, v117, v20
v_mul_f32 v245, v149, v149
v_exp_f32 v242, v242
v_fma_f32 v244, v244, v120, v96
v_mul_f32 v243, v243, v156
v_add_f32 v240, 1.0, v240
v_rcp_f32 v255, v255
v_mul_f32 v135, v135, v253
v_add_f32 v225, v225, v131
v_mfma_f32_16x16x32_bf16 v[184:187], v[92:95], v[56:59], v[184:187]
v_fmac_f32 v233, v131, v131
v_fmac_f32 v157, v117, v22
v_mul_f32 v246, v153, v153
v_exp_f32 v243, v243
v_fma_f32 v245, v245, v122, v98
v_mul_f32 v244, v244, v145
v_add_f32 v241, 1.0, v241
v_rcp_f32 v240, v240
v_mul_f32 v139, v139, v254
v_add_f32 v227, v227, v135
v_fmac_f32 v235, v135, v135
v_fmac_f32 v146, v118, v16
v_mul_f32 v247, v157, v157
v_exp_f32 v244, v244
v_fma_f32 v246, v246, v124, v100
v_mul_f32 v245, v245, v149
v_add_f32 v242, 1.0, v242
v_rcp_f32 v241, v241
v_mul_f32 v143, v143, v255
v_add_f32 v229, v229, v139
v_mfma_f32_16x16x32_bf16 v[188:191], v[92:95], v[60:63], v[188:191]
v_fmac_f32 v237, v139, v139
v_fmac_f32 v150, v118, v18
v_mul_f32 v248, v146, v146
v_exp_f32 v245, v245
v_fma_f32 v247, v247, v126, v102
v_mul_f32 v246, v246, v153
v_add_f32 v243, 1.0, v243
v_rcp_f32 v242, v242
v_mul_f32 v144, v144, v240
v_add_f32 v231, v231, v143
v_fmac_f32 v239, v143, v143
v_fmac_f32 v154, v118, v20
v_mul_f32 v249, v150, v150
v_exp_f32 v246, v246
v_fma_f32 v248, v248, v120, v96
v_mul_f32 v247, v247, v157
v_add_f32 v244, 1.0, v244
v_rcp_f32 v243, v243
v_mul_f32 v148, v148, v241
v_add_f32 v224, v224, v144
v_fmac_f32 v232, v144, v144
v_mfma_f32_16x16x32_bf16 v[188:191], v[84:87], v[44:47], v[188:191]
v_fmac_f32 v158, v118, v22
v_mul_f32 v250, v154, v154
v_exp_f32 v247, v247
v_fma_f32 v249, v249, v122, v98
v_mul_f32 v248, v248, v146
v_add_f32 v245, 1.0, v245
v_rcp_f32 v244, v244
v_mul_f32 v152, v152, v242
v_add_f32 v226, v226, v148
v_fmac_f32 v234, v148, v148
v_fmac_f32 v147, v119, v16
v_mul_f32 v251, v158, v158
v_exp_f32 v248, v248
v_fma_f32 v250, v250, v124, v100
v_mul_f32 v249, v249, v150
v_add_f32 v246, 1.0, v246
v_rcp_f32 v245, v245
v_mul_f32 v156, v156, v243
v_add_f32 v228, v228, v152
v_fmac_f32 v236, v152, v152
v_mfma_f32_16x16x32_bf16 v[172:175], v[80:83], v[44:47], v[172:175]
v_fmac_f32 v151, v119, v18
v_mul_f32 v252, v147, v147
v_exp_f32 v249, v249
v_fma_f32 v251, v251, v126, v102
v_mul_f32 v250, v250, v154
v_add_f32 v247, 1.0, v247
v_rcp_f32 v246, v246
v_mul_f32 v145, v145, v244
v_add_f32 v230, v230, v156
v_fmac_f32 v238, v156, v156
v_fmac_f32 v155, v119, v20
v_mul_f32 v253, v151, v151
v_exp_f32 v250, v250
v_fma_f32 v252, v252, v120, v96
v_mul_f32 v251, v251, v158
v_add_f32 v248, 1.0, v248
v_rcp_f32 v247, v247
v_mul_f32 v149, v149, v245
v_add_f32 v225, v225, v145
v_fmac_f32 v233, v145, v145
v_fmac_f32 v159, v119, v22
v_mfma_f32_16x16x32_bf16 v[172:175], v[88:91], v[60:63], v[172:175]
v_mul_f32 v254, v155, v155
v_exp_f32 v251, v251
v_fma_f32 v253, v253, v122, v98
v_mul_f32 v252, v252, v147
v_add_f32 v249, 1.0, v249
v_rcp_f32 v248, v248
v_mul_f32 v153, v153, v246
v_add_f32 v227, v227, v149
v_fmac_f32 v235, v149, v149
v_mul_f32 v255, v159, v159
v_exp_f32 v252, v252
v_fma_f32 v254, v254, v124, v100
v_mul_f32 v253, v253, v151
v_add_f32 v250, 1.0, v250
v_rcp_f32 v249, v249
v_mul_f32 v157, v157, v247
v_add_f32 v229, v229, v153
v_fmac_f32 v237, v153, v153
v_exp_f32 v253, v253
v_fma_f32 v255, v255, v126, v102
v_mfma_f32_16x16x32_bf16 v[168:171], v[88:91], v[56:59], v[168:171]
v_mul_f32 v254, v254, v155
v_add_f32 v251, 1.0, v251
v_rcp_f32 v250, v250
v_mul_f32 v146, v146, v248
v_add_f32 v231, v231, v157
v_fmac_f32 v239, v157, v157
v_exp_f32 v254, v254
v_mul_f32 v255, v255, v159
v_add_f32 v252, 1.0, v252
v_rcp_f32 v251, v251
v_mul_f32 v150, v150, v249
v_add_f32 v224, v224, v146
v_fmac_f32 v232, v146, v146
v_exp_f32 v255, v255
v_add_f32 v253, 1.0, v253
v_rcp_f32 v252, v252
v_mul_f32 v154, v154, v250
v_add_f32 v226, v226, v150
v_fmac_f32 v234, v150, v150
v_add_f32 v254, 1.0, v254
v_rcp_f32 v253, v253
v_mfma_f32_16x16x32_bf16 v[168:171], v[80:83], v[40:43], v[168:171]
v_mul_f32 v158, v158, v251
v_add_f32 v228, v228, v154
v_fmac_f32 v236, v154, v154
v_add_f32 v255, 1.0, v255
v_rcp_f32 v254, v254
v_mul_f32 v147, v147, v252
v_add_f32 v230, v230, v158
v_fmac_f32 v238, v158, v158
v_rcp_f32 v255, v255
v_mul_f32 v151, v151, v253
v_add_f32 v225, v225, v147
v_fmac_f32 v233, v147, v147
v_mul_f32 v155, v155, v254
v_add_f32 v227, v227, v151
v_fmac_f32 v235, v151, v151
v_mul_f32 v159, v159, v255
v_add_f32 v229, v229, v155
v_fmac_f32 v237, v155, v155
v_add_f32 v231, v231, v159
v_fmac_f32 v239, v159, v159
s_setprio 2
s_waitcnt lgkmcnt(1)
v_pk_fma_f32 v[160:161], v[104:105], v[16:17], v[160:161] op_sel_hi:[1,0,1]
v_pk_fma_f32 v[164:165], v[104:105], v[18:19], v[164:165] op_sel_hi:[1,0,1]
v_pk_mul_f32 v[240:241], v[160:161], v[160:161]
v_pk_fma_f32 v[168:169], v[104:105], v[20:21], v[168:169] op_sel_hi:[1,0,1]
v_pk_mul_f32 v[242:243], v[164:165], v[164:165]
v_pk_fma_f32 v[240:241], v[240:241], v[120:121], v[96:97] op_sel_hi:[1,0,0]
v_pk_fma_f32 v[172:173], v[104:105], v[22:23], v[172:173] op_sel_hi:[1,0,1]
v_pk_mul_f32 v[244:245], v[168:169], v[168:169]
v_pk_fma_f32 v[242:243], v[242:243], v[122:123], v[98:99] op_sel_hi:[1,0,0]
v_pk_mul_f32 v[240:241], v[240:241], v[160:161]
v_exp_f32 v240, v240
v_pk_fma_f32 v[162:163], v[106:107], v[16:17], v[162:163] op_sel_hi:[1,0,1]
v_pk_mul_f32 v[246:247], v[172:173], v[172:173]
v_exp_f32 v241, v241
v_pk_fma_f32 v[244:245], v[244:245], v[124:125], v[100:101] op_sel_hi:[1,0,0]
v_pk_mul_f32 v[242:243], v[242:243], v[164:165]
v_exp_f32 v242, v242
v_pk_fma_f32 v[166:167], v[106:107], v[18:19], v[166:167] op_sel_hi:[1,0,1]
v_pk_mul_f32 v[248:249], v[162:163], v[162:163]
v_exp_f32 v243, v243
v_pk_fma_f32 v[246:247], v[246:247], v[126:127], v[102:103] op_sel_hi:[1,0,0]
v_pk_mul_f32 v[244:245], v[244:245], v[168:169]
v_pk_add_f32 v[240:241], v[240:241], 1.0 op_sel_hi:[1,0]
v_exp_f32 v244, v244
v_pk_fma_f32 v[170:171], v[106:107], v[20:21], v[170:171] op_sel_hi:[1,0,1]
v_pk_mul_f32 v[250:251], v[166:167], v[166:167]
v_exp_f32 v245, v245
v_pk_fma_f32 v[248:249], v[248:249], v[120:121], v[96:97] op_sel_hi:[1,0,0]
v_pk_mul_f32 v[246:247], v[246:247], v[172:173]
v_rcp_f32 v240, v240
v_pk_add_f32 v[242:243], v[242:243], 1.0 op_sel_hi:[1,0]
v_rcp_f32 v241, v241
v_exp_f32 v246, v246
v_pk_fma_f32 v[174:175], v[106:107], v[22:23], v[174:175] op_sel_hi:[1,0,1]
v_pk_mul_f32 v[252:253], v[170:171], v[170:171]
v_exp_f32 v247, v247
v_pk_fma_f32 v[250:251], v[250:251], v[122:123], v[98:99] op_sel_hi:[1,0,0]
v_pk_mul_f32 v[248:249], v[248:249], v[162:163]
v_rcp_f32 v242, v242
v_pk_add_f32 v[244:245], v[244:245], 1.0 op_sel_hi:[1,0]
v_pk_mul_f32 v[160:161], v[160:161], v[240:241]
v_rcp_f32 v243, v243
v_exp_f32 v248, v248
s_waitcnt lgkmcnt(0)
v_pk_fma_f32 v[176:177], v[108:109], v[16:17], v[176:177] op_sel_hi:[1,0,1]
v_pk_mul_f32 v[254:255], v[174:175], v[174:175]
v_exp_f32 v249, v249
v_pk_fma_f32 v[252:253], v[252:253], v[124:125], v[100:101] op_sel_hi:[1,0,0]
v_pk_mul_f32 v[250:251], v[250:251], v[166:167]
v_rcp_f32 v244, v244
v_pk_add_f32 v[246:247], v[246:247], 1.0 op_sel_hi:[1,0]
v_pk_mul_f32 v[164:165], v[164:165], v[242:243]
v_rcp_f32 v245, v245
v_pk_add_f32 v[224:225], v[224:225], v[160:161]
v_pk_fma_f32 v[232:233], v[160:161], v[160:161], v[232:233]
v_exp_f32 v250, v250
v_pk_fma_f32 v[180:181], v[108:109], v[18:19], v[180:181] op_sel_hi:[1,0,1]
v_pk_mul_f32 v[240:241], v[176:177], v[176:177]
v_exp_f32 v251, v251
v_pk_fma_f32 v[254:255], v[254:255], v[126:127], v[102:103] op_sel_hi:[1,0,0]
v_pk_mul_f32 v[252:253], v[252:253], v[170:171]
v_rcp_f32 v246, v246
v_pk_add_f32 v[248:249], v[248:249], 1.0 op_sel_hi:[1,0]
v_pk_mul_f32 v[168:169], v[168:169], v[244:245]
v_rcp_f32 v247, v247
v_pk_add_f32 v[226:227], v[226:227], v[164:165]
v_pk_fma_f32 v[234:235], v[164:165], v[164:165], v[234:235]
v_exp_f32 v252, v252
v_pk_fma_f32 v[184:185], v[108:109], v[20:21], v[184:185] op_sel_hi:[1,0,1]
v_pk_mul_f32 v[242:243], v[180:181], v[180:181]
v_exp_f32 v253, v253
v_pk_fma_f32 v[240:241], v[240:241], v[120:121], v[96:97] op_sel_hi:[1,0,0]
v_pk_mul_f32 v[254:255], v[254:255], v[174:175]
v_rcp_f32 v248, v248
v_pk_add_f32 v[250:251], v[250:251], 1.0 op_sel_hi:[1,0]
v_pk_mul_f32 v[172:173], v[172:173], v[246:247]
v_rcp_f32 v249, v249
v_pk_add_f32 v[228:229], v[228:229], v[168:169]
v_pk_fma_f32 v[236:237], v[168:169], v[168:169], v[236:237]
v_exp_f32 v254, v254
v_pk_fma_f32 v[188:189], v[108:109], v[22:23], v[188:189] op_sel_hi:[1,0,1]
v_pk_mul_f32 v[244:245], v[184:185], v[184:185]
v_exp_f32 v255, v255
v_pk_fma_f32 v[242:243], v[242:243], v[122:123], v[98:99] op_sel_hi:[1,0,0]
v_pk_mul_f32 v[240:241], v[240:241], v[176:177]
v_rcp_f32 v250, v250
v_pk_add_f32 v[252:253], v[252:253], 1.0 op_sel_hi:[1,0]
v_pk_mul_f32 v[162:163], v[162:163], v[248:249]
v_rcp_f32 v251, v251
v_pk_add_f32 v[230:231], v[230:231], v[172:173]
v_pk_fma_f32 v[238:239], v[172:173], v[172:173], v[238:239]
v_exp_f32 v240, v240
v_pk_fma_f32 v[178:179], v[110:111], v[16:17], v[178:179] op_sel_hi:[1,0,1]
v_pk_mul_f32 v[246:247], v[188:189], v[188:189]
v_exp_f32 v241, v241
v_pk_fma_f32 v[244:245], v[244:245], v[124:125], v[100:101] op_sel_hi:[1,0,0]
v_pk_mul_f32 v[242:243], v[242:243], v[180:181]
v_rcp_f32 v252, v252
v_pk_add_f32 v[254:255], v[254:255], 1.0 op_sel_hi:[1,0]
v_pk_mul_f32 v[166:167], v[166:167], v[250:251]
v_rcp_f32 v253, v253
v_pk_add_f32 v[224:225], v[224:225], v[162:163]
v_pk_fma_f32 v[232:233], v[162:163], v[162:163], v[232:233]
v_exp_f32 v242, v242
v_pk_fma_f32 v[182:183], v[110:111], v[18:19], v[182:183] op_sel_hi:[1,0,1]
v_pk_mul_f32 v[248:249], v[178:179], v[178:179]
v_exp_f32 v243, v243
v_pk_fma_f32 v[246:247], v[246:247], v[126:127], v[102:103] op_sel_hi:[1,0,0]
v_pk_mul_f32 v[244:245], v[244:245], v[184:185]
v_rcp_f32 v254, v254
v_pk_add_f32 v[240:241], v[240:241], 1.0 op_sel_hi:[1,0]
v_pk_mul_f32 v[170:171], v[170:171], v[252:253]
v_rcp_f32 v255, v255
v_pk_add_f32 v[226:227], v[226:227], v[166:167]
v_pk_fma_f32 v[234:235], v[166:167], v[166:167], v[234:235]
v_exp_f32 v244, v244
v_pk_fma_f32 v[186:187], v[110:111], v[20:21], v[186:187] op_sel_hi:[1,0,1]
v_pk_mul_f32 v[250:251], v[182:183], v[182:183]
v_exp_f32 v245, v245
v_pk_fma_f32 v[248:249], v[248:249], v[120:121], v[96:97] op_sel_hi:[1,0,0]
v_pk_mul_f32 v[246:247], v[246:247], v[188:189]
v_rcp_f32 v240, v240
v_pk_add_f32 v[242:243], v[242:243], 1.0 op_sel_hi:[1,0]
v_pk_mul_f32 v[174:175], v[174:175], v[254:255]
v_rcp_f32 v241, v241
v_pk_add_f32 v[228:229], v[228:229], v[170:171]
v_pk_fma_f32 v[236:237], v[170:171], v[170:171], v[236:237]
v_exp_f32 v246, v246
v_pk_fma_f32 v[190:191], v[110:111], v[22:23], v[190:191] op_sel_hi:[1,0,1]
v_pk_mul_f32 v[252:253], v[186:187], v[186:187]
v_exp_f32 v247, v247
v_pk_fma_f32 v[250:251], v[250:251], v[122:123], v[98:99] op_sel_hi:[1,0,0]
v_pk_mul_f32 v[248:249], v[248:249], v[178:179]
v_rcp_f32 v242, v242
v_pk_add_f32 v[244:245], v[244:245], 1.0 op_sel_hi:[1,0]
v_pk_mul_f32 v[176:177], v[176:177], v[240:241]
v_rcp_f32 v243, v243
v_pk_add_f32 v[230:231], v[230:231], v[174:175]
v_pk_fma_f32 v[238:239], v[174:175], v[174:175], v[238:239]
v_exp_f32 v248, v248
v_pk_mul_f32 v[254:255], v[190:191], v[190:191]
v_exp_f32 v249, v249
v_pk_fma_f32 v[252:253], v[252:253], v[124:125], v[100:101] op_sel_hi:[1,0,0]
v_pk_mul_f32 v[250:251], v[250:251], v[182:183]
v_rcp_f32 v244, v244
v_pk_add_f32 v[246:247], v[246:247], 1.0 op_sel_hi:[1,0]
v_pk_mul_f32 v[180:181], v[180:181], v[242:243]
v_rcp_f32 v245, v245
v_pk_add_f32 v[224:225], v[224:225], v[176:177]
v_pk_fma_f32 v[232:233], v[176:177], v[176:177], v[232:233]
v_exp_f32 v250, v250
v_exp_f32 v251, v251
v_pk_fma_f32 v[254:255], v[254:255], v[126:127], v[102:103] op_sel_hi:[1,0,0]
v_pk_mul_f32 v[252:253], v[252:253], v[186:187]
v_rcp_f32 v246, v246
v_pk_add_f32 v[248:249], v[248:249], 1.0 op_sel_hi:[1,0]
v_pk_mul_f32 v[184:185], v[184:185], v[244:245]
v_rcp_f32 v247, v247
v_pk_add_f32 v[226:227], v[226:227], v[180:181]
v_pk_fma_f32 v[234:235], v[180:181], v[180:181], v[234:235]
v_exp_f32 v252, v252
v_exp_f32 v253, v253
v_pk_mul_f32 v[254:255], v[254:255], v[190:191]
v_rcp_f32 v248, v248
v_pk_add_f32 v[250:251], v[250:251], 1.0 op_sel_hi:[1,0]
v_pk_mul_f32 v[188:189], v[188:189], v[246:247]
v_rcp_f32 v249, v249
v_pk_add_f32 v[228:229], v[228:229], v[184:185]
v_pk_fma_f32 v[236:237], v[184:185], v[184:185], v[236:237]
v_exp_f32 v254, v254
v_exp_f32 v255, v255
v_rcp_f32 v250, v250
v_pk_add_f32 v[252:253], v[252:253], 1.0 op_sel_hi:[1,0]
v_pk_mul_f32 v[178:179], v[178:179], v[248:249]
v_rcp_f32 v251, v251
v_pk_add_f32 v[230:231], v[230:231], v[188:189]
v_pk_fma_f32 v[238:239], v[188:189], v[188:189], v[238:239]
v_rcp_f32 v252, v252
v_pk_add_f32 v[254:255], v[254:255], 1.0 op_sel_hi:[1,0]
v_pk_mul_f32 v[182:183], v[182:183], v[250:251]
v_rcp_f32 v253, v253
v_pk_add_f32 v[224:225], v[224:225], v[178:179]
v_pk_fma_f32 v[232:233], v[178:179], v[178:179], v[232:233]
v_rcp_f32 v254, v254
v_pk_mul_f32 v[186:187], v[186:187], v[252:253]
v_rcp_f32 v255, v255
v_pk_add_f32 v[226:227], v[226:227], v[182:183]
v_pk_fma_f32 v[234:235], v[182:183], v[182:183], v[234:235]
v_pk_mul_f32 v[190:191], v[190:191], v[254:255]
v_pk_add_f32 v[228:229], v[228:229], v[186:187]
v_pk_fma_f32 v[236:237], v[186:187], v[186:187], v[236:237]
v_pk_add_f32 v[230:231], v[230:231], v[190:191]
v_pk_fma_f32 v[238:239], v[190:191], v[190:191], v[238:239]
v_add_f32 v224, v224, v225
v_add_f32 v226, v226, v227
v_add_f32 v228, v228, v229
v_add_f32 v230, v230, v231
v_add_f32 v232, v232, v233
v_add_f32 v234, v234, v235
v_add_f32 v236, v236, v237
v_add_f32 v238, v238, v239
v_mul_f32 v224, v224, v24
v_mul_f32 v226, v226, v25
v_mul_f32 v228, v228, v26
v_mul_f32 v230, v230, v27
v_mul_f32 v232, v232, v24
v_mul_f32 v234, v234, v25
v_mul_f32 v236, v236, v26
v_mul_f32 v238, v238, v27
v_mul_f32 v232, v232, v24
v_mul_f32 v234, v234, v25
v_mul_f32 v236, v236, v26
v_mul_f32 v238, v238, v27
v_permlane16_swap_b32 v224, v226
v_permlane16_swap_b32 v228, v230
v_permlane16_swap_b32 v232, v234
v_permlane16_swap_b32 v236, v238
v_add_f32 v224, v224, v226
v_add_f32 v228, v228, v230
v_add_f32 v232, v232, v234
v_add_f32 v236, v236, v238
v_permlane32_swap_b32 v224, v228
s_nop 0
v_permlane32_swap_b32 v232, v236
v_add_f32 v28, v224, v228
v_add_f32 v29, v232, v236
v_lshlrev_b32 v5, 4, v0
v_min_f32 v29, 0x7f800000, v29
buffer_store_dwordx2 v[28:29], v5, s[16:19], s39 offen sc0 sc1
s_setprio 0
s_bfe_u32 s27, s2, 0x20003
s_lshr_b32 s34, s2, 5
v_lshlrev_b32 v11, 4, v0
s_add_u32 s34, s34, s2
s_and_b32 s34, s34, 7
s_and_b32 s26, s2, 7
s_lshl_b32 s33, s26, 2
s_add_u32 s33, s33, s27
s_lshl_b32 s30, s34, 14
s_lshl_b32 s27, s42, 12
s_add_u32 s30, s30, s27
s_and_b32 s26, s42, 1
s_lshl_b32 s40, s26, 10
s_lshl_b32 s41, s42, 10
s_add_u32 s41, s41, 131072
v_bfe_u32 v12, v0, 4, 1
v_lshlrev_b32 v12, 7, v12
s_cmp_ge_u32 s42, 2
s_cselect_b32 s26, -1, 0
v_and_b32 v12, s26, v12
v_xor_b32 v7, v11, v12
s_lshl_b32 s26, s33, 17
s_add_u32 s27, s26, 0x400000
s_lshr_b32 s35, s42, 1
s_add_u32 s35, s35, 1
s_lshl_b32 s35, s35, 22
s_add_u32 s35, s35, s27
s_add_u32 s12, s4, s27
s_addc_u32 s13, s5, 0
s_mov_b32 s14, 0x20000
s_mov_b32 s15, 0x20000
s_add_u32 s8, s4, s35
s_addc_u32 s9, s5, 0
s_mov_b32 s10, 0x20000
s_mov_b32 s11, 0x20000
v_lshl_add_u32 v12, v0, 5, s33
v_mul_u32_u24 v13, 43, v12
v_lshrrev_b32 v13, 10, v13
v_mul_u32_u24 v14, 24, v13
v_sub_u32 v12, v12, v14
v_or_b32 v14, 1, v12
v_cmp_gt_u32 vcc, 16, v12
v_subrev_u32 v12, 15, v12
v_mul_u32_u24 v12, 11, v12
v_lshrrev_b32 v12, 5, v12
v_lshlrev_b32 v12, 1, v12
v_cndmask_b32 v12, v12, v14, vcc
v_lshl_add_u32 v12, v13, 4, v12
s_and_b32 s26, s34, 3
v_lshl_add_u32 v12, v12, 2, s26
v_lshlrev_b32 v12, 7, v12
s_barrier
s_barrier
s_barrier
s_barrier
s_barrier
s_barrier
s_barrier
s_mov_b32 s47, 0x4000
L_t_zz2_l:
s_mov_b32 s26, s38
buffer_load_dwordx4 v[64:67], v5, s[16:19], s26 offen offset:0 sc1
buffer_load_dwordx4 v[68:71], v5, s[16:19], s26 offen offset:1024 sc1
buffer_load_dwordx4 v[72:75], v5, s[16:19], s26 offen offset:2048 sc1
buffer_load_dwordx4 v[76:79], v5, s[16:19], s26 offen offset:3072 sc1
s_add_u32 s26, s26, 4096
buffer_load_dwordx4 v[80:83], v5, s[16:19], s26 offen offset:0 sc1
buffer_load_dwordx4 v[84:87], v5, s[16:19], s26 offen offset:1024 sc1
buffer_load_dwordx4 v[88:91], v5, s[16:19], s26 offen offset:2048 sc1
buffer_load_dwordx4 v[92:95], v5, s[16:19], s26 offen offset:3072 sc1
s_add_u32 s26, s26, 4096
buffer_load_dwordx4 v[96:99], v5, s[16:19], s26 offen offset:0 sc1
buffer_load_dwordx4 v[100:103], v5, s[16:19], s26 offen offset:1024 sc1
L_t_zz2_w:
s_waitcnt vmcnt(5)
v_pk_add_f32 v[64:65], v[64:65], v[74:75]
v_pk_add_f32 v[66:67], v[66:67], v[76:77]
v_pk_add_f32 v[68:69], v[68:69], v[78:79]
v_pk_add_f32 v[70:71], v[70:71], v[80:81]
v_pk_add_f32 v[72:73], v[72:73], v[82:83]
s_waitcnt vmcnt(0)
v_pk_add_f32 v[84:85], v[84:85], v[94:95]
v_pk_add_f32 v[86:87], v[86:87], v[96:97]
v_pk_add_f32 v[88:89], v[88:89], v[98:99]
v_pk_add_f32 v[90:91], v[90:91], v[100:101]
v_pk_add_f32 v[92:93], v[92:93], v[102:103]
v_pk_add_f32 v[64:65], v[64:65], v[84:85]
v_pk_add_f32 v[66:67], v[66:67], v[86:87]
v_pk_add_f32 v[68:69], v[68:69], v[88:89]
v_pk_add_f32 v[70:71], v[70:71], v[90:91]
v_pk_add_f32 v[72:73], v[72:73], v[92:93]
v_pk_add_f32 v[64:65], v[64:65], v[66:67]
v_pk_add_f32 v[68:69], v[68:69], v[70:71]
v_pk_add_f32 v[64:65], v[64:65], v[72:73]
v_pk_add_f32 v[64:65], v[64:65], v[68:69]
s_nop 0
v_cmp_u_f32 vcc, v65, v65
s_sub_u32 s47, s47, 1
s_cbranch_scc1 L_t_zz2_g
s_cbranch_vccz L_t_zz2_g
s_sleep 2
s_branch L_t_zz2_l
L_t_zz2_g:
s_mov_b64 exec, 7
buffer_load_dword v9, v12, s[48:51], 0 offen sc1
s_mov_b64 exec, -1
v_mul_f32 v28, 0x3a124925, v64
v_mul_f32 v29, 0x3a124925, v65
v_fma_f32 v29, -v28, v28, v29
v_max_f32 v29, 0, v29
v_add_f32 v29, 0x3727c5ac, v29
v_rsq_f32 v16, v29
s_nop 0
v_mul_f32 v17, -v28, v16
v_mov_b32 v20, v16
v_mov_b32 v21, v17
s_nop 0
v_permlane32_swap_b32 v16, v20
v_permlane32_swap_b32 v17, v21
v_mov_b32 v18, v16
v_mov_b32 v19, v17
v_mov_b32 v22, v20
v_mov_b32 v23, v21
v_permlane16_swap_b32 v16, v18
v_permlane16_swap_b32 v17, v19
v_permlane16_swap_b32 v20, v22
v_permlane16_swap_b32 v21, v23
v_mov_b32 v40, v17
v_mov_b32 v42, v19
v_mov_b32 v44, v21
v_mov_b32 v46, v23
v_mul_f32 v16, v16, v24
v_mul_f32 v18, v18, v25
v_mul_f32 v20, v20, v26
v_mul_f32 v22, v22, v27
v_pk_fma_f32 v[128:129], v[128:129], v[16:17], v[40:41] op_sel_hi:[1,0,0]
v_pk_fma_f32 v[130:131], v[130:131], v[16:17], v[40:41] op_sel_hi:[1,0,0]
v_pk_fma_f32 v[132:133], v[132:133], v[18:19], v[42:43] op_sel_hi:[1,0,0]
v_pk_fma_f32 v[134:135], v[134:135], v[18:19], v[42:43] op_sel_hi:[1,0,0]
v_pk_fma_f32 v[136:137], v[136:137], v[20:21], v[44:45] op_sel_hi:[1,0,0]
v_pk_fma_f32 v[138:139], v[138:139], v[20:21], v[44:45] op_sel_hi:[1,0,0]
v_pk_fma_f32 v[140:141], v[140:141], v[22:23], v[46:47] op_sel_hi:[1,0,0]
v_pk_fma_f32 v[142:143], v[142:143], v[22:23], v[46:47] op_sel_hi:[1,0,0]
v_pk_fma_f32 v[144:145], v[144:145], v[16:17], v[40:41] op_sel_hi:[1,0,0]
v_pk_fma_f32 v[146:147], v[146:147], v[16:17], v[40:41] op_sel_hi:[1,0,0]
v_pk_fma_f32 v[148:149], v[148:149], v[18:19], v[42:43] op_sel_hi:[1,0,0]
v_pk_fma_f32 v[150:151], v[150:151], v[18:19], v[42:43] op_sel_hi:[1,0,0]
v_pk_fma_f32 v[152:153], v[152:153], v[20:21], v[44:45] op_sel_hi:[1,0,0]
v_pk_fma_f32 v[154:155], v[154:155], v[20:21], v[44:45] op_sel_hi:[1,0,0]
v_pk_fma_f32 v[156:157], v[156:157], v[22:23], v[46:47] op_sel_hi:[1,0,0]
v_pk_fma_f32 v[158:159], v[158:159], v[22:23], v[46:47] op_sel_hi:[1,0,0]
s_add_u32 s26, s46, 0
s_cmp_ge_u32 s26, 2
s_cselect_b32 s27, 2, 0
s_sub_u32 s26, s26, s27
s_lshl_b32 s26, s26, 17
s_add_u32 s27, s26, s31
v_cvt_pk_bf16_f32 v128, v128, v129
v_cvt_pk_bf16_f32 v129, v130, v131
v_cvt_pk_bf16_f32 v130, v144, v145
v_cvt_pk_bf16_f32 v131, v146, v147
buffer_store_dwordx4 v[128:131], v4, s[16:19], s27 offen offset:0 sc0 sc1
v_cvt_pk_bf16_f32 v132, v132, v133
v_cvt_pk_bf16_f32 v133, v134, v135
v_cvt_pk_bf16_f32 v134, v148, v149
v_cvt_pk_bf16_f32 v135, v150, v151
buffer_store_dwordx4 v[132:135], v4, s[16:19], s27 offen offset:1024 sc0 sc1
v_cvt_pk_bf16_f32 v136, v136, v137
v_cvt_pk_bf16_f32 v137, v138, v139
v_cvt_pk_bf16_f32 v138, v152, v153
v_cvt_pk_bf16_f32 v139, v154, v155
buffer_store_dwordx4 v[136:139], v4, s[16:19], s27 offen offset:2048 sc0 sc1
v_cvt_pk_bf16_f32 v140, v140, v141
v_cvt_pk_bf16_f32 v141, v142, v143
v_cvt_pk_bf16_f32 v142, v156, v157
v_cvt_pk_bf16_f32 v143, v158, v159
buffer_store_dwordx4 v[140:143], v4, s[16:19], s27 offen offset:3072 sc0 sc1
v_pk_fma_f32 v[160:161], v[160:161], v[16:17], v[40:41] op_sel_hi:[1,0,0]
v_pk_fma_f32 v[162:163], v[162:163], v[16:17], v[40:41] op_sel_hi:[1,0,0]
v_pk_fma_f32 v[164:165], v[164:165], v[18:19], v[42:43] op_sel_hi:[1,0,0]
v_pk_fma_f32 v[166:167], v[166:167], v[18:19], v[42:43] op_sel_hi:[1,0,0]
v_pk_fma_f32 v[168:169], v[168:169], v[20:21], v[44:45] op_sel_hi:[1,0,0]
v_pk_fma_f32 v[170:171], v[170:171], v[20:21], v[44:45] op_sel_hi:[1,0,0]
v_pk_fma_f32 v[172:173], v[172:173], v[22:23], v[46:47] op_sel_hi:[1,0,0]
v_pk_fma_f32 v[174:175], v[174:175], v[22:23], v[46:47] op_sel_hi:[1,0,0]
v_pk_fma_f32 v[176:177], v[176:177], v[16:17], v[40:41] op_sel_hi:[1,0,0]
v_pk_fma_f32 v[178:179], v[178:179], v[16:17], v[40:41] op_sel_hi:[1,0,0]
v_pk_fma_f32 v[180:181], v[180:181], v[18:19], v[42:43] op_sel_hi:[1,0,0]
v_pk_fma_f32 v[182:183], v[182:183], v[18:19], v[42:43] op_sel_hi:[1,0,0]
v_pk_fma_f32 v[184:185], v[184:185], v[20:21], v[44:45] op_sel_hi:[1,0,0]
v_pk_fma_f32 v[186:187], v[186:187], v[20:21], v[44:45] op_sel_hi:[1,0,0]
v_pk_fma_f32 v[188:189], v[188:189], v[22:23], v[46:47] op_sel_hi:[1,0,0]
v_pk_fma_f32 v[190:191], v[190:191], v[22:23], v[46:47] op_sel_hi:[1,0,0]
s_add_u32 s26, s46, 1
s_cmp_ge_u32 s26, 2
s_cselect_b32 s27, 2, 0
s_sub_u32 s26, s26, s27
s_lshl_b32 s26, s26, 17
s_add_u32 s27, s26, s31
v_cvt_pk_bf16_f32 v160, v160, v161
v_cvt_pk_bf16_f32 v161, v162, v163
v_cvt_pk_bf16_f32 v162, v176, v177
v_cvt_pk_bf16_f32 v163, v178, v179
buffer_store_dwordx4 v[160:163], v4, s[16:19], s27 offen offset:0 sc0 sc1
v_cvt_pk_bf16_f32 v164, v164, v165
v_cvt_pk_bf16_f32 v165, v166, v167
v_cvt_pk_bf16_f32 v166, v180, v181
v_cvt_pk_bf16_f32 v167, v182, v183
buffer_store_dwordx4 v[164:167], v4, s[16:19], s27 offen offset:1024 sc0 sc1
v_cvt_pk_bf16_f32 v168, v168, v169
v_cvt_pk_bf16_f32 v169, v170, v171
v_cvt_pk_bf16_f32 v170, v184, v185
v_cvt_pk_bf16_f32 v171, v186, v187
buffer_store_dwordx4 v[168:171], v4, s[16:19], s27 offen offset:2048 sc0 sc1
v_cvt_pk_bf16_f32 v172, v172, v173
v_cvt_pk_bf16_f32 v173, v174, v175
v_cvt_pk_bf16_f32 v174, v188, v189
v_cvt_pk_bf16_f32 v175, v190, v191
buffer_store_dwordx4 v[172:175], v4, s[16:19], s27 offen offset:3072 sc0 sc1
s_mov_b64 exec, 7
s_mov_b32 s47, 0x40000
s_waitcnt vmcnt(8)
s_branch L_t_wz2_k
L_t_wz2_l:
s_waitcnt vmcnt(0)
L_t_wz2_k:
v_cmp_le_u32 s[26:27], 8, v9
s_sub_u32 s47, s47, 1
s_nop 0
s_cmp_eq_u32 s26, 7
s_cbranch_scc1 L_t_wz2_g
s_sleep 1
buffer_load_dword v9, v12, s[48:51], 0 offen sc1
s_cmp_lg_u32 s47, 0
s_cbranch_scc1 L_t_wz2_l
L_t_wz2_g:
s_mov_b64 exec, -1
s_add_u32 m0, s41, 0
s_nop 0
buffer_load_dwordx4 v7, s[8:11], s40 offen lds
s_add_u32 s40, s40, 2048
buffer_load_dwordx4 v[240:243], v11, s[12:15], s30 offen offset:0
buffer_load_dwordx4 v[244:247], v11, s[12:15], s30 offen offset:1024
buffer_load_dwordx4 v[248:251], v11, s[12:15], s30 offen offset:2048
buffer_load_dwordx4 v[252:255], v11, s[12:15], s30 offen offset:3072
s_add_u32 m0, s41, 4096
s_nop 0
buffer_load_dwordx4 v7, s[8:11], s40 offen lds
s_add_u32 s40, s40, 2048
s_add_u32 m0, s41, 8192
s_nop 0
buffer_load_dwordx4 v7, s[8:11], s40 offen lds
s_add_u32 s40, s40, 2048
s_add_u32 m0, s41, 12288
s_nop 0
buffer_load_dwordx4 v7, s[8:11], s40 offen lds
s_add_u32 s40, s40, 2048
s_add_u32 m0, s41, 16384
s_nop 0
buffer_load_dwordx4 v7, s[8:11], s40 offen lds
s_add_u32 s40, s40, 2048
s_add_u32 m0, s41, 20480
s_nop 0
buffer_load_dwordx4 v7, s[8:11], s40 offen lds
s_add_u32 s40, s40, 2048
s_add_u32 m0, s41, 24576
s_nop 0
buffer_load_dwordx4 v7, s[8:11], s40 offen lds
s_add_u32 s40, s40, 2048
s_barrier
v_mov_b32 v13, 159744
v_mov_b32 v14, 1
v_lshlrev_b32 v15, 7, v0
s_mov_b64 exec, 1
s_waitcnt vmcnt(11)
ds_add_rtn_u32 v13, v13, v14
s_waitcnt lgkmcnt(0)
v_readfirstlane_b32 s26, v13
s_mov_b64 exec, 15
s_cmp_lg_u32 s26, 3
s_cbranch_scc1 L_t_pz2
buffer_atomic_add v14, v15, s[48:51], s74 offen sc1
L_t_pz2:
s_mov_b64 exec, -1
s_branch L_att
L_att:
s_setprio 0
s_add_u32 s52, s4, 0x2800000
s_addc_u32 s53, s5, 0
s_mov_b32 s54, 0x400000
s_mov_b32 s55, 0x20000
s_lshl_b32 s26, s34, 3
s_lshl_b32 s27, s42, 1
s_add_u32 s26, s26, s27
s_lshl_b32 s26, s26, 5
s_add_u32 s26, s26, s33
s_lshl_b32 s46, s26, 11
v_add_u32 v4, 131072, v11
v_bfe_u32 v14, v0, 1, 1
v_and_b32 v13, 1, v0
v_lshrrev_b32 v15, 2, v0
v_lshlrev_b32 v12, 3, v14
v_xor_b32 v15, v15, v12
v_lshlrev_b32 v15, 4, v15
v_lshl_add_u32 v15, v13, 3, v15
v_lshl_add_u32 v15, v14, 8, v15
v_add_u32 v5, 133120, v15
v_lshrrev_b32 v12, 5, v0
v_cmp_eq_u32 vcc, v14, v12
v_mul_u32_u24 v13, 0xaaaa, v13
v_add_u32 v156, 0x4444, v13
v_mov_b32 v13, 0x3f803f80
v_cndmask_b32 v152, 0, v13, vcc
v_mov_b32 v153, v152
v_mov_b32 v154, v152
v_mov_b32 v155, v152
s_mov_b32 s45, 6
s_waitcnt vmcnt(6)
s_barrier
ds_read_b128 v[32:35], v4 offset:0
ds_read_b128 v[36:39], v4 offset:1024
s_waitcnt lgkmcnt(0)
v_mfma_f32_16x16x32_bf16 v[64:67], v[32:35], v[240:243], 0
v_mfma_f32_16x16x32_bf16 v[68:71], v[36:39], v[240:243], 0
v_mfma_f32_16x16x32_bf16 v[76:79], v[36:39], v[244:247], 0
v_mfma_f32_16x16x32_bf16 v[72:75], v[32:35], v[244:247], 0
s_nop 7
v_mfma_f32_16x16x32_bf16 v[80:83], v[32:35], v[248:251], 0
ds_read_b64_tr_b16 v[48:49], v5 offset:0
v_exp_f32 v64, v64
v_exp_f32 v65, v65
v_mfma_f32_16x16x32_bf16 v[84:87], v[36:39], v[248:251], 0
ds_read_b64_tr_b16 v[50:51], v5 offset:1024
v_exp_f32 v66, v66
v_exp_f32 v67, v67
v_cvt_pk_bf16_f32 v96, v64, v65
v_mfma_f32_16x16x32_bf16 v[92:95], v[36:39], v[252:255], 0
ds_read_b64_tr_b16 v[52:53], v5 offset:512
v_exp_f32 v68, v68
v_exp_f32 v69, v69
v_cvt_pk_bf16_f32 v97, v66, v67
v_mfma_f32_16x16x32_bf16 v[88:91], v[32:35], v[252:255], 0
ds_read_b64_tr_b16 v[54:55], v5 offset:1536
v_exp_f32 v70, v70
v_exp_f32 v71, v71
v_cvt_pk_bf16_f32 v98, v68, v69
v_mov_b32 v144, 0
s_waitcnt vmcnt(5)
s_barrier
ds_read_b128 v[40:43], v4 offset:4096
s_add_u32 m0, s41, 28672
v_exp_f32 v72, v72
v_exp_f32 v73, v73
v_cvt_pk_bf16_f32 v99, v70, v71
v_mov_b32 v145, 0
ds_read_b128 v[44:47], v4 offset:5120
v_exp_f32 v74, v74
v_exp_f32 v75, v75
v_cvt_pk_bf16_f32 v100, v72, v73
v_mov_b32 v146, 0
v_mov_b32 v149, 0
v_mov_b32 v150, 0
v_mov_b32 v151, 0
v_exp_f32 v76, v76
v_exp_f32 v77, v77
v_cvt_pk_bf16_f32 v101, v74, v75
v_mov_b32 v147, 0
v_exp_f32 v78, v78
v_exp_f32 v79, v79
v_cvt_pk_bf16_f32 v102, v76, v77
v_mov_b32 v148, 0
v_cvt_pk_bf16_f32 v103, v78, v79
s_waitcnt lgkmcnt(1)
v_mfma_f32_16x16x32_bf16 v[64:67], v[40:43], v[240:243], 0
v_exp_f32 v80, v80
v_exp_f32 v81, v81
s_waitcnt lgkmcnt(0)
v_mfma_f32_16x16x32_bf16 v[68:71], v[44:47], v[240:243], 0
v_exp_f32 v82, v82
v_exp_f32 v83, v83
v_cvt_pk_bf16_f32 v104, v80, v81
v_mfma_f32_16x16x32_bf16 v[76:79], v[44:47], v[244:247], 0
buffer_load_dwordx4 v7, s[8:11], s40 offen lds
s_add_u32 s40, s40, 2048
v_exp_f32 v84, v84
v_exp_f32 v85, v85
v_cvt_pk_bf16_f32 v105, v82, v83
v_mfma_f32_16x16x32_bf16 v[72:75], v[40:43], v[244:247], 0
v_exp_f32 v86, v86
v_exp_f32 v87, v87
v_cvt_pk_bf16_f32 v106, v84, v85
v_mfma_f32_16x16x32_bf16 v[112:115], v[48:51], v[96:99], 0
v_exp_f32 v88, v88
v_exp_f32 v89, v89
v_cvt_pk_bf16_f32 v107, v86, v87
v_mfma_f32_16x16x32_bf16 v[116:119], v[52:55], v[96:99], 0
v_exp_f32 v90, v90
v_exp_f32 v91, v91
v_cvt_pk_bf16_f32 v108, v88, v89
v_mfma_f32_16x16x32_bf16 v[124:127], v[52:55], v[100:103], 0
v_exp_f32 v92, v92
v_exp_f32 v93, v93
v_cvt_pk_bf16_f32 v109, v90, v91
v_mfma_f32_16x16x32_bf16 v[120:123], v[48:51], v[100:103], 0
v_exp_f32 v94, v94
v_exp_f32 v95, v95
v_cvt_pk_bf16_f32 v110, v92, v93
v_smfmac_f32_16x16x64_bf16 v[144:147], v[152:155], v[96:103], v156
v_cvt_pk_bf16_f32 v111, v94, v95
v_mfma_f32_16x16x32_bf16 v[80:83], v[40:43], v[248:251], 0
ds_read_b64_tr_b16 v[56:57], v5 offset:4096
v_exp_f32 v64, v64
v_exp_f32 v65, v65
v_mfma_f32_16x16x32_bf16 v[84:87], v[44:47], v[248:251], 0
ds_read_b64_tr_b16 v[58:59], v5 offset:5120
v_exp_f32 v66, v66
v_exp_f32 v67, v67
v_cvt_pk_bf16_f32 v96, v64, v65
v_mfma_f32_16x16x32_bf16 v[92:95], v[44:47], v[252:255], 0
ds_read_b64_tr_b16 v[60:61], v5 offset:4608
v_exp_f32 v68, v68
v_exp_f32 v69, v69
v_cvt_pk_bf16_f32 v97, v66, v67
v_mfma_f32_16x16x32_bf16 v[88:91], v[40:43], v[252:255], 0
ds_read_b64_tr_b16 v[62:63], v5 offset:5632
v_exp_f32 v70, v70
v_exp_f32 v71, v71
v_cvt_pk_bf16_f32 v98, v68, v69
v_mfma_f32_16x16x32_bf16 v[128:131], v[48:51], v[104:107], 0
s_waitcnt vmcnt(5)
s_barrier
ds_read_b128 v[32:35], v4 offset:8192
s_add_u32 m0, s41, 0
v_exp_f32 v72, v72
v_exp_f32 v73, v73
v_cvt_pk_bf16_f32 v99, v70, v71
v_mfma_f32_16x16x32_bf16 v[132:135], v[52:55], v[104:107], 0
ds_read_b128 v[36:39], v4 offset:9216
v_exp_f32 v74, v74
v_exp_f32 v75, v75
v_cvt_pk_bf16_f32 v100, v72, v73
v_mfma_f32_16x16x32_bf16 v[140:143], v[52:55], v[108:111], 0
v_exp_f32 v76, v76
v_exp_f32 v77, v77
v_cvt_pk_bf16_f32 v101, v74, v75
v_mfma_f32_16x16x32_bf16 v[136:139], v[48:51], v[108:111], 0
v_exp_f32 v78, v78
v_exp_f32 v79, v79
v_cvt_pk_bf16_f32 v102, v76, v77
v_smfmac_f32_16x16x64_bf16 v[148:151], v[152:155], v[104:111], v156
v_cvt_pk_bf16_f32 v103, v78, v79
s_waitcnt lgkmcnt(1)
v_mfma_f32_16x16x32_bf16 v[64:67], v[32:35], v[240:243], 0
v_exp_f32 v80, v80
v_exp_f32 v81, v81
s_waitcnt lgkmcnt(0)
v_mfma_f32_16x16x32_bf16 v[68:71], v[36:39], v[240:243], 0
v_exp_f32 v82, v82
v_exp_f32 v83, v83
v_cvt_pk_bf16_f32 v104, v80, v81
v_mfma_f32_16x16x32_bf16 v[76:79], v[36:39], v[244:247], 0
buffer_load_dwordx4 v7, s[8:11], s40 offen lds
s_add_u32 s40, s40, 2048
v_exp_f32 v84, v84
v_exp_f32 v85, v85
v_cvt_pk_bf16_f32 v105, v82, v83
v_mfma_f32_16x16x32_bf16 v[72:75], v[32:35], v[244:247], 0
v_exp_f32 v86, v86
v_exp_f32 v87, v87
v_cvt_pk_bf16_f32 v106, v84, v85
v_mfma_f32_16x16x32_bf16 v[112:115], v[56:59], v[96:99], v[112:115]
v_exp_f32 v88, v88
v_exp_f32 v89, v89
v_cvt_pk_bf16_f32 v107, v86, v87
v_mfma_f32_16x16x32_bf16 v[116:119], v[60:63], v[96:99], v[116:119]
v_exp_f32 v90, v90
v_exp_f32 v91, v91
v_cvt_pk_bf16_f32 v108, v88, v89
v_mfma_f32_16x16x32_bf16 v[124:127], v[60:63], v[100:103], v[124:127]
v_exp_f32 v92, v92
v_exp_f32 v93, v93
v_cvt_pk_bf16_f32 v109, v90, v91
v_mfma_f32_16x16x32_bf16 v[120:123], v[56:59], v[100:103], v[120:123]
v_exp_f32 v94, v94
v_exp_f32 v95, v95
v_cvt_pk_bf16_f32 v110, v92, v93
v_smfmac_f32_16x16x64_bf16 v[144:147], v[152:155], v[96:103], v156
v_cvt_pk_bf16_f32 v111, v94, v95
v_mfma_f32_16x16x32_bf16 v[80:83], v[32:35], v[248:251], 0
ds_read_b64_tr_b16 v[48:49], v5 offset:8192
v_exp_f32 v64, v64
v_exp_f32 v65, v65
v_mfma_f32_16x16x32_bf16 v[84:87], v[36:39], v[248:251], 0
ds_read_b64_tr_b16 v[50:51], v5 offset:9216
v_exp_f32 v66, v66
v_exp_f32 v67, v67
v_cvt_pk_bf16_f32 v96, v64, v65
v_mfma_f32_16x16x32_bf16 v[92:95], v[36:39], v[252:255], 0
ds_read_b64_tr_b16 v[52:53], v5 offset:8704
v_exp_f32 v68, v68
v_exp_f32 v69, v69
v_cvt_pk_bf16_f32 v97, v66, v67
v_mfma_f32_16x16x32_bf16 v[88:91], v[32:35], v[252:255], 0
ds_read_b64_tr_b16 v[54:55], v5 offset:9728
v_exp_f32 v70, v70
v_exp_f32 v71, v71
v_cvt_pk_bf16_f32 v98, v68, v69
v_mfma_f32_16x16x32_bf16 v[128:131], v[56:59], v[104:107], v[128:131]
s_waitcnt vmcnt(5)
s_barrier
ds_read_b128 v[40:43], v4 offset:12288
s_add_u32 m0, s41, 4096
v_exp_f32 v72, v72
v_exp_f32 v73, v73
v_cvt_pk_bf16_f32 v99, v70, v71
v_mfma_f32_16x16x32_bf16 v[132:135], v[60:63], v[104:107], v[132:135]
ds_read_b128 v[44:47], v4 offset:13312
v_exp_f32 v74, v74
v_exp_f32 v75, v75
v_cvt_pk_bf16_f32 v100, v72, v73
v_mfma_f32_16x16x32_bf16 v[140:143], v[60:63], v[108:111], v[140:143]
v_exp_f32 v76, v76
v_exp_f32 v77, v77
v_cvt_pk_bf16_f32 v101, v74, v75
v_mfma_f32_16x16x32_bf16 v[136:139], v[56:59], v[108:111], v[136:139]
v_exp_f32 v78, v78
v_exp_f32 v79, v79
v_cvt_pk_bf16_f32 v102, v76, v77
v_smfmac_f32_16x16x64_bf16 v[148:151], v[152:155], v[104:111], v156
v_cvt_pk_bf16_f32 v103, v78, v79
s_waitcnt lgkmcnt(1)
v_mfma_f32_16x16x32_bf16 v[64:67], v[40:43], v[240:243], 0
v_exp_f32 v80, v80
v_exp_f32 v81, v81
s_waitcnt lgkmcnt(0)
v_mfma_f32_16x16x32_bf16 v[68:71], v[44:47], v[240:243], 0
v_exp_f32 v82, v82
v_exp_f32 v83, v83
v_cvt_pk_bf16_f32 v104, v80, v81
v_mfma_f32_16x16x32_bf16 v[76:79], v[44:47], v[244:247], 0
buffer_load_dwordx4 v7, s[8:11], s40 offen lds
s_add_u32 s40, s40, 2048
v_exp_f32 v84, v84
v_exp_f32 v85, v85
v_cvt_pk_bf16_f32 v105, v82, v83
v_mfma_f32_16x16x32_bf16 v[72:75], v[40:43], v[244:247], 0
v_exp_f32 v86, v86
v_exp_f32 v87, v87
v_cvt_pk_bf16_f32 v106, v84, v85
v_mfma_f32_16x16x32_bf16 v[112:115], v[48:51], v[96:99], v[112:115]
v_exp_f32 v88, v88
v_exp_f32 v89, v89
v_cvt_pk_bf16_f32 v107, v86, v87
v_mfma_f32_16x16x32_bf16 v[116:119], v[52:55], v[96:99], v[116:119]
v_exp_f32 v90, v90
v_exp_f32 v91, v91
v_cvt_pk_bf16_f32 v108, v88, v89
v_mfma_f32_16x16x32_bf16 v[124:127], v[52:55], v[100:103], v[124:127]
v_exp_f32 v92, v92
v_exp_f32 v93, v93
v_cvt_pk_bf16_f32 v109, v90, v91
v_mfma_f32_16x16x32_bf16 v[120:123], v[48:51], v[100:103], v[120:123]
v_exp_f32 v94, v94
v_exp_f32 v95, v95
v_cvt_pk_bf16_f32 v110, v92, v93
v_smfmac_f32_16x16x64_bf16 v[144:147], v[152:155], v[96:103], v156
v_cvt_pk_bf16_f32 v111, v94, v95
v_mfma_f32_16x16x32_bf16 v[80:83], v[40:43], v[248:251], 0
ds_read_b64_tr_b16 v[56:57], v5 offset:12288
v_exp_f32 v64, v64
v_exp_f32 v65, v65
v_mfma_f32_16x16x32_bf16 v[84:87], v[44:47], v[248:251], 0
ds_read_b64_tr_b16 v[58:59], v5 offset:13312
v_exp_f32 v66, v66
v_exp_f32 v67, v67
v_cvt_pk_bf16_f32 v96, v64, v65
v_mfma_f32_16x16x32_bf16 v[92:95], v[44:47], v[252:255], 0
ds_read_b64_tr_b16 v[60:61], v5 offset:12800
v_exp_f32 v68, v68
v_exp_f32 v69, v69
v_cvt_pk_bf16_f32 v97, v66, v67
v_mfma_f32_16x16x32_bf16 v[88:91], v[40:43], v[252:255], 0
ds_read_b64_tr_b16 v[62:63], v5 offset:13824
v_exp_f32 v70, v70
v_exp_f32 v71, v71
v_cvt_pk_bf16_f32 v98, v68, v69
v_mfma_f32_16x16x32_bf16 v[128:131], v[48:51], v[104:107], v[128:131]
s_waitcnt vmcnt(5)
s_barrier
ds_read_b128 v[32:35], v4 offset:16384
s_add_u32 m0, s41, 8192
v_exp_f32 v72, v72
v_exp_f32 v73, v73
v_cvt_pk_bf16_f32 v99, v70, v71
v_mfma_f32_16x16x32_bf16 v[132:135], v[52:55], v[104:107], v[132:135]
ds_read_b128 v[36:39], v4 offset:17408
v_exp_f32 v74, v74
v_exp_f32 v75, v75
v_cvt_pk_bf16_f32 v100, v72, v73
v_mfma_f32_16x16x32_bf16 v[140:143], v[52:55], v[108:111], v[140:143]
v_exp_f32 v76, v76
v_exp_f32 v77, v77
v_cvt_pk_bf16_f32 v101, v74, v75
v_mfma_f32_16x16x32_bf16 v[136:139], v[48:51], v[108:111], v[136:139]
v_exp_f32 v78, v78
v_exp_f32 v79, v79
v_cvt_pk_bf16_f32 v102, v76, v77
v_smfmac_f32_16x16x64_bf16 v[148:151], v[152:155], v[104:111], v156
v_cvt_pk_bf16_f32 v103, v78, v79
s_waitcnt lgkmcnt(1)
v_mfma_f32_16x16x32_bf16 v[64:67], v[32:35], v[240:243], 0
v_exp_f32 v80, v80
v_exp_f32 v81, v81
s_waitcnt lgkmcnt(0)
v_mfma_f32_16x16x32_bf16 v[68:71], v[36:39], v[240:243], 0
v_exp_f32 v82, v82
v_exp_f32 v83, v83
v_cvt_pk_bf16_f32 v104, v80, v81
v_mfma_f32_16x16x32_bf16 v[76:79], v[36:39], v[244:247], 0
buffer_load_dwordx4 v7, s[8:11], s40 offen lds
s_add_u32 s40, s40, 2048
v_exp_f32 v84, v84
v_exp_f32 v85, v85
v_cvt_pk_bf16_f32 v105, v82, v83
v_mfma_f32_16x16x32_bf16 v[72:75], v[32:35], v[244:247], 0
v_exp_f32 v86, v86
v_exp_f32 v87, v87
v_cvt_pk_bf16_f32 v106, v84, v85
v_mfma_f32_16x16x32_bf16 v[112:115], v[56:59], v[96:99], v[112:115]
v_exp_f32 v88, v88
v_exp_f32 v89, v89
v_cvt_pk_bf16_f32 v107, v86, v87
v_mfma_f32_16x16x32_bf16 v[116:119], v[60:63], v[96:99], v[116:119]
v_exp_f32 v90, v90
v_exp_f32 v91, v91
v_cvt_pk_bf16_f32 v108, v88, v89
v_mfma_f32_16x16x32_bf16 v[124:127], v[60:63], v[100:103], v[124:127]
v_exp_f32 v92, v92
v_exp_f32 v93, v93
v_cvt_pk_bf16_f32 v109, v90, v91
v_mfma_f32_16x16x32_bf16 v[120:123], v[56:59], v[100:103], v[120:123]
v_exp_f32 v94, v94
v_exp_f32 v95, v95
v_cvt_pk_bf16_f32 v110, v92, v93
v_smfmac_f32_16x16x64_bf16 v[144:147], v[152:155], v[96:103], v156
v_cvt_pk_bf16_f32 v111, v94, v95
v_mfma_f32_16x16x32_bf16 v[80:83], v[32:35], v[248:251], 0
ds_read_b64_tr_b16 v[48:49], v5 offset:16384
v_exp_f32 v64, v64
v_exp_f32 v65, v65
v_mfma_f32_16x16x32_bf16 v[84:87], v[36:39], v[248:251], 0
ds_read_b64_tr_b16 v[50:51], v5 offset:17408
v_exp_f32 v66, v66
v_exp_f32 v67, v67
v_cvt_pk_bf16_f32 v96, v64, v65
v_mfma_f32_16x16x32_bf16 v[92:95], v[36:39], v[252:255], 0
ds_read_b64_tr_b16 v[52:53], v5 offset:16896
v_exp_f32 v68, v68
v_exp_f32 v69, v69
v_cvt_pk_bf16_f32 v97, v66, v67
v_mfma_f32_16x16x32_bf16 v[88:91], v[32:35], v[252:255], 0
ds_read_b64_tr_b16 v[54:55], v5 offset:17920
v_exp_f32 v70, v70
v_exp_f32 v71, v71
v_cvt_pk_bf16_f32 v98, v68, v69
v_mfma_f32_16x16x32_bf16 v[128:131], v[56:59], v[104:107], v[128:131]
s_waitcnt vmcnt(5)
s_barrier
ds_read_b128 v[40:43], v4 offset:20480
s_add_u32 m0, s41, 12288
v_exp_f32 v72, v72
v_exp_f32 v73, v73
v_cvt_pk_bf16_f32 v99, v70, v71
v_mfma_f32_16x16x32_bf16 v[132:135], v[60:63], v[104:107], v[132:135]
ds_read_b128 v[44:47], v4 offset:21504
v_exp_f32 v74, v74
v_exp_f32 v75, v75
v_cvt_pk_bf16_f32 v100, v72, v73
v_mfma_f32_16x16x32_bf16 v[140:143], v[60:63], v[108:111], v[140:143]
v_exp_f32 v76, v76
v_exp_f32 v77, v77
v_cvt_pk_bf16_f32 v101, v74, v75
v_mfma_f32_16x16x32_bf16 v[136:139], v[56:59], v[108:111], v[136:139]
v_exp_f32 v78, v78
v_exp_f32 v79, v79
v_cvt_pk_bf16_f32 v102, v76, v77
v_smfmac_f32_16x16x64_bf16 v[148:151], v[152:155], v[104:111], v156
v_cvt_pk_bf16_f32 v103, v78, v79
s_waitcnt lgkmcnt(1)
v_mfma_f32_16x16x32_bf16 v[64:67], v[40:43], v[240:243], 0
v_exp_f32 v80, v80
v_exp_f32 v81, v81
s_waitcnt lgkmcnt(0)
v_mfma_f32_16x16x32_bf16 v[68:71], v[44:47], v[240:243], 0
v_exp_f32 v82, v82
v_exp_f32 v83, v83
v_cvt_pk_bf16_f32 v104, v80, v81
v_mfma_f32_16x16x32_bf16 v[76:79], v[44:47], v[244:247], 0
buffer_load_dwordx4 v7, s[8:11], s40 offen lds
s_add_u32 s40, s40, 2048
v_exp_f32 v84, v84
v_exp_f32 v85, v85
v_cvt_pk_bf16_f32 v105, v82, v83
v_mfma_f32_16x16x32_bf16 v[72:75], v[40:43], v[244:247], 0
v_exp_f32 v86, v86
v_exp_f32 v87, v87
v_cvt_pk_bf16_f32 v106, v84, v85
v_mfma_f32_16x16x32_bf16 v[112:115], v[48:51], v[96:99], v[112:115]
v_exp_f32 v88, v88
v_exp_f32 v89, v89
v_cvt_pk_bf16_f32 v107, v86, v87
v_mfma_f32_16x16x32_bf16 v[116:119], v[52:55], v[96:99], v[116:119]
v_exp_f32 v90, v90
v_exp_f32 v91, v91
v_cvt_pk_bf16_f32 v108, v88, v89
v_mfma_f32_16x16x32_bf16 v[124:127], v[52:55], v[100:103], v[124:127]
v_exp_f32 v92, v92
v_exp_f32 v93, v93
v_cvt_pk_bf16_f32 v109, v90, v91
v_mfma_f32_16x16x32_bf16 v[120:123], v[48:51], v[100:103], v[120:123]
v_exp_f32 v94, v94
v_exp_f32 v95, v95
v_cvt_pk_bf16_f32 v110, v92, v93
v_smfmac_f32_16x16x64_bf16 v[144:147], v[152:155], v[96:103], v156
v_cvt_pk_bf16_f32 v111, v94, v95
v_mfma_f32_16x16x32_bf16 v[80:83], v[40:43], v[248:251], 0
ds_read_b64_tr_b16 v[56:57], v5 offset:20480
v_exp_f32 v64, v64
v_exp_f32 v65, v65
v_mfma_f32_16x16x32_bf16 v[84:87], v[44:47], v[248:251], 0
ds_read_b64_tr_b16 v[58:59], v5 offset:21504
v_exp_f32 v66, v66
v_exp_f32 v67, v67
v_cvt_pk_bf16_f32 v96, v64, v65
v_mfma_f32_16x16x32_bf16 v[92:95], v[44:47], v[252:255], 0
ds_read_b64_tr_b16 v[60:61], v5 offset:20992
v_exp_f32 v68, v68
v_exp_f32 v69, v69
v_cvt_pk_bf16_f32 v97, v66, v67
v_mfma_f32_16x16x32_bf16 v[88:91], v[40:43], v[252:255], 0
ds_read_b64_tr_b16 v[62:63], v5 offset:22016
v_exp_f32 v70, v70
v_exp_f32 v71, v71
v_cvt_pk_bf16_f32 v98, v68, v69
v_mfma_f32_16x16x32_bf16 v[128:131], v[48:51], v[104:107], v[128:131]
s_waitcnt vmcnt(5)
s_barrier
ds_read_b128 v[32:35], v4 offset:24576
s_add_u32 m0, s41, 16384
v_exp_f32 v72, v72
v_exp_f32 v73, v73
v_cvt_pk_bf16_f32 v99, v70, v71
v_mfma_f32_16x16x32_bf16 v[132:135], v[52:55], v[104:107], v[132:135]
ds_read_b128 v[36:39], v4 offset:25600
v_exp_f32 v74, v74
v_exp_f32 v75, v75
v_cvt_pk_bf16_f32 v100, v72, v73
v_mfma_f32_16x16x32_bf16 v[140:143], v[52:55], v[108:111], v[140:143]
v_exp_f32 v76, v76
v_exp_f32 v77, v77
v_cvt_pk_bf16_f32 v101, v74, v75
v_mfma_f32_16x16x32_bf16 v[136:139], v[48:51], v[108:111], v[136:139]
v_exp_f32 v78, v78
v_exp_f32 v79, v79
v_cvt_pk_bf16_f32 v102, v76, v77
v_smfmac_f32_16x16x64_bf16 v[148:151], v[152:155], v[104:111], v156
v_cvt_pk_bf16_f32 v103, v78, v79
s_waitcnt lgkmcnt(1)
v_mfma_f32_16x16x32_bf16 v[64:67], v[32:35], v[240:243], 0
v_exp_f32 v80, v80
v_exp_f32 v81, v81
s_waitcnt lgkmcnt(0)
v_mfma_f32_16x16x32_bf16 v[68:71], v[36:39], v[240:243], 0
v_exp_f32 v82, v82
v_exp_f32 v83, v83
v_cvt_pk_bf16_f32 v104, v80, v81
v_mfma_f32_16x16x32_bf16 v[76:79], v[36:39], v[244:247], 0
buffer_load_dwordx4 v7, s[8:11], s40 offen lds
s_add_u32 s40, s40, 2048
v_exp_f32 v84, v84
v_exp_f32 v85, v85
v_cvt_pk_bf16_f32 v105, v82, v83
v_mfma_f32_16x16x32_bf16 v[72:75], v[32:35], v[244:247], 0
v_exp_f32 v86, v86
v_exp_f32 v87, v87
v_cvt_pk_bf16_f32 v106, v84, v85
v_mfma_f32_16x16x32_bf16 v[112:115], v[56:59], v[96:99], v[112:115]
v_exp_f32 v88, v88
v_exp_f32 v89, v89
v_cvt_pk_bf16_f32 v107, v86, v87
v_mfma_f32_16x16x32_bf16 v[116:119], v[60:63], v[96:99], v[116:119]
v_exp_f32 v90, v90
v_exp_f32 v91, v91
v_cvt_pk_bf16_f32 v108, v88, v89
v_mfma_f32_16x16x32_bf16 v[124:127], v[60:63], v[100:103], v[124:127]
v_exp_f32 v92, v92
v_exp_f32 v93, v93
v_cvt_pk_bf16_f32 v109, v90, v91
v_mfma_f32_16x16x32_bf16 v[120:123], v[56:59], v[100:103], v[120:123]
v_exp_f32 v94, v94
v_exp_f32 v95, v95
v_cvt_pk_bf16_f32 v110, v92, v93
v_smfmac_f32_16x16x64_bf16 v[144:147], v[152:155], v[96:103], v156
v_cvt_pk_bf16_f32 v111, v94, v95
v_mfma_f32_16x16x32_bf16 v[80:83], v[32:35], v[248:251], 0
ds_read_b64_tr_b16 v[48:49], v5 offset:24576
v_exp_f32 v64, v64
v_exp_f32 v65, v65
v_mfma_f32_16x16x32_bf16 v[84:87], v[36:39], v[248:251], 0
ds_read_b64_tr_b16 v[50:51], v5 offset:25600
v_exp_f32 v66, v66
v_exp_f32 v67, v67
v_cvt_pk_bf16_f32 v96, v64, v65
v_mfma_f32_16x16x32_bf16 v[92:95], v[36:39], v[252:255], 0
ds_read_b64_tr_b16 v[52:53], v5 offset:25088
v_exp_f32 v68, v68
v_exp_f32 v69, v69
v_cvt_pk_bf16_f32 v97, v66, v67
v_mfma_f32_16x16x32_bf16 v[88:91], v[32:35], v[252:255], 0
ds_read_b64_tr_b16 v[54:55], v5 offset:26112
v_exp_f32 v70, v70
v_exp_f32 v71, v71
v_cvt_pk_bf16_f32 v98, v68, v69
v_mfma_f32_16x16x32_bf16 v[128:131], v[56:59], v[104:107], v[128:131]
s_waitcnt vmcnt(5)
s_barrier
ds_read_b128 v[40:43], v4 offset:28672
s_add_u32 m0, s41, 20480
v_exp_f32 v72, v72
v_exp_f32 v73, v73
v_cvt_pk_bf16_f32 v99, v70, v71
v_mfma_f32_16x16x32_bf16 v[132:135], v[60:63], v[104:107], v[132:135]
ds_read_b128 v[44:47], v4 offset:29696
v_exp_f32 v74, v74
v_exp_f32 v75, v75
v_cvt_pk_bf16_f32 v100, v72, v73
v_mfma_f32_16x16x32_bf16 v[140:143], v[60:63], v[108:111], v[140:143]
v_exp_f32 v76, v76
v_exp_f32 v77, v77
v_cvt_pk_bf16_f32 v101, v74, v75
v_mfma_f32_16x16x32_bf16 v[136:139], v[56:59], v[108:111], v[136:139]
v_exp_f32 v78, v78
v_exp_f32 v79, v79
v_cvt_pk_bf16_f32 v102, v76, v77
v_smfmac_f32_16x16x64_bf16 v[148:151], v[152:155], v[104:111], v156
v_cvt_pk_bf16_f32 v103, v78, v79
s_waitcnt lgkmcnt(1)
v_mfma_f32_16x16x32_bf16 v[64:67], v[40:43], v[240:243], 0
v_exp_f32 v80, v80
v_exp_f32 v81, v81
s_waitcnt lgkmcnt(0)
v_mfma_f32_16x16x32_bf16 v[68:71], v[44:47], v[240:243], 0
v_exp_f32 v82, v82
v_exp_f32 v83, v83
v_cvt_pk_bf16_f32 v104, v80, v81
v_mfma_f32_16x16x32_bf16 v[76:79], v[44:47], v[244:247], 0
buffer_load_dwordx4 v7, s[8:11], s40 offen lds
s_add_u32 s40, s40, 2048
v_exp_f32 v84, v84
v_exp_f32 v85, v85
v_cvt_pk_bf16_f32 v105, v82, v83
v_mfma_f32_16x16x32_bf16 v[72:75], v[40:43], v[244:247], 0
v_exp_f32 v86, v86
v_exp_f32 v87, v87
v_cvt_pk_bf16_f32 v106, v84, v85
v_mfma_f32_16x16x32_bf16 v[112:115], v[48:51], v[96:99], v[112:115]
v_exp_f32 v88, v88
v_exp_f32 v89, v89
v_cvt_pk_bf16_f32 v107, v86, v87
v_mfma_f32_16x16x32_bf16 v[116:119], v[52:55], v[96:99], v[116:119]
v_exp_f32 v90, v90
v_exp_f32 v91, v91
v_cvt_pk_bf16_f32 v108, v88, v89
v_mfma_f32_16x16x32_bf16 v[124:127], v[52:55], v[100:103], v[124:127]
v_exp_f32 v92, v92
v_exp_f32 v93, v93
v_cvt_pk_bf16_f32 v109, v90, v91
v_mfma_f32_16x16x32_bf16 v[120:123], v[48:51], v[100:103], v[120:123]
v_exp_f32 v94, v94
v_exp_f32 v95, v95
v_cvt_pk_bf16_f32 v110, v92, v93
v_smfmac_f32_16x16x64_bf16 v[144:147], v[152:155], v[96:103], v156
v_cvt_pk_bf16_f32 v111, v94, v95
v_mfma_f32_16x16x32_bf16 v[80:83], v[40:43], v[248:251], 0
ds_read_b64_tr_b16 v[56:57], v5 offset:28672
v_exp_f32 v64, v64
v_exp_f32 v65, v65
v_mfma_f32_16x16x32_bf16 v[84:87], v[44:47], v[248:251], 0
ds_read_b64_tr_b16 v[58:59], v5 offset:29696
v_exp_f32 v66, v66
v_exp_f32 v67, v67
v_cvt_pk_bf16_f32 v96, v64, v65
v_mfma_f32_16x16x32_bf16 v[92:95], v[44:47], v[252:255], 0
ds_read_b64_tr_b16 v[60:61], v5 offset:29184
v_exp_f32 v68, v68
v_exp_f32 v69, v69
v_cvt_pk_bf16_f32 v97, v66, v67
v_mfma_f32_16x16x32_bf16 v[88:91], v[40:43], v[252:255], 0
ds_read_b64_tr_b16 v[62:63], v5 offset:30208
v_exp_f32 v70, v70
v_exp_f32 v71, v71
v_cvt_pk_bf16_f32 v98, v68, v69
v_mfma_f32_16x16x32_bf16 v[128:131], v[48:51], v[104:107], v[128:131]
s_waitcnt vmcnt(5)
s_barrier
ds_read_b128 v[32:35], v4 offset:0
s_add_u32 m0, s41, 24576
v_exp_f32 v72, v72
v_exp_f32 v73, v73
v_cvt_pk_bf16_f32 v99, v70, v71
v_mfma_f32_16x16x32_bf16 v[132:135], v[52:55], v[104:107], v[132:135]
ds_read_b128 v[36:39], v4 offset:1024
v_exp_f32 v74, v74
v_exp_f32 v75, v75
v_cvt_pk_bf16_f32 v100, v72, v73
v_mfma_f32_16x16x32_bf16 v[140:143], v[52:55], v[108:111], v[140:143]
v_exp_f32 v76, v76
v_exp_f32 v77, v77
v_cvt_pk_bf16_f32 v101, v74, v75
v_mfma_f32_16x16x32_bf16 v[136:139], v[48:51], v[108:111], v[136:139]
v_exp_f32 v78, v78
v_exp_f32 v79, v79
v_cvt_pk_bf16_f32 v102, v76, v77
v_smfmac_f32_16x16x64_bf16 v[148:151], v[152:155], v[104:111], v156
v_cvt_pk_bf16_f32 v103, v78, v79
s_waitcnt lgkmcnt(1)
v_mfma_f32_16x16x32_bf16 v[64:67], v[32:35], v[240:243], 0
v_exp_f32 v80, v80
v_exp_f32 v81, v81
s_waitcnt lgkmcnt(0)
v_mfma_f32_16x16x32_bf16 v[68:71], v[36:39], v[240:243], 0
v_exp_f32 v82, v82
v_exp_f32 v83, v83
v_cvt_pk_bf16_f32 v104, v80, v81
v_mfma_f32_16x16x32_bf16 v[76:79], v[36:39], v[244:247], 0
buffer_load_dwordx4 v7, s[8:11], s40 offen lds
s_add_u32 s40, s40, 2048
v_exp_f32 v84, v84
v_exp_f32 v85, v85
v_cvt_pk_bf16_f32 v105, v82, v83
v_mfma_f32_16x16x32_bf16 v[72:75], v[32:35], v[244:247], 0
v_exp_f32 v86, v86
v_exp_f32 v87, v87
v_cvt_pk_bf16_f32 v106, v84, v85
v_mfma_f32_16x16x32_bf16 v[112:115], v[56:59], v[96:99], v[112:115]
v_exp_f32 v88, v88
v_exp_f32 v89, v89
v_cvt_pk_bf16_f32 v107, v86, v87
v_mfma_f32_16x16x32_bf16 v[116:119], v[60:63], v[96:99], v[116:119]
v_exp_f32 v90, v90
v_exp_f32 v91, v91
v_cvt_pk_bf16_f32 v108, v88, v89
v_mfma_f32_16x16x32_bf16 v[124:127], v[60:63], v[100:103], v[124:127]
v_exp_f32 v92, v92
v_exp_f32 v93, v93
v_cvt_pk_bf16_f32 v109, v90, v91
v_mfma_f32_16x16x32_bf16 v[120:123], v[56:59], v[100:103], v[120:123]
v_exp_f32 v94, v94
v_exp_f32 v95, v95
v_cvt_pk_bf16_f32 v110, v92, v93
v_smfmac_f32_16x16x64_bf16 v[144:147], v[152:155], v[96:103], v156
v_cvt_pk_bf16_f32 v111, v94, v95
L_att_loop:
v_mfma_f32_16x16x32_bf16 v[80:83], v[32:35], v[248:251], 0
ds_read_b64_tr_b16 v[48:49], v5 offset:0
v_exp_f32 v64, v64
v_exp_f32 v65, v65
v_mfma_f32_16x16x32_bf16 v[84:87], v[36:39], v[248:251], 0
ds_read_b64_tr_b16 v[50:51], v5 offset:1024
v_exp_f32 v66, v66
v_exp_f32 v67, v67
v_cvt_pk_bf16_f32 v96, v64, v65
v_mfma_f32_16x16x32_bf16 v[92:95], v[36:39], v[252:255], 0
ds_read_b64_tr_b16 v[52:53], v5 offset:512
v_exp_f32 v68, v68
v_exp_f32 v69, v69
v_cvt_pk_bf16_f32 v97, v66, v67
v_mfma_f32_16x16x32_bf16 v[88:91], v[32:35], v[252:255], 0
ds_read_b64_tr_b16 v[54:55], v5 offset:1536
v_exp_f32 v70, v70
v_exp_f32 v71, v71
v_cvt_pk_bf16_f32 v98, v68, v69
v_mfma_f32_16x16x32_bf16 v[128:131], v[56:59], v[104:107], v[128:131]
s_waitcnt vmcnt(5)
s_barrier
ds_read_b128 v[40:43], v4 offset:4096
s_add_u32 m0, s41, 28672
v_exp_f32 v72, v72
v_exp_f32 v73, v73
v_cvt_pk_bf16_f32 v99, v70, v71
v_mfma_f32_16x16x32_bf16 v[132:135], v[60:63], v[104:107], v[132:135]
ds_read_b128 v[44:47], v4 offset:5120
v_exp_f32 v74, v74
v_exp_f32 v75, v75
v_cvt_pk_bf16_f32 v100, v72, v73
v_mfma_f32_16x16x32_bf16 v[140:143], v[60:63], v[108:111], v[140:143]
v_exp_f32 v76, v76
v_exp_f32 v77, v77
v_cvt_pk_bf16_f32 v101, v74, v75
v_mfma_f32_16x16x32_bf16 v[136:139], v[56:59], v[108:111], v[136:139]
v_exp_f32 v78, v78
v_exp_f32 v79, v79
v_cvt_pk_bf16_f32 v102, v76, v77
v_smfmac_f32_16x16x64_bf16 v[148:151], v[152:155], v[104:111], v156
v_cvt_pk_bf16_f32 v103, v78, v79
s_waitcnt lgkmcnt(1)
v_mfma_f32_16x16x32_bf16 v[64:67], v[40:43], v[240:243], 0
v_exp_f32 v80, v80
v_exp_f32 v81, v81
s_waitcnt lgkmcnt(0)
v_mfma_f32_16x16x32_bf16 v[68:71], v[44:47], v[240:243], 0
v_exp_f32 v82, v82
v_exp_f32 v83, v83
v_cvt_pk_bf16_f32 v104, v80, v81
v_mfma_f32_16x16x32_bf16 v[76:79], v[44:47], v[244:247], 0
buffer_load_dwordx4 v7, s[8:11], s40 offen lds
s_add_u32 s40, s40, 2048
v_exp_f32 v84, v84
v_exp_f32 v85, v85
v_cvt_pk_bf16_f32 v105, v82, v83
v_mfma_f32_16x16x32_bf16 v[72:75], v[40:43], v[244:247], 0
v_exp_f32 v86, v86
v_exp_f32 v87, v87
v_cvt_pk_bf16_f32 v106, v84, v85
v_mfma_f32_16x16x32_bf16 v[112:115], v[48:51], v[96:99], v[112:115]
v_exp_f32 v88, v88
v_exp_f32 v89, v89
v_cvt_pk_bf16_f32 v107, v86, v87
v_mfma_f32_16x16x32_bf16 v[116:119], v[52:55], v[96:99], v[116:119]
v_exp_f32 v90, v90
v_exp_f32 v91, v91
v_cvt_pk_bf16_f32 v108, v88, v89
v_mfma_f32_16x16x32_bf16 v[124:127], v[52:55], v[100:103], v[124:127]
v_exp_f32 v92, v92
v_exp_f32 v93, v93
v_cvt_pk_bf16_f32 v109, v90, v91
v_mfma_f32_16x16x32_bf16 v[120:123], v[48:51], v[100:103], v[120:123]
v_exp_f32 v94, v94
v_exp_f32 v95, v95
v_cvt_pk_bf16_f32 v110, v92, v93
v_smfmac_f32_16x16x64_bf16 v[144:147], v[152:155], v[96:103], v156
v_cvt_pk_bf16_f32 v111, v94, v95
v_mfma_f32_16x16x32_bf16 v[80:83], v[40:43], v[248:251], 0
ds_read_b64_tr_b16 v[56:57], v5 offset:4096
v_exp_f32 v64, v64
v_exp_f32 v65, v65
v_mfma_f32_16x16x32_bf16 v[84:87], v[44:47], v[248:251], 0
ds_read_b64_tr_b16 v[58:59], v5 offset:5120
v_exp_f32 v66, v66
v_exp_f32 v67, v67
v_cvt_pk_bf16_f32 v96, v64, v65
v_mfma_f32_16x16x32_bf16 v[92:95], v[44:47], v[252:255], 0
ds_read_b64_tr_b16 v[60:61], v5 offset:4608
v_exp_f32 v68, v68
v_exp_f32 v69, v69
v_cvt_pk_bf16_f32 v97, v66, v67
v_mfma_f32_16x16x32_bf16 v[88:91], v[40:43], v[252:255], 0
ds_read_b64_tr_b16 v[62:63], v5 offset:5632
v_exp_f32 v70, v70
v_exp_f32 v71, v71
v_cvt_pk_bf16_f32 v98, v68, v69
v_mfma_f32_16x16x32_bf16 v[128:131], v[48:51], v[104:107], v[128:131]
s_waitcnt vmcnt(5)
s_barrier
ds_read_b128 v[32:35], v4 offset:8192
s_add_u32 m0, s41, 0
v_exp_f32 v72, v72
v_exp_f32 v73, v73
v_cvt_pk_bf16_f32 v99, v70, v71
v_mfma_f32_16x16x32_bf16 v[132:135], v[52:55], v[104:107], v[132:135]
ds_read_b128 v[36:39], v4 offset:9216
v_exp_f32 v74, v74
v_exp_f32 v75, v75
v_cvt_pk_bf16_f32 v100, v72, v73
v_mfma_f32_16x16x32_bf16 v[140:143], v[52:55], v[108:111], v[140:143]
v_exp_f32 v76, v76
v_exp_f32 v77, v77
v_cvt_pk_bf16_f32 v101, v74, v75
v_mfma_f32_16x16x32_bf16 v[136:139], v[48:51], v[108:111], v[136:139]
v_exp_f32 v78, v78
v_exp_f32 v79, v79
v_cvt_pk_bf16_f32 v102, v76, v77
v_smfmac_f32_16x16x64_bf16 v[148:151], v[152:155], v[104:111], v156
v_cvt_pk_bf16_f32 v103, v78, v79
s_waitcnt lgkmcnt(1)
v_mfma_f32_16x16x32_bf16 v[64:67], v[32:35], v[240:243], 0
v_exp_f32 v80, v80
v_exp_f32 v81, v81
s_waitcnt lgkmcnt(0)
v_mfma_f32_16x16x32_bf16 v[68:71], v[36:39], v[240:243], 0
v_exp_f32 v82, v82
v_exp_f32 v83, v83
v_cvt_pk_bf16_f32 v104, v80, v81
v_mfma_f32_16x16x32_bf16 v[76:79], v[36:39], v[244:247], 0
buffer_load_dwordx4 v7, s[8:11], s40 offen lds
s_add_u32 s40, s40, 2048
v_exp_f32 v84, v84
v_exp_f32 v85, v85
v_cvt_pk_bf16_f32 v105, v82, v83
v_mfma_f32_16x16x32_bf16 v[72:75], v[32:35], v[244:247], 0
v_exp_f32 v86, v86
v_exp_f32 v87, v87
v_cvt_pk_bf16_f32 v106, v84, v85
v_mfma_f32_16x16x32_bf16 v[112:115], v[56:59], v[96:99], v[112:115]
v_exp_f32 v88, v88
v_exp_f32 v89, v89
v_cvt_pk_bf16_f32 v107, v86, v87
v_mfma_f32_16x16x32_bf16 v[116:119], v[60:63], v[96:99], v[116:119]
v_exp_f32 v90, v90
v_exp_f32 v91, v91
v_cvt_pk_bf16_f32 v108, v88, v89
v_mfma_f32_16x16x32_bf16 v[124:127], v[60:63], v[100:103], v[124:127]
v_exp_f32 v92, v92
v_exp_f32 v93, v93
v_cvt_pk_bf16_f32 v109, v90, v91
v_mfma_f32_16x16x32_bf16 v[120:123], v[56:59], v[100:103], v[120:123]
v_exp_f32 v94, v94
v_exp_f32 v95, v95
v_cvt_pk_bf16_f32 v110, v92, v93
v_smfmac_f32_16x16x64_bf16 v[144:147], v[152:155], v[96:103], v156
v_cvt_pk_bf16_f32 v111, v94, v95
v_mfma_f32_16x16x32_bf16 v[80:83], v[32:35], v[248:251], 0
ds_read_b64_tr_b16 v[48:49], v5 offset:8192
v_exp_f32 v64, v64
v_exp_f32 v65, v65
v_mfma_f32_16x16x32_bf16 v[84:87], v[36:39], v[248:251], 0
ds_read_b64_tr_b16 v[50:51], v5 offset:9216
v_exp_f32 v66, v66
v_exp_f32 v67, v67
v_cvt_pk_bf16_f32 v96, v64, v65
v_mfma_f32_16x16x32_bf16 v[92:95], v[36:39], v[252:255], 0
ds_read_b64_tr_b16 v[52:53], v5 offset:8704
v_exp_f32 v68, v68
v_exp_f32 v69, v69
v_cvt_pk_bf16_f32 v97, v66, v67
v_mfma_f32_16x16x32_bf16 v[88:91], v[32:35], v[252:255], 0
ds_read_b64_tr_b16 v[54:55], v5 offset:9728
v_exp_f32 v70, v70
v_exp_f32 v71, v71
v_cvt_pk_bf16_f32 v98, v68, v69
v_mfma_f32_16x16x32_bf16 v[128:131], v[56:59], v[104:107], v[128:131]
s_waitcnt vmcnt(5)
s_barrier
ds_read_b128 v[40:43], v4 offset:12288
s_add_u32 m0, s41, 4096
v_exp_f32 v72, v72
v_exp_f32 v73, v73
v_cvt_pk_bf16_f32 v99, v70, v71
v_mfma_f32_16x16x32_bf16 v[132:135], v[60:63], v[104:107], v[132:135]
ds_read_b128 v[44:47], v4 offset:13312
v_exp_f32 v74, v74
v_exp_f32 v75, v75
v_cvt_pk_bf16_f32 v100, v72, v73
v_mfma_f32_16x16x32_bf16 v[140:143], v[60:63], v[108:111], v[140:143]
v_exp_f32 v76, v76
v_exp_f32 v77, v77
v_cvt_pk_bf16_f32 v101, v74, v75
v_mfma_f32_16x16x32_bf16 v[136:139], v[56:59], v[108:111], v[136:139]
v_exp_f32 v78, v78
v_exp_f32 v79, v79
v_cvt_pk_bf16_f32 v102, v76, v77
v_smfmac_f32_16x16x64_bf16 v[148:151], v[152:155], v[104:111], v156
v_cvt_pk_bf16_f32 v103, v78, v79
s_waitcnt lgkmcnt(1)
v_mfma_f32_16x16x32_bf16 v[64:67], v[40:43], v[240:243], 0
v_exp_f32 v80, v80
v_exp_f32 v81, v81
s_waitcnt lgkmcnt(0)
v_mfma_f32_16x16x32_bf16 v[68:71], v[44:47], v[240:243], 0
v_exp_f32 v82, v82
v_exp_f32 v83, v83
v_cvt_pk_bf16_f32 v104, v80, v81
v_mfma_f32_16x16x32_bf16 v[76:79], v[44:47], v[244:247], 0
buffer_load_dwordx4 v7, s[8:11], s40 offen lds
s_add_u32 s40, s40, 2048
v_exp_f32 v84, v84
v_exp_f32 v85, v85
v_cvt_pk_bf16_f32 v105, v82, v83
v_mfma_f32_16x16x32_bf16 v[72:75], v[40:43], v[244:247], 0
v_exp_f32 v86, v86
v_exp_f32 v87, v87
v_cvt_pk_bf16_f32 v106, v84, v85
v_mfma_f32_16x16x32_bf16 v[112:115], v[48:51], v[96:99], v[112:115]
v_exp_f32 v88, v88
v_exp_f32 v89, v89
v_cvt_pk_bf16_f32 v107, v86, v87
v_mfma_f32_16x16x32_bf16 v[116:119], v[52:55], v[96:99], v[116:119]
v_exp_f32 v90, v90
v_exp_f32 v91, v91
v_cvt_pk_bf16_f32 v108, v88, v89
v_mfma_f32_16x16x32_bf16 v[124:127], v[52:55], v[100:103], v[124:127]
v_exp_f32 v92, v92
v_exp_f32 v93, v93
v_cvt_pk_bf16_f32 v109, v90, v91
v_mfma_f32_16x16x32_bf16 v[120:123], v[48:51], v[100:103], v[120:123]
v_exp_f32 v94, v94
v_exp_f32 v95, v95
v_cvt_pk_bf16_f32 v110, v92, v93
v_smfmac_f32_16x16x64_bf16 v[144:147], v[152:155], v[96:103], v156
v_cvt_pk_bf16_f32 v111, v94, v95
v_mfma_f32_16x16x32_bf16 v[80:83], v[40:43], v[248:251], 0
ds_read_b64_tr_b16 v[56:57], v5 offset:12288
v_exp_f32 v64, v64
v_exp_f32 v65, v65
v_mfma_f32_16x16x32_bf16 v[84:87], v[44:47], v[248:251], 0
ds_read_b64_tr_b16 v[58:59], v5 offset:13312
v_exp_f32 v66, v66
v_exp_f32 v67, v67
v_cvt_pk_bf16_f32 v96, v64, v65
v_mfma_f32_16x16x32_bf16 v[92:95], v[44:47], v[252:255], 0
ds_read_b64_tr_b16 v[60:61], v5 offset:12800
v_exp_f32 v68, v68
v_exp_f32 v69, v69
v_cvt_pk_bf16_f32 v97, v66, v67
v_mfma_f32_16x16x32_bf16 v[88:91], v[40:43], v[252:255], 0
ds_read_b64_tr_b16 v[62:63], v5 offset:13824
v_exp_f32 v70, v70
v_exp_f32 v71, v71
v_cvt_pk_bf16_f32 v98, v68, v69
v_mfma_f32_16x16x32_bf16 v[128:131], v[48:51], v[104:107], v[128:131]
s_waitcnt vmcnt(5)
s_barrier
ds_read_b128 v[32:35], v4 offset:16384
s_add_u32 m0, s41, 8192
v_exp_f32 v72, v72
v_exp_f32 v73, v73
v_cvt_pk_bf16_f32 v99, v70, v71
v_mfma_f32_16x16x32_bf16 v[132:135], v[52:55], v[104:107], v[132:135]
ds_read_b128 v[36:39], v4 offset:17408
v_exp_f32 v74, v74
v_exp_f32 v75, v75
v_cvt_pk_bf16_f32 v100, v72, v73
v_mfma_f32_16x16x32_bf16 v[140:143], v[52:55], v[108:111], v[140:143]
v_exp_f32 v76, v76
v_exp_f32 v77, v77
v_cvt_pk_bf16_f32 v101, v74, v75
v_mfma_f32_16x16x32_bf16 v[136:139], v[48:51], v[108:111], v[136:139]
v_exp_f32 v78, v78
v_exp_f32 v79, v79
v_cvt_pk_bf16_f32 v102, v76, v77
v_smfmac_f32_16x16x64_bf16 v[148:151], v[152:155], v[104:111], v156
v_cvt_pk_bf16_f32 v103, v78, v79
s_waitcnt lgkmcnt(1)
v_mfma_f32_16x16x32_bf16 v[64:67], v[32:35], v[240:243], 0
v_exp_f32 v80, v80
v_exp_f32 v81, v81
s_waitcnt lgkmcnt(0)
v_mfma_f32_16x16x32_bf16 v[68:71], v[36:39], v[240:243], 0
v_exp_f32 v82, v82
v_exp_f32 v83, v83
v_cvt_pk_bf16_f32 v104, v80, v81
v_mfma_f32_16x16x32_bf16 v[76:79], v[36:39], v[244:247], 0
buffer_load_dwordx4 v7, s[8:11], s40 offen lds
s_add_u32 s40, s40, 2048
v_exp_f32 v84, v84
v_exp_f32 v85, v85
v_cvt_pk_bf16_f32 v105, v82, v83
v_mfma_f32_16x16x32_bf16 v[72:75], v[32:35], v[244:247], 0
v_exp_f32 v86, v86
v_exp_f32 v87, v87
v_cvt_pk_bf16_f32 v106, v84, v85
v_mfma_f32_16x16x32_bf16 v[112:115], v[56:59], v[96:99], v[112:115]
v_exp_f32 v88, v88
v_exp_f32 v89, v89
v_cvt_pk_bf16_f32 v107, v86, v87
v_mfma_f32_16x16x32_bf16 v[116:119], v[60:63], v[96:99], v[116:119]
v_exp_f32 v90, v90
v_exp_f32 v91, v91
v_cvt_pk_bf16_f32 v108, v88, v89
v_mfma_f32_16x16x32_bf16 v[124:127], v[60:63], v[100:103], v[124:127]
v_exp_f32 v92, v92
v_exp_f32 v93, v93
v_cvt_pk_bf16_f32 v109, v90, v91
v_mfma_f32_16x16x32_bf16 v[120:123], v[56:59], v[100:103], v[120:123]
v_exp_f32 v94, v94
v_exp_f32 v95, v95
v_cvt_pk_bf16_f32 v110, v92, v93
v_smfmac_f32_16x16x64_bf16 v[144:147], v[152:155], v[96:103], v156
v_cvt_pk_bf16_f32 v111, v94, v95
v_mfma_f32_16x16x32_bf16 v[80:83], v[32:35], v[248:251], 0
ds_read_b64_tr_b16 v[48:49], v5 offset:16384
v_exp_f32 v64, v64
v_exp_f32 v65, v65
v_mfma_f32_16x16x32_bf16 v[84:87], v[36:39], v[248:251], 0
ds_read_b64_tr_b16 v[50:51], v5 offset:17408
v_exp_f32 v66, v66
v_exp_f32 v67, v67
v_cvt_pk_bf16_f32 v96, v64, v65
v_mfma_f32_16x16x32_bf16 v[92:95], v[36:39], v[252:255], 0
ds_read_b64_tr_b16 v[52:53], v5 offset:16896
v_exp_f32 v68, v68
v_exp_f32 v69, v69
v_cvt_pk_bf16_f32 v97, v66, v67
v_mfma_f32_16x16x32_bf16 v[88:91], v[32:35], v[252:255], 0
ds_read_b64_tr_b16 v[54:55], v5 offset:17920
v_exp_f32 v70, v70
v_exp_f32 v71, v71
v_cvt_pk_bf16_f32 v98, v68, v69
v_mfma_f32_16x16x32_bf16 v[128:131], v[56:59], v[104:107], v[128:131]
s_waitcnt vmcnt(5)
s_barrier
ds_read_b128 v[40:43], v4 offset:20480
s_add_u32 m0, s41, 12288
v_exp_f32 v72, v72
v_exp_f32 v73, v73
v_cvt_pk_bf16_f32 v99, v70, v71
v_mfma_f32_16x16x32_bf16 v[132:135], v[60:63], v[104:107], v[132:135]
ds_read_b128 v[44:47], v4 offset:21504
v_exp_f32 v74, v74
v_exp_f32 v75, v75
v_cvt_pk_bf16_f32 v100, v72, v73
v_mfma_f32_16x16x32_bf16 v[140:143], v[60:63], v[108:111], v[140:143]
v_exp_f32 v76, v76
v_exp_f32 v77, v77
v_cvt_pk_bf16_f32 v101, v74, v75
v_mfma_f32_16x16x32_bf16 v[136:139], v[56:59], v[108:111], v[136:139]
v_exp_f32 v78, v78
v_exp_f32 v79, v79
v_cvt_pk_bf16_f32 v102, v76, v77
v_smfmac_f32_16x16x64_bf16 v[148:151], v[152:155], v[104:111], v156
v_cvt_pk_bf16_f32 v103, v78, v79
s_waitcnt lgkmcnt(1)
v_mfma_f32_16x16x32_bf16 v[64:67], v[40:43], v[240:243], 0
v_exp_f32 v80, v80
v_exp_f32 v81, v81
s_waitcnt lgkmcnt(0)
v_mfma_f32_16x16x32_bf16 v[68:71], v[44:47], v[240:243], 0
v_exp_f32 v82, v82
v_exp_f32 v83, v83
v_cvt_pk_bf16_f32 v104, v80, v81
v_mfma_f32_16x16x32_bf16 v[76:79], v[44:47], v[244:247], 0
buffer_load_dwordx4 v7, s[8:11], s40 offen lds
s_add_u32 s40, s40, 2048
v_exp_f32 v84, v84
v_exp_f32 v85, v85
v_cvt_pk_bf16_f32 v105, v82, v83
v_mfma_f32_16x16x32_bf16 v[72:75], v[40:43], v[244:247], 0
v_exp_f32 v86, v86
v_exp_f32 v87, v87
v_cvt_pk_bf16_f32 v106, v84, v85
v_mfma_f32_16x16x32_bf16 v[112:115], v[48:51], v[96:99], v[112:115]
v_exp_f32 v88, v88
v_exp_f32 v89, v89
v_cvt_pk_bf16_f32 v107, v86, v87
v_mfma_f32_16x16x32_bf16 v[116:119], v[52:55], v[96:99], v[116:119]
v_exp_f32 v90, v90
v_exp_f32 v91, v91
v_cvt_pk_bf16_f32 v108, v88, v89
v_mfma_f32_16x16x32_bf16 v[124:127], v[52:55], v[100:103], v[124:127]
v_exp_f32 v92, v92
v_exp_f32 v93, v93
v_cvt_pk_bf16_f32 v109, v90, v91
v_mfma_f32_16x16x32_bf16 v[120:123], v[48:51], v[100:103], v[120:123]
v_exp_f32 v94, v94
v_exp_f32 v95, v95
v_cvt_pk_bf16_f32 v110, v92, v93
v_smfmac_f32_16x16x64_bf16 v[144:147], v[152:155], v[96:103], v156
v_cvt_pk_bf16_f32 v111, v94, v95
v_mfma_f32_16x16x32_bf16 v[80:83], v[40:43], v[248:251], 0
ds_read_b64_tr_b16 v[56:57], v5 offset:20480
v_exp_f32 v64, v64
v_exp_f32 v65, v65
v_mfma_f32_16x16x32_bf16 v[84:87], v[44:47], v[248:251], 0
ds_read_b64_tr_b16 v[58:59], v5 offset:21504
v_exp_f32 v66, v66
v_exp_f32 v67, v67
v_cvt_pk_bf16_f32 v96, v64, v65
v_mfma_f32_16x16x32_bf16 v[92:95], v[44:47], v[252:255], 0
ds_read_b64_tr_b16 v[60:61], v5 offset:20992
v_exp_f32 v68, v68
v_exp_f32 v69, v69
v_cvt_pk_bf16_f32 v97, v66, v67
v_mfma_f32_16x16x32_bf16 v[88:91], v[40:43], v[252:255], 0
ds_read_b64_tr_b16 v[62:63], v5 offset:22016
v_exp_f32 v70, v70
v_exp_f32 v71, v71
v_cvt_pk_bf16_f32 v98, v68, v69
v_mfma_f32_16x16x32_bf16 v[128:131], v[48:51], v[104:107], v[128:131]
s_waitcnt vmcnt(5)
s_barrier
ds_read_b128 v[32:35], v4 offset:24576
s_add_u32 m0, s41, 16384
v_exp_f32 v72, v72
v_exp_f32 v73, v73
v_cvt_pk_bf16_f32 v99, v70, v71
v_mfma_f32_16x16x32_bf16 v[132:135], v[52:55], v[104:107], v[132:135]
ds_read_b128 v[36:39], v4 offset:25600
v_exp_f32 v74, v74
v_exp_f32 v75, v75
v_cvt_pk_bf16_f32 v100, v72, v73
v_mfma_f32_16x16x32_bf16 v[140:143], v[52:55], v[108:111], v[140:143]
v_exp_f32 v76, v76
v_exp_f32 v77, v77
v_cvt_pk_bf16_f32 v101, v74, v75
v_mfma_f32_16x16x32_bf16 v[136:139], v[48:51], v[108:111], v[136:139]
v_exp_f32 v78, v78
v_exp_f32 v79, v79
v_cvt_pk_bf16_f32 v102, v76, v77
v_smfmac_f32_16x16x64_bf16 v[148:151], v[152:155], v[104:111], v156
v_cvt_pk_bf16_f32 v103, v78, v79
s_waitcnt lgkmcnt(1)
v_mfma_f32_16x16x32_bf16 v[64:67], v[32:35], v[240:243], 0
v_exp_f32 v80, v80
v_exp_f32 v81, v81
s_waitcnt lgkmcnt(0)
v_mfma_f32_16x16x32_bf16 v[68:71], v[36:39], v[240:243], 0
v_exp_f32 v82, v82
v_exp_f32 v83, v83
v_cvt_pk_bf16_f32 v104, v80, v81
v_mfma_f32_16x16x32_bf16 v[76:79], v[36:39], v[244:247], 0
buffer_load_dwordx4 v7, s[8:11], s40 offen lds
s_add_u32 s40, s40, 2048
v_exp_f32 v84, v84
v_exp_f32 v85, v85
v_cvt_pk_bf16_f32 v105, v82, v83
v_mfma_f32_16x16x32_bf16 v[72:75], v[32:35], v[244:247], 0
v_exp_f32 v86, v86
v_exp_f32 v87, v87
v_cvt_pk_bf16_f32 v106, v84, v85
v_mfma_f32_16x16x32_bf16 v[112:115], v[56:59], v[96:99], v[112:115]
v_exp_f32 v88, v88
v_exp_f32 v89, v89
v_cvt_pk_bf16_f32 v107, v86, v87
v_mfma_f32_16x16x32_bf16 v[116:119], v[60:63], v[96:99], v[116:119]
v_exp_f32 v90, v90
v_exp_f32 v91, v91
v_cvt_pk_bf16_f32 v108, v88, v89
v_mfma_f32_16x16x32_bf16 v[124:127], v[60:63], v[100:103], v[124:127]
v_exp_f32 v92, v92
v_exp_f32 v93, v93
v_cvt_pk_bf16_f32 v109, v90, v91
v_mfma_f32_16x16x32_bf16 v[120:123], v[56:59], v[100:103], v[120:123]
v_exp_f32 v94, v94
v_exp_f32 v95, v95
v_cvt_pk_bf16_f32 v110, v92, v93
v_smfmac_f32_16x16x64_bf16 v[144:147], v[152:155], v[96:103], v156
v_cvt_pk_bf16_f32 v111, v94, v95
v_mfma_f32_16x16x32_bf16 v[80:83], v[32:35], v[248:251], 0
ds_read_b64_tr_b16 v[48:49], v5 offset:24576
v_exp_f32 v64, v64
v_exp_f32 v65, v65
v_mfma_f32_16x16x32_bf16 v[84:87], v[36:39], v[248:251], 0
ds_read_b64_tr_b16 v[50:51], v5 offset:25600
v_exp_f32 v66, v66
v_exp_f32 v67, v67
v_cvt_pk_bf16_f32 v96, v64, v65
v_mfma_f32_16x16x32_bf16 v[92:95], v[36:39], v[252:255], 0
ds_read_b64_tr_b16 v[52:53], v5 offset:25088
v_exp_f32 v68, v68
v_exp_f32 v69, v69
v_cvt_pk_bf16_f32 v97, v66, v67
v_mfma_f32_16x16x32_bf16 v[88:91], v[32:35], v[252:255], 0
ds_read_b64_tr_b16 v[54:55], v5 offset:26112
v_exp_f32 v70, v70
v_exp_f32 v71, v71
v_cvt_pk_bf16_f32 v98, v68, v69
v_mfma_f32_16x16x32_bf16 v[128:131], v[56:59], v[104:107], v[128:131]
s_waitcnt vmcnt(5)
s_barrier
ds_read_b128 v[40:43], v4 offset:28672
s_add_u32 m0, s41, 20480
v_exp_f32 v72, v72
v_exp_f32 v73, v73
v_cvt_pk_bf16_f32 v99, v70, v71
v_mfma_f32_16x16x32_bf16 v[132:135], v[60:63], v[104:107], v[132:135]
ds_read_b128 v[44:47], v4 offset:29696
v_exp_f32 v74, v74
v_exp_f32 v75, v75
v_cvt_pk_bf16_f32 v100, v72, v73
v_mfma_f32_16x16x32_bf16 v[140:143], v[60:63], v[108:111], v[140:143]
v_exp_f32 v76, v76
v_exp_f32 v77, v77
v_cvt_pk_bf16_f32 v101, v74, v75
v_mfma_f32_16x16x32_bf16 v[136:139], v[56:59], v[108:111], v[136:139]
v_exp_f32 v78, v78
v_exp_f32 v79, v79
v_cvt_pk_bf16_f32 v102, v76, v77
v_smfmac_f32_16x16x64_bf16 v[148:151], v[152:155], v[104:111], v156
v_cvt_pk_bf16_f32 v103, v78, v79
s_waitcnt lgkmcnt(1)
v_mfma_f32_16x16x32_bf16 v[64:67], v[40:43], v[240:243], 0
v_exp_f32 v80, v80
v_exp_f32 v81, v81
s_waitcnt lgkmcnt(0)
v_mfma_f32_16x16x32_bf16 v[68:71], v[44:47], v[240:243], 0
v_exp_f32 v82, v82
v_exp_f32 v83, v83
v_cvt_pk_bf16_f32 v104, v80, v81
v_mfma_f32_16x16x32_bf16 v[76:79], v[44:47], v[244:247], 0
buffer_load_dwordx4 v7, s[8:11], s40 offen lds
s_add_u32 s40, s40, 2048
v_exp_f32 v84, v84
v_exp_f32 v85, v85
v_cvt_pk_bf16_f32 v105, v82, v83
v_mfma_f32_16x16x32_bf16 v[72:75], v[40:43], v[244:247], 0
v_exp_f32 v86, v86
v_exp_f32 v87, v87
v_cvt_pk_bf16_f32 v106, v84, v85
v_mfma_f32_16x16x32_bf16 v[112:115], v[48:51], v[96:99], v[112:115]
v_exp_f32 v88, v88
v_exp_f32 v89, v89
v_cvt_pk_bf16_f32 v107, v86, v87
v_mfma_f32_16x16x32_bf16 v[116:119], v[52:55], v[96:99], v[116:119]
v_exp_f32 v90, v90
v_exp_f32 v91, v91
v_cvt_pk_bf16_f32 v108, v88, v89
v_mfma_f32_16x16x32_bf16 v[124:127], v[52:55], v[100:103], v[124:127]
v_exp_f32 v92, v92
v_exp_f32 v93, v93
v_cvt_pk_bf16_f32 v109, v90, v91
v_mfma_f32_16x16x32_bf16 v[120:123], v[48:51], v[100:103], v[120:123]
v_exp_f32 v94, v94
v_exp_f32 v95, v95
v_cvt_pk_bf16_f32 v110, v92, v93
v_smfmac_f32_16x16x64_bf16 v[144:147], v[152:155], v[96:103], v156
v_cvt_pk_bf16_f32 v111, v94, v95
v_mfma_f32_16x16x32_bf16 v[80:83], v[40:43], v[248:251], 0
ds_read_b64_tr_b16 v[56:57], v5 offset:28672
v_exp_f32 v64, v64
v_exp_f32 v65, v65
v_mfma_f32_16x16x32_bf16 v[84:87], v[44:47], v[248:251], 0
ds_read_b64_tr_b16 v[58:59], v5 offset:29696
v_exp_f32 v66, v66
v_exp_f32 v67, v67
v_cvt_pk_bf16_f32 v96, v64, v65
v_mfma_f32_16x16x32_bf16 v[92:95], v[44:47], v[252:255], 0
ds_read_b64_tr_b16 v[60:61], v5 offset:29184
v_exp_f32 v68, v68
v_exp_f32 v69, v69
v_cvt_pk_bf16_f32 v97, v66, v67
v_mfma_f32_16x16x32_bf16 v[88:91], v[40:43], v[252:255], 0
ds_read_b64_tr_b16 v[62:63], v5 offset:30208
v_exp_f32 v70, v70
v_exp_f32 v71, v71
v_cvt_pk_bf16_f32 v98, v68, v69
v_mfma_f32_16x16x32_bf16 v[128:131], v[48:51], v[104:107], v[128:131]
s_waitcnt vmcnt(5)
s_barrier
ds_read_b128 v[32:35], v4 offset:0
s_add_u32 m0, s41, 24576
v_exp_f32 v72, v72
v_exp_f32 v73, v73
v_cvt_pk_bf16_f32 v99, v70, v71
v_mfma_f32_16x16x32_bf16 v[132:135], v[52:55], v[104:107], v[132:135]
ds_read_b128 v[36:39], v4 offset:1024
v_exp_f32 v74, v74
v_exp_f32 v75, v75
v_cvt_pk_bf16_f32 v100, v72, v73
v_mfma_f32_16x16x32_bf16 v[140:143], v[52:55], v[108:111], v[140:143]
v_exp_f32 v76, v76
v_exp_f32 v77, v77
v_cvt_pk_bf16_f32 v101, v74, v75
v_mfma_f32_16x16x32_bf16 v[136:139], v[48:51], v[108:111], v[136:139]
v_exp_f32 v78, v78
v_exp_f32 v79, v79
v_cvt_pk_bf16_f32 v102, v76, v77
v_smfmac_f32_16x16x64_bf16 v[148:151], v[152:155], v[104:111], v156
v_cvt_pk_bf16_f32 v103, v78, v79
s_waitcnt lgkmcnt(1)
v_mfma_f32_16x16x32_bf16 v[64:67], v[32:35], v[240:243], 0
v_exp_f32 v80, v80
v_exp_f32 v81, v81
s_waitcnt lgkmcnt(0)
v_mfma_f32_16x16x32_bf16 v[68:71], v[36:39], v[240:243], 0
v_exp_f32 v82, v82
v_exp_f32 v83, v83
v_cvt_pk_bf16_f32 v104, v80, v81
v_mfma_f32_16x16x32_bf16 v[76:79], v[36:39], v[244:247], 0
buffer_load_dwordx4 v7, s[8:11], s40 offen lds
s_add_u32 s40, s40, 2048
v_exp_f32 v84, v84
v_exp_f32 v85, v85
v_cvt_pk_bf16_f32 v105, v82, v83
v_mfma_f32_16x16x32_bf16 v[72:75], v[32:35], v[244:247], 0
v_exp_f32 v86, v86
v_exp_f32 v87, v87
v_cvt_pk_bf16_f32 v106, v84, v85
v_mfma_f32_16x16x32_bf16 v[112:115], v[56:59], v[96:99], v[112:115]
v_exp_f32 v88, v88
v_exp_f32 v89, v89
v_cvt_pk_bf16_f32 v107, v86, v87
v_mfma_f32_16x16x32_bf16 v[116:119], v[60:63], v[96:99], v[116:119]
v_exp_f32 v90, v90
v_exp_f32 v91, v91
v_cvt_pk_bf16_f32 v108, v88, v89
v_mfma_f32_16x16x32_bf16 v[124:127], v[60:63], v[100:103], v[124:127]
v_exp_f32 v92, v92
v_exp_f32 v93, v93
v_cvt_pk_bf16_f32 v109, v90, v91
v_mfma_f32_16x16x32_bf16 v[120:123], v[56:59], v[100:103], v[120:123]
v_exp_f32 v94, v94
v_exp_f32 v95, v95
v_cvt_pk_bf16_f32 v110, v92, v93
v_smfmac_f32_16x16x64_bf16 v[144:147], v[152:155], v[96:103], v156
v_cvt_pk_bf16_f32 v111, v94, v95
s_sub_u32 s45, s45, 1
s_cmp_lg_u32 s45, 0
s_cbranch_scc1 L_att_loop
v_mfma_f32_16x16x32_bf16 v[80:83], v[32:35], v[248:251], 0
ds_read_b64_tr_b16 v[48:49], v5 offset:0
v_exp_f32 v64, v64
v_exp_f32 v65, v65
v_mfma_f32_16x16x32_bf16 v[84:87], v[36:39], v[248:251], 0
ds_read_b64_tr_b16 v[50:51], v5 offset:1024
v_exp_f32 v66, v66
v_exp_f32 v67, v67
v_cvt_pk_bf16_f32 v96, v64, v65
v_mfma_f32_16x16x32_bf16 v[92:95], v[36:39], v[252:255], 0
ds_read_b64_tr_b16 v[52:53], v5 offset:512
v_exp_f32 v68, v68
v_exp_f32 v69, v69
v_cvt_pk_bf16_f32 v97, v66, v67
v_mfma_f32_16x16x32_bf16 v[88:91], v[32:35], v[252:255], 0
ds_read_b64_tr_b16 v[54:55], v5 offset:1536
v_exp_f32 v70, v70
v_exp_f32 v71, v71
v_cvt_pk_bf16_f32 v98, v68, v69
v_mfma_f32_16x16x32_bf16 v[128:131], v[56:59], v[104:107], v[128:131]
s_waitcnt vmcnt(5)
s_barrier
ds_read_b128 v[40:43], v4 offset:4096
s_add_u32 m0, s41, 28672
v_exp_f32 v72, v72
v_exp_f32 v73, v73
v_cvt_pk_bf16_f32 v99, v70, v71
v_mfma_f32_16x16x32_bf16 v[132:135], v[60:63], v[104:107], v[132:135]
ds_read_b128 v[44:47], v4 offset:5120
v_exp_f32 v74, v74
v_exp_f32 v75, v75
v_cvt_pk_bf16_f32 v100, v72, v73
v_mfma_f32_16x16x32_bf16 v[140:143], v[60:63], v[108:111], v[140:143]
v_exp_f32 v76, v76
v_exp_f32 v77, v77
v_cvt_pk_bf16_f32 v101, v74, v75
v_mfma_f32_16x16x32_bf16 v[136:139], v[56:59], v[108:111], v[136:139]
v_exp_f32 v78, v78
v_exp_f32 v79, v79
v_cvt_pk_bf16_f32 v102, v76, v77
v_smfmac_f32_16x16x64_bf16 v[148:151], v[152:155], v[104:111], v156
v_cvt_pk_bf16_f32 v103, v78, v79
s_waitcnt lgkmcnt(1)
v_mfma_f32_16x16x32_bf16 v[64:67], v[40:43], v[240:243], 0
v_exp_f32 v80, v80
v_exp_f32 v81, v81
s_waitcnt lgkmcnt(0)
v_mfma_f32_16x16x32_bf16 v[68:71], v[44:47], v[240:243], 0
v_exp_f32 v82, v82
v_exp_f32 v83, v83
v_cvt_pk_bf16_f32 v104, v80, v81
v_mfma_f32_16x16x32_bf16 v[76:79], v[44:47], v[244:247], 0
buffer_load_dwordx4 v7, s[8:11], s40 offen lds
s_add_u32 s40, s40, 2048
v_exp_f32 v84, v84
v_exp_f32 v85, v85
v_cvt_pk_bf16_f32 v105, v82, v83
v_mfma_f32_16x16x32_bf16 v[72:75], v[40:43], v[244:247], 0
v_exp_f32 v86, v86
v_exp_f32 v87, v87
v_cvt_pk_bf16_f32 v106, v84, v85
v_mfma_f32_16x16x32_bf16 v[112:115], v[48:51], v[96:99], v[112:115]
v_exp_f32 v88, v88
v_exp_f32 v89, v89
v_cvt_pk_bf16_f32 v107, v86, v87
v_mfma_f32_16x16x32_bf16 v[116:119], v[52:55], v[96:99], v[116:119]
v_exp_f32 v90, v90
v_exp_f32 v91, v91
v_cvt_pk_bf16_f32 v108, v88, v89
v_mfma_f32_16x16x32_bf16 v[124:127], v[52:55], v[100:103], v[124:127]
v_exp_f32 v92, v92
v_exp_f32 v93, v93
v_cvt_pk_bf16_f32 v109, v90, v91
v_mfma_f32_16x16x32_bf16 v[120:123], v[48:51], v[100:103], v[120:123]
v_exp_f32 v94, v94
v_exp_f32 v95, v95
v_cvt_pk_bf16_f32 v110, v92, v93
v_smfmac_f32_16x16x64_bf16 v[144:147], v[152:155], v[96:103], v156
v_cvt_pk_bf16_f32 v111, v94, v95
v_mfma_f32_16x16x32_bf16 v[80:83], v[40:43], v[248:251], 0
ds_read_b64_tr_b16 v[56:57], v5 offset:4096
v_exp_f32 v64, v64
v_exp_f32 v65, v65
v_mfma_f32_16x16x32_bf16 v[84:87], v[44:47], v[248:251], 0
ds_read_b64_tr_b16 v[58:59], v5 offset:5120
v_exp_f32 v66, v66
v_exp_f32 v67, v67
v_cvt_pk_bf16_f32 v96, v64, v65
v_mfma_f32_16x16x32_bf16 v[92:95], v[44:47], v[252:255], 0
ds_read_b64_tr_b16 v[60:61], v5 offset:4608
v_exp_f32 v68, v68
v_exp_f32 v69, v69
v_cvt_pk_bf16_f32 v97, v66, v67
v_mfma_f32_16x16x32_bf16 v[88:91], v[40:43], v[252:255], 0
ds_read_b64_tr_b16 v[62:63], v5 offset:5632
v_exp_f32 v70, v70
v_exp_f32 v71, v71
v_cvt_pk_bf16_f32 v98, v68, v69
v_mfma_f32_16x16x32_bf16 v[128:131], v[48:51], v[104:107], v[128:131]
s_waitcnt vmcnt(5)
s_barrier
v_mov_b32 v12, 0
ds_write_b32 v4, v12
ds_read_b128 v[32:35], v4 offset:8192
v_exp_f32 v72, v72
v_exp_f32 v73, v73
v_cvt_pk_bf16_f32 v99, v70, v71
v_mfma_f32_16x16x32_bf16 v[132:135], v[52:55], v[104:107], v[132:135]
ds_read_b128 v[36:39], v4 offset:9216
v_exp_f32 v74, v74
v_exp_f32 v75, v75
v_cvt_pk_bf16_f32 v100, v72, v73
v_mfma_f32_16x16x32_bf16 v[140:143], v[52:55], v[108:111], v[140:143]
v_exp_f32 v76, v76
v_exp_f32 v77, v77
v_cvt_pk_bf16_f32 v101, v74, v75
v_mfma_f32_16x16x32_bf16 v[136:139], v[48:51], v[108:111], v[136:139]
v_exp_f32 v78, v78
v_exp_f32 v79, v79
v_cvt_pk_bf16_f32 v102, v76, v77
v_smfmac_f32_16x16x64_bf16 v[148:151], v[152:155], v[104:111], v156
v_cvt_pk_bf16_f32 v103, v78, v79
s_waitcnt lgkmcnt(1)
v_mfma_f32_16x16x32_bf16 v[64:67], v[32:35], v[240:243], 0
v_exp_f32 v80, v80
v_exp_f32 v81, v81
s_waitcnt lgkmcnt(0)
v_mfma_f32_16x16x32_bf16 v[68:71], v[36:39], v[240:243], 0
v_exp_f32 v82, v82
v_exp_f32 v83, v83
v_cvt_pk_bf16_f32 v104, v80, v81
v_mfma_f32_16x16x32_bf16 v[76:79], v[36:39], v[244:247], 0
v_exp_f32 v84, v84
v_exp_f32 v85, v85
v_cvt_pk_bf16_f32 v105, v82, v83
v_mfma_f32_16x16x32_bf16 v[72:75], v[32:35], v[244:247], 0
v_exp_f32 v86, v86
v_exp_f32 v87, v87
v_cvt_pk_bf16_f32 v106, v84, v85
v_mfma_f32_16x16x32_bf16 v[112:115], v[56:59], v[96:99], v[112:115]
v_exp_f32 v88, v88
v_exp_f32 v89, v89
v_cvt_pk_bf16_f32 v107, v86, v87
v_mfma_f32_16x16x32_bf16 v[116:119], v[60:63], v[96:99], v[116:119]
v_exp_f32 v90, v90
v_exp_f32 v91, v91
v_cvt_pk_bf16_f32 v108, v88, v89
v_mfma_f32_16x16x32_bf16 v[124:127], v[60:63], v[100:103], v[124:127]
v_exp_f32 v92, v92
v_exp_f32 v93, v93
v_cvt_pk_bf16_f32 v109, v90, v91
v_mfma_f32_16x16x32_bf16 v[120:123], v[56:59], v[100:103], v[120:123]
v_exp_f32 v94, v94
v_exp_f32 v95, v95
v_cvt_pk_bf16_f32 v110, v92, v93
v_smfmac_f32_16x16x64_bf16 v[144:147], v[152:155], v[96:103], v156
v_cvt_pk_bf16_f32 v111, v94, v95
v_mfma_f32_16x16x32_bf16 v[80:83], v[32:35], v[248:251], 0
ds_read_b64_tr_b16 v[48:49], v5 offset:8192
v_exp_f32 v64, v64
v_exp_f32 v65, v65
v_mfma_f32_16x16x32_bf16 v[84:87], v[36:39], v[248:251], 0
ds_read_b64_tr_b16 v[50:51], v5 offset:9216
v_exp_f32 v66, v66
v_exp_f32 v67, v67
v_cvt_pk_bf16_f32 v96, v64, v65
v_mfma_f32_16x16x32_bf16 v[92:95], v[36:39], v[252:255], 0
ds_read_b64_tr_b16 v[52:53], v5 offset:8704
v_exp_f32 v68, v68
v_exp_f32 v69, v69
v_cvt_pk_bf16_f32 v97, v66, v67
v_mfma_f32_16x16x32_bf16 v[88:91], v[32:35], v[252:255], 0
ds_read_b64_tr_b16 v[54:55], v5 offset:9728
v_exp_f32 v70, v70
v_exp_f32 v71, v71
v_cvt_pk_bf16_f32 v98, v68, v69
v_mfma_f32_16x16x32_bf16 v[128:131], v[56:59], v[104:107], v[128:131]
s_waitcnt vmcnt(4)
s_barrier
ds_read_b128 v[40:43], v4 offset:12288
v_exp_f32 v72, v72
v_exp_f32 v73, v73
v_cvt_pk_bf16_f32 v99, v70, v71
v_mfma_f32_16x16x32_bf16 v[132:135], v[60:63], v[104:107], v[132:135]
ds_read_b128 v[44:47], v4 offset:13312
v_exp_f32 v74, v74
v_exp_f32 v75, v75
v_cvt_pk_bf16_f32 v100, v72, v73
v_mfma_f32_16x16x32_bf16 v[140:143], v[60:63], v[108:111], v[140:143]
v_exp_f32 v76, v76
v_exp_f32 v77, v77
v_cvt_pk_bf16_f32 v101, v74, v75
v_mfma_f32_16x16x32_bf16 v[136:139], v[56:59], v[108:111], v[136:139]
v_exp_f32 v78, v78
v_exp_f32 v79, v79
v_cvt_pk_bf16_f32 v102, v76, v77
v_smfmac_f32_16x16x64_bf16 v[148:151], v[152:155], v[104:111], v156
v_cvt_pk_bf16_f32 v103, v78, v79
s_waitcnt lgkmcnt(1)
v_mfma_f32_16x16x32_bf16 v[64:67], v[40:43], v[240:243], 0
v_exp_f32 v80, v80
v_exp_f32 v81, v81
s_waitcnt lgkmcnt(0)
v_mfma_f32_16x16x32_bf16 v[68:71], v[44:47], v[240:243], 0
v_exp_f32 v82, v82
v_exp_f32 v83, v83
v_cvt_pk_bf16_f32 v104, v80, v81
v_mfma_f32_16x16x32_bf16 v[76:79], v[44:47], v[244:247], 0
v_exp_f32 v84, v84
v_exp_f32 v85, v85
v_cvt_pk_bf16_f32 v105, v82, v83
v_mfma_f32_16x16x32_bf16 v[72:75], v[40:43], v[244:247], 0
v_exp_f32 v86, v86
v_exp_f32 v87, v87
v_cvt_pk_bf16_f32 v106, v84, v85
v_mfma_f32_16x16x32_bf16 v[112:115], v[48:51], v[96:99], v[112:115]
v_exp_f32 v88, v88
v_exp_f32 v89, v89
v_cvt_pk_bf16_f32 v107, v86, v87
v_mfma_f32_16x16x32_bf16 v[116:119], v[52:55], v[96:99], v[116:119]
v_exp_f32 v90, v90
v_exp_f32 v91, v91
v_cvt_pk_bf16_f32 v108, v88, v89
v_mfma_f32_16x16x32_bf16 v[124:127], v[52:55], v[100:103], v[124:127]
v_exp_f32 v92, v92
v_exp_f32 v93, v93
v_cvt_pk_bf16_f32 v109, v90, v91
v_mfma_f32_16x16x32_bf16 v[120:123], v[48:51], v[100:103], v[120:123]
v_exp_f32 v94, v94
v_exp_f32 v95, v95
v_cvt_pk_bf16_f32 v110, v92, v93
v_smfmac_f32_16x16x64_bf16 v[144:147], v[152:155], v[96:103], v156
v_cvt_pk_bf16_f32 v111, v94, v95
v_mfma_f32_16x16x32_bf16 v[80:83], v[40:43], v[248:251], 0
ds_read_b64_tr_b16 v[56:57], v5 offset:12288
v_exp_f32 v64, v64
v_exp_f32 v65, v65
v_mfma_f32_16x16x32_bf16 v[84:87], v[44:47], v[248:251], 0
ds_read_b64_tr_b16 v[58:59], v5 offset:13312
v_exp_f32 v66, v66
v_exp_f32 v67, v67
v_cvt_pk_bf16_f32 v96, v64, v65
v_mfma_f32_16x16x32_bf16 v[92:95], v[44:47], v[252:255], 0
ds_read_b64_tr_b16 v[60:61], v5 offset:12800
v_exp_f32 v68, v68
v_exp_f32 v69, v69
v_cvt_pk_bf16_f32 v97, v66, v67
v_mfma_f32_16x16x32_bf16 v[88:91], v[40:43], v[252:255], 0
ds_read_b64_tr_b16 v[62:63], v5 offset:13824
v_exp_f32 v70, v70
v_exp_f32 v71, v71
v_cvt_pk_bf16_f32 v98, v68, v69
v_mfma_f32_16x16x32_bf16 v[128:131], v[48:51], v[104:107], v[128:131]
s_waitcnt vmcnt(3)
s_barrier
ds_read_b128 v[32:35], v4 offset:16384
v_exp_f32 v72, v72
v_exp_f32 v73, v73
v_cvt_pk_bf16_f32 v99, v70, v71
v_mfma_f32_16x16x32_bf16 v[132:135], v[52:55], v[104:107], v[132:135]
ds_read_b128 v[36:39], v4 offset:17408
v_exp_f32 v74, v74
v_exp_f32 v75, v75
v_cvt_pk_bf16_f32 v100, v72, v73
v_mfma_f32_16x16x32_bf16 v[140:143], v[52:55], v[108:111], v[140:143]
v_exp_f32 v76, v76
v_exp_f32 v77, v77
v_cvt_pk_bf16_f32 v101, v74, v75
v_mfma_f32_16x16x32_bf16 v[136:139], v[48:51], v[108:111], v[136:139]
v_exp_f32 v78, v78
v_exp_f32 v79, v79
v_cvt_pk_bf16_f32 v102, v76, v77
v_smfmac_f32_16x16x64_bf16 v[148:151], v[152:155], v[104:111], v156
v_cvt_pk_bf16_f32 v103, v78, v79
s_waitcnt lgkmcnt(1)
v_mfma_f32_16x16x32_bf16 v[64:67], v[32:35], v[240:243], 0
v_exp_f32 v80, v80
v_exp_f32 v81, v81
s_waitcnt lgkmcnt(0)
v_mfma_f32_16x16x32_bf16 v[68:71], v[36:39], v[240:243], 0
v_exp_f32 v82, v82
v_exp_f32 v83, v83
v_cvt_pk_bf16_f32 v104, v80, v81
v_mfma_f32_16x16x32_bf16 v[76:79], v[36:39], v[244:247], 0
v_exp_f32 v84, v84
v_exp_f32 v85, v85
v_cvt_pk_bf16_f32 v105, v82, v83
v_mfma_f32_16x16x32_bf16 v[72:75], v[32:35], v[244:247], 0
v_exp_f32 v86, v86
v_exp_f32 v87, v87
v_cvt_pk_bf16_f32 v106, v84, v85
v_mfma_f32_16x16x32_bf16 v[112:115], v[56:59], v[96:99], v[112:115]
v_exp_f32 v88, v88
v_exp_f32 v89, v89
v_cvt_pk_bf16_f32 v107, v86, v87
v_mfma_f32_16x16x32_bf16 v[116:119], v[60:63], v[96:99], v[116:119]
v_exp_f32 v90, v90
v_exp_f32 v91, v91
v_cvt_pk_bf16_f32 v108, v88, v89
v_mfma_f32_16x16x32_bf16 v[124:127], v[60:63], v[100:103], v[124:127]
v_exp_f32 v92, v92
v_exp_f32 v93, v93
v_cvt_pk_bf16_f32 v109, v90, v91
v_mfma_f32_16x16x32_bf16 v[120:123], v[56:59], v[100:103], v[120:123]
v_exp_f32 v94, v94
v_exp_f32 v95, v95
v_cvt_pk_bf16_f32 v110, v92, v93
v_smfmac_f32_16x16x64_bf16 v[144:147], v[152:155], v[96:103], v156
v_cvt_pk_bf16_f32 v111, v94, v95
v_mfma_f32_16x16x32_bf16 v[80:83], v[32:35], v[248:251], 0
ds_read_b64_tr_b16 v[48:49], v5 offset:16384
v_exp_f32 v64, v64
v_exp_f32 v65, v65
v_mfma_f32_16x16x32_bf16 v[84:87], v[36:39], v[248:251], 0
ds_read_b64_tr_b16 v[50:51], v5 offset:17408
v_exp_f32 v66, v66
v_exp_f32 v67, v67
v_cvt_pk_bf16_f32 v96, v64, v65
v_mfma_f32_16x16x32_bf16 v[92:95], v[36:39], v[252:255], 0
ds_read_b64_tr_b16 v[52:53], v5 offset:16896
v_exp_f32 v68, v68
v_exp_f32 v69, v69
v_cvt_pk_bf16_f32 v97, v66, v67
v_mfma_f32_16x16x32_bf16 v[88:91], v[32:35], v[252:255], 0
ds_read_b64_tr_b16 v[54:55], v5 offset:17920
v_exp_f32 v70, v70
v_exp_f32 v71, v71
v_cvt_pk_bf16_f32 v98, v68, v69
v_mfma_f32_16x16x32_bf16 v[128:131], v[56:59], v[104:107], v[128:131]
s_waitcnt vmcnt(2)
s_barrier
ds_read_b128 v[40:43], v4 offset:20480
v_exp_f32 v72, v72
v_exp_f32 v73, v73
v_cvt_pk_bf16_f32 v99, v70, v71
v_mfma_f32_16x16x32_bf16 v[132:135], v[60:63], v[104:107], v[132:135]
ds_read_b128 v[44:47], v4 offset:21504
v_exp_f32 v74, v74
v_exp_f32 v75, v75
v_cvt_pk_bf16_f32 v100, v72, v73
v_mfma_f32_16x16x32_bf16 v[140:143], v[60:63], v[108:111], v[140:143]
v_exp_f32 v76, v76
v_exp_f32 v77, v77
v_cvt_pk_bf16_f32 v101, v74, v75
v_mfma_f32_16x16x32_bf16 v[136:139], v[56:59], v[108:111], v[136:139]
v_exp_f32 v78, v78
v_exp_f32 v79, v79
v_cvt_pk_bf16_f32 v102, v76, v77
v_smfmac_f32_16x16x64_bf16 v[148:151], v[152:155], v[104:111], v156
v_cvt_pk_bf16_f32 v103, v78, v79
s_waitcnt lgkmcnt(1)
v_mfma_f32_16x16x32_bf16 v[64:67], v[40:43], v[240:243], 0
v_exp_f32 v80, v80
v_exp_f32 v81, v81
s_waitcnt lgkmcnt(0)
v_mfma_f32_16x16x32_bf16 v[68:71], v[44:47], v[240:243], 0
v_exp_f32 v82, v82
v_exp_f32 v83, v83
v_cvt_pk_bf16_f32 v104, v80, v81
v_mfma_f32_16x16x32_bf16 v[76:79], v[44:47], v[244:247], 0
v_exp_f32 v84, v84
v_exp_f32 v85, v85
v_cvt_pk_bf16_f32 v105, v82, v83
v_mfma_f32_16x16x32_bf16 v[72:75], v[40:43], v[244:247], 0
v_exp_f32 v86, v86
v_exp_f32 v87, v87
v_cvt_pk_bf16_f32 v106, v84, v85
v_mfma_f32_16x16x32_bf16 v[112:115], v[48:51], v[96:99], v[112:115]
v_exp_f32 v88, v88
v_exp_f32 v89, v89
v_cvt_pk_bf16_f32 v107, v86, v87
v_mfma_f32_16x16x32_bf16 v[116:119], v[52:55], v[96:99], v[116:119]
v_exp_f32 v90, v90
v_exp_f32 v91, v91
v_cvt_pk_bf16_f32 v108, v88, v89
v_mfma_f32_16x16x32_bf16 v[124:127], v[52:55], v[100:103], v[124:127]
v_exp_f32 v92, v92
v_exp_f32 v93, v93
v_cvt_pk_bf16_f32 v109, v90, v91
v_mfma_f32_16x16x32_bf16 v[120:123], v[48:51], v[100:103], v[120:123]
v_exp_f32 v94, v94
v_exp_f32 v95, v95
v_cvt_pk_bf16_f32 v110, v92, v93
v_smfmac_f32_16x16x64_bf16 v[144:147], v[152:155], v[96:103], v156
v_cvt_pk_bf16_f32 v111, v94, v95
v_mfma_f32_16x16x32_bf16 v[80:83], v[40:43], v[248:251], 0
ds_read_b64_tr_b16 v[56:57], v5 offset:20480
v_exp_f32 v64, v64
v_exp_f32 v65, v65
v_mfma_f32_16x16x32_bf16 v[84:87], v[44:47], v[248:251], 0
ds_read_b64_tr_b16 v[58:59], v5 offset:21504
v_exp_f32 v66, v66
v_exp_f32 v67, v67
v_cvt_pk_bf16_f32 v96, v64, v65
v_mfma_f32_16x16x32_bf16 v[92:95], v[44:47], v[252:255], 0
ds_read_b64_tr_b16 v[60:61], v5 offset:20992
v_exp_f32 v68, v68
v_exp_f32 v69, v69
v_cvt_pk_bf16_f32 v97, v66, v67
v_mfma_f32_16x16x32_bf16 v[88:91], v[40:43], v[252:255], 0
ds_read_b64_tr_b16 v[62:63], v5 offset:22016
v_exp_f32 v70, v70
v_exp_f32 v71, v71
v_cvt_pk_bf16_f32 v98, v68, v69
v_mfma_f32_16x16x32_bf16 v[128:131], v[48:51], v[104:107], v[128:131]
s_waitcnt vmcnt(1)
s_barrier
ds_read_b128 v[32:35], v4 offset:24576
v_exp_f32 v72, v72
v_exp_f32 v73, v73
v_cvt_pk_bf16_f32 v99, v70, v71
v_mfma_f32_16x16x32_bf16 v[132:135], v[52:55], v[104:107], v[132:135]
ds_read_b128 v[36:39], v4 offset:25600
v_exp_f32 v74, v74
v_exp_f32 v75, v75
v_cvt_pk_bf16_f32 v100, v72, v73
v_mfma_f32_16x16x32_bf16 v[140:143], v[52:55], v[108:111], v[140:143]
v_exp_f32 v76, v76
v_exp_f32 v77, v77
v_cvt_pk_bf16_f32 v101, v74, v75
v_mfma_f32_16x16x32_bf16 v[136:139], v[48:51], v[108:111], v[136:139]
v_exp_f32 v78, v78
v_exp_f32 v79, v79
v_cvt_pk_bf16_f32 v102, v76, v77
v_smfmac_f32_16x16x64_bf16 v[148:151], v[152:155], v[104:111], v156
v_cvt_pk_bf16_f32 v103, v78, v79
s_waitcnt lgkmcnt(1)
v_mfma_f32_16x16x32_bf16 v[64:67], v[32:35], v[240:243], 0
v_exp_f32 v80, v80
v_exp_f32 v81, v81
s_waitcnt lgkmcnt(0)
v_mfma_f32_16x16x32_bf16 v[68:71], v[36:39], v[240:243], 0
v_exp_f32 v82, v82
v_exp_f32 v83, v83
v_cvt_pk_bf16_f32 v104, v80, v81
v_mfma_f32_16x16x32_bf16 v[76:79], v[36:39], v[244:247], 0
v_exp_f32 v84, v84
v_exp_f32 v85, v85
v_cvt_pk_bf16_f32 v105, v82, v83
v_mfma_f32_16x16x32_bf16 v[72:75], v[32:35], v[244:247], 0
v_exp_f32 v86, v86
v_exp_f32 v87, v87
v_cvt_pk_bf16_f32 v106, v84, v85
v_mfma_f32_16x16x32_bf16 v[112:115], v[56:59], v[96:99], v[112:115]
v_exp_f32 v88, v88
v_exp_f32 v89, v89
v_cvt_pk_bf16_f32 v107, v86, v87
v_mfma_f32_16x16x32_bf16 v[116:119], v[60:63], v[96:99], v[116:119]
v_exp_f32 v90, v90
v_exp_f32 v91, v91
v_cvt_pk_bf16_f32 v108, v88, v89
v_mfma_f32_16x16x32_bf16 v[124:127], v[60:63], v[100:103], v[124:127]
v_exp_f32 v92, v92
v_exp_f32 v93, v93
v_cvt_pk_bf16_f32 v109, v90, v91
v_mfma_f32_16x16x32_bf16 v[120:123], v[56:59], v[100:103], v[120:123]
v_exp_f32 v94, v94
v_exp_f32 v95, v95
v_cvt_pk_bf16_f32 v110, v92, v93
v_smfmac_f32_16x16x64_bf16 v[144:147], v[152:155], v[96:103], v156
v_cvt_pk_bf16_f32 v111, v94, v95
v_mfma_f32_16x16x32_bf16 v[80:83], v[32:35], v[248:251], 0
ds_read_b64_tr_b16 v[48:49], v5 offset:24576
v_exp_f32 v64, v64
v_exp_f32 v65, v65
v_mfma_f32_16x16x32_bf16 v[84:87], v[36:39], v[248:251], 0
ds_read_b64_tr_b16 v[50:51], v5 offset:25600
v_exp_f32 v66, v66
v_exp_f32 v67, v67
v_cvt_pk_bf16_f32 v96, v64, v65
v_mfma_f32_16x16x32_bf16 v[92:95], v[36:39], v[252:255], 0
ds_read_b64_tr_b16 v[52:53], v5 offset:25088
v_exp_f32 v68, v68
v_exp_f32 v69, v69
v_cvt_pk_bf16_f32 v97, v66, v67
v_mfma_f32_16x16x32_bf16 v[88:91], v[32:35], v[252:255], 0
ds_read_b64_tr_b16 v[54:55], v5 offset:26112
v_exp_f32 v70, v70
v_exp_f32 v71, v71
v_cvt_pk_bf16_f32 v98, v68, v69
v_mfma_f32_16x16x32_bf16 v[128:131], v[56:59], v[104:107], v[128:131]
s_waitcnt vmcnt(0)
s_barrier
ds_read_b128 v[40:43], v4 offset:28672
v_exp_f32 v72, v72
v_exp_f32 v73, v73
v_cvt_pk_bf16_f32 v99, v70, v71
v_mfma_f32_16x16x32_bf16 v[132:135], v[60:63], v[104:107], v[132:135]
ds_read_b128 v[44:47], v4 offset:29696
v_exp_f32 v74, v74
v_exp_f32 v75, v75
v_cvt_pk_bf16_f32 v100, v72, v73
v_mfma_f32_16x16x32_bf16 v[140:143], v[60:63], v[108:111], v[140:143]
v_exp_f32 v76, v76
v_exp_f32 v77, v77
v_cvt_pk_bf16_f32 v101, v74, v75
v_mfma_f32_16x16x32_bf16 v[136:139], v[56:59], v[108:111], v[136:139]
v_exp_f32 v78, v78
v_exp_f32 v79, v79
v_cvt_pk_bf16_f32 v102, v76, v77
v_smfmac_f32_16x16x64_bf16 v[148:151], v[152:155], v[104:111], v156
v_cvt_pk_bf16_f32 v103, v78, v79
s_waitcnt lgkmcnt(1)
v_mfma_f32_16x16x32_bf16 v[64:67], v[40:43], v[240:243], 0
v_exp_f32 v80, v80
v_exp_f32 v81, v81
s_waitcnt lgkmcnt(0)
v_mfma_f32_16x16x32_bf16 v[68:71], v[44:47], v[240:243], 0
v_exp_f32 v82, v82
v_exp_f32 v83, v83
v_cvt_pk_bf16_f32 v104, v80, v81
v_mfma_f32_16x16x32_bf16 v[76:79], v[44:47], v[244:247], 0
v_exp_f32 v84, v84
v_exp_f32 v85, v85
v_cvt_pk_bf16_f32 v105, v82, v83
v_mfma_f32_16x16x32_bf16 v[72:75], v[40:43], v[244:247], 0
v_exp_f32 v86, v86
v_exp_f32 v87, v87
v_cvt_pk_bf16_f32 v106, v84, v85
v_mfma_f32_16x16x32_bf16 v[112:115], v[48:51], v[96:99], v[112:115]
v_exp_f32 v88, v88
v_exp_f32 v89, v89
v_cvt_pk_bf16_f32 v107, v86, v87
v_mfma_f32_16x16x32_bf16 v[116:119], v[52:55], v[96:99], v[116:119]
v_exp_f32 v90, v90
v_exp_f32 v91, v91
v_cvt_pk_bf16_f32 v108, v88, v89
v_mfma_f32_16x16x32_bf16 v[124:127], v[52:55], v[100:103], v[124:127]
v_exp_f32 v92, v92
v_exp_f32 v93, v93
v_cvt_pk_bf16_f32 v109, v90, v91
v_mfma_f32_16x16x32_bf16 v[120:123], v[48:51], v[100:103], v[120:123]
v_exp_f32 v94, v94
v_exp_f32 v95, v95
v_cvt_pk_bf16_f32 v110, v92, v93
v_smfmac_f32_16x16x64_bf16 v[144:147], v[152:155], v[96:103], v156
v_cvt_pk_bf16_f32 v111, v94, v95
v_mfma_f32_16x16x32_bf16 v[80:83], v[40:43], v[248:251], 0
ds_read_b64_tr_b16 v[56:57], v5 offset:28672
v_exp_f32 v64, v64
v_exp_f32 v65, v65
v_mfma_f32_16x16x32_bf16 v[84:87], v[44:47], v[248:251], 0
ds_read_b64_tr_b16 v[58:59], v5 offset:29696
v_exp_f32 v66, v66
v_exp_f32 v67, v67
v_cvt_pk_bf16_f32 v96, v64, v65
v_mfma_f32_16x16x32_bf16 v[92:95], v[44:47], v[252:255], 0
ds_read_b64_tr_b16 v[60:61], v5 offset:29184
v_exp_f32 v68, v68
v_exp_f32 v69, v69
v_cvt_pk_bf16_f32 v97, v66, v67
v_mfma_f32_16x16x32_bf16 v[88:91], v[40:43], v[252:255], 0
ds_read_b64_tr_b16 v[62:63], v5 offset:30208
v_exp_f32 v70, v70
v_exp_f32 v71, v71
v_cvt_pk_bf16_f32 v98, v68, v69
v_mfma_f32_16x16x32_bf16 v[128:131], v[48:51], v[104:107], v[128:131]
s_waitcnt vmcnt(0)
s_barrier
v_exp_f32 v72, v72
v_exp_f32 v73, v73
v_cvt_pk_bf16_f32 v99, v70, v71
v_mfma_f32_16x16x32_bf16 v[132:135], v[52:55], v[104:107], v[132:135]
v_exp_f32 v74, v74
v_exp_f32 v75, v75
v_cvt_pk_bf16_f32 v100, v72, v73
v_mfma_f32_16x16x32_bf16 v[140:143], v[52:55], v[108:111], v[140:143]
v_exp_f32 v76, v76
v_exp_f32 v77, v77
v_cvt_pk_bf16_f32 v101, v74, v75
v_mfma_f32_16x16x32_bf16 v[136:139], v[48:51], v[108:111], v[136:139]
v_exp_f32 v78, v78
v_exp_f32 v79, v79
v_cvt_pk_bf16_f32 v102, v76, v77
v_smfmac_f32_16x16x64_bf16 v[148:151], v[152:155], v[104:111], v156
v_cvt_pk_bf16_f32 v103, v78, v79
s_nop 0
v_exp_f32 v80, v80
v_exp_f32 v81, v81
s_nop 0
v_exp_f32 v82, v82
v_exp_f32 v83, v83
v_cvt_pk_bf16_f32 v104, v80, v81
s_nop 0
v_exp_f32 v84, v84
v_exp_f32 v85, v85
v_cvt_pk_bf16_f32 v105, v82, v83
s_nop 0
v_exp_f32 v86, v86
v_exp_f32 v87, v87
v_cvt_pk_bf16_f32 v106, v84, v85
s_waitcnt lgkmcnt(2)
v_mfma_f32_16x16x32_bf16 v[112:115], v[56:59], v[96:99], v[112:115]
v_exp_f32 v88, v88
v_exp_f32 v89, v89
v_cvt_pk_bf16_f32 v107, v86, v87
s_waitcnt lgkmcnt(0)
v_mfma_f32_16x16x32_bf16 v[116:119], v[60:63], v[96:99], v[116:119]
v_exp_f32 v90, v90
v_exp_f32 v91, v91
v_cvt_pk_bf16_f32 v108, v88, v89
v_mfma_f32_16x16x32_bf16 v[124:127], v[60:63], v[100:103], v[124:127]
v_exp_f32 v92, v92
v_exp_f32 v93, v93
v_cvt_pk_bf16_f32 v109, v90, v91
v_mfma_f32_16x16x32_bf16 v[120:123], v[56:59], v[100:103], v[120:123]
v_exp_f32 v94, v94
v_exp_f32 v95, v95
v_cvt_pk_bf16_f32 v110, v92, v93
v_smfmac_f32_16x16x64_bf16 v[144:147], v[152:155], v[96:103], v156
v_cvt_pk_bf16_f32 v111, v94, v95
v_mfma_f32_16x16x32_bf16 v[128:131], v[56:59], v[104:107], v[128:131]
v_mfma_f32_16x16x32_bf16 v[132:135], v[60:63], v[104:107], v[132:135]
v_mfma_f32_16x16x32_bf16 v[140:143], v[60:63], v[108:111], v[140:143]
v_mfma_f32_16x16x32_bf16 v[136:139], v[56:59], v[108:111], v[136:139]
v_smfmac_f32_16x16x64_bf16 v[148:151], v[152:155], v[104:111], v156
v_mov_b32 v160, 0x1f800000
v_mov_b32 v161, 0x5f800000
v_pk_mul_f32 v[162:163], v[112:113], 0 op_sel_hi:[1,0]
v_pk_fma_f32 v[162:163], v[114:115], 0, v[162:163] op_sel_hi:[1,0,1]
v_pk_fma_f32 v[162:163], v[116:117], 0, v[162:163] op_sel_hi:[1,0,1]
v_pk_fma_f32 v[162:163], v[118:119], 0, v[162:163] op_sel_hi:[1,0,1]
v_pk_fma_f32 v[162:163], v[120:121], 0, v[162:163] op_sel_hi:[1,0,1]
v_pk_fma_f32 v[162:163], v[122:123], 0, v[162:163] op_sel_hi:[1,0,1]
v_pk_fma_f32 v[162:163], v[124:125], 0, v[162:163] op_sel_hi:[1,0,1]
v_pk_fma_f32 v[162:163], v[126:127], 0, v[162:163] op_sel_hi:[1,0,1]
v_add_f32 v144, v144, v145
v_add_f32 v146, v146, v147
v_add_f32 v162, v162, v163
v_add_f32 v163, v162, v146
v_add_f32 v162, v162, v144
v_cmp_nge_f32 vcc, v162, v160
v_cmp_nle_f32 s[56:57], v162, v161
v_cmp_nge_f32 s[26:27], v163, v160
v_cmp_nle_f32 s[58:59], v163, v161
s_or_b64 s[56:57], s[56:57], vcc
s_or_b64 s[26:27], s[26:27], s[58:59]
s_or_b64 s[56:57], s[56:57], s[26:27]
s_cbranch_scc1 L_att_fb0
L_att_fb_ret0:
v_rcp_f32 v162, v144
v_rcp_f32 v164, v146
s_nop 0
v_pk_mul_f32 v[112:113], v[112:113], v[162:163] op_sel_hi:[1,0]
v_pk_mul_f32 v[114:115], v[114:115], v[162:163] op_sel_hi:[1,0]
v_pk_mul_f32 v[116:117], v[116:117], v[162:163] op_sel_hi:[1,0]
v_pk_mul_f32 v[118:119], v[118:119], v[162:163] op_sel_hi:[1,0]
v_pk_mul_f32 v[120:121], v[120:121], v[164:165] op_sel_hi:[1,0]
v_pk_mul_f32 v[122:123], v[122:123], v[164:165] op_sel_hi:[1,0]
v_pk_mul_f32 v[124:125], v[124:125], v[164:165] op_sel_hi:[1,0]
v_pk_mul_f32 v[126:127], v[126:127], v[164:165] op_sel_hi:[1,0]
v_cvt_pk_bf16_f32 v112, v112, v113
v_cvt_pk_bf16_f32 v113, v114, v115
v_cvt_pk_bf16_f32 v114, v116, v117
v_cvt_pk_bf16_f32 v115, v118, v119
v_cvt_pk_bf16_f32 v116, v120, v121
v_cvt_pk_bf16_f32 v117, v122, v123
v_cvt_pk_bf16_f32 v118, v124, v125
v_cvt_pk_bf16_f32 v119, v126, v127
buffer_store_dwordx4 v[112:115], v11, s[52:55], s46 offen offset:0 sc0 sc1
buffer_store_dwordx4 v[116:119], v11, s[52:55], s46 offen offset:1024 sc0 sc1
v_pk_mul_f32 v[162:163], v[128:129], 0 op_sel_hi:[1,0]
v_pk_fma_f32 v[162:163], v[130:131], 0, v[162:163] op_sel_hi:[1,0,1]
v_pk_fma_f32 v[162:163], v[132:133], 0, v[162:163] op_sel_hi:[1,0,1]
v_pk_fma_f32 v[162:163], v[134:135], 0, v[162:163] op_sel_hi:[1,0,1]
v_pk_fma_f32 v[162:163], v[136:137], 0, v[162:163] op_sel_hi:[1,0,1]
v_pk_fma_f32 v[162:163], v[138:139], 0, v[162:163] op_sel_hi:[1,0,1]
v_pk_fma_f32 v[162:163], v[140:141], 0, v[162:163] op_sel_hi:[1,0,1]
v_pk_fma_f32 v[162:163], v[142:143], 0, v[162:163] op_sel_hi:[1,0,1]
v_add_f32 v148, v148, v149
v_add_f32 v150, v150, v151
v_add_f32 v162, v162, v163
v_add_f32 v163, v162, v150
v_add_f32 v162, v162, v148
v_cmp_nge_f32 vcc, v162, v160
v_cmp_nle_f32 s[56:57], v162, v161
v_cmp_nge_f32 s[26:27], v163, v160
v_cmp_nle_f32 s[58:59], v163, v161
s_or_b64 s[56:57], s[56:57], vcc
s_or_b64 s[26:27], s[26:27], s[58:59]
s_or_b64 s[56:57], s[56:57], s[26:27]
s_cbranch_scc1 L_att_fb1
L_att_fb_ret1:
v_rcp_f32 v162, v148
v_rcp_f32 v164, v150
s_nop 0
v_pk_mul_f32 v[128:129], v[128:129], v[162:163] op_sel_hi:[1,0]
v_pk_mul_f32 v[130:131], v[130:131], v[162:163] op_sel_hi:[1,0]
v_pk_mul_f32 v[132:133], v[132:133], v[162:163] op_sel_hi:[1,0]
v_pk_mul_f32 v[134:135], v[134:135], v[162:163] op_sel_hi:[1,0]
v_pk_mul_f32 v[136:137], v[136:137], v[164:165] op_sel_hi:[1,0]
v_pk_mul_f32 v[138:139], v[138:139], v[164:165] op_sel_hi:[1,0]
v_pk_mul_f32 v[140:141], v[140:141], v[164:165] op_sel_hi:[1,0]
v_pk_mul_f32 v[142:143], v[142:143], v[164:165] op_sel_hi:[1,0]
v_cvt_pk_bf16_f32 v128, v128, v129
v_cvt_pk_bf16_f32 v129, v130, v131
v_cvt_pk_bf16_f32 v130, v132, v133
v_cvt_pk_bf16_f32 v131, v134, v135
v_cvt_pk_bf16_f32 v132, v136, v137
v_cvt_pk_bf16_f32 v133, v138, v139
v_cvt_pk_bf16_f32 v134, v140, v141
v_cvt_pk_bf16_f32 v135, v142, v143
s_add_u32 s46, s46, 65536
buffer_store_dwordx4 v[128:131], v11, s[52:55], s46 offen offset:0 sc0 sc1
buffer_store_dwordx4 v[132:135], v11, s[52:55], s46 offen offset:1024 sc0 sc1
s_setprio 0
s_lshl_b32 s30, s34, 10
s_add_u32 s30, s30, 32768
s_and_b32 s26, s2, 7
s_lshl_b32 s26, s26, 2
s_add_u32 s30, s30, s26
v_mov_b32 v12, 1
v_lshlrev_b32 v15, 7, v0
s_barrier
s_mov_b64 exec, 1
s_waitcnt vmcnt(0)
ds_add_rtn_u32 v13, v4, v12
s_waitcnt lgkmcnt(0)
v_readfirstlane_b32 s26, v13
s_mov_b64 exec, 255
s_cmp_lg_u32 s26, 3
s_cbranch_scc1 L_a_np
buffer_atomic_add v12, v15, s[48:51], s30 offen sc1
L_a_np:
s_mov_b64 exec, -1
s_branch L_fin
L_att_fb0:
s_waitcnt vmcnt(0)
s_lshl_b32 s26, s33, 17
s_add_u32 s27, s26, 0x800000
s_add_u32 s16, s4, s27
s_addc_u32 s17, s5, 0
s_mov_b32 s18, 0x20000
s_mov_b32 s19, 0x20000
s_add_u32 s27, s26, 0xc00000
s_add_u32 s20, s4, s27
s_addc_u32 s21, s5, 0
s_mov_b32 s22, 0x20000
s_mov_b32 s23, 0x20000
v_bfe_u32 v12, v0, 4, 1
v_lshlrev_b32 v12, 7, v12
v_xor_b32 v8, v11, v12
v_add_u32 v9, 1024, v8
s_lshl_b32 s26, s42, 10
s_add_u32 s26, s26, 2048
v_add_u32 v2, s26, v5
v_mov_b32 v112, 0
v_mov_b32 v113, 0
v_mov_b32 v114, 0
v_mov_b32 v115, 0
v_mov_b32 v116, 0
v_mov_b32 v117, 0
v_mov_b32 v118, 0
v_mov_b32 v119, 0
v_mov_b32 v120, 0
v_mov_b32 v121, 0
v_mov_b32 v122, 0
v_mov_b32 v123, 0
v_mov_b32 v124, 0
v_mov_b32 v125, 0
v_mov_b32 v126, 0
v_mov_b32 v127, 0
v_mov_b32 v144, 0
v_mov_b32 v146, 0
v_mov_b32 v164, 0xff800000
v_mov_b32 v165, 0xff800000
s_mov_b32 s59, 0
L_att_fbl0:
buffer_load_dwordx4 v[32:35], v11, s[16:19], s59 offen
buffer_load_dwordx4 v[36:39], v11, s[16:19], s59 offen offset:1024
s_add_u32 m0, s41, 4096
s_nop 0
buffer_load_dwordx4 v8, s[20:23], s59 offen lds
s_add_u32 m0, s41, 8192
s_nop 0
buffer_load_dwordx4 v9, s[20:23], s59 offen lds
s_waitcnt vmcnt(0)
ds_read_b64_tr_b16 v[48:49], v2 offset:0
ds_read_b64_tr_b16 v[50:51], v2 offset:4096
ds_read_b64_tr_b16 v[52:53], v2 offset:512
ds_read_b64_tr_b16 v[54:55], v2 offset:4608
v_mfma_f32_16x16x32_bf16 v[64:67], v[32:35], v[240:243], 0
v_mfma_f32_16x16x32_bf16 v[68:71], v[36:39], v[240:243], 0
v_mfma_f32_16x16x32_bf16 v[76:79], v[36:39], v[244:247], 0
v_mfma_f32_16x16x32_bf16 v[72:75], v[32:35], v[244:247], 0
s_nop 4
v_max3_f32 v13, v64, v65, v164
v_max3_f32 v13, v66, v67, v13
v_max3_f32 v13, v68, v69, v13
v_max3_f32 v13, v70, v71, v13
v_mov_b32 v14, v13
s_nop 1
v_permlane16_swap_b32 v13, v14
v_max_f32 v13, v13, v14
v_mov_b32 v14, v13
s_nop 1
v_permlane32_swap_b32 v13, v14
v_max_f32 v13, v13, v14
v_sub_f32 v14, v164, v13
v_exp_f32 v14, v14
v_mov_b32 v164, v13
v_sub_f32 v64, v64, v13
v_sub_f32 v65, v65, v13
v_sub_f32 v66, v66, v13
v_sub_f32 v67, v67, v13
v_sub_f32 v68, v68, v13
v_sub_f32 v69, v69, v13
v_sub_f32 v70, v70, v13
v_sub_f32 v71, v71, v13
v_exp_f32 v64, v64
v_exp_f32 v65, v65
v_exp_f32 v66, v66
v_exp_f32 v67, v67
v_exp_f32 v68, v68
v_exp_f32 v69, v69
v_exp_f32 v70, v70
v_exp_f32 v71, v71
v_mul_f32 v144, v144, v14
v_add_f32 v144, v144, v64
v_mul_f32 v112, v112, v14
v_add_f32 v144, v144, v65
v_mul_f32 v113, v113, v14
v_add_f32 v144, v144, v66
v_mul_f32 v114, v114, v14
v_add_f32 v144, v144, v67
v_mul_f32 v115, v115, v14
v_add_f32 v144, v144, v68
v_mul_f32 v116, v116, v14
v_add_f32 v144, v144, v69
v_mul_f32 v117, v117, v14
v_add_f32 v144, v144, v70
v_mul_f32 v118, v118, v14
v_add_f32 v144, v144, v71
v_mul_f32 v119, v119, v14
v_max3_f32 v13, v72, v73, v165
v_max3_f32 v13, v74, v75, v13
v_max3_f32 v13, v76, v77, v13
v_max3_f32 v13, v78, v79, v13
v_mov_b32 v14, v13
s_nop 1
v_permlane16_swap_b32 v13, v14
v_max_f32 v13, v13, v14
v_mov_b32 v14, v13
s_nop 1
v_permlane32_swap_b32 v13, v14
v_max_f32 v13, v13, v14
v_sub_f32 v14, v165, v13
v_exp_f32 v14, v14
v_mov_b32 v165, v13
v_sub_f32 v72, v72, v13
v_sub_f32 v73, v73, v13
v_sub_f32 v74, v74, v13
v_sub_f32 v75, v75, v13
v_sub_f32 v76, v76, v13
v_sub_f32 v77, v77, v13
v_sub_f32 v78, v78, v13
v_sub_f32 v79, v79, v13
v_exp_f32 v72, v72
v_exp_f32 v73, v73
v_exp_f32 v74, v74
v_exp_f32 v75, v75
v_exp_f32 v76, v76
v_exp_f32 v77, v77
v_exp_f32 v78, v78
v_exp_f32 v79, v79
v_mul_f32 v146, v146, v14
v_add_f32 v146, v146, v72
v_mul_f32 v120, v120, v14
v_add_f32 v146, v146, v73
v_mul_f32 v121, v121, v14
v_add_f32 v146, v146, v74
v_mul_f32 v122, v122, v14
v_add_f32 v146, v146, v75
v_mul_f32 v123, v123, v14
v_add_f32 v146, v146, v76
v_mul_f32 v124, v124, v14
v_add_f32 v146, v146, v77
v_mul_f32 v125, v125, v14
v_add_f32 v146, v146, v78
v_mul_f32 v126, v126, v14
v_add_f32 v146, v146, v79
v_mul_f32 v127, v127, v14
v_cvt_pk_bf16_f32 v96, v64, v65
v_cvt_pk_bf16_f32 v97, v66, v67
v_cvt_pk_bf16_f32 v98, v68, v69
v_cvt_pk_bf16_f32 v99, v70, v71
v_cvt_pk_bf16_f32 v100, v72, v73
v_cvt_pk_bf16_f32 v101, v74, v75
v_cvt_pk_bf16_f32 v102, v76, v77
v_cvt_pk_bf16_f32 v103, v78, v79
s_waitcnt lgkmcnt(0)
v_mfma_f32_16x16x32_bf16 v[112:115], v[48:51], v[96:99], v[112:115]
v_mfma_f32_16x16x32_bf16 v[116:119], v[52:55], v[96:99], v[116:119]
v_mfma_f32_16x16x32_bf16 v[124:127], v[52:55], v[100:103], v[124:127]
v_mfma_f32_16x16x32_bf16 v[120:123], v[48:51], v[100:103], v[120:123]
s_add_u32 s59, s59, 2048
s_cmp_lg_u32 s59, 131072
s_nop 7
s_nop 7
s_cbranch_scc1 L_att_fbl0
v_mov_b32 v14, v144
s_nop 1
v_permlane16_swap_b32 v144, v14
v_add_f32 v144, v144, v14
v_mov_b32 v14, v144
s_nop 1
v_permlane32_swap_b32 v144, v14
v_add_f32 v144, v144, v14
v_mov_b32 v14, v146
s_nop 1
v_permlane16_swap_b32 v146, v14
v_add_f32 v146, v146, v14
v_mov_b32 v14, v146
s_nop 1
v_permlane32_swap_b32 v146, v14
v_add_f32 v146, v146, v14
s_branch L_att_fb_ret0
L_att_fb1:
s_waitcnt vmcnt(0)
s_lshl_b32 s26, s33, 17
s_add_u32 s27, s26, 0x800000
s_add_u32 s16, s4, s27
s_addc_u32 s17, s5, 0
s_mov_b32 s18, 0x20000
s_mov_b32 s19, 0x20000
s_add_u32 s27, s26, 0xc00000
s_add_u32 s20, s4, s27
s_addc_u32 s21, s5, 0
s_mov_b32 s22, 0x20000
s_mov_b32 s23, 0x20000
v_bfe_u32 v12, v0, 4, 1
v_lshlrev_b32 v12, 7, v12
v_xor_b32 v8, v11, v12
v_add_u32 v9, 1024, v8
s_lshl_b32 s26, s42, 10
s_add_u32 s26, s26, 2048
v_add_u32 v2, s26, v5
v_mov_b32 v128, 0
v_mov_b32 v129, 0
v_mov_b32 v130, 0
v_mov_b32 v131, 0
v_mov_b32 v132, 0
v_mov_b32 v133, 0
v_mov_b32 v134, 0
v_mov_b32 v135, 0
v_mov_b32 v136, 0
v_mov_b32 v137, 0
v_mov_b32 v138, 0
v_mov_b32 v139, 0
v_mov_b32 v140, 0
v_mov_b32 v141, 0
v_mov_b32 v142, 0
v_mov_b32 v143, 0
v_mov_b32 v148, 0
v_mov_b32 v150, 0
v_mov_b32 v164, 0xff800000
v_mov_b32 v165, 0xff800000
s_mov_b32 s59, 0
L_att_fbl1:
buffer_load_dwordx4 v[32:35], v11, s[16:19], s59 offen
buffer_load_dwordx4 v[36:39], v11, s[16:19], s59 offen offset:1024
s_add_u32 m0, s41, 4096
s_nop 0
buffer_load_dwordx4 v8, s[20:23], s59 offen lds
s_add_u32 m0, s41, 8192
s_nop 0
buffer_load_dwordx4 v9, s[20:23], s59 offen lds
s_waitcnt vmcnt(0)
ds_read_b64_tr_b16 v[48:49], v2 offset:0
ds_read_b64_tr_b16 v[50:51], v2 offset:4096
ds_read_b64_tr_b16 v[52:53], v2 offset:512
ds_read_b64_tr_b16 v[54:55], v2 offset:4608
v_mfma_f32_16x16x32_bf16 v[64:67], v[32:35], v[248:251], 0
v_mfma_f32_16x16x32_bf16 v[68:71], v[36:39], v[248:251], 0
v_mfma_f32_16x16x32_bf16 v[76:79], v[36:39], v[252:255], 0
v_mfma_f32_16x16x32_bf16 v[72:75], v[32:35], v[252:255], 0
s_nop 4
v_max3_f32 v13, v64, v65, v164
v_max3_f32 v13, v66, v67, v13
v_max3_f32 v13, v68, v69, v13
v_max3_f32 v13, v70, v71, v13
v_mov_b32 v14, v13
s_nop 1
v_permlane16_swap_b32 v13, v14
v_max_f32 v13, v13, v14
v_mov_b32 v14, v13
s_nop 1
v_permlane32_swap_b32 v13, v14
v_max_f32 v13, v13, v14
v_sub_f32 v14, v164, v13
v_exp_f32 v14, v14
v_mov_b32 v164, v13
v_sub_f32 v64, v64, v13
v_sub_f32 v65, v65, v13
v_sub_f32 v66, v66, v13
v_sub_f32 v67, v67, v13
v_sub_f32 v68, v68, v13
v_sub_f32 v69, v69, v13
v_sub_f32 v70, v70, v13
v_sub_f32 v71, v71, v13
v_exp_f32 v64, v64
v_exp_f32 v65, v65
v_exp_f32 v66, v66
v_exp_f32 v67, v67
v_exp_f32 v68, v68
v_exp_f32 v69, v69
v_exp_f32 v70, v70
v_exp_f32 v71, v71
v_mul_f32 v148, v148, v14
v_add_f32 v148, v148, v64
v_mul_f32 v128, v128, v14
v_add_f32 v148, v148, v65
v_mul_f32 v129, v129, v14
v_add_f32 v148, v148, v66
v_mul_f32 v130, v130, v14
v_add_f32 v148, v148, v67
v_mul_f32 v131, v131, v14
v_add_f32 v148, v148, v68
v_mul_f32 v132, v132, v14
v_add_f32 v148, v148, v69
v_mul_f32 v133, v133, v14
v_add_f32 v148, v148, v70
v_mul_f32 v134, v134, v14
v_add_f32 v148, v148, v71
v_mul_f32 v135, v135, v14
v_max3_f32 v13, v72, v73, v165
v_max3_f32 v13, v74, v75, v13
v_max3_f32 v13, v76, v77, v13
v_max3_f32 v13, v78, v79, v13
v_mov_b32 v14, v13
s_nop 1
v_permlane16_swap_b32 v13, v14
v_max_f32 v13, v13, v14
v_mov_b32 v14, v13
s_nop 1
v_permlane32_swap_b32 v13, v14
v_max_f32 v13, v13, v14
v_sub_f32 v14, v165, v13
v_exp_f32 v14, v14
v_mov_b32 v165, v13
v_sub_f32 v72, v72, v13
v_sub_f32 v73, v73, v13
v_sub_f32 v74, v74, v13
v_sub_f32 v75, v75, v13
v_sub_f32 v76, v76, v13
v_sub_f32 v77, v77, v13
v_sub_f32 v78, v78, v13
v_sub_f32 v79, v79, v13
v_exp_f32 v72, v72
v_exp_f32 v73, v73
v_exp_f32 v74, v74
v_exp_f32 v75, v75
v_exp_f32 v76, v76
v_exp_f32 v77, v77
v_exp_f32 v78, v78
v_exp_f32 v79, v79
v_mul_f32 v150, v150, v14
v_add_f32 v150, v150, v72
v_mul_f32 v136, v136, v14
v_add_f32 v150, v150, v73
v_mul_f32 v137, v137, v14
v_add_f32 v150, v150, v74
v_mul_f32 v138, v138, v14
v_add_f32 v150, v150, v75
v_mul_f32 v139, v139, v14
v_add_f32 v150, v150, v76
v_mul_f32 v140, v140, v14
v_add_f32 v150, v150, v77
v_mul_f32 v141, v141, v14
v_add_f32 v150, v150, v78
v_mul_f32 v142, v142, v14
v_add_f32 v150, v150, v79
v_mul_f32 v143, v143, v14
v_cvt_pk_bf16_f32 v96, v64, v65
v_cvt_pk_bf16_f32 v97, v66, v67
v_cvt_pk_bf16_f32 v98, v68, v69
v_cvt_pk_bf16_f32 v99, v70, v71
v_cvt_pk_bf16_f32 v100, v72, v73
v_cvt_pk_bf16_f32 v101, v74, v75
v_cvt_pk_bf16_f32 v102, v76, v77
v_cvt_pk_bf16_f32 v103, v78, v79
s_waitcnt lgkmcnt(0)
v_mfma_f32_16x16x32_bf16 v[128:131], v[48:51], v[96:99], v[128:131]
v_mfma_f32_16x16x32_bf16 v[132:135], v[52:55], v[96:99], v[132:135]
v_mfma_f32_16x16x32_bf16 v[140:143], v[52:55], v[100:103], v[140:143]
v_mfma_f32_16x16x32_bf16 v[136:139], v[48:51], v[100:103], v[136:139]
s_add_u32 s59, s59, 2048
s_cmp_lg_u32 s59, 131072
s_nop 7
s_nop 7
s_cbranch_scc1 L_att_fbl1
v_mov_b32 v14, v148
s_nop 1
v_permlane16_swap_b32 v148, v14
v_add_f32 v148, v148, v14
v_mov_b32 v14, v148
s_nop 1
v_permlane32_swap_b32 v148, v14
v_add_f32 v148, v148, v14
v_mov_b32 v14, v150
s_nop 1
v_permlane16_swap_b32 v150, v14
v_add_f32 v150, v150, v14
v_mov_b32 v14, v150
s_nop 1
v_permlane32_swap_b32 v150, v14
v_add_f32 v150, v150, v14
s_branch L_att_fb_ret1
L_k1_g:
s_mov_b32 m0, s29
s_nop 0
buffer_load_dwordx4 v5, s[12:15], s21 offen offset:0 lds
s_mov_b32 s34, s22
s_lshl_b32 s26, s34, 17
s_add_u32 s31, s31, s26
s_add_u32 s31, s31, 0x400000
s_mov_b32 s35, 0
s_cmp_lt_u32 s34, 32
s_cselect_b32 s56, 0x3e8293ee, 1.0
v_and_b32 v24, 15, v0
v_lshrrev_b32 v25, 4, v0
v_bfe_u32 v26, v0, 1, 3
s_lshl_b32 s26, s42, 13
s_add_u32 s26, s26, 65536
v_lshlrev_b32 v24, 7, v24
v_add_u32 v24, s26, v24
v_xor_b32 v27, v25, v26
v_lshl_add_u32 v9, v27, 4, v24
buffer_load_dwordx4 v6, s[12:15], s21 offen offset:1024 lds
v_xor_b32 v10, 64, v9
v_lshrrev_b32 v24, 5, v0
v_mul_u32_u24 v24, 3072, v24
v_and_b32 v25, 31, v0
v_lshl_add_u32 v24, v25, 3, v24
s_cmp_ge_u32 s42, 2
s_cselect_b32 s27, 2, 0
s_sub_u32 s46, s42, s27
s_add_u32 s26, s46, 0
s_cmp_ge_u32 s26, 2
s_cselect_b32 s27, 2, 0
s_sub_u32 s26, s26, s27
s_lshl_b32 s26, s26, 9
s_add_u32 s26, s26, 98304
v_add_u32 v11, s26, v24
s_add_u32 s26, s46, 1
s_cmp_ge_u32 s26, 2
s_cselect_b32 s27, 2, 0
s_sub_u32 s26, s26, s27
s_lshl_b32 s26, s26, 9
s_add_u32 s26, s26, 98304
v_add_u32 v12, s26, v24
buffer_load_dwordx4 v7, s[12:15], s21 offen offset:2048 lds
v_bfe_u32 v24, v0, 1, 1
v_lshrrev_b32 v25, 5, v0
v_cmp_eq_u32 vcc, v24, v25
v_mov_b32 v24, 0x3f803f80
s_nop 0
v_cndmask_b32 v96, 0, v24, vcc
v_mov_b32 v97, v96
v_mov_b32 v98, v96
v_mov_b32 v99, v96
v_and_b32 v24, 1, v0
v_mul_u32_u24 v24, 0xaaaa, v24
v_add_u32 v15, 0x4444, v24
v_mov_b32 v100, 0
v_mov_b32 v101, 0
v_mov_b32 v102, 0
buffer_load_dwordx4 v8, s[12:15], s21 offen offset:3072 lds
s_add_u32 s21, s21, 128
s_add_u32 s29, s29, 32768
s_cmp_ge_u32 s29, 98304
s_cselect_b32 s26, 98304, 0
s_sub_u32 s29, s29, s26
v_mov_b32 v103, 0
s_waitcnt vmcnt(11)
v_lshlrev_b32 v144, 16, v128
v_and_b32 v145, 0xffff0000, v128
v_lshlrev_b32 v146, 16, v129
v_and_b32 v147, 0xffff0000, v129
v_lshlrev_b32 v148, 16, v130
v_and_b32 v149, 0xffff0000, v130
v_lshlrev_b32 v150, 16, v131
v_and_b32 v151, 0xffff0000, v131
v_lshlrev_b32 v152, 16, v132
v_and_b32 v153, 0xffff0000, v132
v_lshlrev_b32 v154, 16, v133
v_and_b32 v155, 0xffff0000, v133
v_lshlrev_b32 v156, 16, v134
v_and_b32 v157, 0xffff0000, v134
v_lshlrev_b32 v158, 16, v135
s_add_u32 m0, s28, 49152
s_nop 0
buffer_load_dwordx4 v1, s[8:11], s20 offen offset:0 lds
v_and_b32 v159, 0xffff0000, v135
v_pk_add_f32 v[128:129], v[144:145], v[152:153]
v_pk_add_f32 v[130:131], v[146:147], v[154:155]
v_pk_add_f32 v[132:133], v[148:149], v[156:157]
v_pk_add_f32 v[134:135], v[150:151], v[158:159]
v_pk_add_f32 v[128:129], v[128:129], v[130:131]
v_pk_add_f32 v[132:133], v[132:133], v[134:135]
v_pk_add_f32 v[128:129], v[128:129], v[132:133]
v_add_f32 v128, v128, v129
s_nop 1
v_add_f32_dpp v128, v128, v128 quad_perm:[1,0,3,2] row_mask:0xf bank_mask:0xf
s_nop 1
v_add_f32_dpp v128, v128, v128 quad_perm:[2,3,0,1] row_mask:0xf bank_mask:0xf
s_nop 1
v_add_f32_dpp v128, v128, v128 row_half_mirror row_mask:0xf bank_mask:0xf
s_nop 1
v_add_f32_dpp v128, v128, v128 row_mirror row_mask:0xf bank_mask:0xf
v_mov_b32 v129, v128
s_nop 1
v_permlane16_swap_b32 v128, v129
v_add_f32 v128, v128, v129
v_mov_b32 v129, v128
s_nop 1
v_permlane32_swap_b32 v128, v129
buffer_load_dwordx4 v2, s[84:87], s88 offen offset:1024 lds
v_add_f32 v128, v128, v129
v_mul_f32 v16, 0xba800000, v128
v_pk_add_f32 v[144:145], v[144:145], v[16:17] op_sel_hi:[1,0]
v_pk_add_f32 v[146:147], v[146:147], v[16:17] op_sel_hi:[1,0]
v_pk_add_f32 v[148:149], v[148:149], v[16:17] op_sel_hi:[1,0]
v_pk_add_f32 v[150:151], v[150:151], v[16:17] op_sel_hi:[1,0]
v_pk_add_f32 v[152:153], v[152:153], v[16:17] op_sel_hi:[1,0]
v_pk_add_f32 v[154:155], v[154:155], v[16:17] op_sel_hi:[1,0]
v_pk_add_f32 v[156:157], v[156:157], v[16:17] op_sel_hi:[1,0]
v_pk_add_f32 v[158:159], v[158:159], v[16:17] op_sel_hi:[1,0]
v_pk_mul_f32 v[128:129], v[144:145], v[144:145]
v_pk_mul_f32 v[130:131], v[146:147], v[146:147]
v_pk_mul_f32 v[132:133], v[148:149], v[148:149]
v_pk_mul_f32 v[134:135], v[150:151], v[150:151]
v_pk_fma_f32 v[128:129], v[152:153], v[152:153], v[128:129]
v_pk_fma_f32 v[130:131], v[154:155], v[154:155], v[130:131]
v_pk_fma_f32 v[132:133], v[156:157], v[156:157], v[132:133]
v_pk_fma_f32 v[134:135], v[158:159], v[158:159], v[134:135]
buffer_load_dwordx4 v3, s[84:87], s88 offen offset:2048 lds
s_add_u32 s20, s20, 393216
s_add_u32 s88, s88, s89
v_pk_add_f32 v[128:129], v[128:129], v[130:131]
v_pk_add_f32 v[132:133], v[132:133], v[134:135]
v_pk_add_f32 v[128:129], v[128:129], v[132:133]
v_add_f32 v128, v128, v129
s_nop 1
v_add_f32_dpp v128, v128, v128 quad_perm:[1,0,3,2] row_mask:0xf bank_mask:0xf
s_nop 1
v_add_f32_dpp v128, v128, v128 quad_perm:[2,3,0,1] row_mask:0xf bank_mask:0xf
s_nop 1
v_add_f32_dpp v128, v128, v128 row_half_mirror row_mask:0xf bank_mask:0xf
s_nop 1
v_add_f32_dpp v128, v128, v128 row_mirror row_mask:0xf bank_mask:0xf
v_mov_b32 v129, v128
s_nop 1
v_permlane16_swap_b32 v128, v129
v_add_f32 v128, v128, v129
v_mov_b32 v129, v128
s_nop 1
v_permlane32_swap_b32 v128, v129
v_add_f32 v128, v128, v129
v_mov_b32 v129, 0x3727c5ac
v_fmac_f32 v129, 0x3a800000, v128
v_rsq_f32 v17, v129
s_nop 0
buffer_store_dwordx2 v[16:17], v30, s[92:95], 0 offen sc0 sc1
buffer_store_dword v31, v29, s[48:51], 0 offen sc0 sc1
s_waitcnt vmcnt(9)
s_barrier
ds_read_b64_tr_b16 v[64:65], v11 offset:0
ds_read_b64_tr_b16 v[66:67], v11 offset:6144
ds_read_b128 v[32:35], v9 offset:0
ds_read_b64_tr_b16 v[72:73], v11 offset:16384
ds_read_b64_tr_b16 v[74:75], v11 offset:22528
ds_read_b128 v[48:51], v10 offset:0
ds_read_b128 v[52:55], v10 offset:2048
ds_read_b128 v[36:39], v9 offset:2048
ds_read_b64_tr_b16 v[68:69], v11 offset:256
ds_read_b64_tr_b16 v[70:71], v11 offset:6400
ds_read_b64_tr_b16 v[76:77], v11 offset:16640
ds_read_b64_tr_b16 v[78:79], v11 offset:22784
ds_read_b64_tr_b16 v[80:81], v12 offset:0
ds_read_b64_tr_b16 v[82:83], v12 offset:6144
ds_read_b64_tr_b16 v[88:89], v12 offset:16384
s_waitcnt lgkmcnt(14)
ds_read_b64_tr_b16 v[90:91], v12 offset:22528
s_mov_b32 s22, 6
s_mov_b32 m0, s29
s_waitcnt lgkmcnt(13)
v_mfma_f32_16x16x32_bf16 v[128:131], v[64:67], v[32:35], 0
s_setprio 1
buffer_load_dwordx4 v5, s[12:15], s21 offen offset:0 lds
ds_read_b64_tr_b16 v[84:85], v12 offset:256
s_bfe_u32 s65, s2, 0x10002
s_mul_i32 s65, s65, 7
s_lshr_b32 s26, s2, 5
s_add_u32 s65, s65, s26
s_waitcnt lgkmcnt(11)
v_mfma_f32_16x16x32_bf16 v[128:131], v[72:75], v[48:51], v[128:131]
ds_read_b64_tr_b16 v[86:87], v12 offset:6400
s_lshl_b32 s41, s42, 12
s_lshl_b32 s26, s64, 18
s_mov_b32 s52, s36
s_mov_b32 s53, s37
s_mov_b32 s54, 0x700000
s_mov_b32 s55, 0x20000
s_add_u32 s36, s72, s26
s_addc_u32 s37, s73, 0
s_mov_b32 s38, 0x40000
s_waitcnt lgkmcnt(11)
v_mfma_f32_16x16x32_bf16 v[132:135], v[72:75], v[52:55], 0
buffer_load_dwordx4 v6, s[12:15], s21 offen offset:1024 lds
ds_read_b64_tr_b16 v[92:93], v12 offset:16640
s_mov_b32 s39, 0x20000
v_lshrrev_b32 v24, 3, v0
v_lshrrev_b32 v25, 4, v0
s_waitcnt lgkmcnt(11)
v_mfma_f32_16x16x32_bf16 v[132:135], v[64:67], v[36:39], v[132:135]
ds_read_b64_tr_b16 v[94:95], v12 offset:22784
v_and_b32 v26, 7, v0
s_lshl_b32 s26, s42, 5
v_add_u32 v24, s26, v24
s_waitcnt lgkmcnt(10)
v_mfma_f32_16x16x32_bf16 v[148:151], v[68:71], v[36:39], 0
buffer_load_dwordx4 v7, s[12:15], s21 offen offset:2048 lds
ds_read_b128 v[40:43], v9 offset:4096
v_xor_b32 v26, v26, v25
v_xor_b32 v27, 4, v26
v_lshlrev_b32 v26, 4, v26
s_waitcnt lgkmcnt(9)
v_mfma_f32_16x16x32_bf16 v[148:151], v[76:79], v[52:55], v[148:151]
ds_read_b128 v[56:59], v10 offset:4096
v_lshlrev_b32 v27, 4, v27
v_lshl_add_u32 v28, v24, 12, v26
v_add_u32 v224, 0, v28
v_mfma_f32_16x16x32_bf16 v[144:147], v[76:79], v[48:51], 0
buffer_load_dwordx4 v8, s[12:15], s21 offen offset:3072 lds
s_add_u32 s21, s21, 128
s_add_u32 s29, s29, 32768
s_cmp_ge_u32 s29, 98304
s_cselect_b32 s26, 98304, 0
s_sub_u32 s29, s29, s26
ds_read_b128 v[44:47], v9 offset:6144
v_lshl_add_u32 v28, v24, 12, v27
v_add_u32 v225, 31744, v28
v_lshl_add_u32 v28, v24, 12, v26
v_mfma_f32_16x16x32_bf16 v[144:147], v[68:71], v[32:35], v[144:147]
s_setprio 0
ds_read_b128 v[60:63], v10 offset:6144
v_add_u32 v9, s59, v9
v_add_u32 v10, s59, v10
s_add_u32 s40, s40, 1
s_cmp_eq_u32 s40, 3
s_cselect_b32 s40, 0, s40
s_cmp_eq_u32 s40, 2
s_cselect_b32 s59, 0xffff0000, s57
v_smfmac_f32_16x16x64_bf16 v[100:103], v[96:99], v[64:71], v15
v_add_u32 v226, 63488, v28
v_lshl_add_u32 v28, v24, 12, v27
s_waitcnt lgkmcnt(10)
v_mfma_f32_16x16x32_bf16 v[160:163], v[80:83], v[32:35], 0
s_setprio 1
v_add_u32 v227, 95232, v28
v_lshl_add_u32 v28, v24, 11, v26
v_add_u32 v192, 0, v28
s_waitcnt lgkmcnt(8)
v_mfma_f32_16x16x32_bf16 v[160:163], v[88:91], v[48:51], v[160:163]
s_waitcnt lgkmcnt(0)
s_barrier
s_add_u32 m0, s28, 16384
v_lshl_add_u32 v28, v24, 11, v27
v_add_u32 v193, 15360, v28
v_lshl_add_u32 v28, v24, 11, v26
v_mfma_f32_16x16x32_bf16 v[164:167], v[88:91], v[52:55], 0
buffer_load_dwordx4 v1, s[8:11], s20 offen offset:0 lds
v_add_u32 v194, 30720, v28
v_lshl_add_u32 v28, v24, 11, v27
v_mfma_f32_16x16x32_bf16 v[164:167], v[80:83], v[36:39], v[164:167]
v_add_u32 v195, 46080, v28
v_and_b32 v25, 1, v25
v_lshlrev_b32 v25, 6, v25
v_mfma_f32_16x16x32_bf16 v[180:183], v[84:87], v[36:39], 0
v_lshlrev_b32 v24, 4, v0
v_xor_b32 v25, v24, v25
s_lshl_b32 s26, s42, 17
v_add_u32 v228, s26, v25
v_mfma_f32_16x16x32_bf16 v[180:183], v[92:95], v[52:55], v[180:183]
v_and_b32 v24, 15, v0
v_lshrrev_b32 v25, 4, v0
v_bfe_u32 v26, v0, 1, 3
v_mfma_f32_16x16x32_bf16 v[176:179], v[92:95], v[48:51], 0
buffer_load_dwordx4 v2, s[84:87], s88 offen offset:1024 lds
s_lshr_b32 s26, s42, 1
s_lshl_b32 s26, s26, 13
v_lshlrev_b32 v24, 7, v24
v_add_u32 v24, s26, v24
v_xor_b32 v27, v25, v26
v_mfma_f32_16x16x32_bf16 v[176:179], v[84:87], v[32:35], v[176:179]
s_setprio 0
v_smfmac_f32_16x16x64_bf16 v[100:103], v[96:99], v[72:79], v15
s_waitcnt vmcnt(6)
s_barrier
v_lshl_add_u32 v230, v27, 4, v24
v_xor_b32 v231, 64, v230
v_add_u32 v232, 65536, v230
v_mfma_f32_16x16x32_bf16 v[136:139], v[64:67], v[40:43], 0
s_setprio 1
ds_read_b128 v[36:39], v9 offset:2048
v_add_u32 v233, 65536, v231
v_bfe_u32 v24, v0, 4, 1
v_and_b32 v25, 1, v0
v_mfma_f32_16x16x32_bf16 v[136:139], v[72:75], v[56:59], v[136:139]
ds_read_b128 v[52:55], v10 offset:2048
v_bfe_u32 v26, v0, 1, 1
v_bfe_u32 v27, v0, 2, 2
v_mfma_f32_16x16x32_bf16 v[140:143], v[72:75], v[60:63], 0
buffer_load_dwordx4 v3, s[84:87], s88 offen offset:2048 lds
s_add_u32 s20, s20, 393216
s_add_u32 s88, s88, s89
s_mov_b32 m0, s29
ds_read_b128 v[32:35], v9 offset:0
v_lshl_add_u32 v28, v24, 3, v27
v_lshl_add_u32 v28, v26, 2, v28
v_lshlrev_b32 v28, 4, v28
v_mfma_f32_16x16x32_bf16 v[140:143], v[64:67], v[44:47], v[140:143]
buffer_load_dwordx4 v5, s[12:15], s21 offen offset:0 lds
ds_read_b128 v[48:51], v10 offset:0
v_lshl_add_u32 v28, v25, 3, v28
v_lshl_add_u32 v28, v26, 8, v28
v_lshrrev_b32 v23, 5, v0
v_mfma_f32_16x16x32_bf16 v[156:159], v[68:71], v[44:47], 0
ds_read_b64_tr_b16 v[64:65], v11 offset:32768
v_lshl_add_u32 v28, v23, 10, v28
s_and_b32 s27, s42, 1
s_lshl_b32 s26, s27, 13
s_add_u32 s26, s26, 16384
v_add_u32 v238, s26, v28
v_xor_b32 v239, 64, v238
v_add_u32 v240, 65536, v238
v_add_u32 v241, 65536, v239
v_lshlrev_b32 v28, 3, v24
v_lshl_add_u32 v28, v27, 1, v28
v_add_u32 v28, v25, v28
v_lshlrev_b32 v28, 4, v28
v_lshl_add_u32 v28, v26, 3, v28
v_lshl_add_u32 v28, v23, 12, v28
s_lshl_b32 s26, s27, 11
s_add_u32 s26, s26, 16384
v_add_u32 v200, s26, v28
v_add_u32 v201, 65536, v200
v_mfma_f32_16x16x32_bf16 v[156:159], v[76:79], v[60:63], v[156:159]
ds_read_b64_tr_b16 v[66:67], v11 offset:38912
v_bfe_u32 v26, v0, 3, 1
v_bfe_u32 v27, v0, 1, 2
v_mfma_f32_16x16x32_bf16 v[152:155], v[76:79], v[56:59], 0
ds_read_b64_tr_b16 v[72:73], v11 offset:49152
v_lshl_add_u32 v27, v26, 3, v27
s_lshl_b32 s26, s42, 4
v_add_u32 v27, s26, v27
v_lshlrev_b32 v28, 6, v23
v_mfma_f32_16x16x32_bf16 v[152:155], v[68:71], v[40:43], v[152:155]
s_setprio 0
buffer_load_dwordx4 v6, s[12:15], s21 offen offset:1024 lds
ds_read_b64_tr_b16 v[74:75], v11 offset:55296
v_lshl_add_u32 v28, v25, 5, v28
v_lshl_add_u32 v28, v24, 4, v28
s_lshl_b32 s26, s65, 8
v_add_u32 v28, s26, v28
v_mfma_f32_16x16x32_bf16 v[168:171], v[80:83], v[40:43], 0
s_setprio 1
ds_read_b64_tr_b16 v[68:69], v11 offset:33024
s_movk_i32 s26, 7168
v_mad_u32_u24 v196, v27, s26, v28
v_add_u32 v197, 27648, v196
v_mfma_f32_16x16x32_bf16 v[168:171], v[88:91], v[56:59], v[168:171]
ds_read_b64_tr_b16 v[70:71], v11 offset:39168
v_add_u32 v198, 4294965376, v196
v_add_u32 v199, 25728, v196
v_mov_b32 v204, v96
v_mfma_f32_16x16x32_bf16 v[172:175], v[88:91], v[60:63], 0
ds_read_b64_tr_b16 v[76:77], v11 offset:49408
v_mov_b32 v205, v96
v_mov_b32 v206, v96
v_mov_b32 v207, v96
v_mfma_f32_16x16x32_bf16 v[172:175], v[80:83], v[44:47], v[172:175]
buffer_load_dwordx4 v7, s[12:15], s21 offen offset:2048 lds
ds_read_b64_tr_b16 v[78:79], v11 offset:55552
v_mov_b32 v202, v15
v_mov_b32 v234, 0
v_mov_b32 v235, 0
v_mfma_f32_16x16x32_bf16 v[188:191], v[84:87], v[44:47], 0
ds_read_b64_tr_b16 v[80:81], v12 offset:32768
v_mov_b32 v236, 0
v_mov_b32 v237, 0
v_mfma_f32_16x16x32_bf16 v[188:191], v[92:95], v[60:63], v[188:191]
ds_read_b64_tr_b16 v[82:83], v12 offset:38912
v_mov_b32 v250, 0
v_mov_b32 v251, 0
v_mov_b32 v252, 0
v_mfma_f32_16x16x32_bf16 v[184:187], v[92:95], v[56:59], 0
ds_read_b64_tr_b16 v[88:89], v12 offset:49152
v_mov_b32 v253, 0
v_mov_b32 v242, 0
v_mov_b32 v244, 0
v_mfma_f32_16x16x32_bf16 v[184:187], v[84:87], v[40:43], v[184:187]
s_setprio 0
buffer_load_dwordx4 v8, s[12:15], s21 offen offset:3072 lds
s_add_u32 s21, s21, 128
s_add_u32 s29, s29, 32768
s_cmp_ge_u32 s29, 98304
s_cselect_b32 s26, 98304, 0
s_sub_u32 s29, s29, s26
s_waitcnt lgkmcnt(14)
ds_read_b64_tr_b16 v[90:91], v12 offset:55296
v_mov_b32 v246, 0
v_mov_b32 v248, 0
L_k1_loop_g2:
s_waitcnt lgkmcnt(10)
v_mfma_f32_16x16x32_bf16 v[128:131], v[64:67], v[32:35], v[128:131]
s_setprio 1
ds_read_b64_tr_b16 v[84:85], v12 offset:33024
s_waitcnt lgkmcnt(9)
v_mfma_f32_16x16x32_bf16 v[128:131], v[72:75], v[48:51], v[128:131]
ds_read_b64_tr_b16 v[86:87], v12 offset:39168
v_mfma_f32_16x16x32_bf16 v[132:135], v[72:75], v[52:55], v[132:135]
ds_read_b64_tr_b16 v[92:93], v12 offset:49408
v_mfma_f32_16x16x32_bf16 v[132:135], v[64:67], v[36:39], v[132:135]
ds_read_b64_tr_b16 v[94:95], v12 offset:55552
s_waitcnt lgkmcnt(10)
v_mfma_f32_16x16x32_bf16 v[148:151], v[68:71], v[36:39], v[148:151]
ds_read_b128 v[40:43], v9 offset:4096
s_waitcnt lgkmcnt(9)
v_mfma_f32_16x16x32_bf16 v[148:151], v[76:79], v[52:55], v[148:151]
ds_read_b128 v[56:59], v10 offset:4096
v_mfma_f32_16x16x32_bf16 v[144:147], v[76:79], v[48:51], v[144:147]
ds_read_b128 v[44:47], v9 offset:6144
v_mfma_f32_16x16x32_bf16 v[144:147], v[68:71], v[32:35], v[144:147]
s_setprio 0
ds_read_b128 v[60:63], v10 offset:6144
v_add_u32 v9, s59, v9
v_add_u32 v10, s59, v10
s_add_u32 s40, s40, 1
s_cmp_eq_u32 s40, 3
s_cselect_b32 s40, 0, s40
s_cmp_eq_u32 s40, 2
s_cselect_b32 s59, 0xffff0000, s57
v_smfmac_f32_16x16x64_bf16 v[100:103], v[96:99], v[64:71], v15
s_waitcnt lgkmcnt(10)
v_mfma_f32_16x16x32_bf16 v[160:163], v[80:83], v[32:35], v[160:163]
s_setprio 1
s_waitcnt lgkmcnt(8)
v_mfma_f32_16x16x32_bf16 v[160:163], v[88:91], v[48:51], v[160:163]
s_waitcnt lgkmcnt(0)
s_barrier
s_add_u32 m0, s28, 49152
v_mfma_f32_16x16x32_bf16 v[164:167], v[88:91], v[52:55], v[164:167]
buffer_load_dwordx4 v1, s[8:11], s20 offen offset:0 lds
v_mfma_f32_16x16x32_bf16 v[164:167], v[80:83], v[36:39], v[164:167]
v_mfma_f32_16x16x32_bf16 v[180:183], v[84:87], v[36:39], v[180:183]
v_mfma_f32_16x16x32_bf16 v[180:183], v[92:95], v[52:55], v[180:183]
v_mfma_f32_16x16x32_bf16 v[176:179], v[92:95], v[48:51], v[176:179]
buffer_load_dwordx4 v2, s[84:87], s88 offen offset:1024 lds
v_mfma_f32_16x16x32_bf16 v[176:179], v[84:87], v[32:35], v[176:179]
s_setprio 0
v_smfmac_f32_16x16x64_bf16 v[100:103], v[96:99], v[72:79], v15
s_waitcnt vmcnt(6)
s_barrier
v_mfma_f32_16x16x32_bf16 v[136:139], v[64:67], v[40:43], v[136:139]
s_setprio 1
ds_read_b128 v[36:39], v9 offset:2048
v_mfma_f32_16x16x32_bf16 v[136:139], v[72:75], v[56:59], v[136:139]
ds_read_b128 v[52:55], v10 offset:2048
v_mfma_f32_16x16x32_bf16 v[140:143], v[72:75], v[60:63], v[140:143]
buffer_load_dwordx4 v3, s[84:87], s88 offen offset:2048 lds
s_add_u32 s20, s20, 393216
s_add_u32 s88, s88, s89
s_mov_b32 m0, s29
ds_read_b128 v[32:35], v9 offset:0
v_mfma_f32_16x16x32_bf16 v[140:143], v[64:67], v[44:47], v[140:143]
buffer_load_dwordx4 v5, s[12:15], s21 offen offset:0 lds
ds_read_b128 v[48:51], v10 offset:0
v_mfma_f32_16x16x32_bf16 v[156:159], v[68:71], v[44:47], v[156:159]
ds_read_b64_tr_b16 v[64:65], v11 offset:0
v_mfma_f32_16x16x32_bf16 v[156:159], v[76:79], v[60:63], v[156:159]
ds_read_b64_tr_b16 v[66:67], v11 offset:6144
v_mfma_f32_16x16x32_bf16 v[152:155], v[76:79], v[56:59], v[152:155]
ds_read_b64_tr_b16 v[72:73], v11 offset:16384
v_mfma_f32_16x16x32_bf16 v[152:155], v[68:71], v[40:43], v[152:155]
s_setprio 0
buffer_load_dwordx4 v6, s[12:15], s21 offen offset:1024 lds
ds_read_b64_tr_b16 v[74:75], v11 offset:22528
v_mfma_f32_16x16x32_bf16 v[168:171], v[80:83], v[40:43], v[168:171]
s_setprio 1
ds_read_b64_tr_b16 v[68:69], v11 offset:256
v_mfma_f32_16x16x32_bf16 v[168:171], v[88:91], v[56:59], v[168:171]
ds_read_b64_tr_b16 v[70:71], v11 offset:6400
v_mfma_f32_16x16x32_bf16 v[172:175], v[88:91], v[60:63], v[172:175]
ds_read_b64_tr_b16 v[76:77], v11 offset:16640
v_mfma_f32_16x16x32_bf16 v[172:175], v[80:83], v[44:47], v[172:175]
buffer_load_dwordx4 v7, s[12:15], s21 offen offset:2048 lds
ds_read_b64_tr_b16 v[78:79], v11 offset:22784
v_mfma_f32_16x16x32_bf16 v[188:191], v[84:87], v[44:47], v[188:191]
ds_read_b64_tr_b16 v[80:81], v12 offset:0
v_mfma_f32_16x16x32_bf16 v[188:191], v[92:95], v[60:63], v[188:191]
ds_read_b64_tr_b16 v[82:83], v12 offset:6144
v_mfma_f32_16x16x32_bf16 v[184:187], v[92:95], v[56:59], v[184:187]
ds_read_b64_tr_b16 v[88:89], v12 offset:16384
v_mfma_f32_16x16x32_bf16 v[184:187], v[84:87], v[40:43], v[184:187]
s_setprio 0
buffer_load_dwordx4 v8, s[12:15], s21 offen offset:3072 lds
s_add_u32 s21, s21, 128
s_add_u32 s29, s29, 32768
s_cmp_ge_u32 s29, 98304
s_cselect_b32 s26, 98304, 0
s_sub_u32 s29, s29, s26
s_waitcnt lgkmcnt(14)
ds_read_b64_tr_b16 v[90:91], v12 offset:22528
s_waitcnt lgkmcnt(10)
v_mfma_f32_16x16x32_bf16 v[128:131], v[64:67], v[32:35], v[128:131]
s_setprio 1
ds_read_b64_tr_b16 v[84:85], v12 offset:256
s_waitcnt lgkmcnt(9)
v_mfma_f32_16x16x32_bf16 v[128:131], v[72:75], v[48:51], v[128:131]
ds_read_b64_tr_b16 v[86:87], v12 offset:6400
v_mfma_f32_16x16x32_bf16 v[132:135], v[72:75], v[52:55], v[132:135]
ds_read_b64_tr_b16 v[92:93], v12 offset:16640
v_mfma_f32_16x16x32_bf16 v[132:135], v[64:67], v[36:39], v[132:135]
ds_read_b64_tr_b16 v[94:95], v12 offset:22784
s_waitcnt lgkmcnt(10)
v_mfma_f32_16x16x32_bf16 v[148:151], v[68:71], v[36:39], v[148:151]
ds_read_b128 v[40:43], v9 offset:4096
s_waitcnt lgkmcnt(9)
v_mfma_f32_16x16x32_bf16 v[148:151], v[76:79], v[52:55], v[148:151]
ds_read_b128 v[56:59], v10 offset:4096
v_mfma_f32_16x16x32_bf16 v[144:147], v[76:79], v[48:51], v[144:147]
ds_read_b128 v[44:47], v9 offset:6144
v_mfma_f32_16x16x32_bf16 v[144:147], v[68:71], v[32:35], v[144:147]
s_setprio 0
ds_read_b128 v[60:63], v10 offset:6144
v_add_u32 v9, s59, v9
v_add_u32 v10, s59, v10
s_add_u32 s40, s40, 1
s_cmp_eq_u32 s40, 3
s_cselect_b32 s40, 0, s40
s_cmp_eq_u32 s40, 2
s_cselect_b32 s59, 0xffff0000, s57
v_smfmac_f32_16x16x64_bf16 v[100:103], v[96:99], v[64:71], v15
s_waitcnt lgkmcnt(10)
v_mfma_f32_16x16x32_bf16 v[160:163], v[80:83], v[32:35], v[160:163]
s_setprio 1
s_waitcnt lgkmcnt(8)
v_mfma_f32_16x16x32_bf16 v[160:163], v[88:91], v[48:51], v[160:163]
s_waitcnt lgkmcnt(0)
s_barrier
s_add_u32 m0, s28, 16384
v_mfma_f32_16x16x32_bf16 v[164:167], v[88:91], v[52:55], v[164:167]
buffer_load_dwordx4 v1, s[8:11], s20 offen offset:0 lds
v_mfma_f32_16x16x32_bf16 v[164:167], v[80:83], v[36:39], v[164:167]
v_mfma_f32_16x16x32_bf16 v[180:183], v[84:87], v[36:39], v[180:183]
v_mfma_f32_16x16x32_bf16 v[180:183], v[92:95], v[52:55], v[180:183]
v_mfma_f32_16x16x32_bf16 v[176:179], v[92:95], v[48:51], v[176:179]
buffer_load_dwordx4 v2, s[84:87], s88 offen offset:1024 lds
v_mfma_f32_16x16x32_bf16 v[176:179], v[84:87], v[32:35], v[176:179]
s_setprio 0
v_smfmac_f32_16x16x64_bf16 v[100:103], v[96:99], v[72:79], v15
s_waitcnt vmcnt(6)
s_barrier
v_mfma_f32_16x16x32_bf16 v[136:139], v[64:67], v[40:43], v[136:139]
s_setprio 1
ds_read_b128 v[36:39], v9 offset:2048
v_mfma_f32_16x16x32_bf16 v[136:139], v[72:75], v[56:59], v[136:139]
ds_read_b128 v[52:55], v10 offset:2048
v_mfma_f32_16x16x32_bf16 v[140:143], v[72:75], v[60:63], v[140:143]
buffer_load_dwordx4 v3, s[84:87], s88 offen offset:2048 lds
s_add_u32 s20, s20, 393216
s_add_u32 s88, s88, s89
s_mov_b32 m0, s29
ds_read_b128 v[32:35], v9 offset:0
v_mfma_f32_16x16x32_bf16 v[140:143], v[64:67], v[44:47], v[140:143]
buffer_load_dwordx4 v5, s[12:15], s21 offen offset:0 lds
ds_read_b128 v[48:51], v10 offset:0
v_mfma_f32_16x16x32_bf16 v[156:159], v[68:71], v[44:47], v[156:159]
ds_read_b64_tr_b16 v[64:65], v11 offset:32768
v_mfma_f32_16x16x32_bf16 v[156:159], v[76:79], v[60:63], v[156:159]
ds_read_b64_tr_b16 v[66:67], v11 offset:38912
v_mfma_f32_16x16x32_bf16 v[152:155], v[76:79], v[56:59], v[152:155]
ds_read_b64_tr_b16 v[72:73], v11 offset:49152
v_mfma_f32_16x16x32_bf16 v[152:155], v[68:71], v[40:43], v[152:155]
s_setprio 0
buffer_load_dwordx4 v6, s[12:15], s21 offen offset:1024 lds
ds_read_b64_tr_b16 v[74:75], v11 offset:55296
v_mfma_f32_16x16x32_bf16 v[168:171], v[80:83], v[40:43], v[168:171]
s_setprio 1
ds_read_b64_tr_b16 v[68:69], v11 offset:33024
v_mfma_f32_16x16x32_bf16 v[168:171], v[88:91], v[56:59], v[168:171]
ds_read_b64_tr_b16 v[70:71], v11 offset:39168
v_mfma_f32_16x16x32_bf16 v[172:175], v[88:91], v[60:63], v[172:175]
ds_read_b64_tr_b16 v[76:77], v11 offset:49408
v_mfma_f32_16x16x32_bf16 v[172:175], v[80:83], v[44:47], v[172:175]
buffer_load_dwordx4 v7, s[12:15], s21 offen offset:2048 lds
ds_read_b64_tr_b16 v[78:79], v11 offset:55552
v_mfma_f32_16x16x32_bf16 v[188:191], v[84:87], v[44:47], v[188:191]
ds_read_b64_tr_b16 v[80:81], v12 offset:32768
v_mfma_f32_16x16x32_bf16 v[188:191], v[92:95], v[60:63], v[188:191]
ds_read_b64_tr_b16 v[82:83], v12 offset:38912
v_mfma_f32_16x16x32_bf16 v[184:187], v[92:95], v[56:59], v[184:187]
ds_read_b64_tr_b16 v[88:89], v12 offset:49152
v_mfma_f32_16x16x32_bf16 v[184:187], v[84:87], v[40:43], v[184:187]
s_setprio 0
buffer_load_dwordx4 v8, s[12:15], s21 offen offset:3072 lds
s_add_u32 s21, s21, 128
s_add_u32 s29, s29, 32768
s_cmp_ge_u32 s29, 98304
s_cselect_b32 s26, 98304, 0
s_sub_u32 s29, s29, s26
s_waitcnt lgkmcnt(14)
ds_read_b64_tr_b16 v[90:91], v12 offset:55296
s_sub_u32 s22, s22, 1
s_cmp_lg_u32 s22, 0
s_cbranch_scc1 L_k1_loop_g2
s_waitcnt lgkmcnt(10)
v_mfma_f32_16x16x32_bf16 v[128:131], v[64:67], v[32:35], v[128:131]
s_setprio 1
ds_read_b64_tr_b16 v[84:85], v12 offset:33024
s_waitcnt lgkmcnt(9)
v_mfma_f32_16x16x32_bf16 v[128:131], v[72:75], v[48:51], v[128:131]
ds_read_b64_tr_b16 v[86:87], v12 offset:39168
v_mfma_f32_16x16x32_bf16 v[132:135], v[72:75], v[52:55], v[132:135]
ds_read_b64_tr_b16 v[92:93], v12 offset:49408
v_mfma_f32_16x16x32_bf16 v[132:135], v[64:67], v[36:39], v[132:135]
ds_read_b64_tr_b16 v[94:95], v12 offset:55552
s_waitcnt lgkmcnt(10)
v_mfma_f32_16x16x32_bf16 v[148:151], v[68:71], v[36:39], v[148:151]
ds_read_b128 v[40:43], v9 offset:4096
s_waitcnt lgkmcnt(9)
v_mfma_f32_16x16x32_bf16 v[148:151], v[76:79], v[52:55], v[148:151]
ds_read_b128 v[56:59], v10 offset:4096
v_mfma_f32_16x16x32_bf16 v[144:147], v[76:79], v[48:51], v[144:147]
ds_read_b128 v[44:47], v9 offset:6144
v_mfma_f32_16x16x32_bf16 v[144:147], v[68:71], v[32:35], v[144:147]
s_setprio 0
ds_read_b128 v[60:63], v10 offset:6144
v_add_u32 v9, s59, v9
v_add_u32 v10, s59, v10
s_add_u32 s40, s40, 1
s_cmp_eq_u32 s40, 3
s_cselect_b32 s40, 0, s40
s_cmp_eq_u32 s40, 2
s_cselect_b32 s59, 0xffff0000, s57
v_smfmac_f32_16x16x64_bf16 v[100:103], v[96:99], v[64:71], v15
s_waitcnt lgkmcnt(10)
v_mfma_f32_16x16x32_bf16 v[160:163], v[80:83], v[32:35], v[160:163]
s_setprio 1
s_waitcnt lgkmcnt(8)
v_mfma_f32_16x16x32_bf16 v[160:163], v[88:91], v[48:51], v[160:163]
s_waitcnt lgkmcnt(0)
s_barrier
s_add_u32 m0, s28, 49152
v_mfma_f32_16x16x32_bf16 v[164:167], v[88:91], v[52:55], v[164:167]
buffer_load_dwordx4 v1, s[8:11], s20 offen offset:0 lds
v_mfma_f32_16x16x32_bf16 v[164:167], v[80:83], v[36:39], v[164:167]
v_mfma_f32_16x16x32_bf16 v[180:183], v[84:87], v[36:39], v[180:183]
v_mfma_f32_16x16x32_bf16 v[180:183], v[92:95], v[52:55], v[180:183]
v_mfma_f32_16x16x32_bf16 v[176:179], v[92:95], v[48:51], v[176:179]
buffer_load_dwordx4 v2, s[84:87], s88 offen offset:1024 lds
v_mfma_f32_16x16x32_bf16 v[176:179], v[84:87], v[32:35], v[176:179]
s_setprio 0
v_smfmac_f32_16x16x64_bf16 v[100:103], v[96:99], v[72:79], v15
s_waitcnt vmcnt(6)
s_barrier
v_mfma_f32_16x16x32_bf16 v[136:139], v[64:67], v[40:43], v[136:139]
s_setprio 1
ds_read_b128 v[36:39], v9 offset:2048
v_mfma_f32_16x16x32_bf16 v[136:139], v[72:75], v[56:59], v[136:139]
ds_read_b128 v[52:55], v10 offset:2048
v_mfma_f32_16x16x32_bf16 v[140:143], v[72:75], v[60:63], v[140:143]
buffer_load_dwordx4 v3, s[84:87], s88 offen offset:2048 lds
s_add_u32 s20, s20, 393216
s_add_u32 s88, s88, s89
ds_read_b128 v[32:35], v9 offset:0
v_mfma_f32_16x16x32_bf16 v[140:143], v[64:67], v[44:47], v[140:143]
ds_read_b128 v[48:51], v10 offset:0
v_mfma_f32_16x16x32_bf16 v[156:159], v[68:71], v[44:47], v[156:159]
ds_read_b64_tr_b16 v[64:65], v11 offset:0
v_mfma_f32_16x16x32_bf16 v[156:159], v[76:79], v[60:63], v[156:159]
ds_read_b64_tr_b16 v[66:67], v11 offset:6144
v_mfma_f32_16x16x32_bf16 v[152:155], v[76:79], v[56:59], v[152:155]
ds_read_b64_tr_b16 v[72:73], v11 offset:16384
v_mfma_f32_16x16x32_bf16 v[152:155], v[68:71], v[40:43], v[152:155]
s_setprio 0
ds_read_b64_tr_b16 v[74:75], v11 offset:22528
v_mfma_f32_16x16x32_bf16 v[168:171], v[80:83], v[40:43], v[168:171]
s_setprio 1
ds_read_b64_tr_b16 v[68:69], v11 offset:256
v_mfma_f32_16x16x32_bf16 v[168:171], v[88:91], v[56:59], v[168:171]
ds_read_b64_tr_b16 v[70:71], v11 offset:6400
v_mfma_f32_16x16x32_bf16 v[172:175], v[88:91], v[60:63], v[172:175]
ds_read_b64_tr_b16 v[76:77], v11 offset:16640
v_mfma_f32_16x16x32_bf16 v[172:175], v[80:83], v[44:47], v[172:175]
ds_read_b64_tr_b16 v[78:79], v11 offset:22784
v_mfma_f32_16x16x32_bf16 v[188:191], v[84:87], v[44:47], v[188:191]
ds_read_b64_tr_b16 v[80:81], v12 offset:0
v_mfma_f32_16x16x32_bf16 v[188:191], v[92:95], v[60:63], v[188:191]
ds_read_b64_tr_b16 v[82:83], v12 offset:6144
v_mfma_f32_16x16x32_bf16 v[184:187], v[92:95], v[56:59], v[184:187]
ds_read_b64_tr_b16 v[88:89], v12 offset:16384
v_mfma_f32_16x16x32_bf16 v[184:187], v[84:87], v[40:43], v[184:187]
s_setprio 0
s_waitcnt lgkmcnt(14)
ds_read_b64_tr_b16 v[90:91], v12 offset:22528
s_waitcnt lgkmcnt(10)
v_mfma_f32_16x16x32_bf16 v[128:131], v[64:67], v[32:35], v[128:131]
s_setprio 1
ds_read_b64_tr_b16 v[84:85], v12 offset:256
v_and_b32 v2, 31, v0
s_add_u32 s26, s35, s46
s_lshl_b32 s26, s26, 7
s_add_u32 s26, s26, 143360
s_waitcnt lgkmcnt(9)
v_mfma_f32_16x16x32_bf16 v[128:131], v[72:75], v[48:51], v[128:131]
ds_read_b64_tr_b16 v[86:87], v12 offset:6400
v_lshl_add_u32 v2, v2, 2, s26
v_lshrrev_b32 v3, 4, v0
v_mfma_f32_16x16x32_bf16 v[132:135], v[72:75], v[52:55], v[132:135]
ds_read_b64_tr_b16 v[92:93], v12 offset:16640
v_lshlrev_b32 v3, 4, v3
v_lshlrev_b32 v4, 4, v0
v_mfma_f32_16x16x32_bf16 v[132:135], v[64:67], v[36:39], v[132:135]
ds_read_b64_tr_b16 v[94:95], v12 offset:22784
s_mov_b32 s28, 0
s_mov_b32 s29, 0
s_waitcnt lgkmcnt(10)
v_mfma_f32_16x16x32_bf16 v[148:151], v[68:71], v[36:39], v[148:151]
ds_read_b128 v[40:43], v9 offset:4096
s_add_u32 m0, s41, 0
s_waitcnt lgkmcnt(9)
v_mfma_f32_16x16x32_bf16 v[148:151], v[76:79], v[52:55], v[148:151]
ds_read_b128 v[56:59], v10 offset:4096
buffer_load_dwordx4 v192, s[36:39], s28 offen offset:0 lds
v_mfma_f32_16x16x32_bf16 v[144:147], v[76:79], v[48:51], v[144:147]
ds_read_b128 v[44:47], v9 offset:6144
v_mov_b32 v6, 159748
v_mov_b32 v7, 0
buffer_load_dwordx4 v193, s[36:39], s28 offen offset:1024 lds
v_mfma_f32_16x16x32_bf16 v[144:147], v[68:71], v[32:35], v[144:147]
s_setprio 0
ds_read_b128 v[60:63], v10 offset:6144
v_add_u32 v9, s59, v9
v_add_u32 v10, s59, v10
s_add_u32 s40, s40, 1
s_cmp_eq_u32 s40, 3
s_cselect_b32 s40, 0, s40
s_cmp_eq_u32 s40, 2
s_cselect_b32 s59, 0xffff0000, s57
v_smfmac_f32_16x16x64_bf16 v[100:103], v[96:99], v[64:71], v15
ds_write_b32 v6, v7
buffer_load_dwordx4 v194, s[36:39], s28 offen offset:2048 lds
s_waitcnt lgkmcnt(11)
v_mfma_f32_16x16x32_bf16 v[160:163], v[80:83], v[32:35], v[160:163]
s_setprio 1
buffer_load_dwordx4 v195, s[36:39], s28 offen offset:3072 lds
s_add_u32 s28, s28, 128
s_waitcnt lgkmcnt(9)
v_mfma_f32_16x16x32_bf16 v[160:163], v[88:91], v[48:51], v[160:163]
s_waitcnt lgkmcnt(0)
s_barrier
v_mfma_f32_16x16x32_bf16 v[164:167], v[88:91], v[52:55], v[164:167]
s_add_u32 m0, s41, 16384
v_mfma_f32_16x16x32_bf16 v[164:167], v[80:83], v[36:39], v[164:167]
buffer_load_dwordx4 v196, s[52:55], s29 offen offset:0 lds
v_mfma_f32_16x16x32_bf16 v[180:183], v[84:87], v[36:39], v[180:183]
buffer_load_dwordx4 v197, s[52:55], s29 offen offset:1024 lds
v_bfe_u32 v1, v0, 3, 1
v_and_b32 v24, 7, v0
s_lshl_b32 s26, s23, 12
v_mfma_f32_16x16x32_bf16 v[180:183], v[92:95], v[52:55], v[180:183]
buffer_load_dwordx4 v198, s[52:55], s29 offen offset:2048 lds
v_lshlrev_b32 v1, 7, v1
s_lshl_b32 s27, s42, 10
v_mfma_f32_16x16x32_bf16 v[176:179], v[92:95], v[48:51], v[176:179]
buffer_load_dwordx4 v199, s[52:55], s29 offen offset:3072 lds
s_add_u32 s29, s29, 458752
v_lshl_add_u32 v1, v24, 3, v1
s_add_u32 s43, s26, s27
v_mfma_f32_16x16x32_bf16 v[176:179], v[84:87], v[32:35], v[176:179]
s_setprio 0
v_smfmac_f32_16x16x64_bf16 v[100:103], v[96:99], v[72:79], v15
s_waitcnt vmcnt(8)
s_barrier
v_mfma_f32_16x16x32_bf16 v[136:139], v[64:67], v[40:43], v[136:139]
s_setprio 1
ds_read_b128 v[36:39], v9 offset:2048
buffer_load_dwordx2 v[16:17], v1, s[92:95], s43 offen offset:0 sc1
v_mfma_f32_16x16x32_bf16 v[136:139], v[72:75], v[56:59], v[136:139]
ds_read_b128 v[52:55], v10 offset:2048
buffer_load_dwordx2 v[18:19], v1, s[92:95], s43 offen offset:256 sc1
v_mfma_f32_16x16x32_bf16 v[140:143], v[72:75], v[60:63], v[140:143]
ds_read_b128 v[32:35], v9 offset:0
buffer_load_dwordx2 v[20:21], v1, s[92:95], s43 offen offset:512 sc1
v_mfma_f32_16x16x32_bf16 v[140:143], v[64:67], v[44:47], v[140:143]
ds_read_b128 v[48:51], v10 offset:0
buffer_load_dwordx2 v[22:23], v1, s[92:95], s43 offen offset:768 sc1
v_mfma_f32_16x16x32_bf16 v[156:159], v[68:71], v[44:47], v[156:159]
ds_read_b64_tr_b16 v[64:65], v11 offset:32768
v_mfma_f32_16x16x32_bf16 v[156:159], v[76:79], v[60:63], v[156:159]
ds_read_b64_tr_b16 v[66:67], v11 offset:38912
v_mfma_f32_16x16x32_bf16 v[152:155], v[76:79], v[56:59], v[152:155]
ds_read_b64_tr_b16 v[72:73], v11 offset:49152
v_mfma_f32_16x16x32_bf16 v[152:155], v[68:71], v[40:43], v[152:155]
s_setprio 0
ds_read_b64_tr_b16 v[74:75], v11 offset:55296
v_mfma_f32_16x16x32_bf16 v[168:171], v[80:83], v[40:43], v[168:171]
s_setprio 1
ds_read_b64_tr_b16 v[68:69], v11 offset:33024
v_mfma_f32_16x16x32_bf16 v[168:171], v[88:91], v[56:59], v[168:171]
ds_read_b64_tr_b16 v[70:71], v11 offset:39168
s_add_u32 m0, s41, 32768
s_nop 0
buffer_load_dwordx4 v192, s[36:39], s28 offen offset:0 lds
v_mfma_f32_16x16x32_bf16 v[172:175], v[88:91], v[60:63], v[172:175]
ds_read_b64_tr_b16 v[76:77], v11 offset:49408
buffer_load_dwordx4 v193, s[36:39], s28 offen offset:1024 lds
v_mfma_f32_16x16x32_bf16 v[172:175], v[80:83], v[44:47], v[172:175]
ds_read_b64_tr_b16 v[78:79], v11 offset:55552
buffer_load_dwordx4 v194, s[36:39], s28 offen offset:2048 lds
buffer_load_dwordx4 v195, s[36:39], s28 offen offset:3072 lds
s_add_u32 s28, s28, 128
v_mfma_f32_16x16x32_bf16 v[188:191], v[84:87], v[44:47], v[188:191]
ds_read_b64_tr_b16 v[80:81], v12 offset:32768
s_add_u32 m0, s41, 49152
v_mfma_f32_16x16x32_bf16 v[188:191], v[92:95], v[60:63], v[188:191]
ds_read_b64_tr_b16 v[82:83], v12 offset:38912
s_waitcnt lgkmcnt(4)
v_smfmac_f32_16x16x64_bf16 v[100:103], v[96:99], v[64:71], v15
buffer_load_dwordx4 v196, s[52:55], s29 offen offset:0 lds
buffer_load_dwordx4 v197, s[52:55], s29 offen offset:1024 lds
v_mfma_f32_16x16x32_bf16 v[184:187], v[92:95], v[56:59], v[184:187]
ds_read_b64_tr_b16 v[88:89], v12 offset:49152
buffer_load_dwordx4 v198, s[52:55], s29 offen offset:2048 lds
v_mfma_f32_16x16x32_bf16 v[184:187], v[84:87], v[40:43], v[184:187]
s_setprio 0
ds_read_b64_tr_b16 v[90:91], v12 offset:55296
s_waitcnt lgkmcnt(4)
v_smfmac_f32_16x16x64_bf16 v[100:103], v[96:99], v[72:79], v15
buffer_load_dwordx4 v199, s[52:55], s29 offen offset:3072 lds
s_add_u32 s29, s29, 458752
s_setprio 1
s_cmp_eq_u32 s58, 0
s_cbranch_scc1 L_k1_gpz
s_setprio 0
L_k1_gpz:
v_mfma_f32_16x16x32_bf16 v[128:131], v[64:67], v[32:35], v[128:131]
ds_read_b128 v[40:43], v9 offset:4096
v_mfma_f32_16x16x32_bf16 v[128:131], v[72:75], v[48:51], v[128:131]
ds_read_b128 v[56:59], v10 offset:4096
v_bfe_u32 v5, v0, 4, 1
v_mfma_f32_16x16x32_bf16 v[132:135], v[72:75], v[52:55], v[132:135]
ds_read_b128 v[44:47], v9 offset:6144
v_cmp_eq_u32 vcc, 0, v5
v_mfma_f32_16x16x32_bf16 v[132:135], v[64:67], v[36:39], v[132:135]
ds_read_b128 v[60:63], v10 offset:6144
v_mfma_f32_16x16x32_bf16 v[148:151], v[68:71], v[36:39], v[148:151]
v_add_f32 v100, v100, v101
v_add_f32 v102, v102, v103
v_mfma_f32_16x16x32_bf16 v[148:151], v[76:79], v[52:55], v[148:151]
v_cndmask_b32 v100, v102, v100, vcc
ds_write_b32 v2, v100
v_mfma_f32_16x16x32_bf16 v[144:147], v[76:79], v[48:51], v[144:147]
v_mfma_f32_16x16x32_bf16 v[144:147], v[68:71], v[32:35], v[144:147]
s_waitcnt lgkmcnt(0)
s_barrier
s_add_u32 s26, s46, 0
s_cmp_ge_u32 s26, 2
s_cselect_b32 s27, 2, 0
s_sub_u32 s26, s26, s27
s_lshl_b32 s26, s26, 7
s_add_u32 s26, s26, 143360
v_add_u32 v5, s26, v3
ds_read_b128 v[112:115], v5 offset:0
ds_read_b128 v[116:119], v5 offset:64
v_mfma_f32_16x16x32_bf16 v[152:155], v[68:71], v[40:43], v[152:155]
ds_read_b64_tr_b16 v[84:85], v12 offset:33024
s_add_u32 m0, s41, 65536
v_mfma_f32_16x16x32_bf16 v[152:155], v[76:79], v[56:59], v[152:155]
ds_read_b64_tr_b16 v[86:87], v12 offset:39168
buffer_load_dwordx4 v192, s[36:39], s28 offen offset:0 lds
v_mfma_f32_16x16x32_bf16 v[156:159], v[76:79], v[60:63], v[156:159]
ds_read_b64_tr_b16 v[92:93], v12 offset:49408
buffer_load_dwordx4 v193, s[36:39], s28 offen offset:1024 lds
v_mfma_f32_16x16x32_bf16 v[156:159], v[68:71], v[44:47], v[156:159]
ds_read_b64_tr_b16 v[94:95], v12 offset:55552
s_waitcnt vmcnt(10)
buffer_load_dwordx4 v194, s[36:39], s28 offen offset:2048 lds
v_mfma_f32_16x16x32_bf16 v[140:143], v[64:67], v[44:47], v[140:143]
v_mul_f32 v24, s56, v17
buffer_load_dwordx4 v195, s[36:39], s28 offen offset:3072 lds
s_add_u32 s28, s28, 128
v_mfma_f32_16x16x32_bf16 v[140:143], v[72:75], v[60:63], v[140:143]
v_mul_f32 v26, s56, v19
s_add_u32 m0, s41, 81920
v_mfma_f32_16x16x32_bf16 v[136:139], v[72:75], v[56:59], v[136:139]
v_mul_f32 v28, s56, v21
buffer_load_dwordx4 v196, s[52:55], s29 offen offset:0 lds
v_mfma_f32_16x16x32_bf16 v[136:139], v[64:67], v[40:43], v[136:139]
v_mul_f32 v30, s56, v23
buffer_load_dwordx4 v197, s[52:55], s29 offen offset:1024 lds
v_mfma_f32_16x16x32_bf16 v[160:163], v[80:83], v[32:35], v[160:163]
buffer_load_dwordx4 v198, s[52:55], s29 offen offset:2048 lds
s_add_u32 s26, s46, 1
s_cmp_ge_u32 s26, 2
s_cselect_b32 s27, 2, 0
s_sub_u32 s26, s26, s27
s_lshl_b32 s26, s26, 7
s_add_u32 s26, s26, 143360
v_add_u32 v5, s26, v3
v_mfma_f32_16x16x32_bf16 v[160:163], v[88:91], v[48:51], v[160:163]
buffer_load_dwordx4 v199, s[52:55], s29 offen offset:3072 lds
s_add_u32 s29, s29, 458752
ds_read_b128 v[120:123], v5 offset:0
ds_read_b128 v[124:127], v5 offset:64
s_waitcnt lgkmcnt(7)
v_fmac_f32 v128, v112, v16
v_fmac_f32 v129, v113, v16
v_fmac_f32 v130, v114, v16
v_fmac_f32 v131, v115, v16
v_mfma_f32_16x16x32_bf16 v[164:167], v[88:91], v[52:55], v[164:167]
s_add_u32 m0, s41, 98304
v_fmac_f32 v132, v112, v18
v_fmac_f32 v133, v113, v18
v_fmac_f32 v134, v114, v18
v_fmac_f32 v135, v115, v18
v_fmac_f32 v136, v112, v20
v_fmac_f32 v137, v113, v20
v_mfma_f32_16x16x32_bf16 v[164:167], v[80:83], v[36:39], v[164:167]
buffer_load_dwordx4 v192, s[36:39], s28 offen offset:0 lds
v_fmac_f32 v138, v114, v20
v_fmac_f32 v139, v115, v20
v_fmac_f32 v140, v112, v22
v_fmac_f32 v141, v113, v22
v_fmac_f32 v142, v114, v22
v_fmac_f32 v143, v115, v22
s_waitcnt lgkmcnt(4)
v_mfma_f32_16x16x32_bf16 v[180:183], v[84:87], v[36:39], v[180:183]
buffer_load_dwordx4 v193, s[36:39], s28 offen offset:1024 lds
v_mul_f32 v128, v128, v24
v_mul_f32 v129, v129, v24
v_mul_f32 v130, v130, v24
v_mul_f32 v131, v131, v24
v_mul_f32 v132, v132, v26
v_mul_f32 v133, v133, v26
s_waitcnt lgkmcnt(2)
v_mfma_f32_16x16x32_bf16 v[180:183], v[92:95], v[52:55], v[180:183]
buffer_load_dwordx4 v194, s[36:39], s28 offen offset:2048 lds
v_mul_f32 v134, v134, v26
v_mul_f32 v135, v135, v26
v_mul_f32 v136, v136, v28
v_mul_f32 v137, v137, v28
v_mul_f32 v138, v138, v28
v_mul_f32 v139, v139, v28
v_mul_f32 v140, v140, v30
v_mfma_f32_16x16x32_bf16 v[176:179], v[92:95], v[48:51], v[176:179]
buffer_load_dwordx4 v195, s[36:39], s28 offen offset:3072 lds
s_add_u32 s28, s28, 128
v_mul_f32 v141, v141, v30
v_mul_f32 v142, v142, v30
v_mul_f32 v143, v143, v30
v_fmac_f32 v144, v116, v16
v_fmac_f32 v145, v117, v16
v_fmac_f32 v146, v118, v16
v_mfma_f32_16x16x32_bf16 v[176:179], v[84:87], v[32:35], v[176:179]
v_fmac_f32 v147, v119, v16
v_fmac_f32 v148, v116, v18
v_fmac_f32 v149, v117, v18
v_fmac_f32 v150, v118, v18
v_fmac_f32 v151, v119, v18
v_fmac_f32 v152, v116, v20
v_mfma_f32_16x16x32_bf16 v[184:187], v[84:87], v[40:43], v[184:187]
v_fmac_f32 v153, v117, v20
v_fmac_f32 v154, v118, v20
v_fmac_f32 v155, v119, v20
v_fmac_f32 v156, v116, v22
v_fmac_f32 v157, v117, v22
v_fmac_f32 v158, v118, v22
v_mfma_f32_16x16x32_bf16 v[184:187], v[92:95], v[56:59], v[184:187]
v_fmac_f32 v159, v119, v22
v_mul_f32 v144, v144, v24
v_mul_f32 v145, v145, v24
v_mul_f32 v146, v146, v24
v_mul_f32 v147, v147, v24
v_mul_f32 v148, v148, v26
v_mfma_f32_16x16x32_bf16 v[188:191], v[92:95], v[60:63], v[188:191]
v_mul_f32 v149, v149, v26
v_mul_f32 v150, v150, v26
v_mul_f32 v151, v151, v26
v_mul_f32 v152, v152, v28
v_mul_f32 v153, v153, v28
v_mul_f32 v154, v154, v28
v_mul_f32 v155, v155, v28
v_mfma_f32_16x16x32_bf16 v[188:191], v[84:87], v[44:47], v[188:191]
v_mul_f32 v156, v156, v30
v_mul_f32 v157, v157, v30
v_mul_f32 v158, v158, v30
v_mul_f32 v159, v159, v30
s_add_u32 s26, s46, 0
s_cmp_ge_u32 s26, 2
v_mfma_f32_16x16x32_bf16 v[172:175], v[80:83], v[44:47], v[172:175]
s_cselect_b32 s27, 2, 0
s_sub_u32 s26, s26, s27
s_lshl_b32 s26, s26, 17
s_add_u32 s27, s26, s31
v_cvt_pk_bf16_f32 v128, v128, v129
v_cvt_pk_bf16_f32 v129, v130, v131
v_mfma_f32_16x16x32_bf16 v[172:175], v[88:91], v[60:63], v[172:175]
v_cvt_pk_bf16_f32 v130, v144, v145
v_cvt_pk_bf16_f32 v131, v146, v147
buffer_store_dwordx4 v[128:131], v4, s[16:19], s27 offen offset:0 sc0 sc1
v_cvt_pk_bf16_f32 v132, v132, v133
v_cvt_pk_bf16_f32 v133, v134, v135
v_cvt_pk_bf16_f32 v134, v148, v149
v_mfma_f32_16x16x32_bf16 v[168:171], v[88:91], v[56:59], v[168:171]
v_cvt_pk_bf16_f32 v135, v150, v151
buffer_store_dwordx4 v[132:135], v4, s[16:19], s27 offen offset:1024 sc0 sc1
v_cvt_pk_bf16_f32 v136, v136, v137
v_cvt_pk_bf16_f32 v137, v138, v139
v_cvt_pk_bf16_f32 v138, v152, v153
v_cvt_pk_bf16_f32 v139, v154, v155
v_mfma_f32_16x16x32_bf16 v[168:171], v[80:83], v[40:43], v[168:171]
buffer_store_dwordx4 v[136:139], v4, s[16:19], s27 offen offset:2048 sc0 sc1
v_cvt_pk_bf16_f32 v140, v140, v141
v_cvt_pk_bf16_f32 v141, v142, v143
v_cvt_pk_bf16_f32 v142, v156, v157
v_cvt_pk_bf16_f32 v143, v158, v159
buffer_store_dwordx4 v[140:143], v4, s[16:19], s27 offen offset:3072 sc0 sc1
s_waitcnt lgkmcnt(1)
v_pk_fma_f32 v[160:161], v[120:121], v[16:17], v[160:161] op_sel_hi:[1,0,1]
v_pk_fma_f32 v[162:163], v[122:123], v[16:17], v[162:163] op_sel_hi:[1,0,1]
v_pk_fma_f32 v[164:165], v[120:121], v[18:19], v[164:165] op_sel_hi:[1,0,1]
v_pk_fma_f32 v[166:167], v[122:123], v[18:19], v[166:167] op_sel_hi:[1,0,1]
v_pk_fma_f32 v[168:169], v[120:121], v[20:21], v[168:169] op_sel_hi:[1,0,1]
v_pk_fma_f32 v[170:171], v[122:123], v[20:21], v[170:171] op_sel_hi:[1,0,1]
v_pk_fma_f32 v[172:173], v[120:121], v[22:23], v[172:173] op_sel_hi:[1,0,1]
v_pk_fma_f32 v[174:175], v[122:123], v[22:23], v[174:175] op_sel_hi:[1,0,1]
v_pk_mul_f32 v[160:161], v[160:161], v[24:25] op_sel_hi:[1,0]
v_pk_mul_f32 v[162:163], v[162:163], v[24:25] op_sel_hi:[1,0]
v_pk_mul_f32 v[164:165], v[164:165], v[26:27] op_sel_hi:[1,0]
v_pk_mul_f32 v[166:167], v[166:167], v[26:27] op_sel_hi:[1,0]
v_pk_mul_f32 v[168:169], v[168:169], v[28:29] op_sel_hi:[1,0]
v_pk_mul_f32 v[170:171], v[170:171], v[28:29] op_sel_hi:[1,0]
v_pk_mul_f32 v[172:173], v[172:173], v[30:31] op_sel_hi:[1,0]
v_pk_mul_f32 v[174:175], v[174:175], v[30:31] op_sel_hi:[1,0]
s_waitcnt lgkmcnt(0)
v_pk_fma_f32 v[176:177], v[124:125], v[16:17], v[176:177] op_sel_hi:[1,0,1]
v_pk_fma_f32 v[178:179], v[126:127], v[16:17], v[178:179] op_sel_hi:[1,0,1]
v_pk_fma_f32 v[180:181], v[124:125], v[18:19], v[180:181] op_sel_hi:[1,0,1]
v_pk_fma_f32 v[182:183], v[126:127], v[18:19], v[182:183] op_sel_hi:[1,0,1]
v_pk_fma_f32 v[184:185], v[124:125], v[20:21], v[184:185] op_sel_hi:[1,0,1]
v_pk_fma_f32 v[186:187], v[126:127], v[20:21], v[186:187] op_sel_hi:[1,0,1]
v_pk_fma_f32 v[188:189], v[124:125], v[22:23], v[188:189] op_sel_hi:[1,0,1]
v_pk_fma_f32 v[190:191], v[126:127], v[22:23], v[190:191] op_sel_hi:[1,0,1]
v_pk_mul_f32 v[176:177], v[176:177], v[24:25] op_sel_hi:[1,0]
v_pk_mul_f32 v[178:179], v[178:179], v[24:25] op_sel_hi:[1,0]
v_pk_mul_f32 v[180:181], v[180:181], v[26:27] op_sel_hi:[1,0]
v_pk_mul_f32 v[182:183], v[182:183], v[26:27] op_sel_hi:[1,0]
v_pk_mul_f32 v[184:185], v[184:185], v[28:29] op_sel_hi:[1,0]
v_pk_mul_f32 v[186:187], v[186:187], v[28:29] op_sel_hi:[1,0]
v_pk_mul_f32 v[188:189], v[188:189], v[30:31] op_sel_hi:[1,0]
v_pk_mul_f32 v[190:191], v[190:191], v[30:31] op_sel_hi:[1,0]
s_add_u32 s26, s46, 1
s_cmp_ge_u32 s26, 2
s_cselect_b32 s27, 2, 0
s_sub_u32 s26, s26, s27
s_lshl_b32 s26, s26, 17
s_add_u32 s27, s26, s31
v_cvt_pk_bf16_f32 v160, v160, v161
v_cvt_pk_bf16_f32 v161, v162, v163
v_cvt_pk_bf16_f32 v162, v176, v177
v_cvt_pk_bf16_f32 v163, v178, v179
buffer_store_dwordx4 v[160:163], v4, s[16:19], s27 offen offset:0 sc0 sc1
v_cvt_pk_bf16_f32 v164, v164, v165
v_cvt_pk_bf16_f32 v165, v166, v167
v_cvt_pk_bf16_f32 v166, v180, v181
v_cvt_pk_bf16_f32 v167, v182, v183
buffer_store_dwordx4 v[164:167], v4, s[16:19], s27 offen offset:1024 sc0 sc1
v_cvt_pk_bf16_f32 v168, v168, v169
v_cvt_pk_bf16_f32 v169, v170, v171
v_cvt_pk_bf16_f32 v170, v184, v185
v_cvt_pk_bf16_f32 v171, v186, v187
buffer_store_dwordx4 v[168:171], v4, s[16:19], s27 offen offset:2048 sc0 sc1
v_cvt_pk_bf16_f32 v172, v172, v173
v_cvt_pk_bf16_f32 v173, v174, v175
v_cvt_pk_bf16_f32 v174, v188, v189
v_cvt_pk_bf16_f32 v175, v190, v191
buffer_store_dwordx4 v[172:175], v4, s[16:19], s27 offen offset:3072 sc0 sc1
s_setprio 0
v_lshlrev_b32 v11, 4, v0
s_cmp_ge_u32 s2, 224
s_cbranch_scc1 L_g_idle
s_waitcnt vmcnt(32)
s_barrier
ds_read_b128 v[36:39], v230 offset:2048
ds_read_b128 v[68:71], v231 offset:2048
ds_read_b128 v[32:35], v230 offset:0
ds_read_b128 v[64:67], v231 offset:0
ds_read_b64_tr_b16 v[48:49], v200 offset:0
ds_read_b64_tr_b16 v[50:51], v200 offset:1024
ds_read_b64_tr_b16 v[80:81], v200 offset:8192
ds_read_b64_tr_b16 v[82:83], v200 offset:9216
ds_read_b64_tr_b16 v[52:53], v200 offset:256
ds_read_b64_tr_b16 v[54:55], v200 offset:1280
ds_read_b64_tr_b16 v[84:85], v200 offset:8448
ds_read_b64_tr_b16 v[86:87], v200 offset:9472
ds_read_b64_tr_b16 v[56:57], v200 offset:512
ds_read_b64_tr_b16 v[58:59], v200 offset:1536
ds_read_b64_tr_b16 v[88:89], v200 offset:8704
s_waitcnt lgkmcnt(14)
ds_read_b64_tr_b16 v[90:91], v200 offset:9728
s_setprio 0
s_waitcnt lgkmcnt(10)
v_mfma_f32_16x16x32_bf16 v[96:99], v[48:51], v[32:35], 0
s_setprio 1
ds_read_b64_tr_b16 v[60:61], v200 offset:768
s_add_u32 m0, s41, 114688
s_lshr_b32 s34, s2, 5
s_lshl_b32 s26, s65, 2
s_waitcnt lgkmcnt(9)
v_mfma_f32_16x16x32_bf16 v[96:99], v[80:83], v[64:67], v[96:99]
ds_read_b64_tr_b16 v[62:63], v200 offset:1792
buffer_load_dwordx4 v196, s[52:55], s29 offen offset:0 lds
s_and_b32 s27, s42, 1
v_mfma_f32_16x16x32_bf16 v[104:107], v[80:83], v[68:71], 0
ds_read_b64_tr_b16 v[92:93], v200 offset:8960
s_lshl_b32 s27, s27, 1
v_mfma_f32_16x16x32_bf16 v[104:107], v[48:51], v[36:39], v[104:107]
s_setprio 0
ds_read_b64_tr_b16 v[94:95], v200 offset:9984
s_add_u32 s26, s26, s27
s_waitcnt lgkmcnt(10)
v_mfma_f32_16x16x32_bf16 v[108:111], v[52:55], v[36:39], 0
s_setprio 1
ds_read_b128 v[44:47], v230 offset:6144
s_lshl_b32 s30, s64, 2
s_waitcnt lgkmcnt(9)
v_mfma_f32_16x16x32_bf16 v[108:111], v[84:87], v[68:71], v[108:111]
ds_read_b128 v[76:79], v231 offset:6144
buffer_load_dwordx4 v197, s[52:55], s29 offen offset:1024 lds
s_lshr_b32 s27, s42, 1
s_lshl_b32 s27, s27, 1
v_mfma_f32_16x16x32_bf16 v[100:103], v[84:87], v[64:67], 0
ds_read_b128 v[40:43], v230 offset:4096
s_add_u32 s30, s30, s27
v_mfma_f32_16x16x32_bf16 v[100:103], v[52:55], v[32:35], v[100:103]
s_setprio 0
ds_read_b128 v[72:75], v231 offset:4096
v_smfmac_f32_16x16x64_bf16 v[234:237], v[204:207], v[48:55], v202
s_mul_i32 s32, s30, 56
s_waitcnt lgkmcnt(10)
v_mfma_f32_16x16x32_bf16 v[128:131], v[56:59], v[32:35], 0
s_setprio 1
s_add_u32 s32, s32, s26
s_waitcnt lgkmcnt(8)
v_mfma_f32_16x16x32_bf16 v[128:131], v[88:91], v[64:67], v[128:131]
buffer_load_dwordx4 v198, s[52:55], s29 offen offset:2048 lds
s_lshl_b32 s32, s32, 11
v_mfma_f32_16x16x32_bf16 v[136:139], v[88:91], v[68:71], 0
s_lshl_b32 s26, s64, 19
s_add_u32 s16, s60, s26
v_mfma_f32_16x16x32_bf16 v[136:139], v[56:59], v[36:39], v[136:139]
s_setprio 0
v_smfmac_f32_16x16x64_bf16 v[234:237], v[204:207], v[80:87], v202
s_addc_u32 s17, s61, 0
s_waitcnt lgkmcnt(6)
v_mfma_f32_16x16x32_bf16 v[140:143], v[60:63], v[36:39], 0
s_setprio 1
s_mov_b32 s18, 0x80000
s_waitcnt lgkmcnt(4)
v_mfma_f32_16x16x32_bf16 v[140:143], v[92:95], v[68:71], v[140:143]
buffer_load_dwordx4 v199, s[52:55], s29 offen offset:3072 lds
s_add_u32 s29, s29, 458752
s_mov_b32 s19, 0x20000
v_mfma_f32_16x16x32_bf16 v[132:135], v[92:95], v[64:67], 0
s_lshl_b32 s26, s65, 19
v_mfma_f32_16x16x32_bf16 v[132:135], v[60:63], v[32:35], v[132:135]
s_setprio 0
s_waitcnt vmcnt(24) lgkmcnt(0)
s_barrier
s_add_u32 m0, s41, 0
s_add_u32 s26, s26, 0x2000000
v_mfma_f32_16x16x32_bf16 v[112:115], v[48:51], v[40:43], 0
s_setprio 1
ds_read_b128 v[36:39], v230 offset:34816
s_add_u32 s20, s4, s26
s_addc_u32 s21, s5, 0
v_mfma_f32_16x16x32_bf16 v[112:115], v[80:83], v[72:75], v[112:115]
v_smfmac_f32_16x16x64_bf16 v[250:253], v[204:207], v[56:63], v202
ds_read_b128 v[68:71], v231 offset:34816
buffer_load_dwordx4 v192, s[36:39], s28 offen offset:0 lds
s_mov_b32 s22, 0x80000
v_mfma_f32_16x16x32_bf16 v[120:123], v[80:83], v[76:79], 0
ds_read_b128 v[32:35], v230 offset:32768
s_mov_b32 s23, 0x20000
v_mfma_f32_16x16x32_bf16 v[120:123], v[48:51], v[44:47], v[120:123]
s_setprio 0
ds_read_b128 v[64:67], v231 offset:32768
s_mov_b32 s40, 0
v_mfma_f32_16x16x32_bf16 v[124:127], v[52:55], v[44:47], 0
s_setprio 1
ds_read_b64_tr_b16 v[48:49], v200 offset:32768
s_mov_b32 s44, 0
v_mfma_f32_16x16x32_bf16 v[124:127], v[84:87], v[76:79], v[124:127]
v_smfmac_f32_16x16x64_bf16 v[250:253], v[204:207], v[88:95], v202
ds_read_b64_tr_b16 v[50:51], v200 offset:33792
buffer_load_dwordx4 v193, s[36:39], s28 offen offset:1024 lds
s_lshl_b32 s26, s65, 2
v_add_u32 v12, s26, v0
v_mfma_f32_16x16x32_bf16 v[116:119], v[84:87], v[72:75], 0
ds_read_b64_tr_b16 v[80:81], v200 offset:40960
v_mul_u32_u24 v13, 74, v12
v_mfma_f32_16x16x32_bf16 v[116:119], v[52:55], v[40:43], v[116:119]
s_setprio 0
ds_read_b64_tr_b16 v[82:83], v200 offset:41984
v_lshrrev_b32 v13, 10, v13
v_mfma_f32_16x16x32_bf16 v[144:147], v[56:59], v[40:43], 0
s_setprio 1
ds_read_b64_tr_b16 v[52:53], v200 offset:33024
v_mul_u32_u24 v14, 14, v13
v_mfma_f32_16x16x32_bf16 v[144:147], v[88:91], v[72:75], v[144:147]
ds_read_b64_tr_b16 v[54:55], v200 offset:34048
buffer_load_dwordx4 v194, s[36:39], s28 offen offset:2048 lds
v_sub_u32 v12, v12, v14
v_mfma_f32_16x16x32_bf16 v[152:155], v[88:91], v[76:79], 0
ds_read_b64_tr_b16 v[84:85], v200 offset:41216
v_add_u32 v12, 10, v12
v_mul_u32_u24 v12, 43, v12
v_mfma_f32_16x16x32_bf16 v[152:155], v[56:59], v[44:47], v[152:155]
s_setprio 0
ds_read_b64_tr_b16 v[86:87], v200 offset:42240
v_lshrrev_b32 v12, 7, v12
v_mfma_f32_16x16x32_bf16 v[156:159], v[60:63], v[44:47], 0
s_setprio 1
ds_read_b64_tr_b16 v[56:57], v200 offset:33280
v_lshl_add_u32 v12, v13, 3, v12
v_mfma_f32_16x16x32_bf16 v[156:159], v[92:95], v[76:79], v[156:159]
ds_read_b64_tr_b16 v[58:59], v200 offset:34304
buffer_load_dwordx4 v195, s[36:39], s28 offen offset:3072 lds
s_add_u32 s28, s28, 128
s_and_b32 s26, s64, 3
v_mfma_f32_16x16x32_bf16 v[148:151], v[92:95], v[72:75], 0
ds_read_b64_tr_b16 v[88:89], v200 offset:41472
v_lshl_add_u32 v12, v12, 3, s26
v_mfma_f32_16x16x32_bf16 v[148:151], v[60:63], v[40:43], v[148:151]
s_setprio 0
s_waitcnt lgkmcnt(14)
ds_read_b64_tr_b16 v[90:91], v200 offset:42496
v_lshlrev_b32 v29, 7, v12
s_waitcnt lgkmcnt(10)
v_mfma_f32_16x16x32_bf16 v[96:99], v[48:51], v[32:35], v[96:99]
s_setprio 1
ds_read_b64_tr_b16 v[60:61], v200 offset:33536
s_add_u32 m0, s41, 16384
s_waitcnt lgkmcnt(9)
v_mfma_f32_16x16x32_bf16 v[96:99], v[80:83], v[64:67], v[96:99]
ds_read_b64_tr_b16 v[62:63], v200 offset:34560
buffer_load_dwordx4 v196, s[52:55], s29 offen offset:0 lds
v_mfma_f32_16x16x32_bf16 v[104:107], v[80:83], v[68:71], v[104:107]
ds_read_b64_tr_b16 v[92:93], v200 offset:41728
v_mfma_f32_16x16x32_bf16 v[104:107], v[48:51], v[36:39], v[104:107]
s_setprio 0
ds_read_b64_tr_b16 v[94:95], v200 offset:42752
s_waitcnt lgkmcnt(10)
v_mfma_f32_16x16x32_bf16 v[108:111], v[52:55], v[36:39], v[108:111]
s_setprio 1
ds_read_b128 v[44:47], v230 offset:38912
s_waitcnt lgkmcnt(9)
v_mfma_f32_16x16x32_bf16 v[108:111], v[84:87], v[68:71], v[108:111]
ds_read_b128 v[76:79], v231 offset:38912
buffer_load_dwordx4 v197, s[52:55], s29 offen offset:1024 lds
v_mfma_f32_16x16x32_bf16 v[100:103], v[84:87], v[64:67], v[100:103]
ds_read_b128 v[40:43], v230 offset:36864
v_mfma_f32_16x16x32_bf16 v[100:103], v[52:55], v[32:35], v[100:103]
s_setprio 0
ds_read_b128 v[72:75], v231 offset:36864
v_smfmac_f32_16x16x64_bf16 v[234:237], v[204:207], v[48:55], v202
s_waitcnt lgkmcnt(10)
v_mfma_f32_16x16x32_bf16 v[128:131], v[56:59], v[32:35], v[128:131]
s_setprio 1
s_waitcnt lgkmcnt(8)
v_mfma_f32_16x16x32_bf16 v[128:131], v[88:91], v[64:67], v[128:131]
buffer_load_dwordx4 v198, s[52:55], s29 offen offset:2048 lds
v_mfma_f32_16x16x32_bf16 v[136:139], v[88:91], v[68:71], v[136:139]
v_mfma_f32_16x16x32_bf16 v[136:139], v[56:59], v[36:39], v[136:139]
s_setprio 0
v_smfmac_f32_16x16x64_bf16 v[234:237], v[204:207], v[80:87], v202
s_waitcnt lgkmcnt(6)
v_mfma_f32_16x16x32_bf16 v[140:143], v[60:63], v[36:39], v[140:143]
s_setprio 1
s_waitcnt lgkmcnt(4)
v_mfma_f32_16x16x32_bf16 v[140:143], v[92:95], v[68:71], v[140:143]
buffer_load_dwordx4 v199, s[52:55], s29 offen offset:3072 lds
s_add_u32 s29, s29, 458752
v_mfma_f32_16x16x32_bf16 v[132:135], v[92:95], v[64:67], v[132:135]
v_mfma_f32_16x16x32_bf16 v[132:135], v[60:63], v[32:35], v[132:135]
s_setprio 0
v_mov_b32 v13, 159748
v_mov_b32 v14, 1
v_lshlrev_b32 v15, 7, v0
s_mov_b64 exec, 1
s_waitcnt vmcnt(12)
ds_add_rtn_u32 v13, v13, v14
s_waitcnt lgkmcnt(0)
v_readfirstlane_b32 s26, v13
s_mov_b64 exec, 15
s_cmp_lg_u32 s26, 3
s_cbranch_scc1 L_t_g1a
buffer_atomic_add v14, v15, s[48:51], s74 offen sc1
L_t_g1a:
s_mov_b64 exec, -1
L_t_g1:
s_waitcnt vmcnt(24) lgkmcnt(0)
s_barrier
s_add_u32 m0, s41, 32768
v_mfma_f32_16x16x32_bf16 v[112:115], v[48:51], v[40:43], v[112:115]
s_setprio 1
ds_read_b128 v[36:39], v232 offset:2048
v_mfma_f32_16x16x32_bf16 v[112:115], v[80:83], v[72:75], v[112:115]
v_smfmac_f32_16x16x64_bf16 v[250:253], v[204:207], v[56:63], v202
ds_read_b128 v[68:71], v233 offset:2048
buffer_load_dwordx4 v192, s[36:39], s28 offen offset:0 lds
v_mfma_f32_16x16x32_bf16 v[120:123], v[80:83], v[76:79], v[120:123]
ds_read_b128 v[32:35], v232 offset:0
v_mfma_f32_16x16x32_bf16 v[120:123], v[48:51], v[44:47], v[120:123]
s_setprio 0
ds_read_b128 v[64:67], v233 offset:0
v_mfma_f32_16x16x32_bf16 v[124:127], v[52:55], v[44:47], v[124:127]
s_setprio 1
ds_read_b64_tr_b16 v[48:49], v201 offset:0
v_mfma_f32_16x16x32_bf16 v[124:127], v[84:87], v[76:79], v[124:127]
v_smfmac_f32_16x16x64_bf16 v[250:253], v[204:207], v[88:95], v202
ds_read_b64_tr_b16 v[50:51], v201 offset:1024
buffer_load_dwordx4 v193, s[36:39], s28 offen offset:1024 lds
v_mfma_f32_16x16x32_bf16 v[116:119], v[84:87], v[72:75], v[116:119]
ds_read_b64_tr_b16 v[80:81], v201 offset:8192
v_mfma_f32_16x16x32_bf16 v[116:119], v[52:55], v[40:43], v[116:119]
s_setprio 0
ds_read_b64_tr_b16 v[82:83], v201 offset:9216
v_mfma_f32_16x16x32_bf16 v[144:147], v[56:59], v[40:43], v[144:147]
s_setprio 1
ds_read_b64_tr_b16 v[52:53], v201 offset:256
v_mfma_f32_16x16x32_bf16 v[144:147], v[88:91], v[72:75], v[144:147]
ds_read_b64_tr_b16 v[54:55], v201 offset:1280
buffer_load_dwordx4 v194, s[36:39], s28 offen offset:2048 lds
v_mfma_f32_16x16x32_bf16 v[152:155], v[88:91], v[76:79], v[152:155]
ds_read_b64_tr_b16 v[84:85], v201 offset:8448
v_mfma_f32_16x16x32_bf16 v[152:155], v[56:59], v[44:47], v[152:155]
s_setprio 0
ds_read_b64_tr_b16 v[86:87], v201 offset:9472
v_mfma_f32_16x16x32_bf16 v[156:159], v[60:63], v[44:47], v[156:159]
s_setprio 1
ds_read_b64_tr_b16 v[56:57], v201 offset:512
v_mfma_f32_16x16x32_bf16 v[156:159], v[92:95], v[76:79], v[156:159]
ds_read_b64_tr_b16 v[58:59], v201 offset:1536
buffer_load_dwordx4 v195, s[36:39], s28 offen offset:3072 lds
s_add_u32 s28, s28, 128
v_mfma_f32_16x16x32_bf16 v[148:151], v[92:95], v[72:75], v[148:151]
ds_read_b64_tr_b16 v[88:89], v201 offset:8704
v_mfma_f32_16x16x32_bf16 v[148:151], v[60:63], v[40:43], v[148:151]
s_setprio 0
s_waitcnt lgkmcnt(14)
ds_read_b64_tr_b16 v[90:91], v201 offset:9728
s_waitcnt lgkmcnt(10)
v_mfma_f32_16x16x32_bf16 v[96:99], v[48:51], v[32:35], v[96:99]
s_setprio 1
ds_read_b64_tr_b16 v[60:61], v201 offset:768
s_add_u32 m0, s41, 49152
s_mov_b32 s8, s62
s_waitcnt lgkmcnt(9)
v_mfma_f32_16x16x32_bf16 v[96:99], v[80:83], v[64:67], v[96:99]
ds_read_b64_tr_b16 v[62:63], v201 offset:1792
buffer_load_dwordx4 v196, s[52:55], s29 offen offset:0 lds
s_mov_b32 s9, s63
v_mfma_f32_16x16x32_bf16 v[104:107], v[80:83], v[68:71], v[104:107]
ds_read_b64_tr_b16 v[92:93], v201 offset:8960
v_mfma_f32_16x16x32_bf16 v[104:107], v[48:51], v[36:39], v[104:107]
s_setprio 0
ds_read_b64_tr_b16 v[94:95], v201 offset:9984
s_mov_b32 s10, 0x1000
s_waitcnt lgkmcnt(10)
v_mfma_f32_16x16x32_bf16 v[108:111], v[52:55], v[36:39], v[108:111]
s_setprio 1
ds_read_b128 v[44:47], v232 offset:6144
s_mov_b32 s11, 0x20000
s_waitcnt lgkmcnt(9)
v_mfma_f32_16x16x32_bf16 v[108:111], v[84:87], v[68:71], v[108:111]
ds_read_b128 v[76:79], v233 offset:6144
buffer_load_dwordx4 v197, s[52:55], s29 offen offset:1024 lds
v_mfma_f32_16x16x32_bf16 v[100:103], v[84:87], v[64:67], v[100:103]
ds_read_b128 v[40:43], v232 offset:4096
v_and_b32 v12, 15, v0
v_mfma_f32_16x16x32_bf16 v[100:103], v[52:55], v[32:35], v[100:103]
s_setprio 0
ds_read_b128 v[72:75], v233 offset:4096
v_smfmac_f32_16x16x64_bf16 v[234:237], v[204:207], v[48:55], v202
s_waitcnt lgkmcnt(10)
v_mfma_f32_16x16x32_bf16 v[128:131], v[56:59], v[32:35], v[128:131]
s_setprio 1
v_lshlrev_b32 v12, 1, v12
s_waitcnt lgkmcnt(8)
v_mfma_f32_16x16x32_bf16 v[128:131], v[88:91], v[64:67], v[128:131]
buffer_load_dwordx4 v198, s[52:55], s29 offen offset:2048 lds
s_lshl_b32 s26, s30, 6
v_mfma_f32_16x16x32_bf16 v[136:139], v[88:91], v[68:71], v[136:139]
v_mfma_f32_16x16x32_bf16 v[136:139], v[56:59], v[36:39], v[136:139]
s_setprio 0
v_smfmac_f32_16x16x64_bf16 v[234:237], v[204:207], v[80:87], v202
buffer_load_short_d16_hi v242, v12, s[8:11], s26 offen offset:0
s_waitcnt lgkmcnt(6)
v_mfma_f32_16x16x32_bf16 v[140:143], v[60:63], v[36:39], v[140:143]
s_setprio 1
buffer_load_short_d16_hi v244, v12, s[8:11], s26 offen offset:32
s_waitcnt lgkmcnt(4)
v_mfma_f32_16x16x32_bf16 v[140:143], v[92:95], v[68:71], v[140:143]
buffer_load_dwordx4 v199, s[52:55], s29 offen offset:3072 lds
s_add_u32 s29, s29, 458752
v_mfma_f32_16x16x32_bf16 v[132:135], v[92:95], v[64:67], v[132:135]
buffer_load_short_d16_hi v246, v12, s[8:11], s26 offen offset:64
v_mfma_f32_16x16x32_bf16 v[132:135], v[60:63], v[32:35], v[132:135]
s_setprio 0
s_waitcnt vmcnt(19) lgkmcnt(0)
s_barrier
s_add_u32 m0, s41, 65536
v_mfma_f32_16x16x32_bf16 v[112:115], v[48:51], v[40:43], v[112:115]
s_setprio 1
ds_read_b128 v[36:39], v232 offset:34816
buffer_load_short_d16_hi v248, v12, s[8:11], s26 offen offset:96
v_mfma_f32_16x16x32_bf16 v[112:115], v[80:83], v[72:75], v[112:115]
v_smfmac_f32_16x16x64_bf16 v[250:253], v[204:207], v[56:63], v202
ds_read_b128 v[68:71], v233 offset:34816
buffer_load_dwordx4 v192, s[36:39], s28 offen offset:0 lds
s_lshl_b32 s26, s30, 9
v_mfma_f32_16x16x32_bf16 v[120:123], v[80:83], v[76:79], v[120:123]
ds_read_b128 v[32:35], v232 offset:32768
v_mfma_f32_16x16x32_bf16 v[120:123], v[48:51], v[44:47], v[120:123]
s_setprio 0
ds_read_b128 v[64:67], v233 offset:32768
buffer_load_dword v2, v1, s[92:95], s26 offen offset:0 sc1
v_mfma_f32_16x16x32_bf16 v[124:127], v[52:55], v[44:47], v[124:127]
s_setprio 1
ds_read_b64_tr_b16 v[48:49], v201 offset:32768
buffer_load_dword v28, v1, s[92:95], s26 offen offset:4 sc1
v_mfma_f32_16x16x32_bf16 v[124:127], v[84:87], v[76:79], v[124:127]
v_smfmac_f32_16x16x64_bf16 v[250:253], v[204:207], v[88:95], v202
ds_read_b64_tr_b16 v[50:51], v201 offset:33792
buffer_load_dwordx4 v193, s[36:39], s28 offen offset:1024 lds
v_mfma_f32_16x16x32_bf16 v[116:119], v[84:87], v[72:75], v[116:119]
ds_read_b64_tr_b16 v[80:81], v201 offset:40960
buffer_load_dword v4, v1, s[92:95], s26 offen offset:256 sc1
v_mfma_f32_16x16x32_bf16 v[116:119], v[52:55], v[40:43], v[116:119]
s_setprio 0
ds_read_b64_tr_b16 v[82:83], v201 offset:41984
v_mfma_f32_16x16x32_bf16 v[144:147], v[56:59], v[40:43], v[144:147]
s_setprio 1
ds_read_b64_tr_b16 v[52:53], v201 offset:33024
buffer_load_dword v30, v1, s[92:95], s26 offen offset:260 sc1
v_mfma_f32_16x16x32_bf16 v[144:147], v[88:91], v[72:75], v[144:147]
ds_read_b64_tr_b16 v[54:55], v201 offset:34048
buffer_load_dwordx4 v194, s[36:39], s28 offen offset:2048 lds
buffer_load_dword v6, v1, s[92:95], s26 offen offset:512 sc1
v_mfma_f32_16x16x32_bf16 v[152:155], v[88:91], v[76:79], v[152:155]
ds_read_b64_tr_b16 v[84:85], v201 offset:41216
v_mfma_f32_16x16x32_bf16 v[152:155], v[56:59], v[44:47], v[152:155]
s_setprio 0
ds_read_b64_tr_b16 v[86:87], v201 offset:42240
buffer_load_dword v254, v1, s[92:95], s26 offen offset:516 sc1
v_mfma_f32_16x16x32_bf16 v[156:159], v[60:63], v[44:47], v[156:159]
s_setprio 1
ds_read_b64_tr_b16 v[56:57], v201 offset:33280
buffer_load_dword v8, v1, s[92:95], s26 offen offset:768 sc1
v_mfma_f32_16x16x32_bf16 v[156:159], v[92:95], v[76:79], v[156:159]
ds_read_b64_tr_b16 v[58:59], v201 offset:34304
buffer_load_dwordx4 v195, s[36:39], s28 offen offset:3072 lds
s_add_u32 s28, s28, 128
v_mfma_f32_16x16x32_bf16 v[148:151], v[92:95], v[72:75], v[148:151]
ds_read_b64_tr_b16 v[88:89], v201 offset:41472
buffer_load_dword v10, v1, s[92:95], s26 offen offset:772 sc1
v_mfma_f32_16x16x32_bf16 v[148:151], v[60:63], v[40:43], v[148:151]
s_setprio 0
s_waitcnt lgkmcnt(14)
ds_read_b64_tr_b16 v[90:91], v201 offset:42496
s_waitcnt lgkmcnt(10)
v_mfma_f32_16x16x32_bf16 v[96:99], v[48:51], v[32:35], v[96:99]
s_setprio 1
ds_read_b64_tr_b16 v[60:61], v201 offset:33536
s_add_u32 m0, s41, 81920
s_waitcnt lgkmcnt(9)
v_mfma_f32_16x16x32_bf16 v[96:99], v[80:83], v[64:67], v[96:99]
ds_read_b64_tr_b16 v[62:63], v201 offset:34560
buffer_load_dwordx4 v196, s[52:55], s29 offen offset:0 lds
v_mfma_f32_16x16x32_bf16 v[104:107], v[80:83], v[68:71], v[104:107]
ds_read_b64_tr_b16 v[92:93], v201 offset:41728
v_mfma_f32_16x16x32_bf16 v[104:107], v[48:51], v[36:39], v[104:107]
s_setprio 0
ds_read_b64_tr_b16 v[94:95], v201 offset:42752
s_waitcnt lgkmcnt(10)
v_mfma_f32_16x16x32_bf16 v[108:111], v[52:55], v[36:39], v[108:111]
s_setprio 1
ds_read_b128 v[44:47], v232 offset:38912
s_waitcnt lgkmcnt(9)
v_mfma_f32_16x16x32_bf16 v[108:111], v[84:87], v[68:71], v[108:111]
ds_read_b128 v[76:79], v233 offset:38912
buffer_load_dwordx4 v197, s[52:55], s29 offen offset:1024 lds
v_mfma_f32_16x16x32_bf16 v[100:103], v[84:87], v[64:67], v[100:103]
ds_read_b128 v[40:43], v232 offset:36864
v_mfma_f32_16x16x32_bf16 v[100:103], v[52:55], v[32:35], v[100:103]
s_setprio 0
ds_read_b128 v[72:75], v233 offset:36864
v_smfmac_f32_16x16x64_bf16 v[234:237], v[204:207], v[48:55], v202
s_waitcnt lgkmcnt(10)
v_mfma_f32_16x16x32_bf16 v[128:131], v[56:59], v[32:35], v[128:131]
s_setprio 1
s_waitcnt lgkmcnt(8)
v_mfma_f32_16x16x32_bf16 v[128:131], v[88:91], v[64:67], v[128:131]
buffer_load_dwordx4 v198, s[52:55], s29 offen offset:2048 lds
v_mfma_f32_16x16x32_bf16 v[136:139], v[88:91], v[68:71], v[136:139]
v_mfma_f32_16x16x32_bf16 v[136:139], v[56:59], v[36:39], v[136:139]
s_setprio 0
v_smfmac_f32_16x16x64_bf16 v[234:237], v[204:207], v[80:87], v202
s_waitcnt lgkmcnt(6)
v_mfma_f32_16x16x32_bf16 v[140:143], v[60:63], v[36:39], v[140:143]
s_setprio 1
s_waitcnt lgkmcnt(4)
v_mfma_f32_16x16x32_bf16 v[140:143], v[92:95], v[68:71], v[140:143]
buffer_load_dwordx4 v199, s[52:55], s29 offen offset:3072 lds
s_add_u32 s29, s29, 458752
v_mfma_f32_16x16x32_bf16 v[132:135], v[92:95], v[64:67], v[132:135]
v_mfma_f32_16x16x32_bf16 v[132:135], v[60:63], v[32:35], v[132:135]
s_setprio 0
s_waitcnt vmcnt(28) lgkmcnt(0)
s_barrier
s_add_u32 m0, s41, 98304
v_mfma_f32_16x16x32_bf16 v[112:115], v[48:51], v[40:43], v[112:115]
s_setprio 1
ds_read_b128 v[36:39], v230 offset:2048
v_mfma_f32_16x16x32_bf16 v[112:115], v[80:83], v[72:75], v[112:115]
v_smfmac_f32_16x16x64_bf16 v[250:253], v[204:207], v[56:63], v202
ds_read_b128 v[68:71], v231 offset:2048
buffer_load_dwordx4 v192, s[36:39], s28 offen offset:0 lds
v_mfma_f32_16x16x32_bf16 v[120:123], v[80:83], v[76:79], v[120:123]
ds_read_b128 v[32:35], v230 offset:0
v_mfma_f32_16x16x32_bf16 v[120:123], v[48:51], v[44:47], v[120:123]
s_setprio 0
ds_read_b128 v[64:67], v231 offset:0
v_mfma_f32_16x16x32_bf16 v[124:127], v[52:55], v[44:47], v[124:127]
s_setprio 1
ds_read_b64_tr_b16 v[48:49], v200 offset:0
v_mfma_f32_16x16x32_bf16 v[124:127], v[84:87], v[76:79], v[124:127]
v_smfmac_f32_16x16x64_bf16 v[250:253], v[204:207], v[88:95], v202
ds_read_b64_tr_b16 v[50:51], v200 offset:1024
buffer_load_dwordx4 v193, s[36:39], s28 offen offset:1024 lds
v_mfma_f32_16x16x32_bf16 v[116:119], v[84:87], v[72:75], v[116:119]
ds_read_b64_tr_b16 v[80:81], v200 offset:8192
v_mfma_f32_16x16x32_bf16 v[116:119], v[52:55], v[40:43], v[116:119]
s_setprio 0
ds_read_b64_tr_b16 v[82:83], v200 offset:9216
v_mfma_f32_16x16x32_bf16 v[144:147], v[56:59], v[40:43], v[144:147]
s_setprio 1
ds_read_b64_tr_b16 v[52:53], v200 offset:256
v_mfma_f32_16x16x32_bf16 v[144:147], v[88:91], v[72:75], v[144:147]
ds_read_b64_tr_b16 v[54:55], v200 offset:1280
buffer_load_dwordx4 v194, s[36:39], s28 offen offset:2048 lds
v_mfma_f32_16x16x32_bf16 v[152:155], v[88:91], v[76:79], v[152:155]
ds_read_b64_tr_b16 v[84:85], v200 offset:8448
v_mfma_f32_16x16x32_bf16 v[152:155], v[56:59], v[44:47], v[152:155]
s_setprio 0
ds_read_b64_tr_b16 v[86:87], v200 offset:9472
v_mfma_f32_16x16x32_bf16 v[156:159], v[60:63], v[44:47], v[156:159]
s_setprio 1
ds_read_b64_tr_b16 v[56:57], v200 offset:512
v_mfma_f32_16x16x32_bf16 v[156:159], v[92:95], v[76:79], v[156:159]
ds_read_b64_tr_b16 v[58:59], v200 offset:1536
buffer_load_dwordx4 v195, s[36:39], s28 offen offset:3072 lds
s_add_u32 s28, s28, 128
v_mfma_f32_16x16x32_bf16 v[148:151], v[92:95], v[72:75], v[148:151]
ds_read_b64_tr_b16 v[88:89], v200 offset:8704
v_mfma_f32_16x16x32_bf16 v[148:151], v[60:63], v[40:43], v[148:151]
s_setprio 0
s_waitcnt lgkmcnt(14)
ds_read_b64_tr_b16 v[90:91], v200 offset:9728
s_waitcnt lgkmcnt(10)
v_mfma_f32_16x16x32_bf16 v[96:99], v[48:51], v[32:35], v[96:99]
s_setprio 1
ds_read_b64_tr_b16 v[60:61], v200 offset:768
s_add_u32 m0, s41, 114688
s_waitcnt lgkmcnt(9)
v_mfma_f32_16x16x32_bf16 v[96:99], v[80:83], v[64:67], v[96:99]
ds_read_b64_tr_b16 v[62:63], v200 offset:1792
buffer_load_dwordx4 v196, s[52:55], s29 offen offset:0 lds
v_mfma_f32_16x16x32_bf16 v[104:107], v[80:83], v[68:71], v[104:107]
ds_read_b64_tr_b16 v[92:93], v200 offset:8960
v_mfma_f32_16x16x32_bf16 v[104:107], v[48:51], v[36:39], v[104:107]
s_setprio 0
ds_read_b64_tr_b16 v[94:95], v200 offset:9984
s_waitcnt lgkmcnt(10)
v_mfma_f32_16x16x32_bf16 v[108:111], v[52:55], v[36:39], v[108:111]
s_setprio 1
ds_read_b128 v[44:47], v230 offset:6144
s_waitcnt lgkmcnt(9)
v_mfma_f32_16x16x32_bf16 v[108:111], v[84:87], v[68:71], v[108:111]
ds_read_b128 v[76:79], v231 offset:6144
buffer_load_dwordx4 v197, s[52:55], s29 offen offset:1024 lds
v_mfma_f32_16x16x32_bf16 v[100:103], v[84:87], v[64:67], v[100:103]
ds_read_b128 v[40:43], v230 offset:4096
v_mfma_f32_16x16x32_bf16 v[100:103], v[52:55], v[32:35], v[100:103]
s_setprio 0
ds_read_b128 v[72:75], v231 offset:4096
v_smfmac_f32_16x16x64_bf16 v[234:237], v[204:207], v[48:55], v202
s_waitcnt lgkmcnt(10)
v_mfma_f32_16x16x32_bf16 v[128:131], v[56:59], v[32:35], v[128:131]
s_setprio 1
s_waitcnt lgkmcnt(8)
v_mfma_f32_16x16x32_bf16 v[128:131], v[88:91], v[64:67], v[128:131]
buffer_load_dwordx4 v198, s[52:55], s29 offen offset:2048 lds
v_mfma_f32_16x16x32_bf16 v[136:139], v[88:91], v[68:71], v[136:139]
v_mfma_f32_16x16x32_bf16 v[136:139], v[56:59], v[36:39], v[136:139]
s_setprio 0
v_smfmac_f32_16x16x64_bf16 v[234:237], v[204:207], v[80:87], v202
s_waitcnt lgkmcnt(6)
v_mfma_f32_16x16x32_bf16 v[140:143], v[60:63], v[36:39], v[140:143]
s_setprio 1
s_waitcnt lgkmcnt(4)
v_mfma_f32_16x16x32_bf16 v[140:143], v[92:95], v[68:71], v[140:143]
buffer_load_dwordx4 v199, s[52:55], s29 offen offset:3072 lds
s_add_u32 s29, s29, 458752
v_mfma_f32_16x16x32_bf16 v[132:135], v[92:95], v[64:67], v[132:135]
v_mfma_f32_16x16x32_bf16 v[132:135], v[60:63], v[32:35], v[132:135]
s_setprio 0
s_waitcnt vmcnt(26) lgkmcnt(0)
s_barrier
s_add_u32 m0, s41, 0
v_mfma_f32_16x16x32_bf16 v[112:115], v[48:51], v[40:43], v[112:115]
s_setprio 1
ds_read_b128 v[36:39], v230 offset:34816
v_mfma_f32_16x16x32_bf16 v[112:115], v[80:83], v[72:75], v[112:115]
v_smfmac_f32_16x16x64_bf16 v[250:253], v[204:207], v[56:63], v202
ds_read_b128 v[68:71], v231 offset:34816
buffer_load_dwordx4 v192, s[36:39], s28 offen offset:0 lds
v_mfma_f32_16x16x32_bf16 v[120:123], v[80:83], v[76:79], v[120:123]
ds_read_b128 v[32:35], v230 offset:32768
v_mfma_f32_16x16x32_bf16 v[120:123], v[48:51], v[44:47], v[120:123]
s_setprio 0
ds_read_b128 v[64:67], v231 offset:32768
v_mfma_f32_16x16x32_bf16 v[124:127], v[52:55], v[44:47], v[124:127]
s_setprio 1
ds_read_b64_tr_b16 v[48:49], v200 offset:32768
v_mfma_f32_16x16x32_bf16 v[124:127], v[84:87], v[76:79], v[124:127]
v_smfmac_f32_16x16x64_bf16 v[250:253], v[204:207], v[88:95], v202
ds_read_b64_tr_b16 v[50:51], v200 offset:33792
buffer_load_dwordx4 v193, s[36:39], s28 offen offset:1024 lds
v_mfma_f32_16x16x32_bf16 v[116:119], v[84:87], v[72:75], v[116:119]
ds_read_b64_tr_b16 v[80:81], v200 offset:40960
v_mfma_f32_16x16x32_bf16 v[116:119], v[52:55], v[40:43], v[116:119]
s_setprio 0
ds_read_b64_tr_b16 v[82:83], v200 offset:41984
v_mfma_f32_16x16x32_bf16 v[144:147], v[56:59], v[40:43], v[144:147]
s_setprio 1
ds_read_b64_tr_b16 v[52:53], v200 offset:33024
v_mfma_f32_16x16x32_bf16 v[144:147], v[88:91], v[72:75], v[144:147]
ds_read_b64_tr_b16 v[54:55], v200 offset:34048
buffer_load_dwordx4 v194, s[36:39], s28 offen offset:2048 lds
v_mfma_f32_16x16x32_bf16 v[152:155], v[88:91], v[76:79], v[152:155]
ds_read_b64_tr_b16 v[84:85], v200 offset:41216
v_mfma_f32_16x16x32_bf16 v[152:155], v[56:59], v[44:47], v[152:155]
s_setprio 0
ds_read_b64_tr_b16 v[86:87], v200 offset:42240
v_mfma_f32_16x16x32_bf16 v[156:159], v[60:63], v[44:47], v[156:159]
s_setprio 1
ds_read_b64_tr_b16 v[56:57], v200 offset:33280
v_mfma_f32_16x16x32_bf16 v[156:159], v[92:95], v[76:79], v[156:159]
ds_read_b64_tr_b16 v[58:59], v200 offset:34304
buffer_load_dwordx4 v195, s[36:39], s28 offen offset:3072 lds
s_add_u32 s28, s28, 128
v_mfma_f32_16x16x32_bf16 v[148:151], v[92:95], v[72:75], v[148:151]
ds_read_b64_tr_b16 v[88:89], v200 offset:41472
v_mfma_f32_16x16x32_bf16 v[148:151], v[60:63], v[40:43], v[148:151]
s_setprio 0
s_waitcnt lgkmcnt(14)
ds_read_b64_tr_b16 v[90:91], v200 offset:42496
s_waitcnt lgkmcnt(10)
v_mfma_f32_16x16x32_bf16 v[96:99], v[48:51], v[32:35], v[96:99]
s_setprio 1
ds_read_b64_tr_b16 v[60:61], v200 offset:33536
s_add_u32 m0, s41, 16384
s_waitcnt lgkmcnt(9)
v_mfma_f32_16x16x32_bf16 v[96:99], v[80:83], v[64:67], v[96:99]
ds_read_b64_tr_b16 v[62:63], v200 offset:34560
buffer_load_dwordx4 v196, s[52:55], s29 offen offset:0 lds
v_mfma_f32_16x16x32_bf16 v[104:107], v[80:83], v[68:71], v[104:107]
ds_read_b64_tr_b16 v[92:93], v200 offset:41728
v_mfma_f32_16x16x32_bf16 v[104:107], v[48:51], v[36:39], v[104:107]
s_setprio 0
ds_read_b64_tr_b16 v[94:95], v200 offset:42752
s_waitcnt lgkmcnt(10)
v_mfma_f32_16x16x32_bf16 v[108:111], v[52:55], v[36:39], v[108:111]
s_setprio 1
ds_read_b128 v[44:47], v230 offset:38912
s_waitcnt lgkmcnt(9)
v_mfma_f32_16x16x32_bf16 v[108:111], v[84:87], v[68:71], v[108:111]
ds_read_b128 v[76:79], v231 offset:38912
buffer_load_dwordx4 v197, s[52:55], s29 offen offset:1024 lds
v_mfma_f32_16x16x32_bf16 v[100:103], v[84:87], v[64:67], v[100:103]
ds_read_b128 v[40:43], v230 offset:36864
v_mfma_f32_16x16x32_bf16 v[100:103], v[52:55], v[32:35], v[100:103]
s_setprio 0
ds_read_b128 v[72:75], v231 offset:36864
v_smfmac_f32_16x16x64_bf16 v[234:237], v[204:207], v[48:55], v202
s_waitcnt lgkmcnt(10)
v_mfma_f32_16x16x32_bf16 v[128:131], v[56:59], v[32:35], v[128:131]
s_setprio 1
s_waitcnt lgkmcnt(8)
v_mfma_f32_16x16x32_bf16 v[128:131], v[88:91], v[64:67], v[128:131]
buffer_load_dwordx4 v198, s[52:55], s29 offen offset:2048 lds
v_mfma_f32_16x16x32_bf16 v[136:139], v[88:91], v[68:71], v[136:139]
v_mfma_f32_16x16x32_bf16 v[136:139], v[56:59], v[36:39], v[136:139]
s_setprio 0
v_smfmac_f32_16x16x64_bf16 v[234:237], v[204:207], v[80:87], v202
s_waitcnt lgkmcnt(6)
v_mfma_f32_16x16x32_bf16 v[140:143], v[60:63], v[36:39], v[140:143]
s_setprio 1
s_waitcnt lgkmcnt(4)
v_mfma_f32_16x16x32_bf16 v[140:143], v[92:95], v[68:71], v[140:143]
buffer_load_dwordx4 v199, s[52:55], s29 offen offset:3072 lds
s_add_u32 s29, s29, 458752
v_mfma_f32_16x16x32_bf16 v[132:135], v[92:95], v[64:67], v[132:135]
v_mfma_f32_16x16x32_bf16 v[132:135], v[60:63], v[32:35], v[132:135]
s_setprio 0
s_waitcnt vmcnt(16) lgkmcnt(0)
s_barrier
s_add_u32 m0, s41, 32768
v_mfma_f32_16x16x32_bf16 v[112:115], v[48:51], v[40:43], v[112:115]
s_setprio 1
ds_read_b128 v[36:39], v232 offset:2048
v_mfma_f32_16x16x32_bf16 v[112:115], v[80:83], v[72:75], v[112:115]
v_smfmac_f32_16x16x64_bf16 v[250:253], v[204:207], v[56:63], v202
ds_read_b128 v[68:71], v233 offset:2048
buffer_load_dwordx4 v192, s[36:39], s28 offen offset:0 lds
v_mfma_f32_16x16x32_bf16 v[120:123], v[80:83], v[76:79], v[120:123]
ds_read_b128 v[32:35], v232 offset:0
v_mfma_f32_16x16x32_bf16 v[120:123], v[48:51], v[44:47], v[120:123]
s_setprio 0
ds_read_b128 v[64:67], v233 offset:0
v_mfma_f32_16x16x32_bf16 v[124:127], v[52:55], v[44:47], v[124:127]
s_setprio 1
ds_read_b64_tr_b16 v[48:49], v201 offset:0
v_mfma_f32_16x16x32_bf16 v[124:127], v[84:87], v[76:79], v[124:127]
v_smfmac_f32_16x16x64_bf16 v[250:253], v[204:207], v[88:95], v202
ds_read_b64_tr_b16 v[50:51], v201 offset:1024
buffer_load_dwordx4 v193, s[36:39], s28 offen offset:1024 lds
v_mfma_f32_16x16x32_bf16 v[116:119], v[84:87], v[72:75], v[116:119]
ds_read_b64_tr_b16 v[80:81], v201 offset:8192
v_mfma_f32_16x16x32_bf16 v[116:119], v[52:55], v[40:43], v[116:119]
s_setprio 0
ds_read_b64_tr_b16 v[82:83], v201 offset:9216
v_mfma_f32_16x16x32_bf16 v[144:147], v[56:59], v[40:43], v[144:147]
s_setprio 1
ds_read_b64_tr_b16 v[52:53], v201 offset:256
v_mfma_f32_16x16x32_bf16 v[144:147], v[88:91], v[72:75], v[144:147]
ds_read_b64_tr_b16 v[54:55], v201 offset:1280
buffer_load_dwordx4 v194, s[36:39], s28 offen offset:2048 lds
v_mfma_f32_16x16x32_bf16 v[152:155], v[88:91], v[76:79], v[152:155]
ds_read_b64_tr_b16 v[84:85], v201 offset:8448
v_mfma_f32_16x16x32_bf16 v[152:155], v[56:59], v[44:47], v[152:155]
s_setprio 0
ds_read_b64_tr_b16 v[86:87], v201 offset:9472
v_mfma_f32_16x16x32_bf16 v[156:159], v[60:63], v[44:47], v[156:159]
s_setprio 1
ds_read_b64_tr_b16 v[56:57], v201 offset:512
v_mfma_f32_16x16x32_bf16 v[156:159], v[92:95], v[76:79], v[156:159]
ds_read_b64_tr_b16 v[58:59], v201 offset:1536
buffer_load_dwordx4 v195, s[36:39], s28 offen offset:3072 lds
s_add_u32 s28, s28, 128
v_mfma_f32_16x16x32_bf16 v[148:151], v[92:95], v[72:75], v[148:151]
ds_read_b64_tr_b16 v[88:89], v201 offset:8704
v_mfma_f32_16x16x32_bf16 v[148:151], v[60:63], v[40:43], v[148:151]
s_setprio 0
s_waitcnt lgkmcnt(14)
ds_read_b64_tr_b16 v[90:91], v201 offset:9728
s_waitcnt lgkmcnt(10)
v_mfma_f32_16x16x32_bf16 v[96:99], v[48:51], v[32:35], v[96:99]
s_setprio 1
ds_read_b64_tr_b16 v[60:61], v201 offset:768
s_add_u32 m0, s41, 49152
s_waitcnt lgkmcnt(9)
v_mfma_f32_16x16x32_bf16 v[96:99], v[80:83], v[64:67], v[96:99]
ds_read_b64_tr_b16 v[62:63], v201 offset:1792
buffer_load_dwordx4 v196, s[52:55], s29 offen offset:0 lds
v_mfma_f32_16x16x32_bf16 v[104:107], v[80:83], v[68:71], v[104:107]
ds_read_b64_tr_b16 v[92:93], v201 offset:8960
v_mfma_f32_16x16x32_bf16 v[104:107], v[48:51], v[36:39], v[104:107]
s_setprio 0
ds_read_b64_tr_b16 v[94:95], v201 offset:9984
s_waitcnt lgkmcnt(10)
v_mfma_f32_16x16x32_bf16 v[108:111], v[52:55], v[36:39], v[108:111]
s_setprio 1
ds_read_b128 v[44:47], v232 offset:6144
s_waitcnt lgkmcnt(9)
v_mfma_f32_16x16x32_bf16 v[108:111], v[84:87], v[68:71], v[108:111]
ds_read_b128 v[76:79], v233 offset:6144
buffer_load_dwordx4 v197, s[52:55], s29 offen offset:1024 lds
v_mfma_f32_16x16x32_bf16 v[100:103], v[84:87], v[64:67], v[100:103]
ds_read_b128 v[40:43], v232 offset:4096
v_mfma_f32_16x16x32_bf16 v[100:103], v[52:55], v[32:35], v[100:103]
s_setprio 0
ds_read_b128 v[72:75], v233 offset:4096
v_smfmac_f32_16x16x64_bf16 v[234:237], v[204:207], v[48:55], v202
s_waitcnt lgkmcnt(10)
v_mfma_f32_16x16x32_bf16 v[128:131], v[56:59], v[32:35], v[128:131]
s_setprio 1
s_waitcnt lgkmcnt(8)
v_mfma_f32_16x16x32_bf16 v[128:131], v[88:91], v[64:67], v[128:131]
buffer_load_dwordx4 v198, s[52:55], s29 offen offset:2048 lds
v_mfma_f32_16x16x32_bf16 v[136:139], v[88:91], v[68:71], v[136:139]
v_mfma_f32_16x16x32_bf16 v[136:139], v[56:59], v[36:39], v[136:139]
s_setprio 0
v_smfmac_f32_16x16x64_bf16 v[234:237], v[204:207], v[80:87], v202
s_waitcnt lgkmcnt(6)
v_mfma_f32_16x16x32_bf16 v[140:143], v[60:63], v[36:39], v[140:143]
s_setprio 1
s_waitcnt lgkmcnt(4)
v_mfma_f32_16x16x32_bf16 v[140:143], v[92:95], v[68:71], v[140:143]
buffer_load_dwordx4 v199, s[52:55], s29 offen offset:3072 lds
s_add_u32 s29, s29, 458752
v_mfma_f32_16x16x32_bf16 v[132:135], v[92:95], v[64:67], v[132:135]
v_mfma_f32_16x16x32_bf16 v[132:135], v[60:63], v[32:35], v[132:135]
s_setprio 0
s_waitcnt vmcnt(16) lgkmcnt(0)
s_barrier
s_add_u32 m0, s41, 65536
v_mfma_f32_16x16x32_bf16 v[112:115], v[48:51], v[40:43], v[112:115]
s_setprio 1
ds_read_b128 v[36:39], v232 offset:34816
v_mfma_f32_16x16x32_bf16 v[112:115], v[80:83], v[72:75], v[112:115]
v_smfmac_f32_16x16x64_bf16 v[250:253], v[204:207], v[56:63], v202
ds_read_b128 v[68:71], v233 offset:34816
buffer_load_dwordx4 v192, s[36:39], s28 offen offset:0 lds
v_mfma_f32_16x16x32_bf16 v[120:123], v[80:83], v[76:79], v[120:123]
ds_read_b128 v[32:35], v232 offset:32768
v_mfma_f32_16x16x32_bf16 v[120:123], v[48:51], v[44:47], v[120:123]
s_setprio 0
ds_read_b128 v[64:67], v233 offset:32768
v_mfma_f32_16x16x32_bf16 v[124:127], v[52:55], v[44:47], v[124:127]
s_setprio 1
ds_read_b64_tr_b16 v[48:49], v201 offset:32768
v_mfma_f32_16x16x32_bf16 v[124:127], v[84:87], v[76:79], v[124:127]
v_smfmac_f32_16x16x64_bf16 v[250:253], v[204:207], v[88:95], v202
ds_read_b64_tr_b16 v[50:51], v201 offset:33792
buffer_load_dwordx4 v193, s[36:39], s28 offen offset:1024 lds
v_mfma_f32_16x16x32_bf16 v[116:119], v[84:87], v[72:75], v[116:119]
ds_read_b64_tr_b16 v[80:81], v201 offset:40960
v_mfma_f32_16x16x32_bf16 v[116:119], v[52:55], v[40:43], v[116:119]
s_setprio 0
ds_read_b64_tr_b16 v[82:83], v201 offset:41984
v_mfma_f32_16x16x32_bf16 v[144:147], v[56:59], v[40:43], v[144:147]
s_setprio 1
ds_read_b64_tr_b16 v[52:53], v201 offset:33024
v_mfma_f32_16x16x32_bf16 v[144:147], v[88:91], v[72:75], v[144:147]
ds_read_b64_tr_b16 v[54:55], v201 offset:34048
buffer_load_dwordx4 v194, s[36:39], s28 offen offset:2048 lds
v_mfma_f32_16x16x32_bf16 v[152:155], v[88:91], v[76:79], v[152:155]
ds_read_b64_tr_b16 v[84:85], v201 offset:41216
v_mfma_f32_16x16x32_bf16 v[152:155], v[56:59], v[44:47], v[152:155]
s_setprio 0
ds_read_b64_tr_b16 v[86:87], v201 offset:42240
v_mfma_f32_16x16x32_bf16 v[156:159], v[60:63], v[44:47], v[156:159]
s_setprio 1
ds_read_b64_tr_b16 v[56:57], v201 offset:33280
v_mfma_f32_16x16x32_bf16 v[156:159], v[92:95], v[76:79], v[156:159]
ds_read_b64_tr_b16 v[58:59], v201 offset:34304
buffer_load_dwordx4 v195, s[36:39], s28 offen offset:3072 lds
s_add_u32 s28, s28, 128
v_mfma_f32_16x16x32_bf16 v[148:151], v[92:95], v[72:75], v[148:151]
ds_read_b64_tr_b16 v[88:89], v201 offset:41472
v_mfma_f32_16x16x32_bf16 v[148:151], v[60:63], v[40:43], v[148:151]
s_setprio 0
s_waitcnt lgkmcnt(14)
ds_read_b64_tr_b16 v[90:91], v201 offset:42496
s_waitcnt lgkmcnt(10)
v_mfma_f32_16x16x32_bf16 v[96:99], v[48:51], v[32:35], v[96:99]
s_setprio 1
ds_read_b64_tr_b16 v[60:61], v201 offset:33536
s_add_u32 m0, s41, 81920
s_waitcnt lgkmcnt(9)
v_mfma_f32_16x16x32_bf16 v[96:99], v[80:83], v[64:67], v[96:99]
ds_read_b64_tr_b16 v[62:63], v201 offset:34560
buffer_load_dwordx4 v196, s[52:55], s29 offen offset:0 lds
v_mfma_f32_16x16x32_bf16 v[104:107], v[80:83], v[68:71], v[104:107]
ds_read_b64_tr_b16 v[92:93], v201 offset:41728
v_mfma_f32_16x16x32_bf16 v[104:107], v[48:51], v[36:39], v[104:107]
s_setprio 0
ds_read_b64_tr_b16 v[94:95], v201 offset:42752
s_waitcnt lgkmcnt(10)
v_mfma_f32_16x16x32_bf16 v[108:111], v[52:55], v[36:39], v[108:111]
s_setprio 1
ds_read_b128 v[44:47], v232 offset:38912
s_waitcnt lgkmcnt(9)
v_mfma_f32_16x16x32_bf16 v[108:111], v[84:87], v[68:71], v[108:111]
ds_read_b128 v[76:79], v233 offset:38912
buffer_load_dwordx4 v197, s[52:55], s29 offen offset:1024 lds
v_mfma_f32_16x16x32_bf16 v[100:103], v[84:87], v[64:67], v[100:103]
ds_read_b128 v[40:43], v232 offset:36864
v_mfma_f32_16x16x32_bf16 v[100:103], v[52:55], v[32:35], v[100:103]
s_setprio 0
ds_read_b128 v[72:75], v233 offset:36864
v_smfmac_f32_16x16x64_bf16 v[234:237], v[204:207], v[48:55], v202
s_waitcnt lgkmcnt(10)
v_mfma_f32_16x16x32_bf16 v[128:131], v[56:59], v[32:35], v[128:131]
s_setprio 1
s_waitcnt lgkmcnt(8)
v_mfma_f32_16x16x32_bf16 v[128:131], v[88:91], v[64:67], v[128:131]
buffer_load_dwordx4 v198, s[52:55], s29 offen offset:2048 lds
v_mfma_f32_16x16x32_bf16 v[136:139], v[88:91], v[68:71], v[136:139]
v_mfma_f32_16x16x32_bf16 v[136:139], v[56:59], v[36:39], v[136:139]
s_setprio 0
v_smfmac_f32_16x16x64_bf16 v[234:237], v[204:207], v[80:87], v202
s_waitcnt lgkmcnt(6)
v_mfma_f32_16x16x32_bf16 v[140:143], v[60:63], v[36:39], v[140:143]
s_setprio 1
s_waitcnt lgkmcnt(4)
v_mfma_f32_16x16x32_bf16 v[140:143], v[92:95], v[68:71], v[140:143]
buffer_load_dwordx4 v199, s[52:55], s29 offen offset:3072 lds
s_add_u32 s29, s29, 458752
v_mfma_f32_16x16x32_bf16 v[132:135], v[92:95], v[64:67], v[132:135]
v_mfma_f32_16x16x32_bf16 v[132:135], v[60:63], v[32:35], v[132:135]
s_setprio 0
s_waitcnt vmcnt(16) lgkmcnt(0)
s_barrier
s_add_u32 m0, s41, 98304
v_mfma_f32_16x16x32_bf16 v[112:115], v[48:51], v[40:43], v[112:115]
s_setprio 1
ds_read_b128 v[36:39], v230 offset:2048
v_mfma_f32_16x16x32_bf16 v[112:115], v[80:83], v[72:75], v[112:115]
v_smfmac_f32_16x16x64_bf16 v[250:253], v[204:207], v[56:63], v202
ds_read_b128 v[68:71], v231 offset:2048
buffer_load_dwordx4 v192, s[36:39], s28 offen offset:0 lds
v_mfma_f32_16x16x32_bf16 v[120:123], v[80:83], v[76:79], v[120:123]
ds_read_b128 v[32:35], v230 offset:0
v_mfma_f32_16x16x32_bf16 v[120:123], v[48:51], v[44:47], v[120:123]
s_setprio 0
ds_read_b128 v[64:67], v231 offset:0
v_mfma_f32_16x16x32_bf16 v[124:127], v[52:55], v[44:47], v[124:127]
s_setprio 1
ds_read_b64_tr_b16 v[48:49], v200 offset:0
v_mfma_f32_16x16x32_bf16 v[124:127], v[84:87], v[76:79], v[124:127]
v_smfmac_f32_16x16x64_bf16 v[250:253], v[204:207], v[88:95], v202
ds_read_b64_tr_b16 v[50:51], v200 offset:1024
buffer_load_dwordx4 v193, s[36:39], s28 offen offset:1024 lds
v_mfma_f32_16x16x32_bf16 v[116:119], v[84:87], v[72:75], v[116:119]
ds_read_b64_tr_b16 v[80:81], v200 offset:8192
v_mfma_f32_16x16x32_bf16 v[116:119], v[52:55], v[40:43], v[116:119]
s_setprio 0
ds_read_b64_tr_b16 v[82:83], v200 offset:9216
v_mfma_f32_16x16x32_bf16 v[144:147], v[56:59], v[40:43], v[144:147]
s_setprio 1
ds_read_b64_tr_b16 v[52:53], v200 offset:256
v_mfma_f32_16x16x32_bf16 v[144:147], v[88:91], v[72:75], v[144:147]
ds_read_b64_tr_b16 v[54:55], v200 offset:1280
buffer_load_dwordx4 v194, s[36:39], s28 offen offset:2048 lds
v_mfma_f32_16x16x32_bf16 v[152:155], v[88:91], v[76:79], v[152:155]
ds_read_b64_tr_b16 v[84:85], v200 offset:8448
v_mfma_f32_16x16x32_bf16 v[152:155], v[56:59], v[44:47], v[152:155]
s_setprio 0
ds_read_b64_tr_b16 v[86:87], v200 offset:9472
v_mfma_f32_16x16x32_bf16 v[156:159], v[60:63], v[44:47], v[156:159]
s_setprio 1
ds_read_b64_tr_b16 v[56:57], v200 offset:512
v_mfma_f32_16x16x32_bf16 v[156:159], v[92:95], v[76:79], v[156:159]
ds_read_b64_tr_b16 v[58:59], v200 offset:1536
buffer_load_dwordx4 v195, s[36:39], s28 offen offset:3072 lds
s_add_u32 s28, s28, 128
v_mfma_f32_16x16x32_bf16 v[148:151], v[92:95], v[72:75], v[148:151]
ds_read_b64_tr_b16 v[88:89], v200 offset:8704
v_mfma_f32_16x16x32_bf16 v[148:151], v[60:63], v[40:43], v[148:151]
s_setprio 0
s_waitcnt lgkmcnt(14)
ds_read_b64_tr_b16 v[90:91], v200 offset:9728
s_waitcnt lgkmcnt(10)
v_mfma_f32_16x16x32_bf16 v[96:99], v[48:51], v[32:35], v[96:99]
s_setprio 1
ds_read_b64_tr_b16 v[60:61], v200 offset:768
s_add_u32 m0, s41, 114688
s_waitcnt lgkmcnt(9)
v_mfma_f32_16x16x32_bf16 v[96:99], v[80:83], v[64:67], v[96:99]
ds_read_b64_tr_b16 v[62:63], v200 offset:1792
buffer_load_dwordx4 v196, s[52:55], s29 offen offset:0 lds
v_mfma_f32_16x16x32_bf16 v[104:107], v[80:83], v[68:71], v[104:107]
ds_read_b64_tr_b16 v[92:93], v200 offset:8960
v_mfma_f32_16x16x32_bf16 v[104:107], v[48:51], v[36:39], v[104:107]
s_setprio 0
ds_read_b64_tr_b16 v[94:95], v200 offset:9984
s_waitcnt lgkmcnt(10)
v_mfma_f32_16x16x32_bf16 v[108:111], v[52:55], v[36:39], v[108:111]
s_setprio 1
ds_read_b128 v[44:47], v230 offset:6144
s_waitcnt lgkmcnt(9)
v_mfma_f32_16x16x32_bf16 v[108:111], v[84:87], v[68:71], v[108:111]
ds_read_b128 v[76:79], v231 offset:6144
buffer_load_dwordx4 v197, s[52:55], s29 offen offset:1024 lds
v_mfma_f32_16x16x32_bf16 v[100:103], v[84:87], v[64:67], v[100:103]
ds_read_b128 v[40:43], v230 offset:4096
v_mfma_f32_16x16x32_bf16 v[100:103], v[52:55], v[32:35], v[100:103]
s_setprio 0
ds_read_b128 v[72:75], v231 offset:4096
v_smfmac_f32_16x16x64_bf16 v[234:237], v[204:207], v[48:55], v202
s_waitcnt lgkmcnt(10)
v_mfma_f32_16x16x32_bf16 v[128:131], v[56:59], v[32:35], v[128:131]
s_setprio 1
s_waitcnt lgkmcnt(8)
v_mfma_f32_16x16x32_bf16 v[128:131], v[88:91], v[64:67], v[128:131]
buffer_load_dwordx4 v198, s[52:55], s29 offen offset:2048 lds
v_mfma_f32_16x16x32_bf16 v[136:139], v[88:91], v[68:71], v[136:139]
v_mfma_f32_16x16x32_bf16 v[136:139], v[56:59], v[36:39], v[136:139]
s_setprio 0
v_smfmac_f32_16x16x64_bf16 v[234:237], v[204:207], v[80:87], v202
s_waitcnt lgkmcnt(6)
v_mfma_f32_16x16x32_bf16 v[140:143], v[60:63], v[36:39], v[140:143]
s_setprio 1
s_waitcnt lgkmcnt(4)
v_mfma_f32_16x16x32_bf16 v[140:143], v[92:95], v[68:71], v[140:143]
buffer_load_dwordx4 v199, s[52:55], s29 offen offset:3072 lds
s_add_u32 s29, s29, 458752
v_mfma_f32_16x16x32_bf16 v[132:135], v[92:95], v[64:67], v[132:135]
v_mfma_f32_16x16x32_bf16 v[132:135], v[60:63], v[32:35], v[132:135]
s_setprio 0
s_waitcnt vmcnt(16) lgkmcnt(0)
s_barrier
s_add_u32 m0, s41, 0
v_mfma_f32_16x16x32_bf16 v[112:115], v[48:51], v[40:43], v[112:115]
s_setprio 1
ds_read_b128 v[36:39], v230 offset:34816
v_mfma_f32_16x16x32_bf16 v[112:115], v[80:83], v[72:75], v[112:115]
v_smfmac_f32_16x16x64_bf16 v[250:253], v[204:207], v[56:63], v202
ds_read_b128 v[68:71], v231 offset:34816
buffer_load_dwordx4 v192, s[36:39], s28 offen offset:0 lds
v_mfma_f32_16x16x32_bf16 v[120:123], v[80:83], v[76:79], v[120:123]
ds_read_b128 v[32:35], v230 offset:32768
v_mfma_f32_16x16x32_bf16 v[120:123], v[48:51], v[44:47], v[120:123]
s_setprio 0
ds_read_b128 v[64:67], v231 offset:32768
v_mfma_f32_16x16x32_bf16 v[124:127], v[52:55], v[44:47], v[124:127]
s_setprio 1
ds_read_b64_tr_b16 v[48:49], v200 offset:32768
v_mfma_f32_16x16x32_bf16 v[124:127], v[84:87], v[76:79], v[124:127]
v_smfmac_f32_16x16x64_bf16 v[250:253], v[204:207], v[88:95], v202
ds_read_b64_tr_b16 v[50:51], v200 offset:33792
buffer_load_dwordx4 v193, s[36:39], s28 offen offset:1024 lds
v_mfma_f32_16x16x32_bf16 v[116:119], v[84:87], v[72:75], v[116:119]
ds_read_b64_tr_b16 v[80:81], v200 offset:40960
v_mfma_f32_16x16x32_bf16 v[116:119], v[52:55], v[40:43], v[116:119]
s_setprio 0
ds_read_b64_tr_b16 v[82:83], v200 offset:41984
v_mfma_f32_16x16x32_bf16 v[144:147], v[56:59], v[40:43], v[144:147]
s_setprio 1
ds_read_b64_tr_b16 v[52:53], v200 offset:33024
v_mfma_f32_16x16x32_bf16 v[144:147], v[88:91], v[72:75], v[144:147]
ds_read_b64_tr_b16 v[54:55], v200 offset:34048
buffer_load_dwordx4 v194, s[36:39], s28 offen offset:2048 lds
v_mfma_f32_16x16x32_bf16 v[152:155], v[88:91], v[76:79], v[152:155]
ds_read_b64_tr_b16 v[84:85], v200 offset:41216
v_mfma_f32_16x16x32_bf16 v[152:155], v[56:59], v[44:47], v[152:155]
s_setprio 0
ds_read_b64_tr_b16 v[86:87], v200 offset:42240
v_mfma_f32_16x16x32_bf16 v[156:159], v[60:63], v[44:47], v[156:159]
s_setprio 1
ds_read_b64_tr_b16 v[56:57], v200 offset:33280
v_mfma_f32_16x16x32_bf16 v[156:159], v[92:95], v[76:79], v[156:159]
ds_read_b64_tr_b16 v[58:59], v200 offset:34304
buffer_load_dwordx4 v195, s[36:39], s28 offen offset:3072 lds
s_add_u32 s28, s28, 128
v_mfma_f32_16x16x32_bf16 v[148:151], v[92:95], v[72:75], v[148:151]
ds_read_b64_tr_b16 v[88:89], v200 offset:41472
v_mfma_f32_16x16x32_bf16 v[148:151], v[60:63], v[40:43], v[148:151]
s_setprio 0
s_waitcnt lgkmcnt(14)
ds_read_b64_tr_b16 v[90:91], v200 offset:42496
s_waitcnt lgkmcnt(10)
v_mfma_f32_16x16x32_bf16 v[96:99], v[48:51], v[32:35], v[96:99]
s_setprio 1
ds_read_b64_tr_b16 v[60:61], v200 offset:33536
s_add_u32 m0, s41, 16384
s_waitcnt lgkmcnt(9)
v_mfma_f32_16x16x32_bf16 v[96:99], v[80:83], v[64:67], v[96:99]
ds_read_b64_tr_b16 v[62:63], v200 offset:34560
buffer_load_dwordx4 v196, s[52:55], s29 offen offset:0 lds
v_mfma_f32_16x16x32_bf16 v[104:107], v[80:83], v[68:71], v[104:107]
ds_read_b64_tr_b16 v[92:93], v200 offset:41728
v_mfma_f32_16x16x32_bf16 v[104:107], v[48:51], v[36:39], v[104:107]
s_setprio 0
ds_read_b64_tr_b16 v[94:95], v200 offset:42752
s_waitcnt lgkmcnt(10)
v_mfma_f32_16x16x32_bf16 v[108:111], v[52:55], v[36:39], v[108:111]
s_setprio 1
ds_read_b128 v[44:47], v230 offset:38912
s_waitcnt lgkmcnt(9)
v_mfma_f32_16x16x32_bf16 v[108:111], v[84:87], v[68:71], v[108:111]
ds_read_b128 v[76:79], v231 offset:38912
buffer_load_dwordx4 v197, s[52:55], s29 offen offset:1024 lds
v_mfma_f32_16x16x32_bf16 v[100:103], v[84:87], v[64:67], v[100:103]
ds_read_b128 v[40:43], v230 offset:36864
v_mfma_f32_16x16x32_bf16 v[100:103], v[52:55], v[32:35], v[100:103]
s_setprio 0
ds_read_b128 v[72:75], v231 offset:36864
v_smfmac_f32_16x16x64_bf16 v[234:237], v[204:207], v[48:55], v202
s_waitcnt lgkmcnt(10)
v_mfma_f32_16x16x32_bf16 v[128:131], v[56:59], v[32:35], v[128:131]
s_setprio 1
s_waitcnt lgkmcnt(8)
v_mfma_f32_16x16x32_bf16 v[128:131], v[88:91], v[64:67], v[128:131]
buffer_load_dwordx4 v198, s[52:55], s29 offen offset:2048 lds
v_mfma_f32_16x16x32_bf16 v[136:139], v[88:91], v[68:71], v[136:139]
v_mfma_f32_16x16x32_bf16 v[136:139], v[56:59], v[36:39], v[136:139]
s_setprio 0
v_smfmac_f32_16x16x64_bf16 v[234:237], v[204:207], v[80:87], v202
s_waitcnt lgkmcnt(6)
v_mfma_f32_16x16x32_bf16 v[140:143], v[60:63], v[36:39], v[140:143]
s_setprio 1
s_waitcnt lgkmcnt(4)
v_mfma_f32_16x16x32_bf16 v[140:143], v[92:95], v[68:71], v[140:143]
buffer_load_dwordx4 v199, s[52:55], s29 offen offset:3072 lds
s_add_u32 s29, s29, 458752
v_mfma_f32_16x16x32_bf16 v[132:135], v[92:95], v[64:67], v[132:135]
v_mfma_f32_16x16x32_bf16 v[132:135], v[60:63], v[32:35], v[132:135]
s_setprio 0
s_waitcnt vmcnt(16) lgkmcnt(0)
s_barrier
s_add_u32 m0, s41, 32768
v_mfma_f32_16x16x32_bf16 v[112:115], v[48:51], v[40:43], v[112:115]
s_setprio 1
ds_read_b128 v[36:39], v232 offset:2048
v_mfma_f32_16x16x32_bf16 v[112:115], v[80:83], v[72:75], v[112:115]
v_smfmac_f32_16x16x64_bf16 v[250:253], v[204:207], v[56:63], v202
ds_read_b128 v[68:71], v233 offset:2048
buffer_load_dwordx4 v192, s[36:39], s28 offen offset:0 lds
v_mfma_f32_16x16x32_bf16 v[120:123], v[80:83], v[76:79], v[120:123]
ds_read_b128 v[32:35], v232 offset:0
v_mfma_f32_16x16x32_bf16 v[120:123], v[48:51], v[44:47], v[120:123]
s_setprio 0
ds_read_b128 v[64:67], v233 offset:0
v_mfma_f32_16x16x32_bf16 v[124:127], v[52:55], v[44:47], v[124:127]
s_setprio 1
ds_read_b64_tr_b16 v[48:49], v201 offset:0
v_mfma_f32_16x16x32_bf16 v[124:127], v[84:87], v[76:79], v[124:127]
v_smfmac_f32_16x16x64_bf16 v[250:253], v[204:207], v[88:95], v202
ds_read_b64_tr_b16 v[50:51], v201 offset:1024
buffer_load_dwordx4 v193, s[36:39], s28 offen offset:1024 lds
v_mfma_f32_16x16x32_bf16 v[116:119], v[84:87], v[72:75], v[116:119]
ds_read_b64_tr_b16 v[80:81], v201 offset:8192
v_mfma_f32_16x16x32_bf16 v[116:119], v[52:55], v[40:43], v[116:119]
s_setprio 0
ds_read_b64_tr_b16 v[82:83], v201 offset:9216
v_mfma_f32_16x16x32_bf16 v[144:147], v[56:59], v[40:43], v[144:147]
s_setprio 1
ds_read_b64_tr_b16 v[52:53], v201 offset:256
v_mfma_f32_16x16x32_bf16 v[144:147], v[88:91], v[72:75], v[144:147]
ds_read_b64_tr_b16 v[54:55], v201 offset:1280
buffer_load_dwordx4 v194, s[36:39], s28 offen offset:2048 lds
v_mfma_f32_16x16x32_bf16 v[152:155], v[88:91], v[76:79], v[152:155]
ds_read_b64_tr_b16 v[84:85], v201 offset:8448
v_mfma_f32_16x16x32_bf16 v[152:155], v[56:59], v[44:47], v[152:155]
s_setprio 0
ds_read_b64_tr_b16 v[86:87], v201 offset:9472
v_mfma_f32_16x16x32_bf16 v[156:159], v[60:63], v[44:47], v[156:159]
s_setprio 1
ds_read_b64_tr_b16 v[56:57], v201 offset:512
v_mfma_f32_16x16x32_bf16 v[156:159], v[92:95], v[76:79], v[156:159]
ds_read_b64_tr_b16 v[58:59], v201 offset:1536
buffer_load_dwordx4 v195, s[36:39], s28 offen offset:3072 lds
s_add_u32 s28, s28, 128
v_mfma_f32_16x16x32_bf16 v[148:151], v[92:95], v[72:75], v[148:151]
ds_read_b64_tr_b16 v[88:89], v201 offset:8704
v_mfma_f32_16x16x32_bf16 v[148:151], v[60:63], v[40:43], v[148:151]
s_setprio 0
s_waitcnt lgkmcnt(14)
ds_read_b64_tr_b16 v[90:91], v201 offset:9728
s_waitcnt lgkmcnt(10)
v_mfma_f32_16x16x32_bf16 v[96:99], v[48:51], v[32:35], v[96:99]
s_setprio 1
ds_read_b64_tr_b16 v[60:61], v201 offset:768
s_add_u32 m0, s41, 49152
s_waitcnt lgkmcnt(9)
v_mfma_f32_16x16x32_bf16 v[96:99], v[80:83], v[64:67], v[96:99]
ds_read_b64_tr_b16 v[62:63], v201 offset:1792
buffer_load_dwordx4 v196, s[52:55], s29 offen offset:0 lds
v_mfma_f32_16x16x32_bf16 v[104:107], v[80:83], v[68:71], v[104:107]
ds_read_b64_tr_b16 v[92:93], v201 offset:8960
v_mfma_f32_16x16x32_bf16 v[104:107], v[48:51], v[36:39], v[104:107]
s_setprio 0
ds_read_b64_tr_b16 v[94:95], v201 offset:9984
s_waitcnt lgkmcnt(10)
v_mfma_f32_16x16x32_bf16 v[108:111], v[52:55], v[36:39], v[108:111]
s_setprio 1
ds_read_b128 v[44:47], v232 offset:6144
s_waitcnt lgkmcnt(9)
v_mfma_f32_16x16x32_bf16 v[108:111], v[84:87], v[68:71], v[108:111]
ds_read_b128 v[76:79], v233 offset:6144
buffer_load_dwordx4 v197, s[52:55], s29 offen offset:1024 lds
v_mfma_f32_16x16x32_bf16 v[100:103], v[84:87], v[64:67], v[100:103]
ds_read_b128 v[40:43], v232 offset:4096
v_mfma_f32_16x16x32_bf16 v[100:103], v[52:55], v[32:35], v[100:103]
s_setprio 0
ds_read_b128 v[72:75], v233 offset:4096
v_smfmac_f32_16x16x64_bf16 v[234:237], v[204:207], v[48:55], v202
s_waitcnt lgkmcnt(10)
v_mfma_f32_16x16x32_bf16 v[128:131], v[56:59], v[32:35], v[128:131]
s_setprio 1
s_waitcnt lgkmcnt(8)
v_mfma_f32_16x16x32_bf16 v[128:131], v[88:91], v[64:67], v[128:131]
buffer_load_dwordx4 v198, s[52:55], s29 offen offset:2048 lds
v_mfma_f32_16x16x32_bf16 v[136:139], v[88:91], v[68:71], v[136:139]
v_mfma_f32_16x16x32_bf16 v[136:139], v[56:59], v[36:39], v[136:139]
s_setprio 0
v_smfmac_f32_16x16x64_bf16 v[234:237], v[204:207], v[80:87], v202
s_waitcnt lgkmcnt(6)
v_mfma_f32_16x16x32_bf16 v[140:143], v[60:63], v[36:39], v[140:143]
s_setprio 1
s_waitcnt lgkmcnt(4)
v_mfma_f32_16x16x32_bf16 v[140:143], v[92:95], v[68:71], v[140:143]
buffer_load_dwordx4 v199, s[52:55], s29 offen offset:3072 lds
s_add_u32 s29, s29, 458752
v_mfma_f32_16x16x32_bf16 v[132:135], v[92:95], v[64:67], v[132:135]
v_mfma_f32_16x16x32_bf16 v[132:135], v[60:63], v[32:35], v[132:135]
s_setprio 0
s_waitcnt vmcnt(16) lgkmcnt(0)
s_barrier
s_add_u32 m0, s41, 65536
v_mfma_f32_16x16x32_bf16 v[112:115], v[48:51], v[40:43], v[112:115]
s_setprio 1
ds_read_b128 v[36:39], v232 offset:34816
v_mfma_f32_16x16x32_bf16 v[112:115], v[80:83], v[72:75], v[112:115]
v_smfmac_f32_16x16x64_bf16 v[250:253], v[204:207], v[56:63], v202
ds_read_b128 v[68:71], v233 offset:34816
buffer_load_dwordx4 v192, s[36:39], s28 offen offset:0 lds
v_mfma_f32_16x16x32_bf16 v[120:123], v[80:83], v[76:79], v[120:123]
ds_read_b128 v[32:35], v232 offset:32768
v_mfma_f32_16x16x32_bf16 v[120:123], v[48:51], v[44:47], v[120:123]
s_setprio 0
ds_read_b128 v[64:67], v233 offset:32768
v_mfma_f32_16x16x32_bf16 v[124:127], v[52:55], v[44:47], v[124:127]
s_setprio 1
ds_read_b64_tr_b16 v[48:49], v201 offset:32768
v_mfma_f32_16x16x32_bf16 v[124:127], v[84:87], v[76:79], v[124:127]
v_smfmac_f32_16x16x64_bf16 v[250:253], v[204:207], v[88:95], v202
ds_read_b64_tr_b16 v[50:51], v201 offset:33792
buffer_load_dwordx4 v193, s[36:39], s28 offen offset:1024 lds
v_mfma_f32_16x16x32_bf16 v[116:119], v[84:87], v[72:75], v[116:119]
ds_read_b64_tr_b16 v[80:81], v201 offset:40960
v_mfma_f32_16x16x32_bf16 v[116:119], v[52:55], v[40:43], v[116:119]
s_setprio 0
ds_read_b64_tr_b16 v[82:83], v201 offset:41984
v_mfma_f32_16x16x32_bf16 v[144:147], v[56:59], v[40:43], v[144:147]
s_setprio 1
ds_read_b64_tr_b16 v[52:53], v201 offset:33024
v_mfma_f32_16x16x32_bf16 v[144:147], v[88:91], v[72:75], v[144:147]
ds_read_b64_tr_b16 v[54:55], v201 offset:34048
buffer_load_dwordx4 v194, s[36:39], s28 offen offset:2048 lds
v_mfma_f32_16x16x32_bf16 v[152:155], v[88:91], v[76:79], v[152:155]
ds_read_b64_tr_b16 v[84:85], v201 offset:41216
v_mfma_f32_16x16x32_bf16 v[152:155], v[56:59], v[44:47], v[152:155]
s_setprio 0
ds_read_b64_tr_b16 v[86:87], v201 offset:42240
v_mfma_f32_16x16x32_bf16 v[156:159], v[60:63], v[44:47], v[156:159]
s_setprio 1
ds_read_b64_tr_b16 v[56:57], v201 offset:33280
v_mfma_f32_16x16x32_bf16 v[156:159], v[92:95], v[76:79], v[156:159]
ds_read_b64_tr_b16 v[58:59], v201 offset:34304
buffer_load_dwordx4 v195, s[36:39], s28 offen offset:3072 lds
s_add_u32 s28, s28, 128
v_mfma_f32_16x16x32_bf16 v[148:151], v[92:95], v[72:75], v[148:151]
ds_read_b64_tr_b16 v[88:89], v201 offset:41472
v_mfma_f32_16x16x32_bf16 v[148:151], v[60:63], v[40:43], v[148:151]
s_setprio 0
s_waitcnt lgkmcnt(14)
ds_read_b64_tr_b16 v[90:91], v201 offset:42496
s_waitcnt lgkmcnt(10)
v_mfma_f32_16x16x32_bf16 v[96:99], v[48:51], v[32:35], v[96:99]
s_setprio 1
ds_read_b64_tr_b16 v[60:61], v201 offset:33536
s_add_u32 m0, s41, 81920
s_waitcnt lgkmcnt(9)
v_mfma_f32_16x16x32_bf16 v[96:99], v[80:83], v[64:67], v[96:99]
ds_read_b64_tr_b16 v[62:63], v201 offset:34560
buffer_load_dwordx4 v196, s[52:55], s29 offen offset:0 lds
v_mfma_f32_16x16x32_bf16 v[104:107], v[80:83], v[68:71], v[104:107]
ds_read_b64_tr_b16 v[92:93], v201 offset:41728
v_mfma_f32_16x16x32_bf16 v[104:107], v[48:51], v[36:39], v[104:107]
s_setprio 0
ds_read_b64_tr_b16 v[94:95], v201 offset:42752
s_waitcnt lgkmcnt(10)
v_mfma_f32_16x16x32_bf16 v[108:111], v[52:55], v[36:39], v[108:111]
s_setprio 1
ds_read_b128 v[44:47], v232 offset:38912
s_waitcnt lgkmcnt(9)
v_mfma_f32_16x16x32_bf16 v[108:111], v[84:87], v[68:71], v[108:111]
ds_read_b128 v[76:79], v233 offset:38912
buffer_load_dwordx4 v197, s[52:55], s29 offen offset:1024 lds
v_mfma_f32_16x16x32_bf16 v[100:103], v[84:87], v[64:67], v[100:103]
ds_read_b128 v[40:43], v232 offset:36864
v_mfma_f32_16x16x32_bf16 v[100:103], v[52:55], v[32:35], v[100:103]
s_setprio 0
ds_read_b128 v[72:75], v233 offset:36864
v_smfmac_f32_16x16x64_bf16 v[234:237], v[204:207], v[48:55], v202
s_waitcnt lgkmcnt(10)
v_mfma_f32_16x16x32_bf16 v[128:131], v[56:59], v[32:35], v[128:131]
s_setprio 1
s_waitcnt lgkmcnt(8)
v_mfma_f32_16x16x32_bf16 v[128:131], v[88:91], v[64:67], v[128:131]
buffer_load_dwordx4 v198, s[52:55], s29 offen offset:2048 lds
v_mfma_f32_16x16x32_bf16 v[136:139], v[88:91], v[68:71], v[136:139]
v_mfma_f32_16x16x32_bf16 v[136:139], v[56:59], v[36:39], v[136:139]
s_setprio 0
v_smfmac_f32_16x16x64_bf16 v[234:237], v[204:207], v[80:87], v202
s_waitcnt lgkmcnt(6)
v_mfma_f32_16x16x32_bf16 v[140:143], v[60:63], v[36:39], v[140:143]
s_setprio 1
s_waitcnt lgkmcnt(4)
v_mfma_f32_16x16x32_bf16 v[140:143], v[92:95], v[68:71], v[140:143]
buffer_load_dwordx4 v199, s[52:55], s29 offen offset:3072 lds
s_add_u32 s29, s29, 458752
v_mfma_f32_16x16x32_bf16 v[132:135], v[92:95], v[64:67], v[132:135]
v_mfma_f32_16x16x32_bf16 v[132:135], v[60:63], v[32:35], v[132:135]
s_setprio 0
s_waitcnt vmcnt(16) lgkmcnt(0)
s_barrier
s_cmp_lg_u32 s25, 7
s_cbranch_scc1 L_t_z0
s_mov_b64 exec, 15
buffer_load_dword v229, v29, s[48:51], 0 offen sc1
s_mov_b64 exec, -1
L_t_z0:
s_add_u32 m0, s41, 98304
v_mfma_f32_16x16x32_bf16 v[112:115], v[48:51], v[40:43], v[112:115]
s_setprio 1
ds_read_b128 v[36:39], v230 offset:2048
v_mfma_f32_16x16x32_bf16 v[112:115], v[80:83], v[72:75], v[112:115]
v_smfmac_f32_16x16x64_bf16 v[250:253], v[204:207], v[56:63], v202
ds_read_b128 v[68:71], v231 offset:2048
buffer_load_dwordx4 v192, s[36:39], s28 offen offset:0 lds
v_mfma_f32_16x16x32_bf16 v[120:123], v[80:83], v[76:79], v[120:123]
ds_read_b128 v[32:35], v230 offset:0
v_mfma_f32_16x16x32_bf16 v[120:123], v[48:51], v[44:47], v[120:123]
s_setprio 0
ds_read_b128 v[64:67], v231 offset:0
v_mfma_f32_16x16x32_bf16 v[124:127], v[52:55], v[44:47], v[124:127]
s_setprio 1
ds_read_b64_tr_b16 v[48:49], v200 offset:0
v_mfma_f32_16x16x32_bf16 v[124:127], v[84:87], v[76:79], v[124:127]
v_smfmac_f32_16x16x64_bf16 v[250:253], v[204:207], v[88:95], v202
ds_read_b64_tr_b16 v[50:51], v200 offset:1024
buffer_load_dwordx4 v193, s[36:39], s28 offen offset:1024 lds
v_mfma_f32_16x16x32_bf16 v[116:119], v[84:87], v[72:75], v[116:119]
ds_read_b64_tr_b16 v[80:81], v200 offset:8192
v_mfma_f32_16x16x32_bf16 v[116:119], v[52:55], v[40:43], v[116:119]
s_setprio 0
ds_read_b64_tr_b16 v[82:83], v200 offset:9216
v_mfma_f32_16x16x32_bf16 v[144:147], v[56:59], v[40:43], v[144:147]
s_setprio 1
ds_read_b64_tr_b16 v[52:53], v200 offset:256
v_mfma_f32_16x16x32_bf16 v[144:147], v[88:91], v[72:75], v[144:147]
ds_read_b64_tr_b16 v[54:55], v200 offset:1280
buffer_load_dwordx4 v194, s[36:39], s28 offen offset:2048 lds
v_mfma_f32_16x16x32_bf16 v[152:155], v[88:91], v[76:79], v[152:155]
ds_read_b64_tr_b16 v[84:85], v200 offset:8448
v_mfma_f32_16x16x32_bf16 v[152:155], v[56:59], v[44:47], v[152:155]
s_setprio 0
ds_read_b64_tr_b16 v[86:87], v200 offset:9472
v_mfma_f32_16x16x32_bf16 v[156:159], v[60:63], v[44:47], v[156:159]
s_setprio 1
ds_read_b64_tr_b16 v[56:57], v200 offset:512
v_mfma_f32_16x16x32_bf16 v[156:159], v[92:95], v[76:79], v[156:159]
ds_read_b64_tr_b16 v[58:59], v200 offset:1536
buffer_load_dwordx4 v195, s[36:39], s28 offen offset:3072 lds
s_add_u32 s28, s28, 128
v_mfma_f32_16x16x32_bf16 v[148:151], v[92:95], v[72:75], v[148:151]
ds_read_b64_tr_b16 v[88:89], v200 offset:8704
v_mfma_f32_16x16x32_bf16 v[148:151], v[60:63], v[40:43], v[148:151]
s_setprio 0
s_waitcnt lgkmcnt(14)
ds_read_b64_tr_b16 v[90:91], v200 offset:9728
s_waitcnt lgkmcnt(10)
v_mfma_f32_16x16x32_bf16 v[96:99], v[48:51], v[32:35], v[96:99]
s_setprio 1
ds_read_b64_tr_b16 v[60:61], v200 offset:768
s_add_u32 m0, s41, 114688
s_waitcnt lgkmcnt(9)
v_mfma_f32_16x16x32_bf16 v[96:99], v[80:83], v[64:67], v[96:99]
ds_read_b64_tr_b16 v[62:63], v200 offset:1792
buffer_load_dwordx4 v196, s[52:55], s29 offen offset:0 lds
v_mfma_f32_16x16x32_bf16 v[104:107], v[80:83], v[68:71], v[104:107]
ds_read_b64_tr_b16 v[92:93], v200 offset:8960
v_mfma_f32_16x16x32_bf16 v[104:107], v[48:51], v[36:39], v[104:107]
s_setprio 0
ds_read_b64_tr_b16 v[94:95], v200 offset:9984
s_waitcnt lgkmcnt(10)
v_mfma_f32_16x16x32_bf16 v[108:111], v[52:55], v[36:39], v[108:111]
s_setprio 1
ds_read_b128 v[44:47], v230 offset:6144
s_waitcnt lgkmcnt(9)
v_mfma_f32_16x16x32_bf16 v[108:111], v[84:87], v[68:71], v[108:111]
ds_read_b128 v[76:79], v231 offset:6144
buffer_load_dwordx4 v197, s[52:55], s29 offen offset:1024 lds
v_mfma_f32_16x16x32_bf16 v[100:103], v[84:87], v[64:67], v[100:103]
ds_read_b128 v[40:43], v230 offset:4096
v_mfma_f32_16x16x32_bf16 v[100:103], v[52:55], v[32:35], v[100:103]
s_setprio 0
ds_read_b128 v[72:75], v231 offset:4096
v_smfmac_f32_16x16x64_bf16 v[234:237], v[204:207], v[48:55], v202
s_waitcnt lgkmcnt(10)
v_mfma_f32_16x16x32_bf16 v[128:131], v[56:59], v[32:35], v[128:131]
s_setprio 1
s_waitcnt lgkmcnt(8)
v_mfma_f32_16x16x32_bf16 v[128:131], v[88:91], v[64:67], v[128:131]
buffer_load_dwordx4 v198, s[52:55], s29 offen offset:2048 lds
v_mfma_f32_16x16x32_bf16 v[136:139], v[88:91], v[68:71], v[136:139]
v_mfma_f32_16x16x32_bf16 v[136:139], v[56:59], v[36:39], v[136:139]
s_setprio 0
v_smfmac_f32_16x16x64_bf16 v[234:237], v[204:207], v[80:87], v202
s_waitcnt lgkmcnt(6)
v_mfma_f32_16x16x32_bf16 v[140:143], v[60:63], v[36:39], v[140:143]
s_setprio 1
s_waitcnt lgkmcnt(4)
v_mfma_f32_16x16x32_bf16 v[140:143], v[92:95], v[68:71], v[140:143]
buffer_load_dwordx4 v199, s[52:55], s29 offen offset:3072 lds
s_add_u32 s29, s29, 458752
v_mfma_f32_16x16x32_bf16 v[132:135], v[92:95], v[64:67], v[132:135]
v_mfma_f32_16x16x32_bf16 v[132:135], v[60:63], v[32:35], v[132:135]
s_setprio 0
s_waitcnt vmcnt(16) lgkmcnt(0)
s_cmp_lg_u32 s25, 7
s_cbranch_scc1 L_t_z1
s_mov_b64 exec, 15
s_mov_b32 s47, 0x40000
s_waitcnt vmcnt(8)
s_branch L_t_z_k
L_t_z_l:
s_waitcnt vmcnt(0)
L_t_z_k:
v_cmp_le_u32 s[26:27], 8, v229
s_sub_u32 s47, s47, 1
s_nop 0
s_cmp_eq_u32 s26, 15
s_cbranch_scc1 L_t_z_g
s_sleep 1
buffer_load_dword v229, v29, s[48:51], 0 offen sc1
s_cmp_lg_u32 s47, 0
s_cbranch_scc1 L_t_z_l
L_t_z_g:
s_mov_b64 exec, -1
L_t_z1:
s_barrier
s_add_u32 m0, s41, 0
v_mfma_f32_16x16x32_bf16 v[112:115], v[48:51], v[40:43], v[112:115]
s_setprio 1
ds_read_b128 v[36:39], v230 offset:34816
v_mfma_f32_16x16x32_bf16 v[112:115], v[80:83], v[72:75], v[112:115]
v_smfmac_f32_16x16x64_bf16 v[250:253], v[204:207], v[56:63], v202
ds_read_b128 v[68:71], v231 offset:34816
buffer_load_dwordx4 v224, s[16:19], s40 offen offset:0 lds
v_mfma_f32_16x16x32_bf16 v[120:123], v[80:83], v[76:79], v[120:123]
ds_read_b128 v[32:35], v230 offset:32768
v_mfma_f32_16x16x32_bf16 v[120:123], v[48:51], v[44:47], v[120:123]
s_setprio 0
ds_read_b128 v[64:67], v231 offset:32768
v_mfma_f32_16x16x32_bf16 v[124:127], v[52:55], v[44:47], v[124:127]
s_setprio 1
ds_read_b64_tr_b16 v[48:49], v200 offset:32768
v_mfma_f32_16x16x32_bf16 v[124:127], v[84:87], v[76:79], v[124:127]
v_smfmac_f32_16x16x64_bf16 v[250:253], v[204:207], v[88:95], v202
ds_read_b64_tr_b16 v[50:51], v200 offset:33792
buffer_load_dwordx4 v225, s[16:19], s40 offen offset:1024 lds
v_mfma_f32_16x16x32_bf16 v[116:119], v[84:87], v[72:75], v[116:119]
ds_read_b64_tr_b16 v[80:81], v200 offset:40960
v_mfma_f32_16x16x32_bf16 v[116:119], v[52:55], v[40:43], v[116:119]
s_setprio 0
ds_read_b64_tr_b16 v[82:83], v200 offset:41984
v_mfma_f32_16x16x32_bf16 v[144:147], v[56:59], v[40:43], v[144:147]
s_setprio 1
ds_read_b64_tr_b16 v[52:53], v200 offset:33024
v_mfma_f32_16x16x32_bf16 v[144:147], v[88:91], v[72:75], v[144:147]
ds_read_b64_tr_b16 v[54:55], v200 offset:34048
buffer_load_dwordx4 v226, s[16:19], s40 offen offset:2048 lds
v_mfma_f32_16x16x32_bf16 v[152:155], v[88:91], v[76:79], v[152:155]
ds_read_b64_tr_b16 v[84:85], v200 offset:41216
v_mfma_f32_16x16x32_bf16 v[152:155], v[56:59], v[44:47], v[152:155]
s_setprio 0
ds_read_b64_tr_b16 v[86:87], v200 offset:42240
v_mfma_f32_16x16x32_bf16 v[156:159], v[60:63], v[44:47], v[156:159]
s_setprio 1
ds_read_b64_tr_b16 v[56:57], v200 offset:33280
v_mfma_f32_16x16x32_bf16 v[156:159], v[92:95], v[76:79], v[156:159]
ds_read_b64_tr_b16 v[58:59], v200 offset:34304
buffer_load_dwordx4 v227, s[16:19], s40 offen offset:3072 lds
s_add_u32 s40, s40, 128
v_mfma_f32_16x16x32_bf16 v[148:151], v[92:95], v[72:75], v[148:151]
ds_read_b64_tr_b16 v[88:89], v200 offset:41472
v_mfma_f32_16x16x32_bf16 v[148:151], v[60:63], v[40:43], v[148:151]
s_setprio 0
s_waitcnt lgkmcnt(14)
ds_read_b64_tr_b16 v[90:91], v200 offset:42496
s_waitcnt lgkmcnt(10)
v_mfma_f32_16x16x32_bf16 v[96:99], v[48:51], v[32:35], v[96:99]
s_setprio 1
ds_read_b64_tr_b16 v[60:61], v200 offset:33536
s_add_u32 m0, s41, 16384
s_waitcnt lgkmcnt(9)
v_mfma_f32_16x16x32_bf16 v[96:99], v[80:83], v[64:67], v[96:99]
ds_read_b64_tr_b16 v[62:63], v200 offset:34560
buffer_load_dwordx4 v228, s[20:23], s44 offen offset:0 lds
v_mfma_f32_16x16x32_bf16 v[104:107], v[80:83], v[68:71], v[104:107]
ds_read_b64_tr_b16 v[92:93], v200 offset:41728
v_mfma_f32_16x16x32_bf16 v[104:107], v[48:51], v[36:39], v[104:107]
s_setprio 0
ds_read_b64_tr_b16 v[94:95], v200 offset:42752
s_waitcnt lgkmcnt(10)
v_mfma_f32_16x16x32_bf16 v[108:111], v[52:55], v[36:39], v[108:111]
s_setprio 1
ds_read_b128 v[44:47], v230 offset:38912
s_waitcnt lgkmcnt(9)
v_mfma_f32_16x16x32_bf16 v[108:111], v[84:87], v[68:71], v[108:111]
ds_read_b128 v[76:79], v231 offset:38912
buffer_load_dwordx4 v228, s[20:23], s44 offen offset:1024 lds
v_mfma_f32_16x16x32_bf16 v[100:103], v[84:87], v[64:67], v[100:103]
ds_read_b128 v[40:43], v230 offset:36864
v_mfma_f32_16x16x32_bf16 v[100:103], v[52:55], v[32:35], v[100:103]
s_setprio 0
ds_read_b128 v[72:75], v231 offset:36864
v_smfmac_f32_16x16x64_bf16 v[234:237], v[204:207], v[48:55], v202
s_waitcnt lgkmcnt(10)
v_mfma_f32_16x16x32_bf16 v[128:131], v[56:59], v[32:35], v[128:131]
s_setprio 1
s_waitcnt lgkmcnt(8)
v_mfma_f32_16x16x32_bf16 v[128:131], v[88:91], v[64:67], v[128:131]
buffer_load_dwordx4 v228, s[20:23], s44 offen offset:2048 lds
v_mfma_f32_16x16x32_bf16 v[136:139], v[88:91], v[68:71], v[136:139]
v_mfma_f32_16x16x32_bf16 v[136:139], v[56:59], v[36:39], v[136:139]
s_setprio 0
v_smfmac_f32_16x16x64_bf16 v[234:237], v[204:207], v[80:87], v202
s_waitcnt lgkmcnt(6)
v_mfma_f32_16x16x32_bf16 v[140:143], v[60:63], v[36:39], v[140:143]
s_setprio 1
s_waitcnt lgkmcnt(4)
v_mfma_f32_16x16x32_bf16 v[140:143], v[92:95], v[68:71], v[140:143]
buffer_load_dwordx4 v228, s[20:23], s44 offen offset:3072 lds
s_add_u32 s44, s44, 4096
v_mfma_f32_16x16x32_bf16 v[132:135], v[92:95], v[64:67], v[132:135]
v_mfma_f32_16x16x32_bf16 v[132:135], v[60:63], v[32:35], v[132:135]
s_setprio 0
s_waitcnt vmcnt(16) lgkmcnt(0)
s_barrier
s_add_u32 m0, s41, 32768
v_mfma_f32_16x16x32_bf16 v[112:115], v[48:51], v[40:43], v[112:115]
s_setprio 1
ds_read_b128 v[36:39], v232 offset:2048
v_mfma_f32_16x16x32_bf16 v[112:115], v[80:83], v[72:75], v[112:115]
v_smfmac_f32_16x16x64_bf16 v[250:253], v[204:207], v[56:63], v202
ds_read_b128 v[68:71], v233 offset:2048
buffer_load_dwordx4 v224, s[16:19], s40 offen offset:0 lds
v_mfma_f32_16x16x32_bf16 v[120:123], v[80:83], v[76:79], v[120:123]
ds_read_b128 v[32:35], v232 offset:0
v_mfma_f32_16x16x32_bf16 v[120:123], v[48:51], v[44:47], v[120:123]
s_setprio 0
ds_read_b128 v[64:67], v233 offset:0
v_mfma_f32_16x16x32_bf16 v[124:127], v[52:55], v[44:47], v[124:127]
s_setprio 1
ds_read_b64_tr_b16 v[48:49], v201 offset:0
v_mfma_f32_16x16x32_bf16 v[124:127], v[84:87], v[76:79], v[124:127]
v_smfmac_f32_16x16x64_bf16 v[250:253], v[204:207], v[88:95], v202
ds_read_b64_tr_b16 v[50:51], v201 offset:1024
buffer_load_dwordx4 v225, s[16:19], s40 offen offset:1024 lds
v_mfma_f32_16x16x32_bf16 v[116:119], v[84:87], v[72:75], v[116:119]
ds_read_b64_tr_b16 v[80:81], v201 offset:8192
v_mfma_f32_16x16x32_bf16 v[116:119], v[52:55], v[40:43], v[116:119]
s_setprio 0
ds_read_b64_tr_b16 v[82:83], v201 offset:9216
v_mfma_f32_16x16x32_bf16 v[144:147], v[56:59], v[40:43], v[144:147]
s_setprio 1
ds_read_b64_tr_b16 v[52:53], v201 offset:256
v_mfma_f32_16x16x32_bf16 v[144:147], v[88:91], v[72:75], v[144:147]
ds_read_b64_tr_b16 v[54:55], v201 offset:1280
buffer_load_dwordx4 v226, s[16:19], s40 offen offset:2048 lds
v_mfma_f32_16x16x32_bf16 v[152:155], v[88:91], v[76:79], v[152:155]
ds_read_b64_tr_b16 v[84:85], v201 offset:8448
v_mfma_f32_16x16x32_bf16 v[152:155], v[56:59], v[44:47], v[152:155]
s_setprio 0
ds_read_b64_tr_b16 v[86:87], v201 offset:9472
v_mfma_f32_16x16x32_bf16 v[156:159], v[60:63], v[44:47], v[156:159]
s_setprio 1
ds_read_b64_tr_b16 v[56:57], v201 offset:512
v_mfma_f32_16x16x32_bf16 v[156:159], v[92:95], v[76:79], v[156:159]
ds_read_b64_tr_b16 v[58:59], v201 offset:1536
buffer_load_dwordx4 v227, s[16:19], s40 offen offset:3072 lds
s_add_u32 s40, s40, 128
v_mfma_f32_16x16x32_bf16 v[148:151], v[92:95], v[72:75], v[148:151]
ds_read_b64_tr_b16 v[88:89], v201 offset:8704
v_mfma_f32_16x16x32_bf16 v[148:151], v[60:63], v[40:43], v[148:151]
s_setprio 0
s_waitcnt lgkmcnt(14)
ds_read_b64_tr_b16 v[90:91], v201 offset:9728
s_waitcnt lgkmcnt(10)
v_mfma_f32_16x16x32_bf16 v[96:99], v[48:51], v[32:35], v[96:99]
s_setprio 1
ds_read_b64_tr_b16 v[60:61], v201 offset:768
s_add_u32 m0, s41, 49152
s_waitcnt lgkmcnt(9)
v_mfma_f32_16x16x32_bf16 v[96:99], v[80:83], v[64:67], v[96:99]
ds_read_b64_tr_b16 v[62:63], v201 offset:1792
buffer_load_dwordx4 v228, s[20:23], s44 offen offset:0 lds
v_mfma_f32_16x16x32_bf16 v[104:107], v[80:83], v[68:71], v[104:107]
ds_read_b64_tr_b16 v[92:93], v201 offset:8960
v_mfma_f32_16x16x32_bf16 v[104:107], v[48:51], v[36:39], v[104:107]
s_setprio 0
ds_read_b64_tr_b16 v[94:95], v201 offset:9984
s_waitcnt lgkmcnt(10)
v_mfma_f32_16x16x32_bf16 v[108:111], v[52:55], v[36:39], v[108:111]
s_setprio 1
ds_read_b128 v[44:47], v232 offset:6144
s_waitcnt lgkmcnt(9)
v_mfma_f32_16x16x32_bf16 v[108:111], v[84:87], v[68:71], v[108:111]
ds_read_b128 v[76:79], v233 offset:6144
buffer_load_dwordx4 v228, s[20:23], s44 offen offset:1024 lds
v_mfma_f32_16x16x32_bf16 v[100:103], v[84:87], v[64:67], v[100:103]
ds_read_b128 v[40:43], v232 offset:4096
v_mfma_f32_16x16x32_bf16 v[100:103], v[52:55], v[32:35], v[100:103]
s_setprio 0
ds_read_b128 v[72:75], v233 offset:4096
v_smfmac_f32_16x16x64_bf16 v[234:237], v[204:207], v[48:55], v202
s_waitcnt lgkmcnt(10)
v_mfma_f32_16x16x32_bf16 v[128:131], v[56:59], v[32:35], v[128:131]
s_setprio 1
s_waitcnt lgkmcnt(8)
v_mfma_f32_16x16x32_bf16 v[128:131], v[88:91], v[64:67], v[128:131]
buffer_load_dwordx4 v228, s[20:23], s44 offen offset:2048 lds
v_mfma_f32_16x16x32_bf16 v[136:139], v[88:91], v[68:71], v[136:139]
v_mfma_f32_16x16x32_bf16 v[136:139], v[56:59], v[36:39], v[136:139]
s_setprio 0
v_smfmac_f32_16x16x64_bf16 v[234:237], v[204:207], v[80:87], v202
s_waitcnt lgkmcnt(6)
v_mfma_f32_16x16x32_bf16 v[140:143], v[60:63], v[36:39], v[140:143]
s_setprio 1
s_waitcnt lgkmcnt(4)
v_mfma_f32_16x16x32_bf16 v[140:143], v[92:95], v[68:71], v[140:143]
buffer_load_dwordx4 v228, s[20:23], s44 offen offset:3072 lds
s_add_u32 s44, s44, 4096
v_mfma_f32_16x16x32_bf16 v[132:135], v[92:95], v[64:67], v[132:135]
v_mfma_f32_16x16x32_bf16 v[132:135], v[60:63], v[32:35], v[132:135]
s_setprio 0
s_waitcnt vmcnt(16) lgkmcnt(0)
s_barrier
s_add_u32 m0, s41, 65536
v_mfma_f32_16x16x32_bf16 v[112:115], v[48:51], v[40:43], v[112:115]
s_setprio 1
ds_read_b128 v[36:39], v232 offset:34816
v_mfma_f32_16x16x32_bf16 v[112:115], v[80:83], v[72:75], v[112:115]
v_smfmac_f32_16x16x64_bf16 v[250:253], v[204:207], v[56:63], v202
ds_read_b128 v[68:71], v233 offset:34816
buffer_load_dwordx4 v224, s[16:19], s40 offen offset:0 lds
v_mfma_f32_16x16x32_bf16 v[120:123], v[80:83], v[76:79], v[120:123]
ds_read_b128 v[32:35], v232 offset:32768
v_mfma_f32_16x16x32_bf16 v[120:123], v[48:51], v[44:47], v[120:123]
s_setprio 0
ds_read_b128 v[64:67], v233 offset:32768
v_mfma_f32_16x16x32_bf16 v[124:127], v[52:55], v[44:47], v[124:127]
s_setprio 1
ds_read_b64_tr_b16 v[48:49], v201 offset:32768
v_mfma_f32_16x16x32_bf16 v[124:127], v[84:87], v[76:79], v[124:127]
v_smfmac_f32_16x16x64_bf16 v[250:253], v[204:207], v[88:95], v202
ds_read_b64_tr_b16 v[50:51], v201 offset:33792
buffer_load_dwordx4 v225, s[16:19], s40 offen offset:1024 lds
v_mfma_f32_16x16x32_bf16 v[116:119], v[84:87], v[72:75], v[116:119]
ds_read_b64_tr_b16 v[80:81], v201 offset:40960
v_mfma_f32_16x16x32_bf16 v[116:119], v[52:55], v[40:43], v[116:119]
s_setprio 0
ds_read_b64_tr_b16 v[82:83], v201 offset:41984
v_mfma_f32_16x16x32_bf16 v[144:147], v[56:59], v[40:43], v[144:147]
s_setprio 1
ds_read_b64_tr_b16 v[52:53], v201 offset:33024
v_mfma_f32_16x16x32_bf16 v[144:147], v[88:91], v[72:75], v[144:147]
ds_read_b64_tr_b16 v[54:55], v201 offset:34048
buffer_load_dwordx4 v226, s[16:19], s40 offen offset:2048 lds
v_mfma_f32_16x16x32_bf16 v[152:155], v[88:91], v[76:79], v[152:155]
ds_read_b64_tr_b16 v[84:85], v201 offset:41216
v_mfma_f32_16x16x32_bf16 v[152:155], v[56:59], v[44:47], v[152:155]
s_setprio 0
ds_read_b64_tr_b16 v[86:87], v201 offset:42240
v_mfma_f32_16x16x32_bf16 v[156:159], v[60:63], v[44:47], v[156:159]
s_setprio 1
ds_read_b64_tr_b16 v[56:57], v201 offset:33280
v_mfma_f32_16x16x32_bf16 v[156:159], v[92:95], v[76:79], v[156:159]
ds_read_b64_tr_b16 v[58:59], v201 offset:34304
buffer_load_dwordx4 v227, s[16:19], s40 offen offset:3072 lds
s_add_u32 s40, s40, 128
v_mfma_f32_16x16x32_bf16 v[148:151], v[92:95], v[72:75], v[148:151]
ds_read_b64_tr_b16 v[88:89], v201 offset:41472
v_mfma_f32_16x16x32_bf16 v[148:151], v[60:63], v[40:43], v[148:151]
s_setprio 0
s_waitcnt lgkmcnt(14)
ds_read_b64_tr_b16 v[90:91], v201 offset:42496
s_waitcnt lgkmcnt(10)
v_mfma_f32_16x16x32_bf16 v[96:99], v[48:51], v[32:35], v[96:99]
s_setprio 1
ds_read_b64_tr_b16 v[60:61], v201 offset:33536
s_add_u32 m0, s41, 81920
s_waitcnt lgkmcnt(9)
v_mfma_f32_16x16x32_bf16 v[96:99], v[80:83], v[64:67], v[96:99]
ds_read_b64_tr_b16 v[62:63], v201 offset:34560
buffer_load_dwordx4 v228, s[20:23], s44 offen offset:0 lds
v_mfma_f32_16x16x32_bf16 v[104:107], v[80:83], v[68:71], v[104:107]
ds_read_b64_tr_b16 v[92:93], v201 offset:41728
v_mfma_f32_16x16x32_bf16 v[104:107], v[48:51], v[36:39], v[104:107]
s_setprio 0
ds_read_b64_tr_b16 v[94:95], v201 offset:42752
s_waitcnt lgkmcnt(10)
v_mfma_f32_16x16x32_bf16 v[108:111], v[52:55], v[36:39], v[108:111]
s_setprio 1
ds_read_b128 v[44:47], v232 offset:38912
s_waitcnt lgkmcnt(9)
v_mfma_f32_16x16x32_bf16 v[108:111], v[84:87], v[68:71], v[108:111]
ds_read_b128 v[76:79], v233 offset:38912
buffer_load_dwordx4 v228, s[20:23], s44 offen offset:1024 lds
v_mfma_f32_16x16x32_bf16 v[100:103], v[84:87], v[64:67], v[100:103]
ds_read_b128 v[40:43], v232 offset:36864
v_mfma_f32_16x16x32_bf16 v[100:103], v[52:55], v[32:35], v[100:103]
s_setprio 0
ds_read_b128 v[72:75], v233 offset:36864
v_smfmac_f32_16x16x64_bf16 v[234:237], v[204:207], v[48:55], v202
s_waitcnt lgkmcnt(10)
v_mfma_f32_16x16x32_bf16 v[128:131], v[56:59], v[32:35], v[128:131]
s_setprio 1
s_waitcnt lgkmcnt(8)
v_mfma_f32_16x16x32_bf16 v[128:131], v[88:91], v[64:67], v[128:131]
buffer_load_dwordx4 v228, s[20:23], s44 offen offset:2048 lds
v_mfma_f32_16x16x32_bf16 v[136:139], v[88:91], v[68:71], v[136:139]
v_mfma_f32_16x16x32_bf16 v[136:139], v[56:59], v[36:39], v[136:139]
s_setprio 0
v_smfmac_f32_16x16x64_bf16 v[234:237], v[204:207], v[80:87], v202
s_waitcnt lgkmcnt(6)
v_mfma_f32_16x16x32_bf16 v[140:143], v[60:63], v[36:39], v[140:143]
s_setprio 1
s_waitcnt lgkmcnt(4)
v_mfma_f32_16x16x32_bf16 v[140:143], v[92:95], v[68:71], v[140:143]
buffer_load_dwordx4 v228, s[20:23], s44 offen offset:3072 lds
s_add_u32 s44, s44, 4096
v_mfma_f32_16x16x32_bf16 v[132:135], v[92:95], v[64:67], v[132:135]
v_mfma_f32_16x16x32_bf16 v[132:135], v[60:63], v[32:35], v[132:135]
s_setprio 0
s_waitcnt lgkmcnt(0)
s_barrier
s_add_u32 m0, s41, 98304
v_mfma_f32_16x16x32_bf16 v[112:115], v[48:51], v[40:43], v[112:115]
s_setprio 1
v_mfma_f32_16x16x32_bf16 v[112:115], v[80:83], v[72:75], v[112:115]
v_smfmac_f32_16x16x64_bf16 v[250:253], v[204:207], v[56:63], v202
buffer_load_dwordx4 v224, s[16:19], s40 offen offset:0 lds
v_mfma_f32_16x16x32_bf16 v[120:123], v[80:83], v[76:79], v[120:123]
v_mfma_f32_16x16x32_bf16 v[120:123], v[48:51], v[44:47], v[120:123]
s_setprio 0
v_mfma_f32_16x16x32_bf16 v[124:127], v[52:55], v[44:47], v[124:127]
s_setprio 1
v_mfma_f32_16x16x32_bf16 v[124:127], v[84:87], v[76:79], v[124:127]
v_smfmac_f32_16x16x64_bf16 v[250:253], v[204:207], v[88:95], v202
buffer_load_dwordx4 v225, s[16:19], s40 offen offset:1024 lds
v_mfma_f32_16x16x32_bf16 v[116:119], v[84:87], v[72:75], v[116:119]
v_mfma_f32_16x16x32_bf16 v[116:119], v[52:55], v[40:43], v[116:119]
s_setprio 0
v_mfma_f32_16x16x32_bf16 v[144:147], v[56:59], v[40:43], v[144:147]
s_setprio 1
v_mfma_f32_16x16x32_bf16 v[144:147], v[88:91], v[72:75], v[144:147]
buffer_load_dwordx4 v226, s[16:19], s40 offen offset:2048 lds
v_mfma_f32_16x16x32_bf16 v[152:155], v[88:91], v[76:79], v[152:155]
v_mfma_f32_16x16x32_bf16 v[152:155], v[56:59], v[44:47], v[152:155]
s_setprio 0
v_mfma_f32_16x16x32_bf16 v[156:159], v[60:63], v[44:47], v[156:159]
s_setprio 1
v_mfma_f32_16x16x32_bf16 v[156:159], v[92:95], v[76:79], v[156:159]
buffer_load_dwordx4 v227, s[16:19], s40 offen offset:3072 lds
s_add_u32 s40, s40, 128
v_mfma_f32_16x16x32_bf16 v[148:151], v[92:95], v[72:75], v[148:151]
v_mfma_f32_16x16x32_bf16 v[148:151], v[60:63], v[40:43], v[148:151]
s_setprio 0
s_nop 7
v_bfe_u32 v1, v0, 4, 1
v_cmp_eq_u32 vcc, 0, v1
v_lshrrev_b32 v1, 4, v0
v_lshlrev_b32 v1, 4, v1
v_add_f32 v234, v234, v235
v_add_f32 v236, v236, v237
v_cndmask_b32 v234, v236, v234, vcc
v_add_f32 v250, v250, v251
v_add_f32 v252, v252, v253
v_cndmask_b32 v250, v252, v250, vcc
ds_bpermute_b32 v12, v1, v234 offset:0
ds_bpermute_b32 v13, v1, v234 offset:4
ds_bpermute_b32 v14, v1, v234 offset:8
ds_bpermute_b32 v15, v1, v234 offset:12
ds_bpermute_b32 v16, v1, v234 offset:64
ds_bpermute_b32 v17, v1, v234 offset:68
ds_bpermute_b32 v18, v1, v234 offset:72
ds_bpermute_b32 v19, v1, v234 offset:76
ds_bpermute_b32 v20, v1, v250 offset:0
ds_bpermute_b32 v21, v1, v250 offset:4
ds_bpermute_b32 v22, v1, v250 offset:8
ds_bpermute_b32 v23, v1, v250 offset:12
ds_bpermute_b32 v24, v1, v250 offset:64
ds_bpermute_b32 v25, v1, v250 offset:68
ds_bpermute_b32 v26, v1, v250 offset:72
s_waitcnt lgkmcnt(14)
ds_bpermute_b32 v27, v1, v250 offset:76
v_fmac_f32 v96, v12, v2
s_waitcnt lgkmcnt(14)
v_fmac_f32 v97, v13, v2
s_waitcnt lgkmcnt(13)
v_fmac_f32 v98, v14, v2
s_waitcnt lgkmcnt(12)
v_fmac_f32 v99, v15, v2
v_fmac_f32 v104, v12, v4
v_fmac_f32 v105, v13, v4
v_fmac_f32 v106, v14, v4
v_fmac_f32 v107, v15, v4
v_fmac_f32 v112, v12, v6
v_fmac_f32 v113, v13, v6
v_fmac_f32 v114, v14, v6
v_fmac_f32 v115, v15, v6
v_fmac_f32 v120, v12, v8
v_fmac_f32 v121, v13, v8
v_fmac_f32 v122, v14, v8
v_fmac_f32 v123, v15, v8
v_mul_f32 v96, v96, v28
v_mul_f32 v97, v97, v28
v_mul_f32 v98, v98, v28
v_mul_f32 v99, v99, v28
v_mul_f32 v104, v104, v30
v_mul_f32 v105, v105, v30
v_mul_f32 v106, v106, v30
v_mul_f32 v107, v107, v30
v_mul_f32 v112, v112, v254
v_mul_f32 v113, v113, v254
v_mul_f32 v114, v114, v254
v_mul_f32 v115, v115, v254
v_mul_f32 v120, v120, v10
v_mul_f32 v121, v121, v10
v_mul_f32 v122, v122, v10
v_mul_f32 v123, v123, v10
s_waitcnt lgkmcnt(11)
v_fmac_f32 v100, v16, v2
s_waitcnt lgkmcnt(10)
v_fmac_f32 v101, v17, v2
s_waitcnt lgkmcnt(9)
v_fmac_f32 v102, v18, v2
s_waitcnt lgkmcnt(8)
v_fmac_f32 v103, v19, v2
v_fmac_f32 v108, v16, v4
v_fmac_f32 v109, v17, v4
v_fmac_f32 v110, v18, v4
v_fmac_f32 v111, v19, v4
v_fmac_f32 v116, v16, v6
v_fmac_f32 v117, v17, v6
v_fmac_f32 v118, v18, v6
v_fmac_f32 v119, v19, v6
v_fmac_f32 v124, v16, v8
v_fmac_f32 v125, v17, v8
v_fmac_f32 v126, v18, v8
v_fmac_f32 v127, v19, v8
v_mul_f32 v100, v100, v28
v_mul_f32 v101, v101, v28
v_mul_f32 v102, v102, v28
v_mul_f32 v103, v103, v28
v_mul_f32 v108, v108, v30
v_mul_f32 v109, v109, v30
v_mul_f32 v110, v110, v30
v_mul_f32 v111, v111, v30
v_mul_f32 v116, v116, v254
v_mul_f32 v117, v117, v254
v_mul_f32 v118, v118, v254
v_mul_f32 v119, v119, v254
v_mul_f32 v124, v124, v10
v_mul_f32 v125, v125, v10
v_mul_f32 v126, v126, v10
v_mul_f32 v127, v127, v10
s_waitcnt lgkmcnt(7)
v_fmac_f32 v128, v20, v2
s_waitcnt lgkmcnt(6)
v_fmac_f32 v129, v21, v2
s_waitcnt lgkmcnt(5)
v_fmac_f32 v130, v22, v2
s_waitcnt lgkmcnt(4)
v_fmac_f32 v131, v23, v2
v_fmac_f32 v136, v20, v4
v_fmac_f32 v137, v21, v4
v_fmac_f32 v138, v22, v4
v_fmac_f32 v139, v23, v4
v_fmac_f32 v144, v20, v6
v_fmac_f32 v145, v21, v6
v_fmac_f32 v146, v22, v6
v_fmac_f32 v147, v23, v6
v_fmac_f32 v152, v20, v8
v_fmac_f32 v153, v21, v8
v_fmac_f32 v154, v22, v8
v_fmac_f32 v155, v23, v8
v_mul_f32 v128, v128, v28
v_mul_f32 v129, v129, v28
v_mul_f32 v130, v130, v28
v_mul_f32 v131, v131, v28
v_mul_f32 v136, v136, v30
v_mul_f32 v137, v137, v30
v_mul_f32 v138, v138, v30
v_mul_f32 v139, v139, v30
v_mul_f32 v144, v144, v254
v_mul_f32 v145, v145, v254
v_mul_f32 v146, v146, v254
v_mul_f32 v147, v147, v254
v_mul_f32 v152, v152, v10
v_mul_f32 v153, v153, v10
v_mul_f32 v154, v154, v10
v_mul_f32 v155, v155, v10
s_waitcnt lgkmcnt(3)
v_fmac_f32 v132, v24, v2
s_waitcnt lgkmcnt(2)
v_fmac_f32 v133, v25, v2
s_waitcnt lgkmcnt(1)
v_fmac_f32 v134, v26, v2
s_waitcnt lgkmcnt(0)
v_fmac_f32 v135, v27, v2
v_fmac_f32 v140, v24, v4
v_fmac_f32 v141, v25, v4
v_fmac_f32 v142, v26, v4
v_fmac_f32 v143, v27, v4
v_fmac_f32 v148, v24, v6
v_fmac_f32 v149, v25, v6
v_fmac_f32 v150, v26, v6
v_fmac_f32 v151, v27, v6
v_fmac_f32 v156, v24, v8
v_fmac_f32 v157, v25, v8
v_fmac_f32 v158, v26, v8
v_fmac_f32 v159, v27, v8
v_mul_f32 v132, v132, v28
v_mul_f32 v133, v133, v28
v_mul_f32 v134, v134, v28
v_mul_f32 v135, v135, v28
v_mul_f32 v140, v140, v30
v_mul_f32 v141, v141, v30
v_mul_f32 v142, v142, v30
v_mul_f32 v143, v143, v30
v_mul_f32 v148, v148, v254
v_mul_f32 v149, v149, v254
v_mul_f32 v150, v150, v254
v_mul_f32 v151, v151, v254
v_mul_f32 v156, v156, v10
v_mul_f32 v157, v157, v10
v_mul_f32 v158, v158, v10
v_mul_f32 v159, v159, v10
s_waitcnt vmcnt(20)
s_barrier
ds_read_b128 v[36:39], v230 offset:2048
ds_read_b128 v[68:71], v231 offset:2048
ds_read_b128 v[32:35], v230 offset:0
ds_read_b128 v[64:67], v231 offset:0
ds_read_b64_tr_b16 v[48:49], v238 offset:0
ds_read_b64_tr_b16 v[50:51], v239 offset:0
ds_read_b64_tr_b16 v[80:81], v238 offset:2048
ds_read_b64_tr_b16 v[82:83], v239 offset:2048
ds_read_b64_tr_b16 v[52:53], v238 offset:512
ds_read_b64_tr_b16 v[54:55], v239 offset:512
ds_read_b64_tr_b16 v[84:85], v238 offset:2560
ds_read_b64_tr_b16 v[86:87], v239 offset:2560
ds_read_b64_tr_b16 v[56:57], v238 offset:4096
ds_read_b64_tr_b16 v[58:59], v239 offset:4096
ds_read_b64_tr_b16 v[88:89], v238 offset:6144
s_waitcnt lgkmcnt(14)
ds_read_b64_tr_b16 v[90:91], v239 offset:6144
s_waitcnt lgkmcnt(10)
v_mfma_f32_16x16x32_bf16 v[160:163], v[48:51], v[32:35], 0
s_setprio 1
ds_read_b64_tr_b16 v[60:61], v238 offset:4608
s_add_u32 m0, s41, 114688
s_waitcnt lgkmcnt(9)
v_mfma_f32_16x16x32_bf16 v[160:163], v[80:83], v[64:67], v[160:163]
ds_read_b64_tr_b16 v[62:63], v239 offset:4608
buffer_load_dwordx4 v228, s[20:23], s44 offen offset:0 lds
v_mfma_f32_16x16x32_bf16 v[168:171], v[80:83], v[68:71], 0
ds_read_b64_tr_b16 v[92:93], v238 offset:6656
v_mfma_f32_16x16x32_bf16 v[168:171], v[48:51], v[36:39], v[168:171]
s_setprio 0
ds_read_b64_tr_b16 v[94:95], v239 offset:6656
s_waitcnt lgkmcnt(10)
v_mfma_f32_16x16x32_bf16 v[172:175], v[52:55], v[36:39], 0
s_setprio 1
ds_read_b128 v[44:47], v230 offset:6144
s_waitcnt lgkmcnt(9)
v_mfma_f32_16x16x32_bf16 v[172:175], v[84:87], v[68:71], v[172:175]
ds_read_b128 v[76:79], v231 offset:6144
buffer_load_dwordx4 v228, s[20:23], s44 offen offset:1024 lds
v_mfma_f32_16x16x32_bf16 v[164:167], v[84:87], v[64:67], 0
ds_read_b128 v[40:43], v230 offset:4096
v_mfma_f32_16x16x32_bf16 v[164:167], v[52:55], v[32:35], v[164:167]
s_setprio 0
ds_read_b128 v[72:75], v231 offset:4096
s_waitcnt lgkmcnt(10)
v_mfma_f32_16x16x32_bf16 v[192:195], v[56:59], v[32:35], 0
s_setprio 1
s_waitcnt lgkmcnt(8)
v_mfma_f32_16x16x32_bf16 v[192:195], v[88:91], v[64:67], v[192:195]
buffer_load_dwordx4 v228, s[20:23], s44 offen offset:2048 lds
v_mfma_f32_16x16x32_bf16 v[200:203], v[88:91], v[68:71], 0
v_mfma_f32_16x16x32_bf16 v[200:203], v[56:59], v[36:39], v[200:203]
s_setprio 0
s_waitcnt lgkmcnt(6)
v_mfma_f32_16x16x32_bf16 v[204:207], v[60:63], v[36:39], 0
s_setprio 1
s_waitcnt lgkmcnt(4)
v_mfma_f32_16x16x32_bf16 v[204:207], v[92:95], v[68:71], v[204:207]
buffer_load_dwordx4 v228, s[20:23], s44 offen offset:3072 lds
s_add_u32 s44, s44, 4096
v_mfma_f32_16x16x32_bf16 v[196:199], v[92:95], v[64:67], 0
v_mfma_f32_16x16x32_bf16 v[196:199], v[60:63], v[32:35], v[196:199]
s_setprio 0
s_waitcnt vmcnt(16) lgkmcnt(0)
s_barrier
s_add_u32 m0, s41, 0
v_mfma_f32_16x16x32_bf16 v[176:179], v[48:51], v[40:43], 0
s_setprio 1
ds_read_b128 v[36:39], v230 offset:34816
v_mfma_f32_16x16x32_bf16 v[176:179], v[80:83], v[72:75], v[176:179]
ds_read_b128 v[68:71], v231 offset:34816
buffer_load_dwordx4 v224, s[16:19], s40 offen offset:0 lds
v_mfma_f32_16x16x32_bf16 v[184:187], v[80:83], v[76:79], 0
ds_read_b128 v[32:35], v230 offset:32768
v_mfma_f32_16x16x32_bf16 v[184:187], v[48:51], v[44:47], v[184:187]
s_setprio 0
ds_read_b128 v[64:67], v231 offset:32768
v_mfma_f32_16x16x32_bf16 v[188:191], v[52:55], v[44:47], 0
s_setprio 1
ds_read_b64_tr_b16 v[48:49], v238 offset:32768
v_mfma_f32_16x16x32_bf16 v[188:191], v[84:87], v[76:79], v[188:191]
ds_read_b64_tr_b16 v[50:51], v239 offset:32768
buffer_load_dwordx4 v225, s[16:19], s40 offen offset:1024 lds
v_mfma_f32_16x16x32_bf16 v[180:183], v[84:87], v[72:75], 0
ds_read_b64_tr_b16 v[80:81], v238 offset:34816
v_mfma_f32_16x16x32_bf16 v[180:183], v[52:55], v[40:43], v[180:183]
s_setprio 0
ds_read_b64_tr_b16 v[82:83], v239 offset:34816
v_mfma_f32_16x16x32_bf16 v[208:211], v[56:59], v[40:43], 0
s_setprio 1
ds_read_b64_tr_b16 v[52:53], v238 offset:33280
v_mfma_f32_16x16x32_bf16 v[208:211], v[88:91], v[72:75], v[208:211]
ds_read_b64_tr_b16 v[54:55], v239 offset:33280
buffer_load_dwordx4 v226, s[16:19], s40 offen offset:2048 lds
v_mfma_f32_16x16x32_bf16 v[216:219], v[88:91], v[76:79], 0
ds_read_b64_tr_b16 v[84:85], v238 offset:35328
v_mfma_f32_16x16x32_bf16 v[216:219], v[56:59], v[44:47], v[216:219]
s_setprio 0
ds_read_b64_tr_b16 v[86:87], v239 offset:35328
v_mfma_f32_16x16x32_bf16 v[220:223], v[60:63], v[44:47], 0
s_setprio 1
ds_read_b64_tr_b16 v[56:57], v238 offset:36864
v_mfma_f32_16x16x32_bf16 v[220:223], v[92:95], v[76:79], v[220:223]
ds_read_b64_tr_b16 v[58:59], v239 offset:36864
buffer_load_dwordx4 v227, s[16:19], s40 offen offset:3072 lds
s_add_u32 s40, s40, 128
v_mfma_f32_16x16x32_bf16 v[212:215], v[92:95], v[72:75], 0
ds_read_b64_tr_b16 v[88:89], v238 offset:38912
v_mfma_f32_16x16x32_bf16 v[212:215], v[60:63], v[40:43], v[212:215]
s_setprio 0
s_waitcnt lgkmcnt(14)
ds_read_b64_tr_b16 v[90:91], v239 offset:38912
s_waitcnt lgkmcnt(10)
v_mfma_f32_16x16x32_bf16 v[160:163], v[48:51], v[32:35], v[160:163]
s_setprio 1
ds_read_b64_tr_b16 v[60:61], v238 offset:37376
s_add_u32 m0, s41, 16384
s_waitcnt lgkmcnt(9)
v_mfma_f32_16x16x32_bf16 v[160:163], v[80:83], v[64:67], v[160:163]
ds_read_b64_tr_b16 v[62:63], v239 offset:37376
buffer_load_dwordx4 v228, s[20:23], s44 offen offset:0 lds
v_mfma_f32_16x16x32_bf16 v[168:171], v[80:83], v[68:71], v[168:171]
ds_read_b64_tr_b16 v[92:93], v238 offset:39424
v_mfma_f32_16x16x32_bf16 v[168:171], v[48:51], v[36:39], v[168:171]
s_setprio 0
ds_read_b64_tr_b16 v[94:95], v239 offset:39424
s_waitcnt lgkmcnt(10)
v_mfma_f32_16x16x32_bf16 v[172:175], v[52:55], v[36:39], v[172:175]
s_setprio 1
ds_read_b128 v[44:47], v230 offset:38912
s_waitcnt lgkmcnt(9)
v_mfma_f32_16x16x32_bf16 v[172:175], v[84:87], v[68:71], v[172:175]
ds_read_b128 v[76:79], v231 offset:38912
buffer_load_dwordx4 v228, s[20:23], s44 offen offset:1024 lds
v_mfma_f32_16x16x32_bf16 v[164:167], v[84:87], v[64:67], v[164:167]
ds_read_b128 v[40:43], v230 offset:36864
v_mfma_f32_16x16x32_bf16 v[164:167], v[52:55], v[32:35], v[164:167]
s_setprio 0
ds_read_b128 v[72:75], v231 offset:36864
s_waitcnt lgkmcnt(10)
v_mfma_f32_16x16x32_bf16 v[192:195], v[56:59], v[32:35], v[192:195]
s_setprio 1
s_waitcnt lgkmcnt(8)
v_mfma_f32_16x16x32_bf16 v[192:195], v[88:91], v[64:67], v[192:195]
buffer_load_dwordx4 v228, s[20:23], s44 offen offset:2048 lds
v_mfma_f32_16x16x32_bf16 v[200:203], v[88:91], v[68:71], v[200:203]
v_mfma_f32_16x16x32_bf16 v[200:203], v[56:59], v[36:39], v[200:203]
s_setprio 0
s_waitcnt lgkmcnt(6)
v_mfma_f32_16x16x32_bf16 v[204:207], v[60:63], v[36:39], v[204:207]
s_setprio 1
s_waitcnt lgkmcnt(4)
v_mfma_f32_16x16x32_bf16 v[204:207], v[92:95], v[68:71], v[204:207]
buffer_load_dwordx4 v228, s[20:23], s44 offen offset:3072 lds
s_add_u32 s44, s44, 4096
v_mfma_f32_16x16x32_bf16 v[196:199], v[92:95], v[64:67], v[196:199]
v_mfma_f32_16x16x32_bf16 v[196:199], v[60:63], v[32:35], v[196:199]
s_setprio 0
s_waitcnt vmcnt(16) lgkmcnt(0)
s_barrier
s_add_u32 m0, s41, 32768
v_mfma_f32_16x16x32_bf16 v[176:179], v[48:51], v[40:43], v[176:179]
s_setprio 1
ds_read_b128 v[36:39], v232 offset:2048
v_mfma_f32_16x16x32_bf16 v[176:179], v[80:83], v[72:75], v[176:179]
ds_read_b128 v[68:71], v233 offset:2048
buffer_load_dwordx4 v224, s[16:19], s40 offen offset:0 lds
v_mfma_f32_16x16x32_bf16 v[184:187], v[80:83], v[76:79], v[184:187]
ds_read_b128 v[32:35], v232 offset:0
v_mfma_f32_16x16x32_bf16 v[184:187], v[48:51], v[44:47], v[184:187]
s_setprio 0
ds_read_b128 v[64:67], v233 offset:0
v_mfma_f32_16x16x32_bf16 v[188:191], v[52:55], v[44:47], v[188:191]
s_setprio 1
ds_read_b64_tr_b16 v[48:49], v240 offset:0
v_mfma_f32_16x16x32_bf16 v[188:191], v[84:87], v[76:79], v[188:191]
ds_read_b64_tr_b16 v[50:51], v241 offset:0
buffer_load_dwordx4 v225, s[16:19], s40 offen offset:1024 lds
v_mfma_f32_16x16x32_bf16 v[180:183], v[84:87], v[72:75], v[180:183]
ds_read_b64_tr_b16 v[80:81], v240 offset:2048
v_mfma_f32_16x16x32_bf16 v[180:183], v[52:55], v[40:43], v[180:183]
s_setprio 0
ds_read_b64_tr_b16 v[82:83], v241 offset:2048
v_mfma_f32_16x16x32_bf16 v[208:211], v[56:59], v[40:43], v[208:211]
s_setprio 1
ds_read_b64_tr_b16 v[52:53], v240 offset:512
v_mfma_f32_16x16x32_bf16 v[208:211], v[88:91], v[72:75], v[208:211]
ds_read_b64_tr_b16 v[54:55], v241 offset:512
buffer_load_dwordx4 v226, s[16:19], s40 offen offset:2048 lds
v_mfma_f32_16x16x32_bf16 v[216:219], v[88:91], v[76:79], v[216:219]
ds_read_b64_tr_b16 v[84:85], v240 offset:2560
v_mfma_f32_16x16x32_bf16 v[216:219], v[56:59], v[44:47], v[216:219]
s_setprio 0
ds_read_b64_tr_b16 v[86:87], v241 offset:2560
v_mfma_f32_16x16x32_bf16 v[220:223], v[60:63], v[44:47], v[220:223]
s_setprio 1
ds_read_b64_tr_b16 v[56:57], v240 offset:4096
v_mfma_f32_16x16x32_bf16 v[220:223], v[92:95], v[76:79], v[220:223]
ds_read_b64_tr_b16 v[58:59], v241 offset:4096
buffer_load_dwordx4 v227, s[16:19], s40 offen offset:3072 lds
s_add_u32 s40, s40, 128
v_mfma_f32_16x16x32_bf16 v[212:215], v[92:95], v[72:75], v[212:215]
ds_read_b64_tr_b16 v[88:89], v240 offset:6144
v_mfma_f32_16x16x32_bf16 v[212:215], v[60:63], v[40:43], v[212:215]
s_setprio 0
s_waitcnt lgkmcnt(14)
ds_read_b64_tr_b16 v[90:91], v241 offset:6144
s_waitcnt lgkmcnt(10)
v_mfma_f32_16x16x32_bf16 v[160:163], v[48:51], v[32:35], v[160:163]
s_setprio 1
ds_read_b64_tr_b16 v[60:61], v240 offset:4608
s_add_u32 m0, s41, 49152
v_mov_b32 v2, 0xc0135761
s_waitcnt lgkmcnt(9)
v_mfma_f32_16x16x32_bf16 v[160:163], v[80:83], v[64:67], v[160:163]
ds_read_b64_tr_b16 v[62:63], v241 offset:4608
buffer_load_dwordx4 v228, s[20:23], s44 offen offset:0 lds
v_mov_b32 v3, v2
v_mfma_f32_16x16x32_bf16 v[168:171], v[80:83], v[68:71], v[168:171]
ds_read_b64_tr_b16 v[92:93], v240 offset:6656
v_mfma_f32_16x16x32_bf16 v[168:171], v[48:51], v[36:39], v[168:171]
s_setprio 0
ds_read_b64_tr_b16 v[94:95], v241 offset:6656
s_mov_b32 s28, 0xbdd2d3e8
s_waitcnt lgkmcnt(10)
v_mfma_f32_16x16x32_bf16 v[172:175], v[52:55], v[36:39], v[172:175]
s_setprio 1
ds_read_b128 v[44:47], v232 offset:6144
s_waitcnt lgkmcnt(9)
v_mfma_f32_16x16x32_bf16 v[172:175], v[84:87], v[68:71], v[172:175]
ds_read_b128 v[76:79], v233 offset:6144
buffer_load_dwordx4 v228, s[20:23], s44 offen offset:1024 lds
s_mov_b32 s29, s28
v_mfma_f32_16x16x32_bf16 v[164:167], v[84:87], v[64:67], v[164:167]
ds_read_b128 v[40:43], v232 offset:4096
v_mfma_f32_16x16x32_bf16 v[164:167], v[52:55], v[32:35], v[164:167]
s_setprio 0
ds_read_b128 v[72:75], v233 offset:4096
v_mul_f32 v12, v96, v96
s_waitcnt lgkmcnt(10)
v_mfma_f32_16x16x32_bf16 v[192:195], v[56:59], v[32:35], v[192:195]
s_setprio 1
v_mul_f32 v13, v97, v97
s_waitcnt lgkmcnt(8)
v_mfma_f32_16x16x32_bf16 v[192:195], v[88:91], v[64:67], v[192:195]
buffer_load_dwordx4 v228, s[20:23], s44 offen offset:2048 lds
v_mfma_f32_16x16x32_bf16 v[200:203], v[88:91], v[68:71], v[200:203]
v_fma_f32 v12, v12, s28, v2
v_mfma_f32_16x16x32_bf16 v[200:203], v[56:59], v[36:39], v[200:203]
s_setprio 0
s_waitcnt lgkmcnt(6)
v_mfma_f32_16x16x32_bf16 v[204:207], v[60:63], v[36:39], v[204:207]
s_setprio 1
v_mul_f32 v14, v98, v98
s_waitcnt lgkmcnt(4)
v_mfma_f32_16x16x32_bf16 v[204:207], v[92:95], v[68:71], v[204:207]
buffer_load_dwordx4 v228, s[20:23], s44 offen offset:3072 lds
s_add_u32 s44, s44, 4096
v_mfma_f32_16x16x32_bf16 v[196:199], v[92:95], v[64:67], v[196:199]
v_fma_f32 v13, v13, s28, v2
v_mfma_f32_16x16x32_bf16 v[196:199], v[60:63], v[32:35], v[196:199]
s_setprio 0
s_waitcnt vmcnt(16) lgkmcnt(0)
s_barrier
s_add_u32 m0, s41, 65536
v_mfma_f32_16x16x32_bf16 v[176:179], v[48:51], v[40:43], v[176:179]
s_setprio 1
ds_read_b128 v[36:39], v232 offset:34816
v_mul_f32 v12, v12, v96
v_mfma_f32_16x16x32_bf16 v[176:179], v[80:83], v[72:75], v[176:179]
ds_read_b128 v[68:71], v233 offset:34816
buffer_load_dwordx4 v224, s[16:19], s40 offen offset:0 lds
v_mul_f32 v15, v99, v99
v_mfma_f32_16x16x32_bf16 v[184:187], v[80:83], v[76:79], v[184:187]
ds_read_b128 v[32:35], v232 offset:32768
v_mfma_f32_16x16x32_bf16 v[184:187], v[48:51], v[44:47], v[184:187]
s_setprio 0
ds_read_b128 v[64:67], v233 offset:32768
v_exp_f32 v12, v12
v_mfma_f32_16x16x32_bf16 v[188:191], v[52:55], v[44:47], v[188:191]
s_setprio 1
ds_read_b64_tr_b16 v[48:49], v240 offset:32768
v_mfma_f32_16x16x32_bf16 v[188:191], v[84:87], v[76:79], v[188:191]
ds_read_b64_tr_b16 v[50:51], v241 offset:32768
buffer_load_dwordx4 v225, s[16:19], s40 offen offset:1024 lds
v_fma_f32 v14, v14, s28, v2
v_mfma_f32_16x16x32_bf16 v[180:183], v[84:87], v[72:75], v[180:183]
ds_read_b64_tr_b16 v[80:81], v240 offset:34816
v_mfma_f32_16x16x32_bf16 v[180:183], v[52:55], v[40:43], v[180:183]
s_setprio 0
ds_read_b64_tr_b16 v[82:83], v241 offset:34816
v_mul_f32 v13, v13, v97
v_mfma_f32_16x16x32_bf16 v[208:211], v[56:59], v[40:43], v[208:211]
s_setprio 1
ds_read_b64_tr_b16 v[52:53], v240 offset:33280
v_mul_f32 v16, v100, v100
v_mfma_f32_16x16x32_bf16 v[208:211], v[88:91], v[72:75], v[208:211]
ds_read_b64_tr_b16 v[54:55], v241 offset:33280
buffer_load_dwordx4 v226, s[16:19], s40 offen offset:2048 lds
v_mfma_f32_16x16x32_bf16 v[216:219], v[88:91], v[76:79], v[216:219]
ds_read_b64_tr_b16 v[84:85], v240 offset:35328
v_exp_f32 v13, v13
v_mfma_f32_16x16x32_bf16 v[216:219], v[56:59], v[44:47], v[216:219]
s_setprio 0
ds_read_b64_tr_b16 v[86:87], v241 offset:35328
v_mfma_f32_16x16x32_bf16 v[220:223], v[60:63], v[44:47], v[220:223]
s_setprio 1
ds_read_b64_tr_b16 v[56:57], v240 offset:36864
v_fma_f32 v15, v15, s28, v2
v_mfma_f32_16x16x32_bf16 v[220:223], v[92:95], v[76:79], v[220:223]
ds_read_b64_tr_b16 v[58:59], v241 offset:36864
buffer_load_dwordx4 v227, s[16:19], s40 offen offset:3072 lds
s_add_u32 s40, s40, 128
v_mfma_f32_16x16x32_bf16 v[212:215], v[92:95], v[72:75], v[212:215]
ds_read_b64_tr_b16 v[88:89], v240 offset:38912
v_mul_f32 v14, v14, v98
v_mfma_f32_16x16x32_bf16 v[212:215], v[60:63], v[40:43], v[212:215]
s_setprio 0
s_waitcnt lgkmcnt(14)
ds_read_b64_tr_b16 v[90:91], v241 offset:38912
s_waitcnt lgkmcnt(10)
v_mfma_f32_16x16x32_bf16 v[160:163], v[48:51], v[32:35], v[160:163]
s_setprio 1
ds_read_b64_tr_b16 v[60:61], v240 offset:37376
s_add_u32 m0, s41, 81920
v_mul_f32 v17, v101, v101
s_waitcnt lgkmcnt(9)
v_mfma_f32_16x16x32_bf16 v[160:163], v[80:83], v[64:67], v[160:163]
ds_read_b64_tr_b16 v[62:63], v241 offset:37376
buffer_load_dwordx4 v228, s[20:23], s44 offen offset:0 lds
v_exp_f32 v14, v14
v_mfma_f32_16x16x32_bf16 v[168:171], v[80:83], v[68:71], v[168:171]
ds_read_b64_tr_b16 v[92:93], v240 offset:39424
v_mfma_f32_16x16x32_bf16 v[168:171], v[48:51], v[36:39], v[168:171]
s_setprio 0
ds_read_b64_tr_b16 v[94:95], v241 offset:39424
v_fma_f32 v16, v16, s28, v2
s_waitcnt lgkmcnt(10)
v_mfma_f32_16x16x32_bf16 v[172:175], v[52:55], v[36:39], v[172:175]
s_setprio 1
ds_read_b128 v[44:47], v232 offset:38912
s_waitcnt lgkmcnt(9)
v_mfma_f32_16x16x32_bf16 v[172:175], v[84:87], v[68:71], v[172:175]
ds_read_b128 v[76:79], v233 offset:38912
buffer_load_dwordx4 v228, s[20:23], s44 offen offset:1024 lds
v_mul_f32 v15, v15, v99
v_mfma_f32_16x16x32_bf16 v[164:167], v[84:87], v[64:67], v[164:167]
ds_read_b128 v[40:43], v232 offset:36864
v_add_f32 v12, 1.0, v12
v_mfma_f32_16x16x32_bf16 v[164:167], v[52:55], v[32:35], v[164:167]
s_setprio 0
ds_read_b128 v[72:75], v233 offset:36864
s_waitcnt lgkmcnt(10)
v_mfma_f32_16x16x32_bf16 v[192:195], v[56:59], v[32:35], v[192:195]
s_setprio 1
v_mul_f32 v18, v102, v102
s_waitcnt lgkmcnt(8)
v_mfma_f32_16x16x32_bf16 v[192:195], v[88:91], v[64:67], v[192:195]
buffer_load_dwordx4 v228, s[20:23], s44 offen offset:2048 lds
v_mfma_f32_16x16x32_bf16 v[200:203], v[88:91], v[68:71], v[200:203]
v_exp_f32 v15, v15
v_mfma_f32_16x16x32_bf16 v[200:203], v[56:59], v[36:39], v[200:203]
s_setprio 0
v_fma_f32 v17, v17, s28, v2
s_waitcnt lgkmcnt(6)
v_mfma_f32_16x16x32_bf16 v[204:207], v[60:63], v[36:39], v[204:207]
s_setprio 1
s_waitcnt lgkmcnt(4)
v_mfma_f32_16x16x32_bf16 v[204:207], v[92:95], v[68:71], v[204:207]
buffer_load_dwordx4 v228, s[20:23], s44 offen offset:3072 lds
s_add_u32 s44, s44, 4096
v_mul_f32 v16, v16, v100
v_mfma_f32_16x16x32_bf16 v[196:199], v[92:95], v[64:67], v[196:199]
v_mfma_f32_16x16x32_bf16 v[196:199], v[60:63], v[32:35], v[196:199]
s_setprio 0
s_waitcnt vmcnt(16) lgkmcnt(0)
s_barrier
s_add_u32 m0, s41, 98304
v_add_f32 v13, 1.0, v13
v_mfma_f32_16x16x32_bf16 v[176:179], v[48:51], v[40:43], v[176:179]
s_setprio 1
ds_read_b128 v[36:39], v230 offset:2048
v_rcp_f32 v12, v12
v_mfma_f32_16x16x32_bf16 v[176:179], v[80:83], v[72:75], v[176:179]
ds_read_b128 v[68:71], v231 offset:2048
buffer_load_dwordx4 v224, s[16:19], s40 offen offset:0 lds
v_mfma_f32_16x16x32_bf16 v[184:187], v[80:83], v[76:79], v[184:187]
ds_read_b128 v[32:35], v230 offset:0
v_mul_f32 v19, v103, v103
v_mfma_f32_16x16x32_bf16 v[184:187], v[48:51], v[44:47], v[184:187]
s_setprio 0
ds_read_b128 v[64:67], v231 offset:0
v_mfma_f32_16x16x32_bf16 v[188:191], v[52:55], v[44:47], v[188:191]
s_setprio 1
ds_read_b64_tr_b16 v[48:49], v238 offset:0
v_exp_f32 v16, v16
v_mfma_f32_16x16x32_bf16 v[188:191], v[84:87], v[76:79], v[188:191]
ds_read_b64_tr_b16 v[50:51], v239 offset:0
buffer_load_dwordx4 v225, s[16:19], s40 offen offset:1024 lds
v_fma_f32 v18, v18, s28, v2
v_mfma_f32_16x16x32_bf16 v[180:183], v[84:87], v[72:75], v[180:183]
ds_read_b64_tr_b16 v[80:81], v238 offset:2048
v_mfma_f32_16x16x32_bf16 v[180:183], v[52:55], v[40:43], v[180:183]
s_setprio 0
ds_read_b64_tr_b16 v[82:83], v239 offset:2048
v_mul_f32 v17, v17, v101
v_mfma_f32_16x16x32_bf16 v[208:211], v[56:59], v[40:43], v[208:211]
s_setprio 1
ds_read_b64_tr_b16 v[52:53], v238 offset:512
v_mfma_f32_16x16x32_bf16 v[208:211], v[88:91], v[72:75], v[208:211]
ds_read_b64_tr_b16 v[54:55], v239 offset:512
buffer_load_dwordx4 v226, s[16:19], s40 offen offset:2048 lds
v_add_f32 v14, 1.0, v14
v_mfma_f32_16x16x32_bf16 v[216:219], v[88:91], v[76:79], v[216:219]
ds_read_b64_tr_b16 v[84:85], v238 offset:2560
v_rcp_f32 v13, v13
v_mfma_f32_16x16x32_bf16 v[216:219], v[56:59], v[44:47], v[216:219]
s_setprio 0
ds_read_b64_tr_b16 v[86:87], v239 offset:2560
v_mfma_f32_16x16x32_bf16 v[220:223], v[60:63], v[44:47], v[220:223]
s_setprio 1
ds_read_b64_tr_b16 v[56:57], v238 offset:4096
v_mul_f32 v20, v104, v104
v_mfma_f32_16x16x32_bf16 v[220:223], v[92:95], v[76:79], v[220:223]
ds_read_b64_tr_b16 v[58:59], v239 offset:4096
buffer_load_dwordx4 v227, s[16:19], s40 offen offset:3072 lds
s_add_u32 s40, s40, 128
v_mfma_f32_16x16x32_bf16 v[212:215], v[92:95], v[72:75], v[212:215]
ds_read_b64_tr_b16 v[88:89], v238 offset:6144
v_exp_f32 v17, v17
v_mfma_f32_16x16x32_bf16 v[212:215], v[60:63], v[40:43], v[212:215]
s_setprio 0
s_waitcnt lgkmcnt(14)
ds_read_b64_tr_b16 v[90:91], v239 offset:6144
s_waitcnt lgkmcnt(10)
v_mfma_f32_16x16x32_bf16 v[160:163], v[48:51], v[32:35], v[160:163]
s_setprio 1
ds_read_b64_tr_b16 v[60:61], v238 offset:4608
s_add_u32 m0, s41, 114688
v_fma_f32 v19, v19, s28, v2
s_waitcnt lgkmcnt(9)
v_mfma_f32_16x16x32_bf16 v[160:163], v[80:83], v[64:67], v[160:163]
ds_read_b64_tr_b16 v[62:63], v239 offset:4608
buffer_load_dwordx4 v228, s[20:23], s44 offen offset:0 lds
v_mul_f32 v18, v18, v102
v_mfma_f32_16x16x32_bf16 v[168:171], v[80:83], v[68:71], v[168:171]
ds_read_b64_tr_b16 v[92:93], v238 offset:6656
v_mfma_f32_16x16x32_bf16 v[168:171], v[48:51], v[36:39], v[168:171]
s_setprio 0
ds_read_b64_tr_b16 v[94:95], v239 offset:6656
v_add_f32 v15, 1.0, v15
s_waitcnt lgkmcnt(10)
v_mfma_f32_16x16x32_bf16 v[172:175], v[52:55], v[36:39], v[172:175]
s_setprio 1
ds_read_b128 v[44:47], v230 offset:6144
s_waitcnt lgkmcnt(9)
v_mfma_f32_16x16x32_bf16 v[172:175], v[84:87], v[68:71], v[172:175]
ds_read_b128 v[76:79], v231 offset:6144
buffer_load_dwordx4 v228, s[20:23], s44 offen offset:1024 lds
v_rcp_f32 v14, v14
v_mfma_f32_16x16x32_bf16 v[164:167], v[84:87], v[64:67], v[164:167]
ds_read_b128 v[40:43], v230 offset:4096
v_mul_f32 v96, v96, v12
v_mfma_f32_16x16x32_bf16 v[164:167], v[52:55], v[32:35], v[164:167]
s_setprio 0
ds_read_b128 v[72:75], v231 offset:4096
s_waitcnt lgkmcnt(10)
v_mfma_f32_16x16x32_bf16 v[192:195], v[56:59], v[32:35], v[192:195]
s_setprio 1
v_mul_f32 v21, v105, v105
s_waitcnt lgkmcnt(8)
v_mfma_f32_16x16x32_bf16 v[192:195], v[88:91], v[64:67], v[192:195]
buffer_load_dwordx4 v228, s[20:23], s44 offen offset:2048 lds
v_mfma_f32_16x16x32_bf16 v[200:203], v[88:91], v[68:71], v[200:203]
v_exp_f32 v18, v18
v_mfma_f32_16x16x32_bf16 v[200:203], v[56:59], v[36:39], v[200:203]
s_setprio 0
v_fma_f32 v20, v20, s28, v2
s_waitcnt lgkmcnt(6)
v_mfma_f32_16x16x32_bf16 v[204:207], v[60:63], v[36:39], v[204:207]
s_setprio 1
s_waitcnt lgkmcnt(4)
v_mfma_f32_16x16x32_bf16 v[204:207], v[92:95], v[68:71], v[204:207]
buffer_load_dwordx4 v228, s[20:23], s44 offen offset:3072 lds
s_add_u32 s44, s44, 4096
v_mul_f32 v19, v19, v103
v_mfma_f32_16x16x32_bf16 v[196:199], v[92:95], v[64:67], v[196:199]
v_mfma_f32_16x16x32_bf16 v[196:199], v[60:63], v[32:35], v[196:199]
s_setprio 0
s_waitcnt vmcnt(16) lgkmcnt(0)
s_barrier
s_add_u32 m0, s41, 0
v_add_f32 v16, 1.0, v16
v_mfma_f32_16x16x32_bf16 v[176:179], v[48:51], v[40:43], v[176:179]
s_setprio 1
ds_read_b128 v[36:39], v230 offset:34816
v_rcp_f32 v15, v15
v_mfma_f32_16x16x32_bf16 v[176:179], v[80:83], v[72:75], v[176:179]
ds_read_b128 v[68:71], v231 offset:34816
buffer_load_dwordx4 v224, s[16:19], s40 offen offset:0 lds
v_mfma_f32_16x16x32_bf16 v[184:187], v[80:83], v[76:79], v[184:187]
ds_read_b128 v[32:35], v230 offset:32768
v_mul_f32 v97, v97, v13
v_mfma_f32_16x16x32_bf16 v[184:187], v[48:51], v[44:47], v[184:187]
s_setprio 0
ds_read_b128 v[64:67], v231 offset:32768
v_mfma_f32_16x16x32_bf16 v[188:191], v[52:55], v[44:47], v[188:191]
s_setprio 1
ds_read_b64_tr_b16 v[48:49], v238 offset:32768
v_mul_f32 v22, v106, v106
v_mfma_f32_16x16x32_bf16 v[188:191], v[84:87], v[76:79], v[188:191]
ds_read_b64_tr_b16 v[50:51], v239 offset:32768
buffer_load_dwordx4 v225, s[16:19], s40 offen offset:1024 lds
v_exp_f32 v19, v19
v_mfma_f32_16x16x32_bf16 v[180:183], v[84:87], v[72:75], v[180:183]
ds_read_b64_tr_b16 v[80:81], v238 offset:34816
v_mfma_f32_16x16x32_bf16 v[180:183], v[52:55], v[40:43], v[180:183]
s_setprio 0
ds_read_b64_tr_b16 v[82:83], v239 offset:34816
v_fma_f32 v21, v21, s28, v2
v_mfma_f32_16x16x32_bf16 v[208:211], v[56:59], v[40:43], v[208:211]
s_setprio 1
ds_read_b64_tr_b16 v[52:53], v238 offset:33280
v_mfma_f32_16x16x32_bf16 v[208:211], v[88:91], v[72:75], v[208:211]
ds_read_b64_tr_b16 v[54:55], v239 offset:33280
buffer_load_dwordx4 v226, s[16:19], s40 offen offset:2048 lds
v_mul_f32 v20, v20, v104
v_mfma_f32_16x16x32_bf16 v[216:219], v[88:91], v[76:79], v[216:219]
ds_read_b64_tr_b16 v[84:85], v238 offset:35328
v_add_f32 v17, 1.0, v17
v_mfma_f32_16x16x32_bf16 v[216:219], v[56:59], v[44:47], v[216:219]
s_setprio 0
ds_read_b64_tr_b16 v[86:87], v239 offset:35328
v_mfma_f32_16x16x32_bf16 v[220:223], v[60:63], v[44:47], v[220:223]
s_setprio 1
ds_read_b64_tr_b16 v[56:57], v238 offset:36864
v_rcp_f32 v16, v16
v_mfma_f32_16x16x32_bf16 v[220:223], v[92:95], v[76:79], v[220:223]
ds_read_b64_tr_b16 v[58:59], v239 offset:36864
buffer_load_dwordx4 v227, s[16:19], s40 offen offset:3072 lds
s_add_u32 s40, s40, 128
v_mfma_f32_16x16x32_bf16 v[212:215], v[92:95], v[72:75], v[212:215]
ds_read_b64_tr_b16 v[88:89], v238 offset:38912
v_mul_f32 v98, v98, v14
v_mfma_f32_16x16x32_bf16 v[212:215], v[60:63], v[40:43], v[212:215]
s_setprio 0
s_waitcnt lgkmcnt(14)
ds_read_b64_tr_b16 v[90:91], v239 offset:38912
s_waitcnt lgkmcnt(10)
v_mfma_f32_16x16x32_bf16 v[160:163], v[48:51], v[32:35], v[160:163]
s_setprio 1
ds_read_b64_tr_b16 v[60:61], v238 offset:37376
s_add_u32 m0, s41, 16384
v_mul_f32 v23, v107, v107
s_waitcnt lgkmcnt(9)
v_mfma_f32_16x16x32_bf16 v[160:163], v[80:83], v[64:67], v[160:163]
ds_read_b64_tr_b16 v[62:63], v239 offset:37376
buffer_load_dwordx4 v228, s[20:23], s44 offen offset:0 lds
v_exp_f32 v20, v20
v_mfma_f32_16x16x32_bf16 v[168:171], v[80:83], v[68:71], v[168:171]
ds_read_b64_tr_b16 v[92:93], v238 offset:39424
v_mfma_f32_16x16x32_bf16 v[168:171], v[48:51], v[36:39], v[168:171]
s_setprio 0
ds_read_b64_tr_b16 v[94:95], v239 offset:39424
v_fma_f32 v22, v22, s28, v2
s_waitcnt lgkmcnt(10)
v_mfma_f32_16x16x32_bf16 v[172:175], v[52:55], v[36:39], v[172:175]
s_setprio 1
ds_read_b128 v[44:47], v230 offset:38912
s_waitcnt lgkmcnt(9)
v_mfma_f32_16x16x32_bf16 v[172:175], v[84:87], v[68:71], v[172:175]
ds_read_b128 v[76:79], v231 offset:38912
buffer_load_dwordx4 v228, s[20:23], s44 offen offset:1024 lds
v_mul_f32 v21, v21, v105
v_mfma_f32_16x16x32_bf16 v[164:167], v[84:87], v[64:67], v[164:167]
ds_read_b128 v[40:43], v230 offset:36864
v_add_f32 v18, 1.0, v18
v_mfma_f32_16x16x32_bf16 v[164:167], v[52:55], v[32:35], v[164:167]
s_setprio 0
ds_read_b128 v[72:75], v231 offset:36864
s_waitcnt lgkmcnt(10)
v_mfma_f32_16x16x32_bf16 v[192:195], v[56:59], v[32:35], v[192:195]
s_setprio 1
v_rcp_f32 v17, v17
s_waitcnt lgkmcnt(8)
v_mfma_f32_16x16x32_bf16 v[192:195], v[88:91], v[64:67], v[192:195]
buffer_load_dwordx4 v228, s[20:23], s44 offen offset:2048 lds
v_mfma_f32_16x16x32_bf16 v[200:203], v[88:91], v[68:71], v[200:203]
v_mul_f32 v99, v99, v15
v_mfma_f32_16x16x32_bf16 v[200:203], v[56:59], v[36:39], v[200:203]
s_setprio 0
v_mul_f32 v24, v108, v108
s_waitcnt lgkmcnt(6)
v_mfma_f32_16x16x32_bf16 v[204:207], v[60:63], v[36:39], v[204:207]
s_setprio 1
s_waitcnt lgkmcnt(4)
v_mfma_f32_16x16x32_bf16 v[204:207], v[92:95], v[68:71], v[204:207]
buffer_load_dwordx4 v228, s[20:23], s44 offen offset:3072 lds
s_add_u32 s44, s44, 4096
v_exp_f32 v21, v21
v_mfma_f32_16x16x32_bf16 v[196:199], v[92:95], v[64:67], v[196:199]
v_mfma_f32_16x16x32_bf16 v[196:199], v[60:63], v[32:35], v[196:199]
s_setprio 0
s_waitcnt vmcnt(16) lgkmcnt(0)
s_barrier
s_add_u32 m0, s41, 32768
v_fma_f32 v23, v23, s28, v2
v_mfma_f32_16x16x32_bf16 v[176:179], v[48:51], v[40:43], v[176:179]
s_setprio 1
ds_read_b128 v[36:39], v232 offset:2048
v_mul_f32 v22, v22, v106
v_mfma_f32_16x16x32_bf16 v[176:179], v[80:83], v[72:75], v[176:179]
ds_read_b128 v[68:71], v233 offset:2048
buffer_load_dwordx4 v224, s[16:19], s40 offen offset:0 lds
v_mfma_f32_16x16x32_bf16 v[184:187], v[80:83], v[76:79], v[184:187]
ds_read_b128 v[32:35], v232 offset:0
v_add_f32 v19, 1.0, v19
v_mfma_f32_16x16x32_bf16 v[184:187], v[48:51], v[44:47], v[184:187]
s_setprio 0
ds_read_b128 v[64:67], v233 offset:0
v_mfma_f32_16x16x32_bf16 v[188:191], v[52:55], v[44:47], v[188:191]
s_setprio 1
ds_read_b64_tr_b16 v[48:49], v240 offset:0
v_rcp_f32 v18, v18
v_mfma_f32_16x16x32_bf16 v[188:191], v[84:87], v[76:79], v[188:191]
ds_read_b64_tr_b16 v[50:51], v241 offset:0
buffer_load_dwordx4 v225, s[16:19], s40 offen offset:1024 lds
v_mul_f32 v100, v100, v16
v_mfma_f32_16x16x32_bf16 v[180:183], v[84:87], v[72:75], v[180:183]
ds_read_b64_tr_b16 v[80:81], v240 offset:2048
v_mfma_f32_16x16x32_bf16 v[180:183], v[52:55], v[40:43], v[180:183]
s_setprio 0
ds_read_b64_tr_b16 v[82:83], v241 offset:2048
v_mul_f32 v25, v109, v109
v_mfma_f32_16x16x32_bf16 v[208:211], v[56:59], v[40:43], v[208:211]
s_setprio 1
ds_read_b64_tr_b16 v[52:53], v240 offset:512
v_mfma_f32_16x16x32_bf16 v[208:211], v[88:91], v[72:75], v[208:211]
ds_read_b64_tr_b16 v[54:55], v241 offset:512
buffer_load_dwordx4 v226, s[16:19], s40 offen offset:2048 lds
v_exp_f32 v22, v22
v_mfma_f32_16x16x32_bf16 v[216:219], v[88:91], v[76:79], v[216:219]
ds_read_b64_tr_b16 v[84:85], v240 offset:2560
v_fma_f32 v24, v24, s28, v2
v_mfma_f32_16x16x32_bf16 v[216:219], v[56:59], v[44:47], v[216:219]
s_setprio 0
ds_read_b64_tr_b16 v[86:87], v241 offset:2560
v_mfma_f32_16x16x32_bf16 v[220:223], v[60:63], v[44:47], v[220:223]
s_setprio 1
ds_read_b64_tr_b16 v[56:57], v240 offset:4096
v_mul_f32 v23, v23, v107
v_mfma_f32_16x16x32_bf16 v[220:223], v[92:95], v[76:79], v[220:223]
ds_read_b64_tr_b16 v[58:59], v241 offset:4096
buffer_load_dwordx4 v227, s[16:19], s40 offen offset:3072 lds
s_add_u32 s40, s40, 128
v_mfma_f32_16x16x32_bf16 v[212:215], v[92:95], v[72:75], v[212:215]
ds_read_b64_tr_b16 v[88:89], v240 offset:6144
v_add_f32 v20, 1.0, v20
v_mfma_f32_16x16x32_bf16 v[212:215], v[60:63], v[40:43], v[212:215]
s_setprio 0
s_waitcnt lgkmcnt(14)
ds_read_b64_tr_b16 v[90:91], v241 offset:6144
s_waitcnt lgkmcnt(10)
v_mfma_f32_16x16x32_bf16 v[160:163], v[48:51], v[32:35], v[160:163]
s_setprio 1
ds_read_b64_tr_b16 v[60:61], v240 offset:4608
s_add_u32 m0, s41, 49152
v_rcp_f32 v19, v19
s_waitcnt lgkmcnt(9)
v_mfma_f32_16x16x32_bf16 v[160:163], v[80:83], v[64:67], v[160:163]
ds_read_b64_tr_b16 v[62:63], v241 offset:4608
buffer_load_dwordx4 v228, s[20:23], s44 offen offset:0 lds
v_mul_f32 v101, v101, v17
v_mfma_f32_16x16x32_bf16 v[168:171], v[80:83], v[68:71], v[168:171]
ds_read_b64_tr_b16 v[92:93], v240 offset:6656
v_mfma_f32_16x16x32_bf16 v[168:171], v[48:51], v[36:39], v[168:171]
s_setprio 0
ds_read_b64_tr_b16 v[94:95], v241 offset:6656
v_mul_f32 v26, v110, v110
s_waitcnt lgkmcnt(10)
v_mfma_f32_16x16x32_bf16 v[172:175], v[52:55], v[36:39], v[172:175]
s_setprio 1
ds_read_b128 v[44:47], v232 offset:6144
s_waitcnt lgkmcnt(9)
v_mfma_f32_16x16x32_bf16 v[172:175], v[84:87], v[68:71], v[172:175]
ds_read_b128 v[76:79], v233 offset:6144
buffer_load_dwordx4 v228, s[20:23], s44 offen offset:1024 lds
v_exp_f32 v23, v23
v_mfma_f32_16x16x32_bf16 v[164:167], v[84:87], v[64:67], v[164:167]
ds_read_b128 v[40:43], v232 offset:4096
v_fma_f32 v25, v25, s28, v2
v_mfma_f32_16x16x32_bf16 v[164:167], v[52:55], v[32:35], v[164:167]
s_setprio 0
ds_read_b128 v[72:75], v233 offset:4096
s_waitcnt lgkmcnt(10)
v_mfma_f32_16x16x32_bf16 v[192:195], v[56:59], v[32:35], v[192:195]
s_setprio 1
v_mul_f32 v24, v24, v108
s_waitcnt lgkmcnt(8)
v_mfma_f32_16x16x32_bf16 v[192:195], v[88:91], v[64:67], v[192:195]
buffer_load_dwordx4 v228, s[20:23], s44 offen offset:2048 lds
v_mfma_f32_16x16x32_bf16 v[200:203], v[88:91], v[68:71], v[200:203]
v_add_f32 v21, 1.0, v21
v_mfma_f32_16x16x32_bf16 v[200:203], v[56:59], v[36:39], v[200:203]
s_setprio 0
v_rcp_f32 v20, v20
s_waitcnt lgkmcnt(6)
v_mfma_f32_16x16x32_bf16 v[204:207], v[60:63], v[36:39], v[204:207]
s_setprio 1
s_waitcnt lgkmcnt(4)
v_mfma_f32_16x16x32_bf16 v[204:207], v[92:95], v[68:71], v[204:207]
buffer_load_dwordx4 v228, s[20:23], s44 offen offset:3072 lds
s_add_u32 s44, s44, 4096
v_mul_f32 v102, v102, v18
v_mfma_f32_16x16x32_bf16 v[196:199], v[92:95], v[64:67], v[196:199]
v_mfma_f32_16x16x32_bf16 v[196:199], v[60:63], v[32:35], v[196:199]
s_setprio 0
s_waitcnt vmcnt(16) lgkmcnt(0)
s_barrier
s_add_u32 m0, s41, 65536
v_mul_f32 v27, v111, v111
v_mfma_f32_16x16x32_bf16 v[176:179], v[48:51], v[40:43], v[176:179]
s_setprio 1
ds_read_b128 v[36:39], v232 offset:34816
v_exp_f32 v24, v24
v_mfma_f32_16x16x32_bf16 v[176:179], v[80:83], v[72:75], v[176:179]
ds_read_b128 v[68:71], v233 offset:34816
buffer_load_dwordx4 v224, s[16:19], s40 offen offset:0 lds
v_mfma_f32_16x16x32_bf16 v[184:187], v[80:83], v[76:79], v[184:187]
ds_read_b128 v[32:35], v232 offset:32768
v_fma_f32 v26, v26, s28, v2
v_mfma_f32_16x16x32_bf16 v[184:187], v[48:51], v[44:47], v[184:187]
s_setprio 0
ds_read_b128 v[64:67], v233 offset:32768
v_mfma_f32_16x16x32_bf16 v[188:191], v[52:55], v[44:47], v[188:191]
s_setprio 1
ds_read_b64_tr_b16 v[48:49], v240 offset:32768
v_mul_f32 v25, v25, v109
v_mfma_f32_16x16x32_bf16 v[188:191], v[84:87], v[76:79], v[188:191]
ds_read_b64_tr_b16 v[50:51], v241 offset:32768
buffer_load_dwordx4 v225, s[16:19], s40 offen offset:1024 lds
v_add_f32 v22, 1.0, v22
v_mfma_f32_16x16x32_bf16 v[180:183], v[84:87], v[72:75], v[180:183]
ds_read_b64_tr_b16 v[80:81], v240 offset:34816
v_mfma_f32_16x16x32_bf16 v[180:183], v[52:55], v[40:43], v[180:183]
s_setprio 0
ds_read_b64_tr_b16 v[82:83], v241 offset:34816
v_rcp_f32 v21, v21
v_mfma_f32_16x16x32_bf16 v[208:211], v[56:59], v[40:43], v[208:211]
s_setprio 1
ds_read_b64_tr_b16 v[52:53], v240 offset:33280
v_mfma_f32_16x16x32_bf16 v[208:211], v[88:91], v[72:75], v[208:211]
ds_read_b64_tr_b16 v[54:55], v241 offset:33280
buffer_load_dwordx4 v226, s[16:19], s40 offen offset:2048 lds
v_mul_f32 v103, v103, v19
v_mfma_f32_16x16x32_bf16 v[216:219], v[88:91], v[76:79], v[216:219]
ds_read_b64_tr_b16 v[84:85], v240 offset:35328
v_mul_f32 v12, v112, v112
v_mfma_f32_16x16x32_bf16 v[216:219], v[56:59], v[44:47], v[216:219]
s_setprio 0
ds_read_b64_tr_b16 v[86:87], v241 offset:35328
v_mfma_f32_16x16x32_bf16 v[220:223], v[60:63], v[44:47], v[220:223]
s_setprio 1
ds_read_b64_tr_b16 v[56:57], v240 offset:36864
v_exp_f32 v25, v25
v_mfma_f32_16x16x32_bf16 v[220:223], v[92:95], v[76:79], v[220:223]
ds_read_b64_tr_b16 v[58:59], v241 offset:36864
buffer_load_dwordx4 v227, s[16:19], s40 offen offset:3072 lds
s_add_u32 s40, s40, 128
v_mfma_f32_16x16x32_bf16 v[212:215], v[92:95], v[72:75], v[212:215]
ds_read_b64_tr_b16 v[88:89], v240 offset:38912
v_fma_f32 v27, v27, s28, v2
v_mfma_f32_16x16x32_bf16 v[212:215], v[60:63], v[40:43], v[212:215]
s_setprio 0
s_waitcnt lgkmcnt(14)
ds_read_b64_tr_b16 v[90:91], v241 offset:38912
s_waitcnt lgkmcnt(10)
v_mfma_f32_16x16x32_bf16 v[160:163], v[48:51], v[32:35], v[160:163]
s_setprio 1
ds_read_b64_tr_b16 v[60:61], v240 offset:37376
s_add_u32 m0, s41, 81920
v_mul_f32 v26, v26, v110
s_waitcnt lgkmcnt(9)
v_mfma_f32_16x16x32_bf16 v[160:163], v[80:83], v[64:67], v[160:163]
ds_read_b64_tr_b16 v[62:63], v241 offset:37376
buffer_load_dwordx4 v228, s[20:23], s44 offen offset:0 lds
v_add_f32 v23, 1.0, v23
v_mfma_f32_16x16x32_bf16 v[168:171], v[80:83], v[68:71], v[168:171]
ds_read_b64_tr_b16 v[92:93], v240 offset:39424
v_mfma_f32_16x16x32_bf16 v[168:171], v[48:51], v[36:39], v[168:171]
s_setprio 0
ds_read_b64_tr_b16 v[94:95], v241 offset:39424
v_rcp_f32 v22, v22
s_waitcnt lgkmcnt(10)
v_mfma_f32_16x16x32_bf16 v[172:175], v[52:55], v[36:39], v[172:175]
s_setprio 1
ds_read_b128 v[44:47], v232 offset:38912
s_waitcnt lgkmcnt(9)
v_mfma_f32_16x16x32_bf16 v[172:175], v[84:87], v[68:71], v[172:175]
ds_read_b128 v[76:79], v233 offset:38912
buffer_load_dwordx4 v228, s[20:23], s44 offen offset:1024 lds
v_mul_f32 v104, v104, v20
v_mfma_f32_16x16x32_bf16 v[164:167], v[84:87], v[64:67], v[164:167]
ds_read_b128 v[40:43], v232 offset:36864
v_mul_f32 v13, v113, v113
v_mfma_f32_16x16x32_bf16 v[164:167], v[52:55], v[32:35], v[164:167]
s_setprio 0
ds_read_b128 v[72:75], v233 offset:36864
s_waitcnt lgkmcnt(10)
v_mfma_f32_16x16x32_bf16 v[192:195], v[56:59], v[32:35], v[192:195]
s_setprio 1
v_exp_f32 v26, v26
s_waitcnt lgkmcnt(8)
v_mfma_f32_16x16x32_bf16 v[192:195], v[88:91], v[64:67], v[192:195]
buffer_load_dwordx4 v228, s[20:23], s44 offen offset:2048 lds
v_mfma_f32_16x16x32_bf16 v[200:203], v[88:91], v[68:71], v[200:203]
v_fma_f32 v12, v12, s28, v2
v_mfma_f32_16x16x32_bf16 v[200:203], v[56:59], v[36:39], v[200:203]
s_setprio 0
v_mul_f32 v27, v27, v111
s_waitcnt lgkmcnt(6)
v_mfma_f32_16x16x32_bf16 v[204:207], v[60:63], v[36:39], v[204:207]
s_setprio 1
s_waitcnt lgkmcnt(4)
v_mfma_f32_16x16x32_bf16 v[204:207], v[92:95], v[68:71], v[204:207]
buffer_load_dwordx4 v228, s[20:23], s44 offen offset:3072 lds
s_add_u32 s44, s44, 4096
v_add_f32 v24, 1.0, v24
v_mfma_f32_16x16x32_bf16 v[196:199], v[92:95], v[64:67], v[196:199]
v_mfma_f32_16x16x32_bf16 v[196:199], v[60:63], v[32:35], v[196:199]
s_setprio 0
s_waitcnt vmcnt(16) lgkmcnt(0)
s_barrier
s_add_u32 m0, s41, 98304
v_rcp_f32 v23, v23
v_mfma_f32_16x16x32_bf16 v[176:179], v[48:51], v[40:43], v[176:179]
s_setprio 1
ds_read_b128 v[36:39], v230 offset:2048
v_mul_f32 v105, v105, v21
v_mfma_f32_16x16x32_bf16 v[176:179], v[80:83], v[72:75], v[176:179]
ds_read_b128 v[68:71], v231 offset:2048
buffer_load_dwordx4 v224, s[16:19], s40 offen offset:0 lds
v_mfma_f32_16x16x32_bf16 v[184:187], v[80:83], v[76:79], v[184:187]
ds_read_b128 v[32:35], v230 offset:0
v_mul_f32 v14, v114, v114
v_mfma_f32_16x16x32_bf16 v[184:187], v[48:51], v[44:47], v[184:187]
s_setprio 0
ds_read_b128 v[64:67], v231 offset:0
v_mfma_f32_16x16x32_bf16 v[188:191], v[52:55], v[44:47], v[188:191]
s_setprio 1
ds_read_b64_tr_b16 v[48:49], v238 offset:0
v_exp_f32 v27, v27
v_mfma_f32_16x16x32_bf16 v[188:191], v[84:87], v[76:79], v[188:191]
ds_read_b64_tr_b16 v[50:51], v239 offset:0
buffer_load_dwordx4 v225, s[16:19], s40 offen offset:1024 lds
v_fma_f32 v13, v13, s28, v2
v_mfma_f32_16x16x32_bf16 v[180:183], v[84:87], v[72:75], v[180:183]
ds_read_b64_tr_b16 v[80:81], v238 offset:2048
v_mfma_f32_16x16x32_bf16 v[180:183], v[52:55], v[40:43], v[180:183]
s_setprio 0
ds_read_b64_tr_b16 v[82:83], v239 offset:2048
v_mul_f32 v12, v12, v112
v_mfma_f32_16x16x32_bf16 v[208:211], v[56:59], v[40:43], v[208:211]
s_setprio 1
ds_read_b64_tr_b16 v[52:53], v238 offset:512
v_mfma_f32_16x16x32_bf16 v[208:211], v[88:91], v[72:75], v[208:211]
ds_read_b64_tr_b16 v[54:55], v239 offset:512
buffer_load_dwordx4 v226, s[16:19], s40 offen offset:2048 lds
v_add_f32 v25, 1.0, v25
v_mfma_f32_16x16x32_bf16 v[216:219], v[88:91], v[76:79], v[216:219]
ds_read_b64_tr_b16 v[84:85], v238 offset:2560
v_rcp_f32 v24, v24
v_mfma_f32_16x16x32_bf16 v[216:219], v[56:59], v[44:47], v[216:219]
s_setprio 0
ds_read_b64_tr_b16 v[86:87], v239 offset:2560
v_mfma_f32_16x16x32_bf16 v[220:223], v[60:63], v[44:47], v[220:223]
s_setprio 1
ds_read_b64_tr_b16 v[56:57], v238 offset:4096
v_mul_f32 v106, v106, v22
v_mfma_f32_16x16x32_bf16 v[220:223], v[92:95], v[76:79], v[220:223]
ds_read_b64_tr_b16 v[58:59], v239 offset:4096
buffer_load_dwordx4 v227, s[16:19], s40 offen offset:3072 lds
s_add_u32 s40, s40, 128
v_mfma_f32_16x16x32_bf16 v[212:215], v[92:95], v[72:75], v[212:215]
ds_read_b64_tr_b16 v[88:89], v238 offset:6144
v_mul_f32 v15, v115, v115
v_mfma_f32_16x16x32_bf16 v[212:215], v[60:63], v[40:43], v[212:215]
s_setprio 0
s_waitcnt lgkmcnt(14)
ds_read_b64_tr_b16 v[90:91], v239 offset:6144
s_waitcnt lgkmcnt(10)
v_mfma_f32_16x16x32_bf16 v[160:163], v[48:51], v[32:35], v[160:163]
s_setprio 1
ds_read_b64_tr_b16 v[60:61], v238 offset:4608
s_add_u32 m0, s41, 114688
v_exp_f32 v12, v12
s_waitcnt lgkmcnt(9)
v_mfma_f32_16x16x32_bf16 v[160:163], v[80:83], v[64:67], v[160:163]
ds_read_b64_tr_b16 v[62:63], v239 offset:4608
buffer_load_dwordx4 v228, s[20:23], s44 offen offset:0 lds
v_fma_f32 v14, v14, s28, v2
v_mfma_f32_16x16x32_bf16 v[168:171], v[80:83], v[68:71], v[168:171]
ds_read_b64_tr_b16 v[92:93], v238 offset:6656
v_mfma_f32_16x16x32_bf16 v[168:171], v[48:51], v[36:39], v[168:171]
s_setprio 0
ds_read_b64_tr_b16 v[94:95], v239 offset:6656
v_mul_f32 v13, v13, v113
s_waitcnt lgkmcnt(10)
v_mfma_f32_16x16x32_bf16 v[172:175], v[52:55], v[36:39], v[172:175]
s_setprio 1
ds_read_b128 v[44:47], v230 offset:6144
s_waitcnt lgkmcnt(9)
v_mfma_f32_16x16x32_bf16 v[172:175], v[84:87], v[68:71], v[172:175]
ds_read_b128 v[76:79], v231 offset:6144
buffer_load_dwordx4 v228, s[20:23], s44 offen offset:1024 lds
v_add_f32 v26, 1.0, v26
v_mfma_f32_16x16x32_bf16 v[164:167], v[84:87], v[64:67], v[164:167]
ds_read_b128 v[40:43], v230 offset:4096
v_mfma_f32_16x16x32_bf16 v[164:167], v[52:55], v[32:35], v[164:167]
s_setprio 0
ds_read_b128 v[72:75], v231 offset:4096
v_rcp_f32 v25, v25
s_waitcnt lgkmcnt(10)
v_mfma_f32_16x16x32_bf16 v[192:195], v[56:59], v[32:35], v[192:195]
s_setprio 1
v_mul_f32 v107, v107, v23
s_waitcnt lgkmcnt(8)
v_mfma_f32_16x16x32_bf16 v[192:195], v[88:91], v[64:67], v[192:195]
buffer_load_dwordx4 v228, s[20:23], s44 offen offset:2048 lds
v_mfma_f32_16x16x32_bf16 v[200:203], v[88:91], v[68:71], v[200:203]
v_mul_f32 v16, v116, v116
v_mfma_f32_16x16x32_bf16 v[200:203], v[56:59], v[36:39], v[200:203]
s_setprio 0
s_waitcnt lgkmcnt(6)
v_mfma_f32_16x16x32_bf16 v[204:207], v[60:63], v[36:39], v[204:207]
s_setprio 1
v_exp_f32 v13, v13
s_waitcnt lgkmcnt(4)
v_mfma_f32_16x16x32_bf16 v[204:207], v[92:95], v[68:71], v[204:207]
buffer_load_dwordx4 v228, s[20:23], s44 offen offset:3072 lds
s_add_u32 s44, s44, 4096
v_mfma_f32_16x16x32_bf16 v[196:199], v[92:95], v[64:67], v[196:199]
v_fma_f32 v15, v15, s28, v2
v_mfma_f32_16x16x32_bf16 v[196:199], v[60:63], v[32:35], v[196:199]
s_setprio 0
s_waitcnt vmcnt(16) lgkmcnt(0)
s_barrier
s_add_u32 m0, s41, 0
v_mfma_f32_16x16x32_bf16 v[176:179], v[48:51], v[40:43], v[176:179]
s_setprio 1
ds_read_b128 v[36:39], v230 offset:34816
v_mul_f32 v14, v14, v114
v_mfma_f32_16x16x32_bf16 v[176:179], v[80:83], v[72:75], v[176:179]
ds_read_b128 v[68:71], v231 offset:34816
buffer_load_dwordx4 v224, s[16:19], s40 offen offset:0 lds
v_add_f32 v27, 1.0, v27
v_mfma_f32_16x16x32_bf16 v[184:187], v[80:83], v[76:79], v[184:187]
ds_read_b128 v[32:35], v230 offset:32768
v_mfma_f32_16x16x32_bf16 v[184:187], v[48:51], v[44:47], v[184:187]
s_setprio 0
ds_read_b128 v[64:67], v231 offset:32768
v_rcp_f32 v26, v26
v_mfma_f32_16x16x32_bf16 v[188:191], v[52:55], v[44:47], v[188:191]
s_setprio 1
ds_read_b64_tr_b16 v[48:49], v238 offset:32768
v_mfma_f32_16x16x32_bf16 v[188:191], v[84:87], v[76:79], v[188:191]
ds_read_b64_tr_b16 v[50:51], v239 offset:32768
buffer_load_dwordx4 v225, s[16:19], s40 offen offset:1024 lds
v_mul_f32 v108, v108, v24
v_mfma_f32_16x16x32_bf16 v[180:183], v[84:87], v[72:75], v[180:183]
ds_read_b64_tr_b16 v[80:81], v238 offset:34816
v_mfma_f32_16x16x32_bf16 v[180:183], v[52:55], v[40:43], v[180:183]
s_setprio 0
ds_read_b64_tr_b16 v[82:83], v239 offset:34816
v_mul_f32 v17, v117, v117
v_mfma_f32_16x16x32_bf16 v[208:211], v[56:59], v[40:43], v[208:211]
s_setprio 1
ds_read_b64_tr_b16 v[52:53], v238 offset:33280
v_exp_f32 v14, v14
v_mfma_f32_16x16x32_bf16 v[208:211], v[88:91], v[72:75], v[208:211]
ds_read_b64_tr_b16 v[54:55], v239 offset:33280
buffer_load_dwordx4 v226, s[16:19], s40 offen offset:2048 lds
v_mfma_f32_16x16x32_bf16 v[216:219], v[88:91], v[76:79], v[216:219]
ds_read_b64_tr_b16 v[84:85], v238 offset:35328
v_fma_f32 v16, v16, s28, v2
v_mfma_f32_16x16x32_bf16 v[216:219], v[56:59], v[44:47], v[216:219]
s_setprio 0
ds_read_b64_tr_b16 v[86:87], v239 offset:35328
v_mfma_f32_16x16x32_bf16 v[220:223], v[60:63], v[44:47], v[220:223]
s_setprio 1
ds_read_b64_tr_b16 v[56:57], v238 offset:36864
v_mul_f32 v15, v15, v115
v_mfma_f32_16x16x32_bf16 v[220:223], v[92:95], v[76:79], v[220:223]
ds_read_b64_tr_b16 v[58:59], v239 offset:36864
buffer_load_dwordx4 v227, s[16:19], s40 offen offset:3072 lds
s_add_u32 s40, s40, 128
v_mfma_f32_16x16x32_bf16 v[212:215], v[92:95], v[72:75], v[212:215]
ds_read_b64_tr_b16 v[88:89], v238 offset:38912
v_add_f32 v12, 1.0, v12
v_mfma_f32_16x16x32_bf16 v[212:215], v[60:63], v[40:43], v[212:215]
s_setprio 0
s_waitcnt lgkmcnt(14)
ds_read_b64_tr_b16 v[90:91], v239 offset:38912
s_waitcnt lgkmcnt(10)
v_mfma_f32_16x16x32_bf16 v[160:163], v[48:51], v[32:35], v[160:163]
s_setprio 1
ds_read_b64_tr_b16 v[60:61], v238 offset:37376
s_add_u32 m0, s41, 16384
v_rcp_f32 v27, v27
s_waitcnt lgkmcnt(9)
v_mfma_f32_16x16x32_bf16 v[160:163], v[80:83], v[64:67], v[160:163]
ds_read_b64_tr_b16 v[62:63], v239 offset:37376
buffer_load_dwordx4 v228, s[20:23], s44 offen offset:0 lds
v_mul_f32 v109, v109, v25
v_mfma_f32_16x16x32_bf16 v[168:171], v[80:83], v[68:71], v[168:171]
ds_read_b64_tr_b16 v[92:93], v238 offset:39424
v_mfma_f32_16x16x32_bf16 v[168:171], v[48:51], v[36:39], v[168:171]
s_setprio 0
ds_read_b64_tr_b16 v[94:95], v239 offset:39424
v_mul_f32 v18, v118, v118
s_waitcnt lgkmcnt(10)
v_mfma_f32_16x16x32_bf16 v[172:175], v[52:55], v[36:39], v[172:175]
s_setprio 1
ds_read_b128 v[44:47], v230 offset:38912
s_waitcnt lgkmcnt(9)
v_mfma_f32_16x16x32_bf16 v[172:175], v[84:87], v[68:71], v[172:175]
ds_read_b128 v[76:79], v231 offset:38912
buffer_load_dwordx4 v228, s[20:23], s44 offen offset:1024 lds
v_exp_f32 v15, v15
v_mfma_f32_16x16x32_bf16 v[164:167], v[84:87], v[64:67], v[164:167]
ds_read_b128 v[40:43], v230 offset:36864
v_fma_f32 v17, v17, s28, v2
v_mfma_f32_16x16x32_bf16 v[164:167], v[52:55], v[32:35], v[164:167]
s_setprio 0
ds_read_b128 v[72:75], v231 offset:36864
s_waitcnt lgkmcnt(10)
v_mfma_f32_16x16x32_bf16 v[192:195], v[56:59], v[32:35], v[192:195]
s_setprio 1
v_mul_f32 v16, v16, v116
s_waitcnt lgkmcnt(8)
v_mfma_f32_16x16x32_bf16 v[192:195], v[88:91], v[64:67], v[192:195]
buffer_load_dwordx4 v228, s[20:23], s44 offen offset:2048 lds
v_mfma_f32_16x16x32_bf16 v[200:203], v[88:91], v[68:71], v[200:203]
v_add_f32 v13, 1.0, v13
v_mfma_f32_16x16x32_bf16 v[200:203], v[56:59], v[36:39], v[200:203]
s_setprio 0
v_rcp_f32 v12, v12
s_waitcnt lgkmcnt(6)
v_mfma_f32_16x16x32_bf16 v[204:207], v[60:63], v[36:39], v[204:207]
s_setprio 1
s_waitcnt lgkmcnt(4)
v_mfma_f32_16x16x32_bf16 v[204:207], v[92:95], v[68:71], v[204:207]
buffer_load_dwordx4 v228, s[20:23], s44 offen offset:3072 lds
s_add_u32 s44, s44, 4096
v_mul_f32 v110, v110, v26
v_mfma_f32_16x16x32_bf16 v[196:199], v[92:95], v[64:67], v[196:199]
v_mfma_f32_16x16x32_bf16 v[196:199], v[60:63], v[32:35], v[196:199]
s_setprio 0
s_waitcnt vmcnt(16) lgkmcnt(0)
s_barrier
s_add_u32 m0, s41, 32768
v_mul_f32 v19, v119, v119
v_mfma_f32_16x16x32_bf16 v[176:179], v[48:51], v[40:43], v[176:179]
s_setprio 1
ds_read_b128 v[36:39], v232 offset:2048
v_exp_f32 v16, v16
v_mfma_f32_16x16x32_bf16 v[176:179], v[80:83], v[72:75], v[176:179]
ds_read_b128 v[68:71], v233 offset:2048
buffer_load_dwordx4 v224, s[16:19], s40 offen offset:0 lds
v_mfma_f32_16x16x32_bf16 v[184:187], v[80:83], v[76:79], v[184:187]
ds_read_b128 v[32:35], v232 offset:0
v_fma_f32 v18, v18, s28, v2
v_mfma_f32_16x16x32_bf16 v[184:187], v[48:51], v[44:47], v[184:187]
s_setprio 0
ds_read_b128 v[64:67], v233 offset:0
v_mfma_f32_16x16x32_bf16 v[188:191], v[52:55], v[44:47], v[188:191]
s_setprio 1
ds_read_b64_tr_b16 v[48:49], v240 offset:0
v_mul_f32 v17, v17, v117
v_mfma_f32_16x16x32_bf16 v[188:191], v[84:87], v[76:79], v[188:191]
ds_read_b64_tr_b16 v[50:51], v241 offset:0
buffer_load_dwordx4 v225, s[16:19], s40 offen offset:1024 lds
v_add_f32 v14, 1.0, v14
v_mfma_f32_16x16x32_bf16 v[180:183], v[84:87], v[72:75], v[180:183]
ds_read_b64_tr_b16 v[80:81], v240 offset:2048
v_mfma_f32_16x16x32_bf16 v[180:183], v[52:55], v[40:43], v[180:183]
s_setprio 0
ds_read_b64_tr_b16 v[82:83], v241 offset:2048
v_rcp_f32 v13, v13
v_mfma_f32_16x16x32_bf16 v[208:211], v[56:59], v[40:43], v[208:211]
s_setprio 1
ds_read_b64_tr_b16 v[52:53], v240 offset:512
v_mfma_f32_16x16x32_bf16 v[208:211], v[88:91], v[72:75], v[208:211]
ds_read_b64_tr_b16 v[54:55], v241 offset:512
buffer_load_dwordx4 v226, s[16:19], s40 offen offset:2048 lds
v_mul_f32 v111, v111, v27
v_mfma_f32_16x16x32_bf16 v[216:219], v[88:91], v[76:79], v[216:219]
ds_read_b64_tr_b16 v[84:85], v240 offset:2560
v_mul_f32 v20, v120, v120
v_mfma_f32_16x16x32_bf16 v[216:219], v[56:59], v[44:47], v[216:219]
s_setprio 0
ds_read_b64_tr_b16 v[86:87], v241 offset:2560
v_mfma_f32_16x16x32_bf16 v[220:223], v[60:63], v[44:47], v[220:223]
s_setprio 1
ds_read_b64_tr_b16 v[56:57], v240 offset:4096
v_exp_f32 v17, v17
v_mfma_f32_16x16x32_bf16 v[220:223], v[92:95], v[76:79], v[220:223]
ds_read_b64_tr_b16 v[58:59], v241 offset:4096
buffer_load_dwordx4 v227, s[16:19], s40 offen offset:3072 lds
s_add_u32 s40, s40, 128
v_mfma_f32_16x16x32_bf16 v[212:215], v[92:95], v[72:75], v[212:215]
ds_read_b64_tr_b16 v[88:89], v240 offset:6144
v_fma_f32 v19, v19, s28, v2
v_mfma_f32_16x16x32_bf16 v[212:215], v[60:63], v[40:43], v[212:215]
s_setprio 0
s_waitcnt lgkmcnt(14)
ds_read_b64_tr_b16 v[90:91], v241 offset:6144
s_waitcnt lgkmcnt(10)
v_mfma_f32_16x16x32_bf16 v[160:163], v[48:51], v[32:35], v[160:163]
s_setprio 1
ds_read_b64_tr_b16 v[60:61], v240 offset:4608
s_add_u32 m0, s41, 49152
v_mul_f32 v18, v18, v118
s_waitcnt lgkmcnt(9)
v_mfma_f32_16x16x32_bf16 v[160:163], v[80:83], v[64:67], v[160:163]
ds_read_b64_tr_b16 v[62:63], v241 offset:4608
buffer_load_dwordx4 v228, s[20:23], s44 offen offset:0 lds
v_add_f32 v15, 1.0, v15
v_mfma_f32_16x16x32_bf16 v[168:171], v[80:83], v[68:71], v[168:171]
ds_read_b64_tr_b16 v[92:93], v240 offset:6656
v_mfma_f32_16x16x32_bf16 v[168:171], v[48:51], v[36:39], v[168:171]
s_setprio 0
ds_read_b64_tr_b16 v[94:95], v241 offset:6656
v_rcp_f32 v14, v14
s_waitcnt lgkmcnt(10)
v_mfma_f32_16x16x32_bf16 v[172:175], v[52:55], v[36:39], v[172:175]
s_setprio 1
ds_read_b128 v[44:47], v232 offset:6144
s_waitcnt lgkmcnt(9)
v_mfma_f32_16x16x32_bf16 v[172:175], v[84:87], v[68:71], v[172:175]
ds_read_b128 v[76:79], v233 offset:6144
buffer_load_dwordx4 v228, s[20:23], s44 offen offset:1024 lds
v_mul_f32 v112, v112, v12
v_mfma_f32_16x16x32_bf16 v[164:167], v[84:87], v[64:67], v[164:167]
ds_read_b128 v[40:43], v232 offset:4096
v_mul_f32 v21, v121, v121
v_mfma_f32_16x16x32_bf16 v[164:167], v[52:55], v[32:35], v[164:167]
s_setprio 0
ds_read_b128 v[72:75], v233 offset:4096
s_waitcnt lgkmcnt(10)
v_mfma_f32_16x16x32_bf16 v[192:195], v[56:59], v[32:35], v[192:195]
s_setprio 1
v_exp_f32 v18, v18
s_waitcnt lgkmcnt(8)
v_mfma_f32_16x16x32_bf16 v[192:195], v[88:91], v[64:67], v[192:195]
buffer_load_dwordx4 v228, s[20:23], s44 offen offset:2048 lds
v_mfma_f32_16x16x32_bf16 v[200:203], v[88:91], v[68:71], v[200:203]
v_fma_f32 v20, v20, s28, v2
v_mfma_f32_16x16x32_bf16 v[200:203], v[56:59], v[36:39], v[200:203]
s_setprio 0
v_mul_f32 v19, v19, v119
s_waitcnt lgkmcnt(6)
v_mfma_f32_16x16x32_bf16 v[204:207], v[60:63], v[36:39], v[204:207]
s_setprio 1
s_waitcnt lgkmcnt(4)
v_mfma_f32_16x16x32_bf16 v[204:207], v[92:95], v[68:71], v[204:207]
buffer_load_dwordx4 v228, s[20:23], s44 offen offset:3072 lds
s_add_u32 s44, s44, 4096
v_add_f32 v16, 1.0, v16
v_mfma_f32_16x16x32_bf16 v[196:199], v[92:95], v[64:67], v[196:199]
v_mfma_f32_16x16x32_bf16 v[196:199], v[60:63], v[32:35], v[196:199]
s_setprio 0
s_waitcnt vmcnt(16) lgkmcnt(0)
s_barrier
s_add_u32 m0, s41, 65536
v_rcp_f32 v15, v15
v_mfma_f32_16x16x32_bf16 v[176:179], v[48:51], v[40:43], v[176:179]
s_setprio 1
ds_read_b128 v[36:39], v232 offset:34816
v_mul_f32 v113, v113, v13
v_mfma_f32_16x16x32_bf16 v[176:179], v[80:83], v[72:75], v[176:179]
ds_read_b128 v[68:71], v233 offset:34816
buffer_load_dwordx4 v224, s[16:19], s40 offen offset:0 lds
v_mfma_f32_16x16x32_bf16 v[184:187], v[80:83], v[76:79], v[184:187]
ds_read_b128 v[32:35], v232 offset:32768
v_mul_f32 v22, v122, v122
v_mfma_f32_16x16x32_bf16 v[184:187], v[48:51], v[44:47], v[184:187]
s_setprio 0
ds_read_b128 v[64:67], v233 offset:32768
v_mfma_f32_16x16x32_bf16 v[188:191], v[52:55], v[44:47], v[188:191]
s_setprio 1
ds_read_b64_tr_b16 v[48:49], v240 offset:32768
v_exp_f32 v19, v19
v_mfma_f32_16x16x32_bf16 v[188:191], v[84:87], v[76:79], v[188:191]
ds_read_b64_tr_b16 v[50:51], v241 offset:32768
buffer_load_dwordx4 v225, s[16:19], s40 offen offset:1024 lds
v_fma_f32 v21, v21, s28, v2
v_mfma_f32_16x16x32_bf16 v[180:183], v[84:87], v[72:75], v[180:183]
ds_read_b64_tr_b16 v[80:81], v240 offset:34816
v_mfma_f32_16x16x32_bf16 v[180:183], v[52:55], v[40:43], v[180:183]
s_setprio 0
ds_read_b64_tr_b16 v[82:83], v241 offset:34816
v_mul_f32 v20, v20, v120
v_mfma_f32_16x16x32_bf16 v[208:211], v[56:59], v[40:43], v[208:211]
s_setprio 1
ds_read_b64_tr_b16 v[52:53], v240 offset:33280
v_mfma_f32_16x16x32_bf16 v[208:211], v[88:91], v[72:75], v[208:211]
ds_read_b64_tr_b16 v[54:55], v241 offset:33280
buffer_load_dwordx4 v226, s[16:19], s40 offen offset:2048 lds
v_add_f32 v17, 1.0, v17
v_mfma_f32_16x16x32_bf16 v[216:219], v[88:91], v[76:79], v[216:219]
ds_read_b64_tr_b16 v[84:85], v240 offset:35328
v_rcp_f32 v16, v16
v_mfma_f32_16x16x32_bf16 v[216:219], v[56:59], v[44:47], v[216:219]
s_setprio 0
ds_read_b64_tr_b16 v[86:87], v241 offset:35328
v_mfma_f32_16x16x32_bf16 v[220:223], v[60:63], v[44:47], v[220:223]
s_setprio 1
ds_read_b64_tr_b16 v[56:57], v240 offset:36864
v_mul_f32 v114, v114, v14
v_mfma_f32_16x16x32_bf16 v[220:223], v[92:95], v[76:79], v[220:223]
ds_read_b64_tr_b16 v[58:59], v241 offset:36864
buffer_load_dwordx4 v227, s[16:19], s40 offen offset:3072 lds
s_add_u32 s40, s40, 128
v_mfma_f32_16x16x32_bf16 v[212:215], v[92:95], v[72:75], v[212:215]
ds_read_b64_tr_b16 v[88:89], v240 offset:38912
v_mul_f32 v23, v123, v123
v_mfma_f32_16x16x32_bf16 v[212:215], v[60:63], v[40:43], v[212:215]
s_setprio 0
s_waitcnt lgkmcnt(14)
ds_read_b64_tr_b16 v[90:91], v241 offset:38912
s_waitcnt lgkmcnt(10)
v_mfma_f32_16x16x32_bf16 v[160:163], v[48:51], v[32:35], v[160:163]
s_setprio 1
ds_read_b64_tr_b16 v[60:61], v240 offset:37376
s_add_u32 m0, s41, 81920
v_exp_f32 v20, v20
s_waitcnt lgkmcnt(9)
v_mfma_f32_16x16x32_bf16 v[160:163], v[80:83], v[64:67], v[160:163]
ds_read_b64_tr_b16 v[62:63], v241 offset:37376
buffer_load_dwordx4 v228, s[20:23], s44 offen offset:0 lds
v_fma_f32 v22, v22, s28, v2
v_mfma_f32_16x16x32_bf16 v[168:171], v[80:83], v[68:71], v[168:171]
ds_read_b64_tr_b16 v[92:93], v240 offset:39424
v_mfma_f32_16x16x32_bf16 v[168:171], v[48:51], v[36:39], v[168:171]
s_setprio 0
ds_read_b64_tr_b16 v[94:95], v241 offset:39424
v_mul_f32 v21, v21, v121
s_waitcnt lgkmcnt(10)
v_mfma_f32_16x16x32_bf16 v[172:175], v[52:55], v[36:39], v[172:175]
s_setprio 1
ds_read_b128 v[44:47], v232 offset:38912
s_waitcnt lgkmcnt(9)
v_mfma_f32_16x16x32_bf16 v[172:175], v[84:87], v[68:71], v[172:175]
ds_read_b128 v[76:79], v233 offset:38912
buffer_load_dwordx4 v228, s[20:23], s44 offen offset:1024 lds
v_add_f32 v18, 1.0, v18
v_mfma_f32_16x16x32_bf16 v[164:167], v[84:87], v[64:67], v[164:167]
ds_read_b128 v[40:43], v232 offset:36864
v_rcp_f32 v17, v17
v_mfma_f32_16x16x32_bf16 v[164:167], v[52:55], v[32:35], v[164:167]
s_setprio 0
ds_read_b128 v[72:75], v233 offset:36864
s_waitcnt lgkmcnt(10)
v_mfma_f32_16x16x32_bf16 v[192:195], v[56:59], v[32:35], v[192:195]
s_setprio 1
v_mul_f32 v115, v115, v15
s_waitcnt lgkmcnt(8)
v_mfma_f32_16x16x32_bf16 v[192:195], v[88:91], v[64:67], v[192:195]
buffer_load_dwordx4 v228, s[20:23], s44 offen offset:2048 lds
v_mfma_f32_16x16x32_bf16 v[200:203], v[88:91], v[68:71], v[200:203]
v_mul_f32 v24, v124, v124
v_mfma_f32_16x16x32_bf16 v[200:203], v[56:59], v[36:39], v[200:203]
s_setprio 0
v_exp_f32 v21, v21
s_waitcnt lgkmcnt(6)
v_mfma_f32_16x16x32_bf16 v[204:207], v[60:63], v[36:39], v[204:207]
s_setprio 1
s_waitcnt lgkmcnt(4)
v_mfma_f32_16x16x32_bf16 v[204:207], v[92:95], v[68:71], v[204:207]
buffer_load_dwordx4 v228, s[20:23], s44 offen offset:3072 lds
s_add_u32 s44, s44, 4096
v_fma_f32 v23, v23, s28, v2
v_mfma_f32_16x16x32_bf16 v[196:199], v[92:95], v[64:67], v[196:199]
v_mfma_f32_16x16x32_bf16 v[196:199], v[60:63], v[32:35], v[196:199]
s_setprio 0
s_waitcnt vmcnt(16) lgkmcnt(0)
s_barrier
s_add_u32 m0, s41, 98304
v_mul_f32 v22, v22, v122
v_mfma_f32_16x16x32_bf16 v[176:179], v[48:51], v[40:43], v[176:179]
s_setprio 1
ds_read_b128 v[36:39], v230 offset:2048
v_add_f32 v19, 1.0, v19
v_mfma_f32_16x16x32_bf16 v[176:179], v[80:83], v[72:75], v[176:179]
ds_read_b128 v[68:71], v231 offset:2048
buffer_load_dwordx4 v224, s[16:19], s40 offen offset:0 lds
v_mfma_f32_16x16x32_bf16 v[184:187], v[80:83], v[76:79], v[184:187]
ds_read_b128 v[32:35], v230 offset:0
v_rcp_f32 v18, v18
v_mfma_f32_16x16x32_bf16 v[184:187], v[48:51], v[44:47], v[184:187]
s_setprio 0
ds_read_b128 v[64:67], v231 offset:0
v_mfma_f32_16x16x32_bf16 v[188:191], v[52:55], v[44:47], v[188:191]
s_setprio 1
ds_read_b64_tr_b16 v[48:49], v238 offset:0
v_mul_f32 v116, v116, v16
v_mfma_f32_16x16x32_bf16 v[188:191], v[84:87], v[76:79], v[188:191]
ds_read_b64_tr_b16 v[50:51], v239 offset:0
buffer_load_dwordx4 v225, s[16:19], s40 offen offset:1024 lds
v_mul_f32 v25, v125, v125
v_mfma_f32_16x16x32_bf16 v[180:183], v[84:87], v[72:75], v[180:183]
ds_read_b64_tr_b16 v[80:81], v238 offset:2048
v_mfma_f32_16x16x32_bf16 v[180:183], v[52:55], v[40:43], v[180:183]
s_setprio 0
ds_read_b64_tr_b16 v[82:83], v239 offset:2048
v_exp_f32 v22, v22
v_mfma_f32_16x16x32_bf16 v[208:211], v[56:59], v[40:43], v[208:211]
s_setprio 1
ds_read_b64_tr_b16 v[52:53], v238 offset:512
v_mfma_f32_16x16x32_bf16 v[208:211], v[88:91], v[72:75], v[208:211]
ds_read_b64_tr_b16 v[54:55], v239 offset:512
buffer_load_dwordx4 v226, s[16:19], s40 offen offset:2048 lds
v_fma_f32 v24, v24, s28, v2
v_mfma_f32_16x16x32_bf16 v[216:219], v[88:91], v[76:79], v[216:219]
ds_read_b64_tr_b16 v[84:85], v238 offset:2560
v_mul_f32 v23, v23, v123
v_mfma_f32_16x16x32_bf16 v[216:219], v[56:59], v[44:47], v[216:219]
s_setprio 0
ds_read_b64_tr_b16 v[86:87], v239 offset:2560
v_mfma_f32_16x16x32_bf16 v[220:223], v[60:63], v[44:47], v[220:223]
s_setprio 1
ds_read_b64_tr_b16 v[56:57], v238 offset:4096
v_add_f32 v20, 1.0, v20
v_mfma_f32_16x16x32_bf16 v[220:223], v[92:95], v[76:79], v[220:223]
ds_read_b64_tr_b16 v[58:59], v239 offset:4096
buffer_load_dwordx4 v227, s[16:19], s40 offen offset:3072 lds
s_add_u32 s40, s40, 128
v_mfma_f32_16x16x32_bf16 v[212:215], v[92:95], v[72:75], v[212:215]
ds_read_b64_tr_b16 v[88:89], v238 offset:6144
v_rcp_f32 v19, v19
v_mfma_f32_16x16x32_bf16 v[212:215], v[60:63], v[40:43], v[212:215]
s_setprio 0
s_waitcnt lgkmcnt(14)
ds_read_b64_tr_b16 v[90:91], v239 offset:6144
s_waitcnt lgkmcnt(10)
v_mfma_f32_16x16x32_bf16 v[160:163], v[48:51], v[32:35], v[160:163]
s_setprio 1
ds_read_b64_tr_b16 v[60:61], v238 offset:4608
s_add_u32 m0, s41, 114688
v_mul_f32 v117, v117, v17
s_waitcnt lgkmcnt(9)
v_mfma_f32_16x16x32_bf16 v[160:163], v[80:83], v[64:67], v[160:163]
ds_read_b64_tr_b16 v[62:63], v239 offset:4608
buffer_load_dwordx4 v228, s[20:23], s44 offen offset:0 lds
v_mul_f32 v26, v126, v126
v_mfma_f32_16x16x32_bf16 v[168:171], v[80:83], v[68:71], v[168:171]
ds_read_b64_tr_b16 v[92:93], v238 offset:6656
v_mfma_f32_16x16x32_bf16 v[168:171], v[48:51], v[36:39], v[168:171]
s_setprio 0
ds_read_b64_tr_b16 v[94:95], v239 offset:6656
v_exp_f32 v23, v23
s_waitcnt lgkmcnt(10)
v_mfma_f32_16x16x32_bf16 v[172:175], v[52:55], v[36:39], v[172:175]
s_setprio 1
ds_read_b128 v[44:47], v230 offset:6144
s_waitcnt lgkmcnt(9)
v_mfma_f32_16x16x32_bf16 v[172:175], v[84:87], v[68:71], v[172:175]
ds_read_b128 v[76:79], v231 offset:6144
buffer_load_dwordx4 v228, s[20:23], s44 offen offset:1024 lds
v_fma_f32 v25, v25, s28, v2
v_mfma_f32_16x16x32_bf16 v[164:167], v[84:87], v[64:67], v[164:167]
ds_read_b128 v[40:43], v230 offset:4096
v_mul_f32 v24, v24, v124
v_mfma_f32_16x16x32_bf16 v[164:167], v[52:55], v[32:35], v[164:167]
s_setprio 0
ds_read_b128 v[72:75], v231 offset:4096
s_waitcnt lgkmcnt(10)
v_mfma_f32_16x16x32_bf16 v[192:195], v[56:59], v[32:35], v[192:195]
s_setprio 1
v_add_f32 v21, 1.0, v21
s_waitcnt lgkmcnt(8)
v_mfma_f32_16x16x32_bf16 v[192:195], v[88:91], v[64:67], v[192:195]
buffer_load_dwordx4 v228, s[20:23], s44 offen offset:2048 lds
v_mfma_f32_16x16x32_bf16 v[200:203], v[88:91], v[68:71], v[200:203]
v_rcp_f32 v20, v20
v_mfma_f32_16x16x32_bf16 v[200:203], v[56:59], v[36:39], v[200:203]
s_setprio 0
v_mul_f32 v118, v118, v18
s_waitcnt lgkmcnt(6)
v_mfma_f32_16x16x32_bf16 v[204:207], v[60:63], v[36:39], v[204:207]
s_setprio 1
s_waitcnt lgkmcnt(4)
v_mfma_f32_16x16x32_bf16 v[204:207], v[92:95], v[68:71], v[204:207]
buffer_load_dwordx4 v228, s[20:23], s44 offen offset:3072 lds
s_add_u32 s44, s44, 4096
v_mul_f32 v27, v127, v127
v_mfma_f32_16x16x32_bf16 v[196:199], v[92:95], v[64:67], v[196:199]
v_mfma_f32_16x16x32_bf16 v[196:199], v[60:63], v[32:35], v[196:199]
s_setprio 0
s_waitcnt vmcnt(16) lgkmcnt(0)
s_barrier
s_add_u32 m0, s41, 0
v_exp_f32 v24, v24
v_mfma_f32_16x16x32_bf16 v[176:179], v[48:51], v[40:43], v[176:179]
s_setprio 1
ds_read_b128 v[36:39], v230 offset:34816
v_fma_f32 v26, v26, s28, v2
v_mfma_f32_16x16x32_bf16 v[176:179], v[80:83], v[72:75], v[176:179]
ds_read_b128 v[68:71], v231 offset:34816
buffer_load_dwordx4 v224, s[16:19], s40 offen offset:0 lds
v_mfma_f32_16x16x32_bf16 v[184:187], v[80:83], v[76:79], v[184:187]
ds_read_b128 v[32:35], v230 offset:32768
v_mul_f32 v25, v25, v125
v_mfma_f32_16x16x32_bf16 v[184:187], v[48:51], v[44:47], v[184:187]
s_setprio 0
ds_read_b128 v[64:67], v231 offset:32768
v_mfma_f32_16x16x32_bf16 v[188:191], v[52:55], v[44:47], v[188:191]
s_setprio 1
ds_read_b64_tr_b16 v[48:49], v238 offset:32768
v_add_f32 v22, 1.0, v22
v_mfma_f32_16x16x32_bf16 v[188:191], v[84:87], v[76:79], v[188:191]
ds_read_b64_tr_b16 v[50:51], v239 offset:32768
buffer_load_dwordx4 v225, s[16:19], s40 offen offset:1024 lds
v_rcp_f32 v21, v21
v_mfma_f32_16x16x32_bf16 v[180:183], v[84:87], v[72:75], v[180:183]
ds_read_b64_tr_b16 v[80:81], v238 offset:34816
v_mfma_f32_16x16x32_bf16 v[180:183], v[52:55], v[40:43], v[180:183]
s_setprio 0
ds_read_b64_tr_b16 v[82:83], v239 offset:34816
v_mul_f32 v119, v119, v19
v_mfma_f32_16x16x32_bf16 v[208:211], v[56:59], v[40:43], v[208:211]
s_setprio 1
ds_read_b64_tr_b16 v[52:53], v238 offset:33280
v_mfma_f32_16x16x32_bf16 v[208:211], v[88:91], v[72:75], v[208:211]
ds_read_b64_tr_b16 v[54:55], v239 offset:33280
buffer_load_dwordx4 v226, s[16:19], s40 offen offset:2048 lds
v_mul_f32 v12, v128, v128
v_mfma_f32_16x16x32_bf16 v[216:219], v[88:91], v[76:79], v[216:219]
ds_read_b64_tr_b16 v[84:85], v238 offset:35328
v_exp_f32 v25, v25
v_mfma_f32_16x16x32_bf16 v[216:219], v[56:59], v[44:47], v[216:219]
s_setprio 0
ds_read_b64_tr_b16 v[86:87], v239 offset:35328
v_mfma_f32_16x16x32_bf16 v[220:223], v[60:63], v[44:47], v[220:223]
s_setprio 1
ds_read_b64_tr_b16 v[56:57], v238 offset:36864
v_fma_f32 v27, v27, s28, v2
v_mfma_f32_16x16x32_bf16 v[220:223], v[92:95], v[76:79], v[220:223]
ds_read_b64_tr_b16 v[58:59], v239 offset:36864
buffer_load_dwordx4 v227, s[16:19], s40 offen offset:3072 lds
s_add_u32 s40, s40, 128
v_mfma_f32_16x16x32_bf16 v[212:215], v[92:95], v[72:75], v[212:215]
ds_read_b64_tr_b16 v[88:89], v238 offset:38912
v_mul_f32 v26, v26, v126
v_mfma_f32_16x16x32_bf16 v[212:215], v[60:63], v[40:43], v[212:215]
s_setprio 0
s_waitcnt lgkmcnt(14)
ds_read_b64_tr_b16 v[90:91], v239 offset:38912
s_waitcnt lgkmcnt(10)
v_mfma_f32_16x16x32_bf16 v[160:163], v[48:51], v[32:35], v[160:163]
s_setprio 1
ds_read_b64_tr_b16 v[60:61], v238 offset:37376
s_add_u32 m0, s41, 16384
v_add_f32 v23, 1.0, v23
s_waitcnt lgkmcnt(9)
v_mfma_f32_16x16x32_bf16 v[160:163], v[80:83], v[64:67], v[160:163]
ds_read_b64_tr_b16 v[62:63], v239 offset:37376
buffer_load_dwordx4 v228, s[20:23], s44 offen offset:0 lds
v_rcp_f32 v22, v22
v_mfma_f32_16x16x32_bf16 v[168:171], v[80:83], v[68:71], v[168:171]
ds_read_b64_tr_b16 v[92:93], v238 offset:39424
v_mfma_f32_16x16x32_bf16 v[168:171], v[48:51], v[36:39], v[168:171]
s_setprio 0
ds_read_b64_tr_b16 v[94:95], v239 offset:39424
v_mul_f32 v120, v120, v20
s_waitcnt lgkmcnt(10)
v_mfma_f32_16x16x32_bf16 v[172:175], v[52:55], v[36:39], v[172:175]
s_setprio 1
ds_read_b128 v[44:47], v230 offset:38912
s_waitcnt lgkmcnt(9)
v_mfma_f32_16x16x32_bf16 v[172:175], v[84:87], v[68:71], v[172:175]
ds_read_b128 v[76:79], v231 offset:38912
buffer_load_dwordx4 v228, s[20:23], s44 offen offset:1024 lds
v_mul_f32 v13, v129, v129
v_mfma_f32_16x16x32_bf16 v[164:167], v[84:87], v[64:67], v[164:167]
ds_read_b128 v[40:43], v230 offset:36864
v_exp_f32 v26, v26
v_mfma_f32_16x16x32_bf16 v[164:167], v[52:55], v[32:35], v[164:167]
s_setprio 0
ds_read_b128 v[72:75], v231 offset:36864
s_waitcnt lgkmcnt(10)
v_mfma_f32_16x16x32_bf16 v[192:195], v[56:59], v[32:35], v[192:195]
s_setprio 1
v_fma_f32 v12, v12, s28, v2
s_waitcnt lgkmcnt(8)
v_mfma_f32_16x16x32_bf16 v[192:195], v[88:91], v[64:67], v[192:195]
buffer_load_dwordx4 v228, s[20:23], s44 offen offset:2048 lds
v_mfma_f32_16x16x32_bf16 v[200:203], v[88:91], v[68:71], v[200:203]
v_mul_f32 v27, v27, v127
v_mfma_f32_16x16x32_bf16 v[200:203], v[56:59], v[36:39], v[200:203]
s_setprio 0
v_add_f32 v24, 1.0, v24
s_waitcnt lgkmcnt(6)
v_mfma_f32_16x16x32_bf16 v[204:207], v[60:63], v[36:39], v[204:207]
s_setprio 1
s_waitcnt lgkmcnt(4)
v_mfma_f32_16x16x32_bf16 v[204:207], v[92:95], v[68:71], v[204:207]
buffer_load_dwordx4 v228, s[20:23], s44 offen offset:3072 lds
s_add_u32 s44, s44, 4096
v_rcp_f32 v23, v23
v_mfma_f32_16x16x32_bf16 v[196:199], v[92:95], v[64:67], v[196:199]
v_mfma_f32_16x16x32_bf16 v[196:199], v[60:63], v[32:35], v[196:199]
s_setprio 0
s_waitcnt vmcnt(16) lgkmcnt(0)
s_barrier
s_add_u32 m0, s41, 32768
v_mul_f32 v121, v121, v21
v_mfma_f32_16x16x32_bf16 v[176:179], v[48:51], v[40:43], v[176:179]
s_setprio 1
ds_read_b128 v[36:39], v232 offset:2048
v_mul_f32 v14, v130, v130
v_mfma_f32_16x16x32_bf16 v[176:179], v[80:83], v[72:75], v[176:179]
ds_read_b128 v[68:71], v233 offset:2048
buffer_load_dwordx4 v224, s[16:19], s40 offen offset:0 lds
v_mfma_f32_16x16x32_bf16 v[184:187], v[80:83], v[76:79], v[184:187]
ds_read_b128 v[32:35], v232 offset:0
v_exp_f32 v27, v27
v_mfma_f32_16x16x32_bf16 v[184:187], v[48:51], v[44:47], v[184:187]
s_setprio 0
ds_read_b128 v[64:67], v233 offset:0
v_mfma_f32_16x16x32_bf16 v[188:191], v[52:55], v[44:47], v[188:191]
s_setprio 1
ds_read_b64_tr_b16 v[48:49], v240 offset:0
v_fma_f32 v13, v13, s28, v2
v_mfma_f32_16x16x32_bf16 v[188:191], v[84:87], v[76:79], v[188:191]
ds_read_b64_tr_b16 v[50:51], v241 offset:0
buffer_load_dwordx4 v225, s[16:19], s40 offen offset:1024 lds
v_mul_f32 v12, v12, v128
v_mfma_f32_16x16x32_bf16 v[180:183], v[84:87], v[72:75], v[180:183]
ds_read_b64_tr_b16 v[80:81], v240 offset:2048
v_mfma_f32_16x16x32_bf16 v[180:183], v[52:55], v[40:43], v[180:183]
s_setprio 0
ds_read_b64_tr_b16 v[82:83], v241 offset:2048
v_add_f32 v25, 1.0, v25
v_mfma_f32_16x16x32_bf16 v[208:211], v[56:59], v[40:43], v[208:211]
s_setprio 1
ds_read_b64_tr_b16 v[52:53], v240 offset:512
v_mfma_f32_16x16x32_bf16 v[208:211], v[88:91], v[72:75], v[208:211]
ds_read_b64_tr_b16 v[54:55], v241 offset:512
buffer_load_dwordx4 v226, s[16:19], s40 offen offset:2048 lds
v_rcp_f32 v24, v24
v_mfma_f32_16x16x32_bf16 v[216:219], v[88:91], v[76:79], v[216:219]
ds_read_b64_tr_b16 v[84:85], v240 offset:2560
v_mul_f32 v122, v122, v22
v_mfma_f32_16x16x32_bf16 v[216:219], v[56:59], v[44:47], v[216:219]
s_setprio 0
ds_read_b64_tr_b16 v[86:87], v241 offset:2560
v_mfma_f32_16x16x32_bf16 v[220:223], v[60:63], v[44:47], v[220:223]
s_setprio 1
ds_read_b64_tr_b16 v[56:57], v240 offset:4096
v_mul_f32 v15, v131, v131
v_mfma_f32_16x16x32_bf16 v[220:223], v[92:95], v[76:79], v[220:223]
ds_read_b64_tr_b16 v[58:59], v241 offset:4096
buffer_load_dwordx4 v227, s[16:19], s40 offen offset:3072 lds
s_add_u32 s40, s40, 128
v_mfma_f32_16x16x32_bf16 v[212:215], v[92:95], v[72:75], v[212:215]
ds_read_b64_tr_b16 v[88:89], v240 offset:6144
v_exp_f32 v12, v12
v_mfma_f32_16x16x32_bf16 v[212:215], v[60:63], v[40:43], v[212:215]
s_setprio 0
s_waitcnt lgkmcnt(14)
ds_read_b64_tr_b16 v[90:91], v241 offset:6144
s_waitcnt lgkmcnt(10)
v_mfma_f32_16x16x32_bf16 v[160:163], v[48:51], v[32:35], v[160:163]
s_setprio 1
ds_read_b64_tr_b16 v[60:61], v240 offset:4608
s_add_u32 m0, s41, 49152
v_fma_f32 v14, v14, s28, v2
s_waitcnt lgkmcnt(9)
v_mfma_f32_16x16x32_bf16 v[160:163], v[80:83], v[64:67], v[160:163]
ds_read_b64_tr_b16 v[62:63], v241 offset:4608
buffer_load_dwordx4 v228, s[20:23], s44 offen offset:0 lds
v_mul_f32 v13, v13, v129
v_mfma_f32_16x16x32_bf16 v[168:171], v[80:83], v[68:71], v[168:171]
ds_read_b64_tr_b16 v[92:93], v240 offset:6656
v_mfma_f32_16x16x32_bf16 v[168:171], v[48:51], v[36:39], v[168:171]
s_setprio 0
ds_read_b64_tr_b16 v[94:95], v241 offset:6656
v_add_f32 v26, 1.0, v26
s_waitcnt lgkmcnt(10)
v_mfma_f32_16x16x32_bf16 v[172:175], v[52:55], v[36:39], v[172:175]
s_setprio 1
ds_read_b128 v[44:47], v232 offset:6144
s_waitcnt lgkmcnt(9)
v_mfma_f32_16x16x32_bf16 v[172:175], v[84:87], v[68:71], v[172:175]
ds_read_b128 v[76:79], v233 offset:6144
buffer_load_dwordx4 v228, s[20:23], s44 offen offset:1024 lds
v_rcp_f32 v25, v25
v_mfma_f32_16x16x32_bf16 v[164:167], v[84:87], v[64:67], v[164:167]
ds_read_b128 v[40:43], v232 offset:4096
v_mfma_f32_16x16x32_bf16 v[164:167], v[52:55], v[32:35], v[164:167]
s_setprio 0
ds_read_b128 v[72:75], v233 offset:4096
v_mul_f32 v123, v123, v23
s_waitcnt lgkmcnt(10)
v_mfma_f32_16x16x32_bf16 v[192:195], v[56:59], v[32:35], v[192:195]
s_setprio 1
v_mul_f32 v16, v132, v132
s_waitcnt lgkmcnt(8)
v_mfma_f32_16x16x32_bf16 v[192:195], v[88:91], v[64:67], v[192:195]
buffer_load_dwordx4 v228, s[20:23], s44 offen offset:2048 lds
v_mfma_f32_16x16x32_bf16 v[200:203], v[88:91], v[68:71], v[200:203]
v_exp_f32 v13, v13
v_mfma_f32_16x16x32_bf16 v[200:203], v[56:59], v[36:39], v[200:203]
s_setprio 0
s_waitcnt lgkmcnt(6)
v_mfma_f32_16x16x32_bf16 v[204:207], v[60:63], v[36:39], v[204:207]
s_setprio 1
v_fma_f32 v15, v15, s28, v2
s_waitcnt lgkmcnt(4)
v_mfma_f32_16x16x32_bf16 v[204:207], v[92:95], v[68:71], v[204:207]
buffer_load_dwordx4 v228, s[20:23], s44 offen offset:3072 lds
s_add_u32 s44, s44, 4096
v_mfma_f32_16x16x32_bf16 v[196:199], v[92:95], v[64:67], v[196:199]
v_mul_f32 v14, v14, v130
v_mfma_f32_16x16x32_bf16 v[196:199], v[60:63], v[32:35], v[196:199]
s_setprio 0
s_waitcnt vmcnt(16) lgkmcnt(0)
s_barrier
s_add_u32 m0, s41, 65536
v_mfma_f32_16x16x32_bf16 v[176:179], v[48:51], v[40:43], v[176:179]
s_setprio 1
ds_read_b128 v[36:39], v232 offset:34816
v_add_f32 v27, 1.0, v27
v_mfma_f32_16x16x32_bf16 v[176:179], v[80:83], v[72:75], v[176:179]
ds_read_b128 v[68:71], v233 offset:34816
buffer_load_dwordx4 v224, s[16:19], s40 offen offset:0 lds
v_rcp_f32 v26, v26
v_mfma_f32_16x16x32_bf16 v[184:187], v[80:83], v[76:79], v[184:187]
ds_read_b128 v[32:35], v232 offset:32768
v_mfma_f32_16x16x32_bf16 v[184:187], v[48:51], v[44:47], v[184:187]
s_setprio 0
ds_read_b128 v[64:67], v233 offset:32768
v_mul_f32 v124, v124, v24
v_mfma_f32_16x16x32_bf16 v[188:191], v[52:55], v[44:47], v[188:191]
s_setprio 1
ds_read_b64_tr_b16 v[48:49], v240 offset:32768
v_mfma_f32_16x16x32_bf16 v[188:191], v[84:87], v[76:79], v[188:191]
ds_read_b64_tr_b16 v[50:51], v241 offset:32768
buffer_load_dwordx4 v225, s[16:19], s40 offen offset:1024 lds
v_mul_f32 v17, v133, v133
v_mfma_f32_16x16x32_bf16 v[180:183], v[84:87], v[72:75], v[180:183]
ds_read_b64_tr_b16 v[80:81], v240 offset:34816
v_mfma_f32_16x16x32_bf16 v[180:183], v[52:55], v[40:43], v[180:183]
s_setprio 0
ds_read_b64_tr_b16 v[82:83], v241 offset:34816
v_exp_f32 v14, v14
v_mfma_f32_16x16x32_bf16 v[208:211], v[56:59], v[40:43], v[208:211]
s_setprio 1
ds_read_b64_tr_b16 v[52:53], v240 offset:33280
v_fma_f32 v16, v16, s28, v2
v_mfma_f32_16x16x32_bf16 v[208:211], v[88:91], v[72:75], v[208:211]
ds_read_b64_tr_b16 v[54:55], v241 offset:33280
buffer_load_dwordx4 v226, s[16:19], s40 offen offset:2048 lds
v_mfma_f32_16x16x32_bf16 v[216:219], v[88:91], v[76:79], v[216:219]
ds_read_b64_tr_b16 v[84:85], v240 offset:35328
v_mul_f32 v15, v15, v131
v_mfma_f32_16x16x32_bf16 v[216:219], v[56:59], v[44:47], v[216:219]
s_setprio 0
ds_read_b64_tr_b16 v[86:87], v241 offset:35328
v_mfma_f32_16x16x32_bf16 v[220:223], v[60:63], v[44:47], v[220:223]
s_setprio 1
ds_read_b64_tr_b16 v[56:57], v240 offset:36864
v_add_f32 v12, 1.0, v12
v_mfma_f32_16x16x32_bf16 v[220:223], v[92:95], v[76:79], v[220:223]
ds_read_b64_tr_b16 v[58:59], v241 offset:36864
buffer_load_dwordx4 v227, s[16:19], s40 offen offset:3072 lds
s_add_u32 s40, s40, 128
v_mfma_f32_16x16x32_bf16 v[212:215], v[92:95], v[72:75], v[212:215]
ds_read_b64_tr_b16 v[88:89], v240 offset:38912
v_rcp_f32 v27, v27
v_mfma_f32_16x16x32_bf16 v[212:215], v[60:63], v[40:43], v[212:215]
s_setprio 0
s_waitcnt lgkmcnt(14)
ds_read_b64_tr_b16 v[90:91], v241 offset:38912
s_waitcnt lgkmcnt(10)
v_mfma_f32_16x16x32_bf16 v[160:163], v[48:51], v[32:35], v[160:163]
s_setprio 1
ds_read_b64_tr_b16 v[60:61], v240 offset:37376
s_add_u32 m0, s41, 81920
v_mul_f32 v125, v125, v25
s_waitcnt lgkmcnt(9)
v_mfma_f32_16x16x32_bf16 v[160:163], v[80:83], v[64:67], v[160:163]
ds_read_b64_tr_b16 v[62:63], v241 offset:37376
buffer_load_dwordx4 v228, s[20:23], s44 offen offset:0 lds
v_mul_f32 v18, v134, v134
v_mfma_f32_16x16x32_bf16 v[168:171], v[80:83], v[68:71], v[168:171]
ds_read_b64_tr_b16 v[92:93], v240 offset:39424
v_mfma_f32_16x16x32_bf16 v[168:171], v[48:51], v[36:39], v[168:171]
s_setprio 0
ds_read_b64_tr_b16 v[94:95], v241 offset:39424
v_exp_f32 v15, v15
s_waitcnt lgkmcnt(10)
v_mfma_f32_16x16x32_bf16 v[172:175], v[52:55], v[36:39], v[172:175]
s_setprio 1
ds_read_b128 v[44:47], v232 offset:38912
s_waitcnt lgkmcnt(9)
v_mfma_f32_16x16x32_bf16 v[172:175], v[84:87], v[68:71], v[172:175]
ds_read_b128 v[76:79], v233 offset:38912
buffer_load_dwordx4 v228, s[20:23], s44 offen offset:1024 lds
v_fma_f32 v17, v17, s28, v2
v_mfma_f32_16x16x32_bf16 v[164:167], v[84:87], v[64:67], v[164:167]
ds_read_b128 v[40:43], v232 offset:36864
v_mul_f32 v16, v16, v132
v_mfma_f32_16x16x32_bf16 v[164:167], v[52:55], v[32:35], v[164:167]
s_setprio 0
ds_read_b128 v[72:75], v233 offset:36864
s_waitcnt lgkmcnt(10)
v_mfma_f32_16x16x32_bf16 v[192:195], v[56:59], v[32:35], v[192:195]
s_setprio 1
v_add_f32 v13, 1.0, v13
s_waitcnt lgkmcnt(8)
v_mfma_f32_16x16x32_bf16 v[192:195], v[88:91], v[64:67], v[192:195]
buffer_load_dwordx4 v228, s[20:23], s44 offen offset:2048 lds
v_mfma_f32_16x16x32_bf16 v[200:203], v[88:91], v[68:71], v[200:203]
v_rcp_f32 v12, v12
v_mfma_f32_16x16x32_bf16 v[200:203], v[56:59], v[36:39], v[200:203]
s_setprio 0
v_mul_f32 v126, v126, v26
s_waitcnt lgkmcnt(6)
v_mfma_f32_16x16x32_bf16 v[204:207], v[60:63], v[36:39], v[204:207]
s_setprio 1
s_waitcnt lgkmcnt(4)
v_mfma_f32_16x16x32_bf16 v[204:207], v[92:95], v[68:71], v[204:207]
buffer_load_dwordx4 v228, s[20:23], s44 offen offset:3072 lds
s_add_u32 s44, s44, 4096
v_mul_f32 v19, v135, v135
v_mfma_f32_16x16x32_bf16 v[196:199], v[92:95], v[64:67], v[196:199]
v_mfma_f32_16x16x32_bf16 v[196:199], v[60:63], v[32:35], v[196:199]
s_setprio 0
s_waitcnt vmcnt(16) lgkmcnt(0)
s_barrier
s_add_u32 m0, s41, 98304
v_exp_f32 v16, v16
v_mfma_f32_16x16x32_bf16 v[176:179], v[48:51], v[40:43], v[176:179]
s_setprio 1
ds_read_b128 v[36:39], v230 offset:2048
v_fma_f32 v18, v18, s28, v2
v_mfma_f32_16x16x32_bf16 v[176:179], v[80:83], v[72:75], v[176:179]
ds_read_b128 v[68:71], v231 offset:2048
buffer_load_dwordx4 v224, s[16:19], s40 offen offset:0 lds
v_mfma_f32_16x16x32_bf16 v[184:187], v[80:83], v[76:79], v[184:187]
ds_read_b128 v[32:35], v230 offset:0
v_mul_f32 v17, v17, v133
v_mfma_f32_16x16x32_bf16 v[184:187], v[48:51], v[44:47], v[184:187]
s_setprio 0
ds_read_b128 v[64:67], v231 offset:0
v_mfma_f32_16x16x32_bf16 v[188:191], v[52:55], v[44:47], v[188:191]
s_setprio 1
ds_read_b64_tr_b16 v[48:49], v238 offset:0
v_add_f32 v14, 1.0, v14
v_mfma_f32_16x16x32_bf16 v[188:191], v[84:87], v[76:79], v[188:191]
ds_read_b64_tr_b16 v[50:51], v239 offset:0
buffer_load_dwordx4 v225, s[16:19], s40 offen offset:1024 lds
v_rcp_f32 v13, v13
v_mfma_f32_16x16x32_bf16 v[180:183], v[84:87], v[72:75], v[180:183]
ds_read_b64_tr_b16 v[80:81], v238 offset:2048
v_mfma_f32_16x16x32_bf16 v[180:183], v[52:55], v[40:43], v[180:183]
s_setprio 0
ds_read_b64_tr_b16 v[82:83], v239 offset:2048
v_mul_f32 v127, v127, v27
v_mfma_f32_16x16x32_bf16 v[208:211], v[56:59], v[40:43], v[208:211]
s_setprio 1
ds_read_b64_tr_b16 v[52:53], v238 offset:512
v_mfma_f32_16x16x32_bf16 v[208:211], v[88:91], v[72:75], v[208:211]
ds_read_b64_tr_b16 v[54:55], v239 offset:512
buffer_load_dwordx4 v226, s[16:19], s40 offen offset:2048 lds
v_mul_f32 v20, v136, v136
v_mfma_f32_16x16x32_bf16 v[216:219], v[88:91], v[76:79], v[216:219]
ds_read_b64_tr_b16 v[84:85], v238 offset:2560
v_exp_f32 v17, v17
v_mfma_f32_16x16x32_bf16 v[216:219], v[56:59], v[44:47], v[216:219]
s_setprio 0
ds_read_b64_tr_b16 v[86:87], v239 offset:2560
v_mfma_f32_16x16x32_bf16 v[220:223], v[60:63], v[44:47], v[220:223]
s_setprio 1
ds_read_b64_tr_b16 v[56:57], v238 offset:4096
v_fma_f32 v19, v19, s28, v2
v_mfma_f32_16x16x32_bf16 v[220:223], v[92:95], v[76:79], v[220:223]
ds_read_b64_tr_b16 v[58:59], v239 offset:4096
buffer_load_dwordx4 v227, s[16:19], s40 offen offset:3072 lds
s_add_u32 s40, s40, 128
v_mfma_f32_16x16x32_bf16 v[212:215], v[92:95], v[72:75], v[212:215]
ds_read_b64_tr_b16 v[88:89], v238 offset:6144
v_mul_f32 v18, v18, v134
v_mfma_f32_16x16x32_bf16 v[212:215], v[60:63], v[40:43], v[212:215]
s_setprio 0
s_waitcnt lgkmcnt(14)
ds_read_b64_tr_b16 v[90:91], v239 offset:6144
s_waitcnt lgkmcnt(10)
v_mfma_f32_16x16x32_bf16 v[160:163], v[48:51], v[32:35], v[160:163]
s_setprio 1
ds_read_b64_tr_b16 v[60:61], v238 offset:4608
s_add_u32 m0, s41, 114688
v_add_f32 v15, 1.0, v15
s_waitcnt lgkmcnt(9)
v_mfma_f32_16x16x32_bf16 v[160:163], v[80:83], v[64:67], v[160:163]
ds_read_b64_tr_b16 v[62:63], v239 offset:4608
buffer_load_dwordx4 v228, s[20:23], s44 offen offset:0 lds
v_rcp_f32 v14, v14
v_mfma_f32_16x16x32_bf16 v[168:171], v[80:83], v[68:71], v[168:171]
ds_read_b64_tr_b16 v[92:93], v238 offset:6656
v_mfma_f32_16x16x32_bf16 v[168:171], v[48:51], v[36:39], v[168:171]
s_setprio 0
ds_read_b64_tr_b16 v[94:95], v239 offset:6656
v_mul_f32 v128, v128, v12
s_waitcnt lgkmcnt(10)
v_mfma_f32_16x16x32_bf16 v[172:175], v[52:55], v[36:39], v[172:175]
s_setprio 1
ds_read_b128 v[44:47], v230 offset:6144
s_waitcnt lgkmcnt(9)
v_mfma_f32_16x16x32_bf16 v[172:175], v[84:87], v[68:71], v[172:175]
ds_read_b128 v[76:79], v231 offset:6144
buffer_load_dwordx4 v228, s[20:23], s44 offen offset:1024 lds
v_mul_f32 v21, v137, v137
v_mfma_f32_16x16x32_bf16 v[164:167], v[84:87], v[64:67], v[164:167]
ds_read_b128 v[40:43], v230 offset:4096
v_exp_f32 v18, v18
v_mfma_f32_16x16x32_bf16 v[164:167], v[52:55], v[32:35], v[164:167]
s_setprio 0
ds_read_b128 v[72:75], v231 offset:4096
s_waitcnt lgkmcnt(10)
v_mfma_f32_16x16x32_bf16 v[192:195], v[56:59], v[32:35], v[192:195]
s_setprio 1
v_fma_f32 v20, v20, s28, v2
s_waitcnt lgkmcnt(8)
v_mfma_f32_16x16x32_bf16 v[192:195], v[88:91], v[64:67], v[192:195]
buffer_load_dwordx4 v228, s[20:23], s44 offen offset:2048 lds
v_mfma_f32_16x16x32_bf16 v[200:203], v[88:91], v[68:71], v[200:203]
v_mul_f32 v19, v19, v135
v_mfma_f32_16x16x32_bf16 v[200:203], v[56:59], v[36:39], v[200:203]
s_setprio 0
v_add_f32 v16, 1.0, v16
s_waitcnt lgkmcnt(6)
v_mfma_f32_16x16x32_bf16 v[204:207], v[60:63], v[36:39], v[204:207]
s_setprio 1
s_waitcnt lgkmcnt(4)
v_mfma_f32_16x16x32_bf16 v[204:207], v[92:95], v[68:71], v[204:207]
buffer_load_dwordx4 v228, s[20:23], s44 offen offset:3072 lds
s_add_u32 s44, s44, 4096
v_rcp_f32 v15, v15
v_mfma_f32_16x16x32_bf16 v[196:199], v[92:95], v[64:67], v[196:199]
v_mfma_f32_16x16x32_bf16 v[196:199], v[60:63], v[32:35], v[196:199]
s_setprio 0
s_waitcnt vmcnt(16) lgkmcnt(0)
s_barrier
s_add_u32 m0, s41, 0
v_mul_f32 v129, v129, v13
v_mfma_f32_16x16x32_bf16 v[176:179], v[48:51], v[40:43], v[176:179]
s_setprio 1
ds_read_b128 v[36:39], v230 offset:34816
v_mul_f32 v22, v138, v138
v_mfma_f32_16x16x32_bf16 v[176:179], v[80:83], v[72:75], v[176:179]
ds_read_b128 v[68:71], v231 offset:34816
buffer_load_dwordx4 v224, s[16:19], s40 offen offset:0 lds
v_mfma_f32_16x16x32_bf16 v[184:187], v[80:83], v[76:79], v[184:187]
ds_read_b128 v[32:35], v230 offset:32768
v_exp_f32 v19, v19
v_mfma_f32_16x16x32_bf16 v[184:187], v[48:51], v[44:47], v[184:187]
s_setprio 0
ds_read_b128 v[64:67], v231 offset:32768
v_mfma_f32_16x16x32_bf16 v[188:191], v[52:55], v[44:47], v[188:191]
s_setprio 1
ds_read_b64_tr_b16 v[48:49], v238 offset:32768
v_fma_f32 v21, v21, s28, v2
v_mfma_f32_16x16x32_bf16 v[188:191], v[84:87], v[76:79], v[188:191]
ds_read_b64_tr_b16 v[50:51], v239 offset:32768
buffer_load_dwordx4 v225, s[16:19], s40 offen offset:1024 lds
v_mul_f32 v20, v20, v136
v_mfma_f32_16x16x32_bf16 v[180:183], v[84:87], v[72:75], v[180:183]
ds_read_b64_tr_b16 v[80:81], v238 offset:34816
v_mfma_f32_16x16x32_bf16 v[180:183], v[52:55], v[40:43], v[180:183]
s_setprio 0
ds_read_b64_tr_b16 v[82:83], v239 offset:34816
v_add_f32 v17, 1.0, v17
v_mfma_f32_16x16x32_bf16 v[208:211], v[56:59], v[40:43], v[208:211]
s_setprio 1
ds_read_b64_tr_b16 v[52:53], v238 offset:33280
v_mfma_f32_16x16x32_bf16 v[208:211], v[88:91], v[72:75], v[208:211]
ds_read_b64_tr_b16 v[54:55], v239 offset:33280
buffer_load_dwordx4 v226, s[16:19], s40 offen offset:2048 lds
v_rcp_f32 v16, v16
v_mfma_f32_16x16x32_bf16 v[216:219], v[88:91], v[76:79], v[216:219]
ds_read_b64_tr_b16 v[84:85], v238 offset:35328
v_mul_f32 v130, v130, v14
v_mfma_f32_16x16x32_bf16 v[216:219], v[56:59], v[44:47], v[216:219]
s_setprio 0
ds_read_b64_tr_b16 v[86:87], v239 offset:35328
v_mfma_f32_16x16x32_bf16 v[220:223], v[60:63], v[44:47], v[220:223]
s_setprio 1
ds_read_b64_tr_b16 v[56:57], v238 offset:36864
v_mul_f32 v23, v139, v139
v_mfma_f32_16x16x32_bf16 v[220:223], v[92:95], v[76:79], v[220:223]
ds_read_b64_tr_b16 v[58:59], v239 offset:36864
buffer_load_dwordx4 v227, s[16:19], s40 offen offset:3072 lds
s_add_u32 s40, s40, 128
v_mfma_f32_16x16x32_bf16 v[212:215], v[92:95], v[72:75], v[212:215]
ds_read_b64_tr_b16 v[88:89], v238 offset:38912
v_exp_f32 v20, v20
v_mfma_f32_16x16x32_bf16 v[212:215], v[60:63], v[40:43], v[212:215]
s_setprio 0
s_waitcnt lgkmcnt(14)
ds_read_b64_tr_b16 v[90:91], v239 offset:38912
s_waitcnt lgkmcnt(10)
v_mfma_f32_16x16x32_bf16 v[160:163], v[48:51], v[32:35], v[160:163]
s_setprio 1
ds_read_b64_tr_b16 v[60:61], v238 offset:37376
s_add_u32 m0, s41, 16384
v_fma_f32 v22, v22, s28, v2
s_waitcnt lgkmcnt(9)
v_mfma_f32_16x16x32_bf16 v[160:163], v[80:83], v[64:67], v[160:163]
ds_read_b64_tr_b16 v[62:63], v239 offset:37376
buffer_load_dwordx4 v228, s[20:23], s44 offen offset:0 lds
v_mul_f32 v21, v21, v137
v_mfma_f32_16x16x32_bf16 v[168:171], v[80:83], v[68:71], v[168:171]
ds_read_b64_tr_b16 v[92:93], v238 offset:39424
v_mfma_f32_16x16x32_bf16 v[168:171], v[48:51], v[36:39], v[168:171]
s_setprio 0
ds_read_b64_tr_b16 v[94:95], v239 offset:39424
v_add_f32 v18, 1.0, v18
s_waitcnt lgkmcnt(10)
v_mfma_f32_16x16x32_bf16 v[172:175], v[52:55], v[36:39], v[172:175]
s_setprio 1
ds_read_b128 v[44:47], v230 offset:38912
s_waitcnt lgkmcnt(9)
v_mfma_f32_16x16x32_bf16 v[172:175], v[84:87], v[68:71], v[172:175]
ds_read_b128 v[76:79], v231 offset:38912
buffer_load_dwordx4 v228, s[20:23], s44 offen offset:1024 lds
v_rcp_f32 v17, v17
v_mfma_f32_16x16x32_bf16 v[164:167], v[84:87], v[64:67], v[164:167]
ds_read_b128 v[40:43], v230 offset:36864
v_mul_f32 v131, v131, v15
v_mfma_f32_16x16x32_bf16 v[164:167], v[52:55], v[32:35], v[164:167]
s_setprio 0
ds_read_b128 v[72:75], v231 offset:36864
s_waitcnt lgkmcnt(10)
v_mfma_f32_16x16x32_bf16 v[192:195], v[56:59], v[32:35], v[192:195]
s_setprio 1
v_mul_f32 v24, v140, v140
s_waitcnt lgkmcnt(8)
v_mfma_f32_16x16x32_bf16 v[192:195], v[88:91], v[64:67], v[192:195]
buffer_load_dwordx4 v228, s[20:23], s44 offen offset:2048 lds
v_mfma_f32_16x16x32_bf16 v[200:203], v[88:91], v[68:71], v[200:203]
v_exp_f32 v21, v21
v_mfma_f32_16x16x32_bf16 v[200:203], v[56:59], v[36:39], v[200:203]
s_setprio 0
v_fma_f32 v23, v23, s28, v2
s_waitcnt lgkmcnt(6)
v_mfma_f32_16x16x32_bf16 v[204:207], v[60:63], v[36:39], v[204:207]
s_setprio 1
s_waitcnt lgkmcnt(4)
v_mfma_f32_16x16x32_bf16 v[204:207], v[92:95], v[68:71], v[204:207]
buffer_load_dwordx4 v228, s[20:23], s44 offen offset:3072 lds
s_add_u32 s44, s44, 4096
v_mul_f32 v22, v22, v138
v_mfma_f32_16x16x32_bf16 v[196:199], v[92:95], v[64:67], v[196:199]
v_mfma_f32_16x16x32_bf16 v[196:199], v[60:63], v[32:35], v[196:199]
s_setprio 0
s_waitcnt vmcnt(16) lgkmcnt(0)
s_barrier
s_add_u32 m0, s41, 32768
v_add_f32 v19, 1.0, v19
v_mfma_f32_16x16x32_bf16 v[176:179], v[48:51], v[40:43], v[176:179]
s_setprio 1
ds_read_b128 v[36:39], v232 offset:2048
v_rcp_f32 v18, v18
v_mfma_f32_16x16x32_bf16 v[176:179], v[80:83], v[72:75], v[176:179]
ds_read_b128 v[68:71], v233 offset:2048
buffer_load_dwordx4 v224, s[16:19], s40 offen offset:0 lds
v_mfma_f32_16x16x32_bf16 v[184:187], v[80:83], v[76:79], v[184:187]
ds_read_b128 v[32:35], v232 offset:0
v_mul_f32 v132, v132, v16
v_mfma_f32_16x16x32_bf16 v[184:187], v[48:51], v[44:47], v[184:187]
s_setprio 0
ds_read_b128 v[64:67], v233 offset:0
v_mfma_f32_16x16x32_bf16 v[188:191], v[52:55], v[44:47], v[188:191]
s_setprio 1
ds_read_b64_tr_b16 v[48:49], v240 offset:0
v_mul_f32 v25, v141, v141
v_mfma_f32_16x16x32_bf16 v[188:191], v[84:87], v[76:79], v[188:191]
ds_read_b64_tr_b16 v[50:51], v241 offset:0
buffer_load_dwordx4 v225, s[16:19], s40 offen offset:1024 lds
v_exp_f32 v22, v22
v_mfma_f32_16x16x32_bf16 v[180:183], v[84:87], v[72:75], v[180:183]
ds_read_b64_tr_b16 v[80:81], v240 offset:2048
v_mfma_f32_16x16x32_bf16 v[180:183], v[52:55], v[40:43], v[180:183]
s_setprio 0
ds_read_b64_tr_b16 v[82:83], v241 offset:2048
v_fma_f32 v24, v24, s28, v2
v_mfma_f32_16x16x32_bf16 v[208:211], v[56:59], v[40:43], v[208:211]
s_setprio 1
ds_read_b64_tr_b16 v[52:53], v240 offset:512
v_mfma_f32_16x16x32_bf16 v[208:211], v[88:91], v[72:75], v[208:211]
ds_read_b64_tr_b16 v[54:55], v241 offset:512
buffer_load_dwordx4 v226, s[16:19], s40 offen offset:2048 lds
v_mul_f32 v23, v23, v139
v_mfma_f32_16x16x32_bf16 v[216:219], v[88:91], v[76:79], v[216:219]
ds_read_b64_tr_b16 v[84:85], v240 offset:2560
v_add_f32 v20, 1.0, v20
v_mfma_f32_16x16x32_bf16 v[216:219], v[56:59], v[44:47], v[216:219]
s_setprio 0
ds_read_b64_tr_b16 v[86:87], v241 offset:2560
v_mfma_f32_16x16x32_bf16 v[220:223], v[60:63], v[44:47], v[220:223]
s_setprio 1
ds_read_b64_tr_b16 v[56:57], v240 offset:4096
v_rcp_f32 v19, v19
v_mfma_f32_16x16x32_bf16 v[220:223], v[92:95], v[76:79], v[220:223]
ds_read_b64_tr_b16 v[58:59], v241 offset:4096
buffer_load_dwordx4 v227, s[16:19], s40 offen offset:3072 lds
s_add_u32 s40, s40, 128
v_mfma_f32_16x16x32_bf16 v[212:215], v[92:95], v[72:75], v[212:215]
ds_read_b64_tr_b16 v[88:89], v240 offset:6144
v_mul_f32 v133, v133, v17
v_mfma_f32_16x16x32_bf16 v[212:215], v[60:63], v[40:43], v[212:215]
s_setprio 0
s_waitcnt lgkmcnt(14)
ds_read_b64_tr_b16 v[90:91], v241 offset:6144
s_waitcnt lgkmcnt(10)
v_mfma_f32_16x16x32_bf16 v[160:163], v[48:51], v[32:35], v[160:163]
s_setprio 1
ds_read_b64_tr_b16 v[60:61], v240 offset:4608
s_add_u32 m0, s41, 49152
v_mul_f32 v26, v142, v142
s_waitcnt lgkmcnt(9)
v_mfma_f32_16x16x32_bf16 v[160:163], v[80:83], v[64:67], v[160:163]
ds_read_b64_tr_b16 v[62:63], v241 offset:4608
buffer_load_dwordx4 v228, s[20:23], s44 offen offset:0 lds
v_exp_f32 v23, v23
v_mfma_f32_16x16x32_bf16 v[168:171], v[80:83], v[68:71], v[168:171]
ds_read_b64_tr_b16 v[92:93], v240 offset:6656
v_mfma_f32_16x16x32_bf16 v[168:171], v[48:51], v[36:39], v[168:171]
s_setprio 0
ds_read_b64_tr_b16 v[94:95], v241 offset:6656
v_fma_f32 v25, v25, s28, v2
s_waitcnt lgkmcnt(10)
v_mfma_f32_16x16x32_bf16 v[172:175], v[52:55], v[36:39], v[172:175]
s_setprio 1
ds_read_b128 v[44:47], v232 offset:6144
s_waitcnt lgkmcnt(9)
v_mfma_f32_16x16x32_bf16 v[172:175], v[84:87], v[68:71], v[172:175]
ds_read_b128 v[76:79], v233 offset:6144
buffer_load_dwordx4 v228, s[20:23], s44 offen offset:1024 lds
v_mul_f32 v24, v24, v140
v_mfma_f32_16x16x32_bf16 v[164:167], v[84:87], v[64:67], v[164:167]
ds_read_b128 v[40:43], v232 offset:4096
v_add_f32 v21, 1.0, v21
v_mfma_f32_16x16x32_bf16 v[164:167], v[52:55], v[32:35], v[164:167]
s_setprio 0
ds_read_b128 v[72:75], v233 offset:4096
s_waitcnt lgkmcnt(10)
v_mfma_f32_16x16x32_bf16 v[192:195], v[56:59], v[32:35], v[192:195]
s_setprio 1
v_rcp_f32 v20, v20
s_waitcnt lgkmcnt(8)
v_mfma_f32_16x16x32_bf16 v[192:195], v[88:91], v[64:67], v[192:195]
buffer_load_dwordx4 v228, s[20:23], s44 offen offset:2048 lds
v_mfma_f32_16x16x32_bf16 v[200:203], v[88:91], v[68:71], v[200:203]
v_mul_f32 v134, v134, v18
v_mfma_f32_16x16x32_bf16 v[200:203], v[56:59], v[36:39], v[200:203]
s_setprio 0
v_mul_f32 v27, v143, v143
s_waitcnt lgkmcnt(6)
v_mfma_f32_16x16x32_bf16 v[204:207], v[60:63], v[36:39], v[204:207]
s_setprio 1
s_waitcnt lgkmcnt(4)
v_mfma_f32_16x16x32_bf16 v[204:207], v[92:95], v[68:71], v[204:207]
buffer_load_dwordx4 v228, s[20:23], s44 offen offset:3072 lds
s_add_u32 s44, s44, 4096
v_exp_f32 v24, v24
v_mfma_f32_16x16x32_bf16 v[196:199], v[92:95], v[64:67], v[196:199]
v_mfma_f32_16x16x32_bf16 v[196:199], v[60:63], v[32:35], v[196:199]
s_setprio 0
s_waitcnt vmcnt(16) lgkmcnt(0)
s_barrier
s_add_u32 m0, s41, 65536
v_fma_f32 v26, v26, s28, v2
v_mfma_f32_16x16x32_bf16 v[176:179], v[48:51], v[40:43], v[176:179]
s_setprio 1
ds_read_b128 v[36:39], v232 offset:34816
v_mul_f32 v25, v25, v141
v_mfma_f32_16x16x32_bf16 v[176:179], v[80:83], v[72:75], v[176:179]
ds_read_b128 v[68:71], v233 offset:34816
buffer_load_dwordx4 v224, s[16:19], s40 offen offset:0 lds
v_mfma_f32_16x16x32_bf16 v[184:187], v[80:83], v[76:79], v[184:187]
ds_read_b128 v[32:35], v232 offset:32768
v_add_f32 v22, 1.0, v22
v_mfma_f32_16x16x32_bf16 v[184:187], v[48:51], v[44:47], v[184:187]
s_setprio 0
ds_read_b128 v[64:67], v233 offset:32768
v_mfma_f32_16x16x32_bf16 v[188:191], v[52:55], v[44:47], v[188:191]
s_setprio 1
ds_read_b64_tr_b16 v[48:49], v240 offset:32768
v_rcp_f32 v21, v21
v_mfma_f32_16x16x32_bf16 v[188:191], v[84:87], v[76:79], v[188:191]
ds_read_b64_tr_b16 v[50:51], v241 offset:32768
buffer_load_dwordx4 v225, s[16:19], s40 offen offset:1024 lds
v_mul_f32 v135, v135, v19
v_mfma_f32_16x16x32_bf16 v[180:183], v[84:87], v[72:75], v[180:183]
ds_read_b64_tr_b16 v[80:81], v240 offset:34816
v_mfma_f32_16x16x32_bf16 v[180:183], v[52:55], v[40:43], v[180:183]
s_setprio 0
ds_read_b64_tr_b16 v[82:83], v241 offset:34816
v_mul_f32 v12, v144, v144
v_mfma_f32_16x16x32_bf16 v[208:211], v[56:59], v[40:43], v[208:211]
s_setprio 1
ds_read_b64_tr_b16 v[52:53], v240 offset:33280
v_mfma_f32_16x16x32_bf16 v[208:211], v[88:91], v[72:75], v[208:211]
ds_read_b64_tr_b16 v[54:55], v241 offset:33280
buffer_load_dwordx4 v226, s[16:19], s40 offen offset:2048 lds
v_exp_f32 v25, v25
v_mfma_f32_16x16x32_bf16 v[216:219], v[88:91], v[76:79], v[216:219]
ds_read_b64_tr_b16 v[84:85], v240 offset:35328
v_fma_f32 v27, v27, s28, v2
v_mfma_f32_16x16x32_bf16 v[216:219], v[56:59], v[44:47], v[216:219]
s_setprio 0
ds_read_b64_tr_b16 v[86:87], v241 offset:35328
v_mfma_f32_16x16x32_bf16 v[220:223], v[60:63], v[44:47], v[220:223]
s_setprio 1
ds_read_b64_tr_b16 v[56:57], v240 offset:36864
v_mul_f32 v26, v26, v142
v_mfma_f32_16x16x32_bf16 v[220:223], v[92:95], v[76:79], v[220:223]
ds_read_b64_tr_b16 v[58:59], v241 offset:36864
buffer_load_dwordx4 v227, s[16:19], s40 offen offset:3072 lds
s_add_u32 s40, s40, 128
v_mfma_f32_16x16x32_bf16 v[212:215], v[92:95], v[72:75], v[212:215]
ds_read_b64_tr_b16 v[88:89], v240 offset:38912
v_add_f32 v23, 1.0, v23
v_mfma_f32_16x16x32_bf16 v[212:215], v[60:63], v[40:43], v[212:215]
s_setprio 0
s_waitcnt lgkmcnt(14)
ds_read_b64_tr_b16 v[90:91], v241 offset:38912
s_waitcnt lgkmcnt(10)
v_mfma_f32_16x16x32_bf16 v[160:163], v[48:51], v[32:35], v[160:163]
s_setprio 1
ds_read_b64_tr_b16 v[60:61], v240 offset:37376
s_add_u32 m0, s41, 81920
v_rcp_f32 v22, v22
s_waitcnt lgkmcnt(9)
v_mfma_f32_16x16x32_bf16 v[160:163], v[80:83], v[64:67], v[160:163]
ds_read_b64_tr_b16 v[62:63], v241 offset:37376
buffer_load_dwordx4 v228, s[20:23], s44 offen offset:0 lds
v_mul_f32 v136, v136, v20
v_mfma_f32_16x16x32_bf16 v[168:171], v[80:83], v[68:71], v[168:171]
ds_read_b64_tr_b16 v[92:93], v240 offset:39424
v_mfma_f32_16x16x32_bf16 v[168:171], v[48:51], v[36:39], v[168:171]
s_setprio 0
ds_read_b64_tr_b16 v[94:95], v241 offset:39424
v_mul_f32 v13, v145, v145
s_waitcnt lgkmcnt(10)
v_mfma_f32_16x16x32_bf16 v[172:175], v[52:55], v[36:39], v[172:175]
s_setprio 1
ds_read_b128 v[44:47], v232 offset:38912
s_waitcnt lgkmcnt(9)
v_mfma_f32_16x16x32_bf16 v[172:175], v[84:87], v[68:71], v[172:175]
ds_read_b128 v[76:79], v233 offset:38912
buffer_load_dwordx4 v228, s[20:23], s44 offen offset:1024 lds
v_exp_f32 v26, v26
v_mfma_f32_16x16x32_bf16 v[164:167], v[84:87], v[64:67], v[164:167]
ds_read_b128 v[40:43], v232 offset:36864
v_fma_f32 v12, v12, s28, v2
v_mfma_f32_16x16x32_bf16 v[164:167], v[52:55], v[32:35], v[164:167]
s_setprio 0
ds_read_b128 v[72:75], v233 offset:36864
s_waitcnt lgkmcnt(10)
v_mfma_f32_16x16x32_bf16 v[192:195], v[56:59], v[32:35], v[192:195]
s_setprio 1
v_mul_f32 v27, v27, v143
s_waitcnt lgkmcnt(8)
v_mfma_f32_16x16x32_bf16 v[192:195], v[88:91], v[64:67], v[192:195]
buffer_load_dwordx4 v228, s[20:23], s44 offen offset:2048 lds
v_mfma_f32_16x16x32_bf16 v[200:203], v[88:91], v[68:71], v[200:203]
v_add_f32 v24, 1.0, v24
v_mfma_f32_16x16x32_bf16 v[200:203], v[56:59], v[36:39], v[200:203]
s_setprio 0
v_rcp_f32 v23, v23
s_waitcnt lgkmcnt(6)
v_mfma_f32_16x16x32_bf16 v[204:207], v[60:63], v[36:39], v[204:207]
s_setprio 1
s_waitcnt lgkmcnt(4)
v_mfma_f32_16x16x32_bf16 v[204:207], v[92:95], v[68:71], v[204:207]
buffer_load_dwordx4 v228, s[20:23], s44 offen offset:3072 lds
s_add_u32 s44, s44, 4096
v_mul_f32 v137, v137, v21
v_mfma_f32_16x16x32_bf16 v[196:199], v[92:95], v[64:67], v[196:199]
v_mfma_f32_16x16x32_bf16 v[196:199], v[60:63], v[32:35], v[196:199]
s_setprio 0
s_waitcnt vmcnt(16) lgkmcnt(0)
s_barrier
s_add_u32 m0, s41, 98304
v_mul_f32 v14, v146, v146
v_mfma_f32_16x16x32_bf16 v[176:179], v[48:51], v[40:43], v[176:179]
s_setprio 1
ds_read_b128 v[36:39], v230 offset:2048
v_exp_f32 v27, v27
v_mfma_f32_16x16x32_bf16 v[176:179], v[80:83], v[72:75], v[176:179]
ds_read_b128 v[68:71], v231 offset:2048
buffer_load_dwordx4 v224, s[16:19], s40 offen offset:0 lds
v_mfma_f32_16x16x32_bf16 v[184:187], v[80:83], v[76:79], v[184:187]
ds_read_b128 v[32:35], v230 offset:0
v_fma_f32 v13, v13, s28, v2
v_mfma_f32_16x16x32_bf16 v[184:187], v[48:51], v[44:47], v[184:187]
s_setprio 0
ds_read_b128 v[64:67], v231 offset:0
v_mfma_f32_16x16x32_bf16 v[188:191], v[52:55], v[44:47], v[188:191]
s_setprio 1
ds_read_b64_tr_b16 v[48:49], v238 offset:0
v_mul_f32 v12, v12, v144
v_mfma_f32_16x16x32_bf16 v[188:191], v[84:87], v[76:79], v[188:191]
ds_read_b64_tr_b16 v[50:51], v239 offset:0
buffer_load_dwordx4 v225, s[16:19], s40 offen offset:1024 lds
v_add_f32 v25, 1.0, v25
v_mfma_f32_16x16x32_bf16 v[180:183], v[84:87], v[72:75], v[180:183]
ds_read_b64_tr_b16 v[80:81], v238 offset:2048
v_mfma_f32_16x16x32_bf16 v[180:183], v[52:55], v[40:43], v[180:183]
s_setprio 0
ds_read_b64_tr_b16 v[82:83], v239 offset:2048
v_rcp_f32 v24, v24
v_mfma_f32_16x16x32_bf16 v[208:211], v[56:59], v[40:43], v[208:211]
s_setprio 1
ds_read_b64_tr_b16 v[52:53], v238 offset:512
v_mfma_f32_16x16x32_bf16 v[208:211], v[88:91], v[72:75], v[208:211]
ds_read_b64_tr_b16 v[54:55], v239 offset:512
buffer_load_dwordx4 v226, s[16:19], s40 offen offset:2048 lds
v_mul_f32 v138, v138, v22
v_mfma_f32_16x16x32_bf16 v[216:219], v[88:91], v[76:79], v[216:219]
ds_read_b64_tr_b16 v[84:85], v238 offset:2560
v_mul_f32 v15, v147, v147
v_mfma_f32_16x16x32_bf16 v[216:219], v[56:59], v[44:47], v[216:219]
s_setprio 0
ds_read_b64_tr_b16 v[86:87], v239 offset:2560
v_mfma_f32_16x16x32_bf16 v[220:223], v[60:63], v[44:47], v[220:223]
s_setprio 1
ds_read_b64_tr_b16 v[56:57], v238 offset:4096
v_exp_f32 v12, v12
v_mfma_f32_16x16x32_bf16 v[220:223], v[92:95], v[76:79], v[220:223]
ds_read_b64_tr_b16 v[58:59], v239 offset:4096
buffer_load_dwordx4 v227, s[16:19], s40 offen offset:3072 lds
s_add_u32 s40, s40, 128
v_mfma_f32_16x16x32_bf16 v[212:215], v[92:95], v[72:75], v[212:215]
ds_read_b64_tr_b16 v[88:89], v238 offset:6144
v_fma_f32 v14, v14, s28, v2
v_mfma_f32_16x16x32_bf16 v[212:215], v[60:63], v[40:43], v[212:215]
s_setprio 0
s_waitcnt lgkmcnt(14)
ds_read_b64_tr_b16 v[90:91], v239 offset:6144
s_waitcnt lgkmcnt(10)
v_mfma_f32_16x16x32_bf16 v[160:163], v[48:51], v[32:35], v[160:163]
s_setprio 1
ds_read_b64_tr_b16 v[60:61], v238 offset:4608
s_add_u32 m0, s41, 114688
v_mul_f32 v13, v13, v145
s_waitcnt lgkmcnt(9)
v_mfma_f32_16x16x32_bf16 v[160:163], v[80:83], v[64:67], v[160:163]
ds_read_b64_tr_b16 v[62:63], v239 offset:4608
buffer_load_dwordx4 v228, s[20:23], s44 offen offset:0 lds
v_add_f32 v26, 1.0, v26
v_mfma_f32_16x16x32_bf16 v[168:171], v[80:83], v[68:71], v[168:171]
ds_read_b64_tr_b16 v[92:93], v238 offset:6656
v_mfma_f32_16x16x32_bf16 v[168:171], v[48:51], v[36:39], v[168:171]
s_setprio 0
ds_read_b64_tr_b16 v[94:95], v239 offset:6656
v_rcp_f32 v25, v25
s_waitcnt lgkmcnt(10)
v_mfma_f32_16x16x32_bf16 v[172:175], v[52:55], v[36:39], v[172:175]
s_setprio 1
ds_read_b128 v[44:47], v230 offset:6144
s_waitcnt lgkmcnt(9)
v_mfma_f32_16x16x32_bf16 v[172:175], v[84:87], v[68:71], v[172:175]
ds_read_b128 v[76:79], v231 offset:6144
buffer_load_dwordx4 v228, s[20:23], s44 offen offset:1024 lds
v_mul_f32 v139, v139, v23
v_mfma_f32_16x16x32_bf16 v[164:167], v[84:87], v[64:67], v[164:167]
ds_read_b128 v[40:43], v230 offset:4096
v_mfma_f32_16x16x32_bf16 v[164:167], v[52:55], v[32:35], v[164:167]
s_setprio 0
ds_read_b128 v[72:75], v231 offset:4096
v_mul_f32 v16, v148, v148
s_waitcnt lgkmcnt(10)
v_mfma_f32_16x16x32_bf16 v[192:195], v[56:59], v[32:35], v[192:195]
s_setprio 1
v_exp_f32 v13, v13
s_waitcnt lgkmcnt(8)
v_mfma_f32_16x16x32_bf16 v[192:195], v[88:91], v[64:67], v[192:195]
buffer_load_dwordx4 v228, s[20:23], s44 offen offset:2048 lds
v_mfma_f32_16x16x32_bf16 v[200:203], v[88:91], v[68:71], v[200:203]
v_fma_f32 v15, v15, s28, v2
v_mfma_f32_16x16x32_bf16 v[200:203], v[56:59], v[36:39], v[200:203]
s_setprio 0
s_waitcnt lgkmcnt(6)
v_mfma_f32_16x16x32_bf16 v[204:207], v[60:63], v[36:39], v[204:207]
s_setprio 1
v_mul_f32 v14, v14, v146
s_waitcnt lgkmcnt(4)
v_mfma_f32_16x16x32_bf16 v[204:207], v[92:95], v[68:71], v[204:207]
buffer_load_dwordx4 v228, s[20:23], s44 offen offset:3072 lds
s_add_u32 s44, s44, 4096
v_mfma_f32_16x16x32_bf16 v[196:199], v[92:95], v[64:67], v[196:199]
v_add_f32 v27, 1.0, v27
v_mfma_f32_16x16x32_bf16 v[196:199], v[60:63], v[32:35], v[196:199]
s_setprio 0
s_waitcnt vmcnt(16) lgkmcnt(0)
s_barrier
s_add_u32 m0, s41, 0
v_mfma_f32_16x16x32_bf16 v[176:179], v[48:51], v[40:43], v[176:179]
s_setprio 1
ds_read_b128 v[36:39], v230 offset:34816
v_rcp_f32 v26, v26
v_mfma_f32_16x16x32_bf16 v[176:179], v[80:83], v[72:75], v[176:179]
ds_read_b128 v[68:71], v231 offset:34816
buffer_load_dwordx4 v224, s[16:19], s40 offen offset:0 lds
v_mul_f32 v140, v140, v24
v_mfma_f32_16x16x32_bf16 v[184:187], v[80:83], v[76:79], v[184:187]
ds_read_b128 v[32:35], v230 offset:32768
v_mfma_f32_16x16x32_bf16 v[184:187], v[48:51], v[44:47], v[184:187]
s_setprio 0
ds_read_b128 v[64:67], v231 offset:32768
v_mul_f32 v17, v149, v149
v_mfma_f32_16x16x32_bf16 v[188:191], v[52:55], v[44:47], v[188:191]
s_setprio 1
ds_read_b64_tr_b16 v[48:49], v238 offset:32768
v_mfma_f32_16x16x32_bf16 v[188:191], v[84:87], v[76:79], v[188:191]
ds_read_b64_tr_b16 v[50:51], v239 offset:32768
buffer_load_dwordx4 v225, s[16:19], s40 offen offset:1024 lds
v_exp_f32 v14, v14
v_mfma_f32_16x16x32_bf16 v[180:183], v[84:87], v[72:75], v[180:183]
ds_read_b64_tr_b16 v[80:81], v238 offset:34816
v_mfma_f32_16x16x32_bf16 v[180:183], v[52:55], v[40:43], v[180:183]
s_setprio 0
ds_read_b64_tr_b16 v[82:83], v239 offset:34816
v_fma_f32 v16, v16, s28, v2
v_mfma_f32_16x16x32_bf16 v[208:211], v[56:59], v[40:43], v[208:211]
s_setprio 1
ds_read_b64_tr_b16 v[52:53], v238 offset:33280
v_mul_f32 v15, v15, v147
v_mfma_f32_16x16x32_bf16 v[208:211], v[88:91], v[72:75], v[208:211]
ds_read_b64_tr_b16 v[54:55], v239 offset:33280
buffer_load_dwordx4 v226, s[16:19], s40 offen offset:2048 lds
v_mfma_f32_16x16x32_bf16 v[216:219], v[88:91], v[76:79], v[216:219]
ds_read_b64_tr_b16 v[84:85], v238 offset:35328
v_add_f32 v12, 1.0, v12
v_mfma_f32_16x16x32_bf16 v[216:219], v[56:59], v[44:47], v[216:219]
s_setprio 0
ds_read_b64_tr_b16 v[86:87], v239 offset:35328
v_mfma_f32_16x16x32_bf16 v[220:223], v[60:63], v[44:47], v[220:223]
s_setprio 1
ds_read_b64_tr_b16 v[56:57], v238 offset:36864
v_rcp_f32 v27, v27
v_mfma_f32_16x16x32_bf16 v[220:223], v[92:95], v[76:79], v[220:223]
ds_read_b64_tr_b16 v[58:59], v239 offset:36864
buffer_load_dwordx4 v227, s[16:19], s40 offen offset:3072 lds
s_add_u32 s40, s40, 128
v_mfma_f32_16x16x32_bf16 v[212:215], v[92:95], v[72:75], v[212:215]
ds_read_b64_tr_b16 v[88:89], v238 offset:38912
v_mul_f32 v141, v141, v25
v_mfma_f32_16x16x32_bf16 v[212:215], v[60:63], v[40:43], v[212:215]
s_setprio 0
s_waitcnt lgkmcnt(14)
ds_read_b64_tr_b16 v[90:91], v239 offset:38912
s_waitcnt lgkmcnt(10)
v_mfma_f32_16x16x32_bf16 v[160:163], v[48:51], v[32:35], v[160:163]
s_setprio 1
ds_read_b64_tr_b16 v[60:61], v238 offset:37376
s_add_u32 m0, s41, 16384
v_mul_f32 v18, v150, v150
s_waitcnt lgkmcnt(9)
v_mfma_f32_16x16x32_bf16 v[160:163], v[80:83], v[64:67], v[160:163]
ds_read_b64_tr_b16 v[62:63], v239 offset:37376
buffer_load_dwordx4 v228, s[20:23], s44 offen offset:0 lds
v_exp_f32 v15, v15
v_mfma_f32_16x16x32_bf16 v[168:171], v[80:83], v[68:71], v[168:171]
ds_read_b64_tr_b16 v[92:93], v238 offset:39424
v_mfma_f32_16x16x32_bf16 v[168:171], v[48:51], v[36:39], v[168:171]
s_setprio 0
ds_read_b64_tr_b16 v[94:95], v239 offset:39424
v_fma_f32 v17, v17, s28, v2
s_waitcnt lgkmcnt(10)
v_mfma_f32_16x16x32_bf16 v[172:175], v[52:55], v[36:39], v[172:175]
s_setprio 1
ds_read_b128 v[44:47], v230 offset:38912
s_waitcnt lgkmcnt(9)
v_mfma_f32_16x16x32_bf16 v[172:175], v[84:87], v[68:71], v[172:175]
ds_read_b128 v[76:79], v231 offset:38912
buffer_load_dwordx4 v228, s[20:23], s44 offen offset:1024 lds
v_mul_f32 v16, v16, v148
v_mfma_f32_16x16x32_bf16 v[164:167], v[84:87], v[64:67], v[164:167]
ds_read_b128 v[40:43], v230 offset:36864
v_add_f32 v13, 1.0, v13
v_mfma_f32_16x16x32_bf16 v[164:167], v[52:55], v[32:35], v[164:167]
s_setprio 0
ds_read_b128 v[72:75], v231 offset:36864
s_waitcnt lgkmcnt(10)
v_mfma_f32_16x16x32_bf16 v[192:195], v[56:59], v[32:35], v[192:195]
s_setprio 1
v_rcp_f32 v12, v12
s_waitcnt lgkmcnt(8)
v_mfma_f32_16x16x32_bf16 v[192:195], v[88:91], v[64:67], v[192:195]
buffer_load_dwordx4 v228, s[20:23], s44 offen offset:2048 lds
v_mfma_f32_16x16x32_bf16 v[200:203], v[88:91], v[68:71], v[200:203]
v_mul_f32 v142, v142, v26
v_mfma_f32_16x16x32_bf16 v[200:203], v[56:59], v[36:39], v[200:203]
s_setprio 0
v_mul_f32 v19, v151, v151
s_waitcnt lgkmcnt(6)
v_mfma_f32_16x16x32_bf16 v[204:207], v[60:63], v[36:39], v[204:207]
s_setprio 1
s_waitcnt lgkmcnt(4)
v_mfma_f32_16x16x32_bf16 v[204:207], v[92:95], v[68:71], v[204:207]
buffer_load_dwordx4 v228, s[20:23], s44 offen offset:3072 lds
s_add_u32 s44, s44, 4096
v_exp_f32 v16, v16
v_mfma_f32_16x16x32_bf16 v[196:199], v[92:95], v[64:67], v[196:199]
v_mfma_f32_16x16x32_bf16 v[196:199], v[60:63], v[32:35], v[196:199]
s_setprio 0
s_waitcnt vmcnt(16) lgkmcnt(0)
s_barrier
s_add_u32 m0, s41, 32768
v_fma_f32 v18, v18, s28, v2
v_mfma_f32_16x16x32_bf16 v[176:179], v[48:51], v[40:43], v[176:179]
s_setprio 1
ds_read_b128 v[36:39], v232 offset:2048
v_mul_f32 v17, v17, v149
v_mfma_f32_16x16x32_bf16 v[176:179], v[80:83], v[72:75], v[176:179]
ds_read_b128 v[68:71], v233 offset:2048
buffer_load_dwordx4 v224, s[16:19], s40 offen offset:0 lds
v_mfma_f32_16x16x32_bf16 v[184:187], v[80:83], v[76:79], v[184:187]
ds_read_b128 v[32:35], v232 offset:0
v_add_f32 v14, 1.0, v14
v_mfma_f32_16x16x32_bf16 v[184:187], v[48:51], v[44:47], v[184:187]
s_setprio 0
ds_read_b128 v[64:67], v233 offset:0
v_mfma_f32_16x16x32_bf16 v[188:191], v[52:55], v[44:47], v[188:191]
s_setprio 1
ds_read_b64_tr_b16 v[48:49], v240 offset:0
v_rcp_f32 v13, v13
v_mfma_f32_16x16x32_bf16 v[188:191], v[84:87], v[76:79], v[188:191]
ds_read_b64_tr_b16 v[50:51], v241 offset:0
buffer_load_dwordx4 v225, s[16:19], s40 offen offset:1024 lds
v_mul_f32 v143, v143, v27
v_mfma_f32_16x16x32_bf16 v[180:183], v[84:87], v[72:75], v[180:183]
ds_read_b64_tr_b16 v[80:81], v240 offset:2048
v_mfma_f32_16x16x32_bf16 v[180:183], v[52:55], v[40:43], v[180:183]
s_setprio 0
ds_read_b64_tr_b16 v[82:83], v241 offset:2048
v_mul_f32 v20, v152, v152
v_mfma_f32_16x16x32_bf16 v[208:211], v[56:59], v[40:43], v[208:211]
s_setprio 1
ds_read_b64_tr_b16 v[52:53], v240 offset:512
v_mfma_f32_16x16x32_bf16 v[208:211], v[88:91], v[72:75], v[208:211]
ds_read_b64_tr_b16 v[54:55], v241 offset:512
buffer_load_dwordx4 v226, s[16:19], s40 offen offset:2048 lds
v_exp_f32 v17, v17
v_mfma_f32_16x16x32_bf16 v[216:219], v[88:91], v[76:79], v[216:219]
ds_read_b64_tr_b16 v[84:85], v240 offset:2560
v_fma_f32 v19, v19, s28, v2
v_mfma_f32_16x16x32_bf16 v[216:219], v[56:59], v[44:47], v[216:219]
s_setprio 0
ds_read_b64_tr_b16 v[86:87], v241 offset:2560
v_mfma_f32_16x16x32_bf16 v[220:223], v[60:63], v[44:47], v[220:223]
s_setprio 1
ds_read_b64_tr_b16 v[56:57], v240 offset:4096
v_mul_f32 v18, v18, v150
v_mfma_f32_16x16x32_bf16 v[220:223], v[92:95], v[76:79], v[220:223]
ds_read_b64_tr_b16 v[58:59], v241 offset:4096
buffer_load_dwordx4 v227, s[16:19], s40 offen offset:3072 lds
s_add_u32 s40, s40, 128
v_mfma_f32_16x16x32_bf16 v[212:215], v[92:95], v[72:75], v[212:215]
ds_read_b64_tr_b16 v[88:89], v240 offset:6144
v_add_f32 v15, 1.0, v15
v_mfma_f32_16x16x32_bf16 v[212:215], v[60:63], v[40:43], v[212:215]
s_setprio 0
s_waitcnt lgkmcnt(14)
ds_read_b64_tr_b16 v[90:91], v241 offset:6144
s_waitcnt lgkmcnt(10)
v_mfma_f32_16x16x32_bf16 v[160:163], v[48:51], v[32:35], v[160:163]
s_setprio 1
ds_read_b64_tr_b16 v[60:61], v240 offset:4608
s_add_u32 m0, s41, 49152
v_rcp_f32 v14, v14
s_waitcnt lgkmcnt(9)
v_mfma_f32_16x16x32_bf16 v[160:163], v[80:83], v[64:67], v[160:163]
ds_read_b64_tr_b16 v[62:63], v241 offset:4608
buffer_load_dwordx4 v228, s[20:23], s44 offen offset:0 lds
v_mul_f32 v144, v144, v12
v_mfma_f32_16x16x32_bf16 v[168:171], v[80:83], v[68:71], v[168:171]
ds_read_b64_tr_b16 v[92:93], v240 offset:6656
v_mfma_f32_16x16x32_bf16 v[168:171], v[48:51], v[36:39], v[168:171]
s_setprio 0
ds_read_b64_tr_b16 v[94:95], v241 offset:6656
v_mul_f32 v21, v153, v153
s_waitcnt lgkmcnt(10)
v_mfma_f32_16x16x32_bf16 v[172:175], v[52:55], v[36:39], v[172:175]
s_setprio 1
ds_read_b128 v[44:47], v232 offset:6144
s_waitcnt lgkmcnt(9)
v_mfma_f32_16x16x32_bf16 v[172:175], v[84:87], v[68:71], v[172:175]
ds_read_b128 v[76:79], v233 offset:6144
buffer_load_dwordx4 v228, s[20:23], s44 offen offset:1024 lds
v_exp_f32 v18, v18
v_mfma_f32_16x16x32_bf16 v[164:167], v[84:87], v[64:67], v[164:167]
ds_read_b128 v[40:43], v232 offset:4096
v_fma_f32 v20, v20, s28, v2
v_mfma_f32_16x16x32_bf16 v[164:167], v[52:55], v[32:35], v[164:167]
s_setprio 0
ds_read_b128 v[72:75], v233 offset:4096
s_waitcnt lgkmcnt(10)
v_mfma_f32_16x16x32_bf16 v[192:195], v[56:59], v[32:35], v[192:195]
s_setprio 1
v_mul_f32 v19, v19, v151
s_waitcnt lgkmcnt(8)
v_mfma_f32_16x16x32_bf16 v[192:195], v[88:91], v[64:67], v[192:195]
buffer_load_dwordx4 v228, s[20:23], s44 offen offset:2048 lds
v_mfma_f32_16x16x32_bf16 v[200:203], v[88:91], v[68:71], v[200:203]
v_add_f32 v16, 1.0, v16
v_mfma_f32_16x16x32_bf16 v[200:203], v[56:59], v[36:39], v[200:203]
s_setprio 0
v_rcp_f32 v15, v15
s_waitcnt lgkmcnt(6)
v_mfma_f32_16x16x32_bf16 v[204:207], v[60:63], v[36:39], v[204:207]
s_setprio 1
s_waitcnt lgkmcnt(4)
v_mfma_f32_16x16x32_bf16 v[204:207], v[92:95], v[68:71], v[204:207]
buffer_load_dwordx4 v228, s[20:23], s44 offen offset:3072 lds
s_add_u32 s44, s44, 4096
v_mul_f32 v145, v145, v13
v_mfma_f32_16x16x32_bf16 v[196:199], v[92:95], v[64:67], v[196:199]
v_mfma_f32_16x16x32_bf16 v[196:199], v[60:63], v[32:35], v[196:199]
s_setprio 0
s_waitcnt vmcnt(16) lgkmcnt(0)
s_barrier
s_add_u32 m0, s41, 65536
v_mul_f32 v22, v154, v154
v_mfma_f32_16x16x32_bf16 v[176:179], v[48:51], v[40:43], v[176:179]
s_setprio 1
ds_read_b128 v[36:39], v232 offset:34816
v_exp_f32 v19, v19
v_mfma_f32_16x16x32_bf16 v[176:179], v[80:83], v[72:75], v[176:179]
ds_read_b128 v[68:71], v233 offset:34816
buffer_load_dwordx4 v224, s[16:19], s40 offen offset:0 lds
v_mfma_f32_16x16x32_bf16 v[184:187], v[80:83], v[76:79], v[184:187]
ds_read_b128 v[32:35], v232 offset:32768
v_fma_f32 v21, v21, s28, v2
v_mfma_f32_16x16x32_bf16 v[184:187], v[48:51], v[44:47], v[184:187]
s_setprio 0
ds_read_b128 v[64:67], v233 offset:32768
v_mfma_f32_16x16x32_bf16 v[188:191], v[52:55], v[44:47], v[188:191]
s_setprio 1
ds_read_b64_tr_b16 v[48:49], v240 offset:32768
v_mul_f32 v20, v20, v152
v_mfma_f32_16x16x32_bf16 v[188:191], v[84:87], v[76:79], v[188:191]
ds_read_b64_tr_b16 v[50:51], v241 offset:32768
buffer_load_dwordx4 v225, s[16:19], s40 offen offset:1024 lds
v_add_f32 v17, 1.0, v17
v_mfma_f32_16x16x32_bf16 v[180:183], v[84:87], v[72:75], v[180:183]
ds_read_b64_tr_b16 v[80:81], v240 offset:34816
v_mfma_f32_16x16x32_bf16 v[180:183], v[52:55], v[40:43], v[180:183]
s_setprio 0
ds_read_b64_tr_b16 v[82:83], v241 offset:34816
v_rcp_f32 v16, v16
v_mfma_f32_16x16x32_bf16 v[208:211], v[56:59], v[40:43], v[208:211]
s_setprio 1
ds_read_b64_tr_b16 v[52:53], v240 offset:33280
v_mfma_f32_16x16x32_bf16 v[208:211], v[88:91], v[72:75], v[208:211]
ds_read_b64_tr_b16 v[54:55], v241 offset:33280
buffer_load_dwordx4 v226, s[16:19], s40 offen offset:2048 lds
v_mul_f32 v146, v146, v14
v_mfma_f32_16x16x32_bf16 v[216:219], v[88:91], v[76:79], v[216:219]
ds_read_b64_tr_b16 v[84:85], v240 offset:35328
v_mul_f32 v23, v155, v155
v_mfma_f32_16x16x32_bf16 v[216:219], v[56:59], v[44:47], v[216:219]
s_setprio 0
ds_read_b64_tr_b16 v[86:87], v241 offset:35328
v_mfma_f32_16x16x32_bf16 v[220:223], v[60:63], v[44:47], v[220:223]
s_setprio 1
ds_read_b64_tr_b16 v[56:57], v240 offset:36864
v_exp_f32 v20, v20
v_mfma_f32_16x16x32_bf16 v[220:223], v[92:95], v[76:79], v[220:223]
ds_read_b64_tr_b16 v[58:59], v241 offset:36864
buffer_load_dwordx4 v227, s[16:19], s40 offen offset:3072 lds
s_add_u32 s40, s40, 128
v_mfma_f32_16x16x32_bf16 v[212:215], v[92:95], v[72:75], v[212:215]
ds_read_b64_tr_b16 v[88:89], v240 offset:38912
v_fma_f32 v22, v22, s28, v2
v_mfma_f32_16x16x32_bf16 v[212:215], v[60:63], v[40:43], v[212:215]
s_setprio 0
s_waitcnt lgkmcnt(14)
ds_read_b64_tr_b16 v[90:91], v241 offset:38912
s_waitcnt lgkmcnt(10)
v_mfma_f32_16x16x32_bf16 v[160:163], v[48:51], v[32:35], v[160:163]
s_setprio 1
ds_read_b64_tr_b16 v[60:61], v240 offset:37376
s_add_u32 m0, s41, 81920
v_mul_f32 v21, v21, v153
s_waitcnt lgkmcnt(9)
v_mfma_f32_16x16x32_bf16 v[160:163], v[80:83], v[64:67], v[160:163]
ds_read_b64_tr_b16 v[62:63], v241 offset:37376
buffer_load_dwordx4 v228, s[20:23], s44 offen offset:0 lds
v_add_f32 v18, 1.0, v18
v_mfma_f32_16x16x32_bf16 v[168:171], v[80:83], v[68:71], v[168:171]
ds_read_b64_tr_b16 v[92:93], v240 offset:39424
v_mfma_f32_16x16x32_bf16 v[168:171], v[48:51], v[36:39], v[168:171]
s_setprio 0
ds_read_b64_tr_b16 v[94:95], v241 offset:39424
v_rcp_f32 v17, v17
s_waitcnt lgkmcnt(10)
v_mfma_f32_16x16x32_bf16 v[172:175], v[52:55], v[36:39], v[172:175]
s_setprio 1
ds_read_b128 v[44:47], v232 offset:38912
s_waitcnt lgkmcnt(9)
v_mfma_f32_16x16x32_bf16 v[172:175], v[84:87], v[68:71], v[172:175]
ds_read_b128 v[76:79], v233 offset:38912
buffer_load_dwordx4 v228, s[20:23], s44 offen offset:1024 lds
v_mul_f32 v147, v147, v15
v_mfma_f32_16x16x32_bf16 v[164:167], v[84:87], v[64:67], v[164:167]
ds_read_b128 v[40:43], v232 offset:36864
v_mul_f32 v24, v156, v156
v_mfma_f32_16x16x32_bf16 v[164:167], v[52:55], v[32:35], v[164:167]
s_setprio 0
ds_read_b128 v[72:75], v233 offset:36864
s_waitcnt lgkmcnt(10)
v_mfma_f32_16x16x32_bf16 v[192:195], v[56:59], v[32:35], v[192:195]
s_setprio 1
v_exp_f32 v21, v21
s_waitcnt lgkmcnt(8)
v_mfma_f32_16x16x32_bf16 v[192:195], v[88:91], v[64:67], v[192:195]
buffer_load_dwordx4 v228, s[20:23], s44 offen offset:2048 lds
v_mfma_f32_16x16x32_bf16 v[200:203], v[88:91], v[68:71], v[200:203]
v_fma_f32 v23, v23, s28, v2
v_mfma_f32_16x16x32_bf16 v[200:203], v[56:59], v[36:39], v[200:203]
s_setprio 0
v_mul_f32 v22, v22, v154
s_waitcnt lgkmcnt(6)
v_mfma_f32_16x16x32_bf16 v[204:207], v[60:63], v[36:39], v[204:207]
s_setprio 1
s_waitcnt lgkmcnt(4)
v_mfma_f32_16x16x32_bf16 v[204:207], v[92:95], v[68:71], v[204:207]
buffer_load_dwordx4 v228, s[20:23], s44 offen offset:3072 lds
s_add_u32 s44, s44, 4096
v_add_f32 v19, 1.0, v19
v_mfma_f32_16x16x32_bf16 v[196:199], v[92:95], v[64:67], v[196:199]
v_mfma_f32_16x16x32_bf16 v[196:199], v[60:63], v[32:35], v[196:199]
s_setprio 0
s_waitcnt vmcnt(16) lgkmcnt(0)
s_barrier
s_add_u32 m0, s41, 98304
v_rcp_f32 v18, v18
v_mfma_f32_16x16x32_bf16 v[176:179], v[48:51], v[40:43], v[176:179]
s_setprio 1
ds_read_b128 v[36:39], v230 offset:2048
v_mul_f32 v148, v148, v16
v_mfma_f32_16x16x32_bf16 v[176:179], v[80:83], v[72:75], v[176:179]
ds_read_b128 v[68:71], v231 offset:2048
buffer_load_dwordx4 v224, s[16:19], s40 offen offset:0 lds
v_mfma_f32_16x16x32_bf16 v[184:187], v[80:83], v[76:79], v[184:187]
ds_read_b128 v[32:35], v230 offset:0
v_mul_f32 v25, v157, v157
v_mfma_f32_16x16x32_bf16 v[184:187], v[48:51], v[44:47], v[184:187]
s_setprio 0
ds_read_b128 v[64:67], v231 offset:0
v_mfma_f32_16x16x32_bf16 v[188:191], v[52:55], v[44:47], v[188:191]
s_setprio 1
ds_read_b64_tr_b16 v[48:49], v238 offset:0
v_exp_f32 v22, v22
v_mfma_f32_16x16x32_bf16 v[188:191], v[84:87], v[76:79], v[188:191]
ds_read_b64_tr_b16 v[50:51], v239 offset:0
buffer_load_dwordx4 v225, s[16:19], s40 offen offset:1024 lds
v_fma_f32 v24, v24, s28, v2
v_mfma_f32_16x16x32_bf16 v[180:183], v[84:87], v[72:75], v[180:183]
ds_read_b64_tr_b16 v[80:81], v238 offset:2048
v_mfma_f32_16x16x32_bf16 v[180:183], v[52:55], v[40:43], v[180:183]
s_setprio 0
ds_read_b64_tr_b16 v[82:83], v239 offset:2048
v_mul_f32 v23, v23, v155
v_mfma_f32_16x16x32_bf16 v[208:211], v[56:59], v[40:43], v[208:211]
s_setprio 1
ds_read_b64_tr_b16 v[52:53], v238 offset:512
v_mfma_f32_16x16x32_bf16 v[208:211], v[88:91], v[72:75], v[208:211]
ds_read_b64_tr_b16 v[54:55], v239 offset:512
buffer_load_dwordx4 v226, s[16:19], s40 offen offset:2048 lds
v_add_f32 v20, 1.0, v20
v_mfma_f32_16x16x32_bf16 v[216:219], v[88:91], v[76:79], v[216:219]
ds_read_b64_tr_b16 v[84:85], v238 offset:2560
v_rcp_f32 v19, v19
v_mfma_f32_16x16x32_bf16 v[216:219], v[56:59], v[44:47], v[216:219]
s_setprio 0
ds_read_b64_tr_b16 v[86:87], v239 offset:2560
v_mfma_f32_16x16x32_bf16 v[220:223], v[60:63], v[44:47], v[220:223]
s_setprio 1
ds_read_b64_tr_b16 v[56:57], v238 offset:4096
v_mul_f32 v149, v149, v17
v_mfma_f32_16x16x32_bf16 v[220:223], v[92:95], v[76:79], v[220:223]
ds_read_b64_tr_b16 v[58:59], v239 offset:4096
buffer_load_dwordx4 v227, s[16:19], s40 offen offset:3072 lds
s_add_u32 s40, s40, 128
v_mfma_f32_16x16x32_bf16 v[212:215], v[92:95], v[72:75], v[212:215]
ds_read_b64_tr_b16 v[88:89], v238 offset:6144
v_mul_f32 v26, v158, v158
v_mfma_f32_16x16x32_bf16 v[212:215], v[60:63], v[40:43], v[212:215]
s_setprio 0
s_waitcnt lgkmcnt(14)
ds_read_b64_tr_b16 v[90:91], v239 offset:6144
s_waitcnt lgkmcnt(10)
v_mfma_f32_16x16x32_bf16 v[160:163], v[48:51], v[32:35], v[160:163]
s_setprio 1
ds_read_b64_tr_b16 v[60:61], v238 offset:4608
s_add_u32 m0, s41, 114688
v_exp_f32 v23, v23
s_waitcnt lgkmcnt(9)
v_mfma_f32_16x16x32_bf16 v[160:163], v[80:83], v[64:67], v[160:163]
ds_read_b64_tr_b16 v[62:63], v239 offset:4608
buffer_load_dwordx4 v228, s[20:23], s44 offen offset:0 lds
v_fma_f32 v25, v25, s28, v2
v_mfma_f32_16x16x32_bf16 v[168:171], v[80:83], v[68:71], v[168:171]
ds_read_b64_tr_b16 v[92:93], v238 offset:6656
v_mfma_f32_16x16x32_bf16 v[168:171], v[48:51], v[36:39], v[168:171]
s_setprio 0
ds_read_b64_tr_b16 v[94:95], v239 offset:6656
v_mul_f32 v24, v24, v156
s_waitcnt lgkmcnt(10)
v_mfma_f32_16x16x32_bf16 v[172:175], v[52:55], v[36:39], v[172:175]
s_setprio 1
ds_read_b128 v[44:47], v230 offset:6144
s_waitcnt lgkmcnt(9)
v_mfma_f32_16x16x32_bf16 v[172:175], v[84:87], v[68:71], v[172:175]
ds_read_b128 v[76:79], v231 offset:6144
buffer_load_dwordx4 v228, s[20:23], s44 offen offset:1024 lds
v_add_f32 v21, 1.0, v21
v_mfma_f32_16x16x32_bf16 v[164:167], v[84:87], v[64:67], v[164:167]
ds_read_b128 v[40:43], v230 offset:4096
v_rcp_f32 v20, v20
v_mfma_f32_16x16x32_bf16 v[164:167], v[52:55], v[32:35], v[164:167]
s_setprio 0
ds_read_b128 v[72:75], v231 offset:4096
s_waitcnt lgkmcnt(10)
v_mfma_f32_16x16x32_bf16 v[192:195], v[56:59], v[32:35], v[192:195]
s_setprio 1
v_mul_f32 v150, v150, v18
s_waitcnt lgkmcnt(8)
v_mfma_f32_16x16x32_bf16 v[192:195], v[88:91], v[64:67], v[192:195]
buffer_load_dwordx4 v228, s[20:23], s44 offen offset:2048 lds
v_mfma_f32_16x16x32_bf16 v[200:203], v[88:91], v[68:71], v[200:203]
v_mul_f32 v27, v159, v159
v_mfma_f32_16x16x32_bf16 v[200:203], v[56:59], v[36:39], v[200:203]
s_setprio 0
v_exp_f32 v24, v24
s_waitcnt lgkmcnt(6)
v_mfma_f32_16x16x32_bf16 v[204:207], v[60:63], v[36:39], v[204:207]
s_setprio 1
s_waitcnt lgkmcnt(4)
v_mfma_f32_16x16x32_bf16 v[204:207], v[92:95], v[68:71], v[204:207]
buffer_load_dwordx4 v228, s[20:23], s44 offen offset:3072 lds
s_add_u32 s44, s44, 4096
v_fma_f32 v26, v26, s28, v2
v_mfma_f32_16x16x32_bf16 v[196:199], v[92:95], v[64:67], v[196:199]
v_mfma_f32_16x16x32_bf16 v[196:199], v[60:63], v[32:35], v[196:199]
s_setprio 0
s_waitcnt vmcnt(16) lgkmcnt(0)
s_barrier
s_add_u32 m0, s41, 0
v_mul_f32 v25, v25, v157
v_mfma_f32_16x16x32_bf16 v[176:179], v[48:51], v[40:43], v[176:179]
s_setprio 1
ds_read_b128 v[36:39], v230 offset:34816
v_add_f32 v22, 1.0, v22
v_mfma_f32_16x16x32_bf16 v[176:179], v[80:83], v[72:75], v[176:179]
ds_read_b128 v[68:71], v231 offset:34816
buffer_load_dwordx4 v224, s[16:19], s40 offen offset:0 lds
v_mfma_f32_16x16x32_bf16 v[184:187], v[80:83], v[76:79], v[184:187]
ds_read_b128 v[32:35], v230 offset:32768
v_rcp_f32 v21, v21
v_mfma_f32_16x16x32_bf16 v[184:187], v[48:51], v[44:47], v[184:187]
s_setprio 0
ds_read_b128 v[64:67], v231 offset:32768
v_mfma_f32_16x16x32_bf16 v[188:191], v[52:55], v[44:47], v[188:191]
s_setprio 1
ds_read_b64_tr_b16 v[48:49], v238 offset:32768
v_mul_f32 v151, v151, v19
v_mfma_f32_16x16x32_bf16 v[188:191], v[84:87], v[76:79], v[188:191]
ds_read_b64_tr_b16 v[50:51], v239 offset:32768
buffer_load_dwordx4 v225, s[16:19], s40 offen offset:1024 lds
v_exp_f32 v25, v25
v_mfma_f32_16x16x32_bf16 v[180:183], v[84:87], v[72:75], v[180:183]
ds_read_b64_tr_b16 v[80:81], v238 offset:34816
v_mfma_f32_16x16x32_bf16 v[180:183], v[52:55], v[40:43], v[180:183]
s_setprio 0
ds_read_b64_tr_b16 v[82:83], v239 offset:34816
v_fma_f32 v27, v27, s28, v2
v_mfma_f32_16x16x32_bf16 v[208:211], v[56:59], v[40:43], v[208:211]
s_setprio 1
ds_read_b64_tr_b16 v[52:53], v238 offset:33280
v_mfma_f32_16x16x32_bf16 v[208:211], v[88:91], v[72:75], v[208:211]
ds_read_b64_tr_b16 v[54:55], v239 offset:33280
buffer_load_dwordx4 v226, s[16:19], s40 offen offset:2048 lds
v_mul_f32 v26, v26, v158
v_mfma_f32_16x16x32_bf16 v[216:219], v[88:91], v[76:79], v[216:219]
ds_read_b64_tr_b16 v[84:85], v238 offset:35328
v_add_f32 v23, 1.0, v23
v_mfma_f32_16x16x32_bf16 v[216:219], v[56:59], v[44:47], v[216:219]
s_setprio 0
ds_read_b64_tr_b16 v[86:87], v239 offset:35328
v_mfma_f32_16x16x32_bf16 v[220:223], v[60:63], v[44:47], v[220:223]
s_setprio 1
ds_read_b64_tr_b16 v[56:57], v238 offset:36864
v_rcp_f32 v22, v22
v_mfma_f32_16x16x32_bf16 v[220:223], v[92:95], v[76:79], v[220:223]
ds_read_b64_tr_b16 v[58:59], v239 offset:36864
buffer_load_dwordx4 v227, s[16:19], s40 offen offset:3072 lds
s_add_u32 s40, s40, 128
v_mfma_f32_16x16x32_bf16 v[212:215], v[92:95], v[72:75], v[212:215]
ds_read_b64_tr_b16 v[88:89], v238 offset:38912
v_mul_f32 v152, v152, v20
v_mfma_f32_16x16x32_bf16 v[212:215], v[60:63], v[40:43], v[212:215]
s_setprio 0
s_waitcnt lgkmcnt(14)
ds_read_b64_tr_b16 v[90:91], v239 offset:38912
s_waitcnt lgkmcnt(10)
v_mfma_f32_16x16x32_bf16 v[160:163], v[48:51], v[32:35], v[160:163]
s_setprio 1
ds_read_b64_tr_b16 v[60:61], v238 offset:37376
s_add_u32 m0, s41, 16384
v_exp_f32 v26, v26
s_waitcnt lgkmcnt(9)
v_mfma_f32_16x16x32_bf16 v[160:163], v[80:83], v[64:67], v[160:163]
ds_read_b64_tr_b16 v[62:63], v239 offset:37376
buffer_load_dwordx4 v228, s[20:23], s44 offen offset:0 lds
v_mul_f32 v27, v27, v159
v_mfma_f32_16x16x32_bf16 v[168:171], v[80:83], v[68:71], v[168:171]
ds_read_b64_tr_b16 v[92:93], v238 offset:39424
v_mfma_f32_16x16x32_bf16 v[168:171], v[48:51], v[36:39], v[168:171]
s_setprio 0
ds_read_b64_tr_b16 v[94:95], v239 offset:39424
v_add_f32 v24, 1.0, v24
s_waitcnt lgkmcnt(10)
v_mfma_f32_16x16x32_bf16 v[172:175], v[52:55], v[36:39], v[172:175]
s_setprio 1
ds_read_b128 v[44:47], v230 offset:38912
s_waitcnt lgkmcnt(9)
v_mfma_f32_16x16x32_bf16 v[172:175], v[84:87], v[68:71], v[172:175]
ds_read_b128 v[76:79], v231 offset:38912
buffer_load_dwordx4 v228, s[20:23], s44 offen offset:1024 lds
v_rcp_f32 v23, v23
v_mfma_f32_16x16x32_bf16 v[164:167], v[84:87], v[64:67], v[164:167]
ds_read_b128 v[40:43], v230 offset:36864
v_mul_f32 v153, v153, v21
v_mfma_f32_16x16x32_bf16 v[164:167], v[52:55], v[32:35], v[164:167]
s_setprio 0
ds_read_b128 v[72:75], v231 offset:36864
s_waitcnt lgkmcnt(10)
v_mfma_f32_16x16x32_bf16 v[192:195], v[56:59], v[32:35], v[192:195]
s_setprio 1
v_exp_f32 v27, v27
s_waitcnt lgkmcnt(8)
v_mfma_f32_16x16x32_bf16 v[192:195], v[88:91], v[64:67], v[192:195]
buffer_load_dwordx4 v228, s[20:23], s44 offen offset:2048 lds
v_mfma_f32_16x16x32_bf16 v[200:203], v[88:91], v[68:71], v[200:203]
v_add_f32 v25, 1.0, v25
v_mfma_f32_16x16x32_bf16 v[200:203], v[56:59], v[36:39], v[200:203]
s_setprio 0
v_rcp_f32 v24, v24
s_waitcnt lgkmcnt(6)
v_mfma_f32_16x16x32_bf16 v[204:207], v[60:63], v[36:39], v[204:207]
s_setprio 1
s_waitcnt lgkmcnt(4)
v_mfma_f32_16x16x32_bf16 v[204:207], v[92:95], v[68:71], v[204:207]
buffer_load_dwordx4 v228, s[20:23], s44 offen offset:3072 lds
s_add_u32 s44, s44, 4096
v_mul_f32 v154, v154, v22
v_mfma_f32_16x16x32_bf16 v[196:199], v[92:95], v[64:67], v[196:199]
v_mfma_f32_16x16x32_bf16 v[196:199], v[60:63], v[32:35], v[196:199]
s_setprio 0
s_waitcnt vmcnt(16) lgkmcnt(0)
s_barrier
s_add_u32 m0, s41, 32768
v_add_f32 v26, 1.0, v26
v_mfma_f32_16x16x32_bf16 v[176:179], v[48:51], v[40:43], v[176:179]
s_setprio 1
ds_read_b128 v[36:39], v232 offset:2048
v_rcp_f32 v25, v25
v_mfma_f32_16x16x32_bf16 v[176:179], v[80:83], v[72:75], v[176:179]
ds_read_b128 v[68:71], v233 offset:2048
buffer_load_dwordx4 v224, s[16:19], s40 offen offset:0 lds
v_mfma_f32_16x16x32_bf16 v[184:187], v[80:83], v[76:79], v[184:187]
ds_read_b128 v[32:35], v232 offset:0
v_mul_f32 v155, v155, v23
v_mfma_f32_16x16x32_bf16 v[184:187], v[48:51], v[44:47], v[184:187]
s_setprio 0
ds_read_b128 v[64:67], v233 offset:0
v_mfma_f32_16x16x32_bf16 v[188:191], v[52:55], v[44:47], v[188:191]
s_setprio 1
ds_read_b64_tr_b16 v[48:49], v240 offset:0
v_add_f32 v27, 1.0, v27
v_mfma_f32_16x16x32_bf16 v[188:191], v[84:87], v[76:79], v[188:191]
ds_read_b64_tr_b16 v[50:51], v241 offset:0
buffer_load_dwordx4 v225, s[16:19], s40 offen offset:1024 lds
v_rcp_f32 v26, v26
v_mfma_f32_16x16x32_bf16 v[180:183], v[84:87], v[72:75], v[180:183]
ds_read_b64_tr_b16 v[80:81], v240 offset:2048
v_mfma_f32_16x16x32_bf16 v[180:183], v[52:55], v[40:43], v[180:183]
s_setprio 0
ds_read_b64_tr_b16 v[82:83], v241 offset:2048
v_mul_f32 v156, v156, v24
v_mfma_f32_16x16x32_bf16 v[208:211], v[56:59], v[40:43], v[208:211]
s_setprio 1
ds_read_b64_tr_b16 v[52:53], v240 offset:512
v_mfma_f32_16x16x32_bf16 v[208:211], v[88:91], v[72:75], v[208:211]
ds_read_b64_tr_b16 v[54:55], v241 offset:512
buffer_load_dwordx4 v226, s[16:19], s40 offen offset:2048 lds
v_rcp_f32 v27, v27
v_mfma_f32_16x16x32_bf16 v[216:219], v[88:91], v[76:79], v[216:219]
ds_read_b64_tr_b16 v[84:85], v240 offset:2560
v_mul_f32 v157, v157, v25
v_mfma_f32_16x16x32_bf16 v[216:219], v[56:59], v[44:47], v[216:219]
s_setprio 0
ds_read_b64_tr_b16 v[86:87], v241 offset:2560
v_mfma_f32_16x16x32_bf16 v[220:223], v[60:63], v[44:47], v[220:223]
s_setprio 1
ds_read_b64_tr_b16 v[56:57], v240 offset:4096
v_mul_f32 v158, v158, v26
v_mfma_f32_16x16x32_bf16 v[220:223], v[92:95], v[76:79], v[220:223]
ds_read_b64_tr_b16 v[58:59], v241 offset:4096
buffer_load_dwordx4 v227, s[16:19], s40 offen offset:3072 lds
s_add_u32 s40, s40, 128
v_mfma_f32_16x16x32_bf16 v[212:215], v[92:95], v[72:75], v[212:215]
ds_read_b64_tr_b16 v[88:89], v240 offset:6144
v_mul_f32 v159, v159, v27
v_mfma_f32_16x16x32_bf16 v[212:215], v[60:63], v[40:43], v[212:215]
s_setprio 0
s_waitcnt lgkmcnt(14)
ds_read_b64_tr_b16 v[90:91], v241 offset:6144
s_waitcnt lgkmcnt(10)
v_mfma_f32_16x16x32_bf16 v[160:163], v[48:51], v[32:35], v[160:163]
s_setprio 1
ds_read_b64_tr_b16 v[60:61], v240 offset:4608
s_add_u32 m0, s41, 49152
s_add_u32 s52, s4, 0x2c00000
s_waitcnt lgkmcnt(9)
v_mfma_f32_16x16x32_bf16 v[160:163], v[80:83], v[64:67], v[160:163]
ds_read_b64_tr_b16 v[62:63], v241 offset:4608
buffer_load_dwordx4 v228, s[20:23], s44 offen offset:0 lds
s_addc_u32 s53, s5, 0
v_mfma_f32_16x16x32_bf16 v[168:171], v[80:83], v[68:71], v[168:171]
ds_read_b64_tr_b16 v[92:93], v240 offset:6656
s_mov_b32 s54, 0x700000
v_mfma_f32_16x16x32_bf16 v[168:171], v[48:51], v[36:39], v[168:171]
s_setprio 0
ds_read_b64_tr_b16 v[94:95], v241 offset:6656
s_waitcnt lgkmcnt(10)
v_mfma_f32_16x16x32_bf16 v[172:175], v[52:55], v[36:39], v[172:175]
s_setprio 1
ds_read_b128 v[44:47], v232 offset:6144
s_mov_b32 s55, 0x20000
s_waitcnt lgkmcnt(9)
v_mfma_f32_16x16x32_bf16 v[172:175], v[84:87], v[68:71], v[172:175]
ds_read_b128 v[76:79], v233 offset:6144
buffer_load_dwordx4 v228, s[20:23], s44 offen offset:1024 lds
s_bfe_u32 s26, s2, 0x10002
v_mfma_f32_16x16x32_bf16 v[164:167], v[84:87], v[64:67], v[164:167]
ds_read_b128 v[40:43], v232 offset:4096
v_mfma_f32_16x16x32_bf16 v[164:167], v[52:55], v[32:35], v[164:167]
s_setprio 0
ds_read_b128 v[72:75], v233 offset:4096
s_lshl_b32 s26, s26, 3
s_waitcnt lgkmcnt(10)
v_mfma_f32_16x16x32_bf16 v[192:195], v[56:59], v[32:35], v[192:195]
s_setprio 1
s_add_u32 s59, s26, s34
s_waitcnt lgkmcnt(8)
v_mfma_f32_16x16x32_bf16 v[192:195], v[88:91], v[64:67], v[192:195]
buffer_load_dwordx4 v228, s[20:23], s44 offen offset:2048 lds
v_mfma_f32_16x16x32_bf16 v[200:203], v[88:91], v[68:71], v[200:203]
s_lshl_b32 s59, s59, 7
v_mfma_f32_16x16x32_bf16 v[200:203], v[56:59], v[36:39], v[200:203]
s_setprio 0
v_bfe_u32 v10, v0, 3, 1
s_waitcnt lgkmcnt(6)
v_mfma_f32_16x16x32_bf16 v[204:207], v[60:63], v[36:39], v[204:207]
s_setprio 1
s_waitcnt lgkmcnt(4)
v_mfma_f32_16x16x32_bf16 v[204:207], v[92:95], v[68:71], v[204:207]
buffer_load_dwordx4 v228, s[20:23], s44 offen offset:3072 lds
s_add_u32 s44, s44, 4096
v_bfe_u32 v12, v0, 1, 2
v_mfma_f32_16x16x32_bf16 v[196:199], v[92:95], v[64:67], v[196:199]
v_lshl_add_u32 v10, v10, 4, v12
v_mfma_f32_16x16x32_bf16 v[196:199], v[60:63], v[32:35], v[196:199]
s_setprio 0
s_waitcnt vmcnt(16) lgkmcnt(0)
s_barrier
s_add_u32 m0, s41, 65536
v_mfma_f32_16x16x32_bf16 v[176:179], v[48:51], v[40:43], v[176:179]
s_setprio 1
ds_read_b128 v[36:39], v232 offset:34816
s_lshl_b32 s26, s42, 5
v_mfma_f32_16x16x32_bf16 v[176:179], v[80:83], v[72:75], v[176:179]
ds_read_b128 v[68:71], v233 offset:34816
buffer_load_dwordx4 v224, s[16:19], s40 offen offset:0 lds
v_add_u32 v10, s26, v10
v_mfma_f32_16x16x32_bf16 v[184:187], v[80:83], v[76:79], v[184:187]
ds_read_b128 v[32:35], v232 offset:32768
v_lshlrev_b32 v10, 11, v10
v_mfma_f32_16x16x32_bf16 v[184:187], v[48:51], v[44:47], v[184:187]
s_setprio 0
ds_read_b128 v[64:67], v233 offset:32768
v_mfma_f32_16x16x32_bf16 v[188:191], v[52:55], v[44:47], v[188:191]
s_setprio 1
ds_read_b64_tr_b16 v[48:49], v240 offset:32768
v_lshrrev_b32 v13, 4, v0
v_mfma_f32_16x16x32_bf16 v[188:191], v[84:87], v[76:79], v[188:191]
ds_read_b64_tr_b16 v[50:51], v241 offset:32768
buffer_load_dwordx4 v225, s[16:19], s40 offen offset:1024 lds
v_lshl_add_u32 v10, v13, 5, v10
v_mfma_f32_16x16x32_bf16 v[180:183], v[84:87], v[72:75], v[180:183]
ds_read_b64_tr_b16 v[80:81], v240 offset:34816
v_mfma_f32_16x16x32_bf16 v[180:183], v[52:55], v[40:43], v[180:183]
s_setprio 0
ds_read_b64_tr_b16 v[82:83], v241 offset:34816
v_and_b32 v12, 1, v0
v_mfma_f32_16x16x32_bf16 v[208:211], v[56:59], v[40:43], v[208:211]
s_setprio 1
ds_read_b64_tr_b16 v[52:53], v240 offset:33280
v_lshl_add_u32 v16, v12, 4, v10
v_mfma_f32_16x16x32_bf16 v[208:211], v[88:91], v[72:75], v[208:211]
ds_read_b64_tr_b16 v[54:55], v241 offset:33280
buffer_load_dwordx4 v226, s[16:19], s40 offen offset:2048 lds
v_mfma_f32_16x16x32_bf16 v[216:219], v[88:91], v[76:79], v[216:219]
ds_read_b64_tr_b16 v[84:85], v240 offset:35328
v_add_u32 v17, 7168, v16
v_mfma_f32_16x16x32_bf16 v[216:219], v[56:59], v[44:47], v[216:219]
s_setprio 0
ds_read_b64_tr_b16 v[86:87], v241 offset:35328
v_add_u32 v18, 14336, v16
v_mfma_f32_16x16x32_bf16 v[220:223], v[60:63], v[44:47], v[220:223]
s_setprio 1
ds_read_b64_tr_b16 v[56:57], v240 offset:36864
v_mfma_f32_16x16x32_bf16 v[220:223], v[92:95], v[76:79], v[220:223]
ds_read_b64_tr_b16 v[58:59], v241 offset:36864
buffer_load_dwordx4 v227, s[16:19], s40 offen offset:3072 lds
s_add_u32 s40, s40, 128
v_add_u32 v19, 21504, v16
v_mfma_f32_16x16x32_bf16 v[212:215], v[92:95], v[72:75], v[212:215]
ds_read_b64_tr_b16 v[88:89], v240 offset:38912
v_and_b32 v10, 15, v0
v_mfma_f32_16x16x32_bf16 v[212:215], v[60:63], v[40:43], v[212:215]
s_setprio 0
s_waitcnt lgkmcnt(14)
ds_read_b64_tr_b16 v[90:91], v241 offset:38912
s_waitcnt lgkmcnt(10)
v_mfma_f32_16x16x32_bf16 v[160:163], v[48:51], v[32:35], v[160:163]
s_setprio 1
ds_read_b64_tr_b16 v[60:61], v240 offset:37376
s_add_u32 m0, s41, 81920
v_lshlrev_b32 v10, 11, v10
s_waitcnt lgkmcnt(9)
v_mfma_f32_16x16x32_bf16 v[160:163], v[80:83], v[64:67], v[160:163]
ds_read_b64_tr_b16 v[62:63], v241 offset:37376
buffer_load_dwordx4 v228, s[20:23], s44 offen offset:0 lds
v_lshrrev_b32 v12, 5, v0
v_mfma_f32_16x16x32_bf16 v[168:171], v[80:83], v[68:71], v[168:171]
ds_read_b64_tr_b16 v[92:93], v240 offset:39424
v_lshl_add_u32 v10, v12, 4, v10
v_mfma_f32_16x16x32_bf16 v[168:171], v[48:51], v[36:39], v[168:171]
s_setprio 0
ds_read_b64_tr_b16 v[94:95], v241 offset:39424
s_waitcnt lgkmcnt(10)
v_mfma_f32_16x16x32_bf16 v[172:175], v[52:55], v[36:39], v[172:175]
s_setprio 1
ds_read_b128 v[44:47], v232 offset:38912
v_bfe_u32 v12, v0, 4, 1
s_waitcnt lgkmcnt(9)
v_mfma_f32_16x16x32_bf16 v[172:175], v[84:87], v[68:71], v[172:175]
ds_read_b128 v[76:79], v233 offset:38912
buffer_load_dwordx4 v228, s[20:23], s44 offen offset:1024 lds
v_lshl_add_u32 v28, v12, 5, v10
v_mfma_f32_16x16x32_bf16 v[164:167], v[84:87], v[64:67], v[164:167]
ds_read_b128 v[40:43], v232 offset:36864
v_mfma_f32_16x16x32_bf16 v[164:167], v[52:55], v[32:35], v[164:167]
s_setprio 0
ds_read_b128 v[72:75], v233 offset:36864
v_lshrrev_b32 v13, 5, v0
s_waitcnt lgkmcnt(10)
v_mfma_f32_16x16x32_bf16 v[192:195], v[56:59], v[32:35], v[192:195]
s_setprio 1
v_and_b32 v12, 31, v0
s_waitcnt lgkmcnt(8)
v_mfma_f32_16x16x32_bf16 v[192:195], v[88:91], v[64:67], v[192:195]
buffer_load_dwordx4 v228, s[20:23], s44 offen offset:2048 lds
v_mfma_f32_16x16x32_bf16 v[200:203], v[88:91], v[68:71], v[200:203]
v_lshlrev_b32 v12, 3, v12
v_mfma_f32_16x16x32_bf16 v[200:203], v[56:59], v[36:39], v[200:203]
s_setprio 0
v_lshl_add_u32 v22, v13, 10, v12
s_waitcnt lgkmcnt(6)
v_mfma_f32_16x16x32_bf16 v[204:207], v[60:63], v[36:39], v[204:207]
s_setprio 1
s_waitcnt lgkmcnt(4)
v_mfma_f32_16x16x32_bf16 v[204:207], v[92:95], v[68:71], v[204:207]
buffer_load_dwordx4 v228, s[20:23], s44 offen offset:3072 lds
s_add_u32 s44, s44, 4096
v_add_u32 v23, 65536, v22
v_mfma_f32_16x16x32_bf16 v[196:199], v[92:95], v[64:67], v[196:199]
v_mov_b32 v20, v11
v_mfma_f32_16x16x32_bf16 v[196:199], v[60:63], v[32:35], v[196:199]
s_setprio 0
s_waitcnt vmcnt(16) lgkmcnt(0)
s_barrier
s_add_u32 m0, s41, 98304
v_mfma_f32_16x16x32_bf16 v[176:179], v[48:51], v[40:43], v[176:179]
s_setprio 1
ds_read_b128 v[36:39], v230 offset:2048
v_add_u32 v21, 4096, v11
v_mfma_f32_16x16x32_bf16 v[176:179], v[80:83], v[72:75], v[176:179]
ds_read_b128 v[68:71], v231 offset:2048
buffer_load_dwordx4 v224, s[16:19], s40 offen offset:0 lds
s_lshl_b32 s43, s64, 2
v_mfma_f32_16x16x32_bf16 v[184:187], v[80:83], v[76:79], v[184:187]
ds_read_b128 v[32:35], v230 offset:0
s_add_u32 s43, s43, s42
v_mfma_f32_16x16x32_bf16 v[184:187], v[48:51], v[44:47], v[184:187]
s_setprio 0
ds_read_b128 v[64:67], v231 offset:0
v_mfma_f32_16x16x32_bf16 v[188:191], v[52:55], v[44:47], v[188:191]
s_setprio 1
ds_read_b64_tr_b16 v[48:49], v238 offset:0
s_bfe_u32 s75, s2, 0x10002
v_mfma_f32_16x16x32_bf16 v[188:191], v[84:87], v[76:79], v[188:191]
ds_read_b64_tr_b16 v[50:51], v239 offset:0
buffer_load_dwordx4 v225, s[16:19], s40 offen offset:1024 lds
s_mul_i32 s56, s75, 1835008
v_mfma_f32_16x16x32_bf16 v[180:183], v[84:87], v[72:75], v[180:183]
ds_read_b64_tr_b16 v[80:81], v238 offset:2048
v_mfma_f32_16x16x32_bf16 v[180:183], v[52:55], v[40:43], v[180:183]
s_setprio 0
ds_read_b64_tr_b16 v[82:83], v239 offset:2048
s_sub_u32 s57, 0, s56
v_mfma_f32_16x16x32_bf16 v[208:211], v[56:59], v[40:43], v[208:211]
s_setprio 1
ds_read_b64_tr_b16 v[52:53], v238 offset:512
s_sub_u32 s26, 0x380000, s59
v_mfma_f32_16x16x32_bf16 v[208:211], v[88:91], v[72:75], v[208:211]
ds_read_b64_tr_b16 v[54:55], v239 offset:512
buffer_load_dwordx4 v226, s[16:19], s40 offen offset:2048 lds
v_mfma_f32_16x16x32_bf16 v[216:219], v[88:91], v[76:79], v[216:219]
ds_read_b64_tr_b16 v[84:85], v238 offset:2560
s_add_u32 s12, s68, s59
v_mfma_f32_16x16x32_bf16 v[216:219], v[56:59], v[44:47], v[216:219]
s_setprio 0
ds_read_b64_tr_b16 v[86:87], v239 offset:2560
s_addc_u32 s13, s69, 0
v_mfma_f32_16x16x32_bf16 v[220:223], v[60:63], v[44:47], v[220:223]
s_setprio 1
ds_read_b64_tr_b16 v[56:57], v238 offset:4096
v_mfma_f32_16x16x32_bf16 v[220:223], v[92:95], v[76:79], v[220:223]
ds_read_b64_tr_b16 v[58:59], v239 offset:4096
buffer_load_dwordx4 v227, s[16:19], s40 offen offset:3072 lds
s_add_u32 s40, s40, 128
s_mov_b32 s14, s26
v_mfma_f32_16x16x32_bf16 v[212:215], v[92:95], v[72:75], v[212:215]
ds_read_b64_tr_b16 v[88:89], v238 offset:6144
s_mov_b32 s15, 0x20000
v_mfma_f32_16x16x32_bf16 v[212:215], v[60:63], v[40:43], v[212:215]
s_setprio 0
s_waitcnt lgkmcnt(14)
ds_read_b64_tr_b16 v[90:91], v239 offset:6144
s_waitcnt lgkmcnt(10)
v_mfma_f32_16x16x32_bf16 v[160:163], v[48:51], v[32:35], v[160:163]
s_setprio 1
ds_read_b64_tr_b16 v[60:61], v238 offset:4608
s_add_u32 m0, s41, 114688
s_waitcnt lgkmcnt(9)
v_mfma_f32_16x16x32_bf16 v[160:163], v[80:83], v[64:67], v[160:163]
ds_read_b64_tr_b16 v[62:63], v239 offset:4608
buffer_load_dwordx4 v228, s[20:23], s44 offen offset:0 lds
v_mfma_f32_16x16x32_bf16 v[168:171], v[80:83], v[68:71], v[168:171]
ds_read_b64_tr_b16 v[92:93], v238 offset:6656
v_mfma_f32_16x16x32_bf16 v[168:171], v[48:51], v[36:39], v[168:171]
s_setprio 0
ds_read_b64_tr_b16 v[94:95], v239 offset:6656
s_waitcnt lgkmcnt(10)
v_mfma_f32_16x16x32_bf16 v[172:175], v[52:55], v[36:39], v[172:175]
s_setprio 1
ds_read_b128 v[44:47], v230 offset:6144
s_waitcnt lgkmcnt(9)
v_mfma_f32_16x16x32_bf16 v[172:175], v[84:87], v[68:71], v[172:175]
ds_read_b128 v[76:79], v231 offset:6144
buffer_load_dwordx4 v228, s[20:23], s44 offen offset:1024 lds
v_mfma_f32_16x16x32_bf16 v[164:167], v[84:87], v[64:67], v[164:167]
ds_read_b128 v[40:43], v230 offset:4096
v_mfma_f32_16x16x32_bf16 v[164:167], v[52:55], v[32:35], v[164:167]
s_setprio 0
ds_read_b128 v[72:75], v231 offset:4096
s_waitcnt lgkmcnt(10)
v_mfma_f32_16x16x32_bf16 v[192:195], v[56:59], v[32:35], v[192:195]
s_setprio 1
s_waitcnt lgkmcnt(8)
v_mfma_f32_16x16x32_bf16 v[192:195], v[88:91], v[64:67], v[192:195]
buffer_load_dwordx4 v228, s[20:23], s44 offen offset:2048 lds
v_mfma_f32_16x16x32_bf16 v[200:203], v[88:91], v[68:71], v[200:203]
v_mfma_f32_16x16x32_bf16 v[200:203], v[56:59], v[36:39], v[200:203]
s_setprio 0
s_waitcnt lgkmcnt(6)
v_mfma_f32_16x16x32_bf16 v[204:207], v[60:63], v[36:39], v[204:207]
s_setprio 1
s_waitcnt lgkmcnt(4)
v_mfma_f32_16x16x32_bf16 v[204:207], v[92:95], v[68:71], v[204:207]
buffer_load_dwordx4 v228, s[20:23], s44 offen offset:3072 lds
s_add_u32 s44, s44, 4096
v_mfma_f32_16x16x32_bf16 v[196:199], v[92:95], v[64:67], v[196:199]
v_mfma_f32_16x16x32_bf16 v[196:199], v[60:63], v[32:35], v[196:199]
s_setprio 0
s_waitcnt vmcnt(16) lgkmcnt(0)
s_barrier
s_add_u32 m0, s41, 0
s_add_u32 s58, s56, 0
v_mfma_f32_16x16x32_bf16 v[176:179], v[48:51], v[40:43], v[176:179]
s_setprio 1
ds_read_b128 v[36:39], v230 offset:34816
v_mfma_f32_16x16x32_bf16 v[176:179], v[80:83], v[72:75], v[176:179]
ds_read_b128 v[68:71], v231 offset:34816
buffer_load_dwordx4 v16, s[12:15], s58 offen offset:0 lds
v_mfma_f32_16x16x32_bf16 v[184:187], v[80:83], v[76:79], v[184:187]
ds_read_b128 v[32:35], v230 offset:32768
v_mfma_f32_16x16x32_bf16 v[184:187], v[48:51], v[44:47], v[184:187]
s_setprio 0
ds_read_b128 v[64:67], v231 offset:32768
v_mfma_f32_16x16x32_bf16 v[188:191], v[52:55], v[44:47], v[188:191]
s_setprio 1
ds_read_b64_tr_b16 v[48:49], v238 offset:32768
v_mfma_f32_16x16x32_bf16 v[188:191], v[84:87], v[76:79], v[188:191]
ds_read_b64_tr_b16 v[50:51], v239 offset:32768
buffer_load_dwordx4 v17, s[12:15], s58 offen offset:1024 lds
v_mfma_f32_16x16x32_bf16 v[180:183], v[84:87], v[72:75], v[180:183]
ds_read_b64_tr_b16 v[80:81], v238 offset:34816
v_mfma_f32_16x16x32_bf16 v[180:183], v[52:55], v[40:43], v[180:183]
s_setprio 0
ds_read_b64_tr_b16 v[82:83], v239 offset:34816
v_mfma_f32_16x16x32_bf16 v[208:211], v[56:59], v[40:43], v[208:211]
s_setprio 1
ds_read_b64_tr_b16 v[52:53], v238 offset:33280
v_mfma_f32_16x16x32_bf16 v[208:211], v[88:91], v[72:75], v[208:211]
ds_read_b64_tr_b16 v[54:55], v239 offset:33280
buffer_load_dwordx4 v18, s[12:15], s58 offen offset:2048 lds
v_mfma_f32_16x16x32_bf16 v[216:219], v[88:91], v[76:79], v[216:219]
ds_read_b64_tr_b16 v[84:85], v238 offset:35328
v_mfma_f32_16x16x32_bf16 v[216:219], v[56:59], v[44:47], v[216:219]
s_setprio 0
ds_read_b64_tr_b16 v[86:87], v239 offset:35328
v_mfma_f32_16x16x32_bf16 v[220:223], v[60:63], v[44:47], v[220:223]
s_setprio 1
ds_read_b64_tr_b16 v[56:57], v238 offset:36864
v_mfma_f32_16x16x32_bf16 v[220:223], v[92:95], v[76:79], v[220:223]
ds_read_b64_tr_b16 v[58:59], v239 offset:36864
buffer_load_dwordx4 v19, s[12:15], s58 offen offset:3072 lds
v_mfma_f32_16x16x32_bf16 v[212:215], v[92:95], v[72:75], v[212:215]
ds_read_b64_tr_b16 v[88:89], v238 offset:38912
v_mfma_f32_16x16x32_bf16 v[212:215], v[60:63], v[40:43], v[212:215]
s_setprio 0
s_waitcnt lgkmcnt(14)
ds_read_b64_tr_b16 v[90:91], v239 offset:38912
s_add_u32 m0, s41, 16384
s_add_u32 s58, s56, 262144
s_waitcnt lgkmcnt(10)
v_mfma_f32_16x16x32_bf16 v[160:163], v[48:51], v[32:35], v[160:163]
s_setprio 1
ds_read_b64_tr_b16 v[60:61], v238 offset:37376
s_waitcnt lgkmcnt(9)
v_mfma_f32_16x16x32_bf16 v[160:163], v[80:83], v[64:67], v[160:163]
ds_read_b64_tr_b16 v[62:63], v239 offset:37376
buffer_load_dwordx4 v16, s[12:15], s58 offen offset:0 lds
v_mfma_f32_16x16x32_bf16 v[168:171], v[80:83], v[68:71], v[168:171]
ds_read_b64_tr_b16 v[92:93], v238 offset:39424
v_mfma_f32_16x16x32_bf16 v[168:171], v[48:51], v[36:39], v[168:171]
s_setprio 0
ds_read_b64_tr_b16 v[94:95], v239 offset:39424
s_waitcnt lgkmcnt(10)
v_mfma_f32_16x16x32_bf16 v[172:175], v[52:55], v[36:39], v[172:175]
s_setprio 1
ds_read_b128 v[44:47], v230 offset:38912
s_waitcnt lgkmcnt(9)
v_mfma_f32_16x16x32_bf16 v[172:175], v[84:87], v[68:71], v[172:175]
ds_read_b128 v[76:79], v231 offset:38912
buffer_load_dwordx4 v17, s[12:15], s58 offen offset:1024 lds
v_mfma_f32_16x16x32_bf16 v[164:167], v[84:87], v[64:67], v[164:167]
ds_read_b128 v[40:43], v230 offset:36864
v_mfma_f32_16x16x32_bf16 v[164:167], v[52:55], v[32:35], v[164:167]
s_setprio 0
ds_read_b128 v[72:75], v231 offset:36864
s_waitcnt lgkmcnt(10)
v_mfma_f32_16x16x32_bf16 v[192:195], v[56:59], v[32:35], v[192:195]
s_setprio 1
s_waitcnt lgkmcnt(8)
v_mfma_f32_16x16x32_bf16 v[192:195], v[88:91], v[64:67], v[192:195]
buffer_load_dwordx4 v18, s[12:15], s58 offen offset:2048 lds
v_mfma_f32_16x16x32_bf16 v[200:203], v[88:91], v[68:71], v[200:203]
v_mfma_f32_16x16x32_bf16 v[200:203], v[56:59], v[36:39], v[200:203]
s_setprio 0
s_waitcnt lgkmcnt(6)
v_mfma_f32_16x16x32_bf16 v[204:207], v[60:63], v[36:39], v[204:207]
s_setprio 1
s_waitcnt lgkmcnt(4)
v_mfma_f32_16x16x32_bf16 v[204:207], v[92:95], v[68:71], v[204:207]
buffer_load_dwordx4 v19, s[12:15], s58 offen offset:3072 lds
v_mfma_f32_16x16x32_bf16 v[196:199], v[92:95], v[64:67], v[196:199]
v_mfma_f32_16x16x32_bf16 v[196:199], v[60:63], v[32:35], v[196:199]
s_setprio 0
s_waitcnt vmcnt(16) lgkmcnt(0)
s_barrier
s_add_u32 m0, s41, 32768
s_add_u32 s58, s56, 524288
v_mfma_f32_16x16x32_bf16 v[176:179], v[48:51], v[40:43], v[176:179]
s_setprio 1
ds_read_b128 v[36:39], v232 offset:2048
v_mfma_f32_16x16x32_bf16 v[176:179], v[80:83], v[72:75], v[176:179]
ds_read_b128 v[68:71], v233 offset:2048
buffer_load_dwordx4 v16, s[12:15], s58 offen offset:0 lds
v_mfma_f32_16x16x32_bf16 v[184:187], v[80:83], v[76:79], v[184:187]
ds_read_b128 v[32:35], v232 offset:0
v_mfma_f32_16x16x32_bf16 v[184:187], v[48:51], v[44:47], v[184:187]
s_setprio 0
ds_read_b128 v[64:67], v233 offset:0
v_mfma_f32_16x16x32_bf16 v[188:191], v[52:55], v[44:47], v[188:191]
s_setprio 1
ds_read_b64_tr_b16 v[48:49], v240 offset:0
v_mfma_f32_16x16x32_bf16 v[188:191], v[84:87], v[76:79], v[188:191]
ds_read_b64_tr_b16 v[50:51], v241 offset:0
buffer_load_dwordx4 v17, s[12:15], s58 offen offset:1024 lds
v_mfma_f32_16x16x32_bf16 v[180:183], v[84:87], v[72:75], v[180:183]
ds_read_b64_tr_b16 v[80:81], v240 offset:2048
v_mfma_f32_16x16x32_bf16 v[180:183], v[52:55], v[40:43], v[180:183]
s_setprio 0
ds_read_b64_tr_b16 v[82:83], v241 offset:2048
v_mfma_f32_16x16x32_bf16 v[208:211], v[56:59], v[40:43], v[208:211]
s_setprio 1
ds_read_b64_tr_b16 v[52:53], v240 offset:512
v_mfma_f32_16x16x32_bf16 v[208:211], v[88:91], v[72:75], v[208:211]
ds_read_b64_tr_b16 v[54:55], v241 offset:512
buffer_load_dwordx4 v18, s[12:15], s58 offen offset:2048 lds
v_mfma_f32_16x16x32_bf16 v[216:219], v[88:91], v[76:79], v[216:219]
ds_read_b64_tr_b16 v[84:85], v240 offset:2560
v_mfma_f32_16x16x32_bf16 v[216:219], v[56:59], v[44:47], v[216:219]
s_setprio 0
ds_read_b64_tr_b16 v[86:87], v241 offset:2560
v_mfma_f32_16x16x32_bf16 v[220:223], v[60:63], v[44:47], v[220:223]
s_setprio 1
ds_read_b64_tr_b16 v[56:57], v240 offset:4096
v_mfma_f32_16x16x32_bf16 v[220:223], v[92:95], v[76:79], v[220:223]
ds_read_b64_tr_b16 v[58:59], v241 offset:4096
buffer_load_dwordx4 v19, s[12:15], s58 offen offset:3072 lds
v_mfma_f32_16x16x32_bf16 v[212:215], v[92:95], v[72:75], v[212:215]
ds_read_b64_tr_b16 v[88:89], v240 offset:6144
v_mfma_f32_16x16x32_bf16 v[212:215], v[60:63], v[40:43], v[212:215]
s_setprio 0
s_waitcnt lgkmcnt(14)
ds_read_b64_tr_b16 v[90:91], v241 offset:6144
s_add_u32 m0, s41, 49152
s_add_u32 s58, s56, 786432
s_waitcnt lgkmcnt(10)
v_mfma_f32_16x16x32_bf16 v[160:163], v[48:51], v[32:35], v[160:163]
s_setprio 1
ds_read_b64_tr_b16 v[60:61], v240 offset:4608
s_waitcnt lgkmcnt(9)
v_mfma_f32_16x16x32_bf16 v[160:163], v[80:83], v[64:67], v[160:163]
ds_read_b64_tr_b16 v[62:63], v241 offset:4608
buffer_load_dwordx4 v16, s[12:15], s58 offen offset:0 lds
v_mfma_f32_16x16x32_bf16 v[168:171], v[80:83], v[68:71], v[168:171]
ds_read_b64_tr_b16 v[92:93], v240 offset:6656
v_mfma_f32_16x16x32_bf16 v[168:171], v[48:51], v[36:39], v[168:171]
s_setprio 0
ds_read_b64_tr_b16 v[94:95], v241 offset:6656
s_waitcnt lgkmcnt(10)
v_mfma_f32_16x16x32_bf16 v[172:175], v[52:55], v[36:39], v[172:175]
s_setprio 1
ds_read_b128 v[44:47], v232 offset:6144
s_waitcnt lgkmcnt(9)
v_mfma_f32_16x16x32_bf16 v[172:175], v[84:87], v[68:71], v[172:175]
ds_read_b128 v[76:79], v233 offset:6144
buffer_load_dwordx4 v17, s[12:15], s58 offen offset:1024 lds
v_mfma_f32_16x16x32_bf16 v[164:167], v[84:87], v[64:67], v[164:167]
ds_read_b128 v[40:43], v232 offset:4096
v_mfma_f32_16x16x32_bf16 v[164:167], v[52:55], v[32:35], v[164:167]
s_setprio 0
ds_read_b128 v[72:75], v233 offset:4096
s_waitcnt lgkmcnt(10)
v_mfma_f32_16x16x32_bf16 v[192:195], v[56:59], v[32:35], v[192:195]
s_setprio 1
s_waitcnt lgkmcnt(8)
v_mfma_f32_16x16x32_bf16 v[192:195], v[88:91], v[64:67], v[192:195]
buffer_load_dwordx4 v18, s[12:15], s58 offen offset:2048 lds
v_mfma_f32_16x16x32_bf16 v[200:203], v[88:91], v[68:71], v[200:203]
v_mfma_f32_16x16x32_bf16 v[200:203], v[56:59], v[36:39], v[200:203]
s_setprio 0
s_waitcnt lgkmcnt(6)
v_mfma_f32_16x16x32_bf16 v[204:207], v[60:63], v[36:39], v[204:207]
s_setprio 1
s_waitcnt lgkmcnt(4)
v_mfma_f32_16x16x32_bf16 v[204:207], v[92:95], v[68:71], v[204:207]
buffer_load_dwordx4 v19, s[12:15], s58 offen offset:3072 lds
v_mfma_f32_16x16x32_bf16 v[196:199], v[92:95], v[64:67], v[196:199]
v_mfma_f32_16x16x32_bf16 v[196:199], v[60:63], v[32:35], v[196:199]
s_setprio 0
s_waitcnt vmcnt(16) lgkmcnt(0)
s_barrier
s_add_u32 m0, s41, 65536
s_add_u32 s58, s56, 1048576
v_mfma_f32_16x16x32_bf16 v[176:179], v[48:51], v[40:43], v[176:179]
s_setprio 1
ds_read_b128 v[36:39], v232 offset:34816
v_mfma_f32_16x16x32_bf16 v[176:179], v[80:83], v[72:75], v[176:179]
ds_read_b128 v[68:71], v233 offset:34816
buffer_load_dwordx4 v16, s[12:15], s58 offen offset:0 lds
v_mfma_f32_16x16x32_bf16 v[184:187], v[80:83], v[76:79], v[184:187]
ds_read_b128 v[32:35], v232 offset:32768
v_mfma_f32_16x16x32_bf16 v[184:187], v[48:51], v[44:47], v[184:187]
s_setprio 0
ds_read_b128 v[64:67], v233 offset:32768
v_mfma_f32_16x16x32_bf16 v[188:191], v[52:55], v[44:47], v[188:191]
s_setprio 1
ds_read_b64_tr_b16 v[48:49], v240 offset:32768
v_mfma_f32_16x16x32_bf16 v[188:191], v[84:87], v[76:79], v[188:191]
ds_read_b64_tr_b16 v[50:51], v241 offset:32768
buffer_load_dwordx4 v17, s[12:15], s58 offen offset:1024 lds
v_mfma_f32_16x16x32_bf16 v[180:183], v[84:87], v[72:75], v[180:183]
ds_read_b64_tr_b16 v[80:81], v240 offset:34816
v_mfma_f32_16x16x32_bf16 v[180:183], v[52:55], v[40:43], v[180:183]
s_setprio 0
ds_read_b64_tr_b16 v[82:83], v241 offset:34816
v_mfma_f32_16x16x32_bf16 v[208:211], v[56:59], v[40:43], v[208:211]
s_setprio 1
ds_read_b64_tr_b16 v[52:53], v240 offset:33280
v_mfma_f32_16x16x32_bf16 v[208:211], v[88:91], v[72:75], v[208:211]
ds_read_b64_tr_b16 v[54:55], v241 offset:33280
buffer_load_dwordx4 v18, s[12:15], s58 offen offset:2048 lds
v_mfma_f32_16x16x32_bf16 v[216:219], v[88:91], v[76:79], v[216:219]
ds_read_b64_tr_b16 v[84:85], v240 offset:35328
v_mfma_f32_16x16x32_bf16 v[216:219], v[56:59], v[44:47], v[216:219]
s_setprio 0
ds_read_b64_tr_b16 v[86:87], v241 offset:35328
v_mfma_f32_16x16x32_bf16 v[220:223], v[60:63], v[44:47], v[220:223]
s_setprio 1
ds_read_b64_tr_b16 v[56:57], v240 offset:36864
v_mfma_f32_16x16x32_bf16 v[220:223], v[92:95], v[76:79], v[220:223]
ds_read_b64_tr_b16 v[58:59], v241 offset:36864
buffer_load_dwordx4 v19, s[12:15], s58 offen offset:3072 lds
v_mfma_f32_16x16x32_bf16 v[212:215], v[92:95], v[72:75], v[212:215]
ds_read_b64_tr_b16 v[88:89], v240 offset:38912
v_mfma_f32_16x16x32_bf16 v[212:215], v[60:63], v[40:43], v[212:215]
s_setprio 0
s_waitcnt lgkmcnt(14)
ds_read_b64_tr_b16 v[90:91], v241 offset:38912
s_add_u32 m0, s41, 81920
s_add_u32 s58, s56, 1310720
s_waitcnt lgkmcnt(10)
v_mfma_f32_16x16x32_bf16 v[160:163], v[48:51], v[32:35], v[160:163]
s_setprio 1
ds_read_b64_tr_b16 v[60:61], v240 offset:37376
s_waitcnt lgkmcnt(9)
v_mfma_f32_16x16x32_bf16 v[160:163], v[80:83], v[64:67], v[160:163]
ds_read_b64_tr_b16 v[62:63], v241 offset:37376
buffer_load_dwordx4 v16, s[12:15], s58 offen offset:0 lds
v_mfma_f32_16x16x32_bf16 v[168:171], v[80:83], v[68:71], v[168:171]
ds_read_b64_tr_b16 v[92:93], v240 offset:39424
v_mfma_f32_16x16x32_bf16 v[168:171], v[48:51], v[36:39], v[168:171]
s_setprio 0
ds_read_b64_tr_b16 v[94:95], v241 offset:39424
s_waitcnt lgkmcnt(10)
v_mfma_f32_16x16x32_bf16 v[172:175], v[52:55], v[36:39], v[172:175]
s_setprio 1
ds_read_b128 v[44:47], v232 offset:38912
s_waitcnt lgkmcnt(9)
v_mfma_f32_16x16x32_bf16 v[172:175], v[84:87], v[68:71], v[172:175]
ds_read_b128 v[76:79], v233 offset:38912
buffer_load_dwordx4 v17, s[12:15], s58 offen offset:1024 lds
v_mfma_f32_16x16x32_bf16 v[164:167], v[84:87], v[64:67], v[164:167]
ds_read_b128 v[40:43], v232 offset:36864
v_mfma_f32_16x16x32_bf16 v[164:167], v[52:55], v[32:35], v[164:167]
s_setprio 0
ds_read_b128 v[72:75], v233 offset:36864
s_waitcnt lgkmcnt(10)
v_mfma_f32_16x16x32_bf16 v[192:195], v[56:59], v[32:35], v[192:195]
s_setprio 1
s_waitcnt lgkmcnt(8)
v_mfma_f32_16x16x32_bf16 v[192:195], v[88:91], v[64:67], v[192:195]
buffer_load_dwordx4 v18, s[12:15], s58 offen offset:2048 lds
v_mfma_f32_16x16x32_bf16 v[200:203], v[88:91], v[68:71], v[200:203]
v_mfma_f32_16x16x32_bf16 v[200:203], v[56:59], v[36:39], v[200:203]
s_setprio 0
s_waitcnt lgkmcnt(6)
v_mfma_f32_16x16x32_bf16 v[204:207], v[60:63], v[36:39], v[204:207]
s_setprio 1
s_waitcnt lgkmcnt(4)
v_mfma_f32_16x16x32_bf16 v[204:207], v[92:95], v[68:71], v[204:207]
buffer_load_dwordx4 v19, s[12:15], s58 offen offset:3072 lds
v_mfma_f32_16x16x32_bf16 v[196:199], v[92:95], v[64:67], v[196:199]
v_mfma_f32_16x16x32_bf16 v[196:199], v[60:63], v[32:35], v[196:199]
s_setprio 0
s_waitcnt lgkmcnt(0)
s_barrier
s_add_u32 m0, s41, 98304
s_add_u32 s58, s56, 1572864
v_mfma_f32_16x16x32_bf16 v[176:179], v[48:51], v[40:43], v[176:179]
s_setprio 1
v_mfma_f32_16x16x32_bf16 v[176:179], v[80:83], v[72:75], v[176:179]
buffer_load_dwordx4 v16, s[12:15], s58 offen offset:0 lds
v_mfma_f32_16x16x32_bf16 v[184:187], v[80:83], v[76:79], v[184:187]
v_mfma_f32_16x16x32_bf16 v[184:187], v[48:51], v[44:47], v[184:187]
s_setprio 0
v_mfma_f32_16x16x32_bf16 v[188:191], v[52:55], v[44:47], v[188:191]
s_setprio 1
v_mfma_f32_16x16x32_bf16 v[188:191], v[84:87], v[76:79], v[188:191]
buffer_load_dwordx4 v17, s[12:15], s58 offen offset:1024 lds
v_mfma_f32_16x16x32_bf16 v[180:183], v[84:87], v[72:75], v[180:183]
v_mfma_f32_16x16x32_bf16 v[180:183], v[52:55], v[40:43], v[180:183]
s_setprio 0
v_mfma_f32_16x16x32_bf16 v[208:211], v[56:59], v[40:43], v[208:211]
s_setprio 1
v_mfma_f32_16x16x32_bf16 v[208:211], v[88:91], v[72:75], v[208:211]
buffer_load_dwordx4 v18, s[12:15], s58 offen offset:2048 lds
v_mfma_f32_16x16x32_bf16 v[216:219], v[88:91], v[76:79], v[216:219]
v_mfma_f32_16x16x32_bf16 v[216:219], v[56:59], v[44:47], v[216:219]
s_setprio 0
v_mfma_f32_16x16x32_bf16 v[220:223], v[60:63], v[44:47], v[220:223]
s_setprio 1
v_mfma_f32_16x16x32_bf16 v[220:223], v[92:95], v[76:79], v[220:223]
buffer_load_dwordx4 v19, s[12:15], s58 offen offset:3072 lds
v_mfma_f32_16x16x32_bf16 v[212:215], v[92:95], v[72:75], v[212:215]
v_mfma_f32_16x16x32_bf16 v[212:215], v[60:63], v[40:43], v[212:215]
s_setprio 0
v_pk_add_f32 v[160:161], v[160:161], v[242:243] op_sel_hi:[1,0]
v_pk_add_f32 v[162:163], v[162:163], v[242:243] op_sel_hi:[1,0]
v_pk_add_f32 v[164:165], v[164:165], v[242:243] op_sel_hi:[1,0]
v_pk_add_f32 v[166:167], v[166:167], v[242:243] op_sel_hi:[1,0]
v_pk_add_f32 v[168:169], v[168:169], v[244:245] op_sel_hi:[1,0]
v_pk_add_f32 v[170:171], v[170:171], v[244:245] op_sel_hi:[1,0]
v_pk_add_f32 v[172:173], v[172:173], v[244:245] op_sel_hi:[1,0]
v_pk_add_f32 v[174:175], v[174:175], v[244:245] op_sel_hi:[1,0]
v_pk_mul_f32 v[160:161], v[160:161], v[96:97]
v_pk_mul_f32 v[162:163], v[162:163], v[98:99]
v_pk_mul_f32 v[164:165], v[164:165], v[100:101]
v_pk_mul_f32 v[166:167], v[166:167], v[102:103]
v_pk_mul_f32 v[168:169], v[168:169], v[104:105]
v_pk_mul_f32 v[170:171], v[170:171], v[106:107]
v_pk_mul_f32 v[172:173], v[172:173], v[108:109]
v_pk_mul_f32 v[174:175], v[174:175], v[110:111]
v_cvt_pk_bf16_f32 v160, v160, v161
v_cvt_pk_bf16_f32 v161, v162, v163
v_cvt_pk_bf16_f32 v162, v164, v165
v_cvt_pk_bf16_f32 v163, v166, v167
v_cvt_pk_bf16_f32 v164, v168, v169
v_cvt_pk_bf16_f32 v165, v170, v171
v_cvt_pk_bf16_f32 v166, v172, v173
v_cvt_pk_bf16_f32 v167, v174, v175
s_add_u32 s26, s32, 0
buffer_store_dwordx4 v[160:163], v11, s[52:55], s26 offen offset:0 sc0 sc1
buffer_store_dwordx4 v[164:167], v11, s[52:55], s26 offen offset:1024 sc0 sc1
v_pk_add_f32 v[176:177], v[176:177], v[246:247] op_sel_hi:[1,0]
v_pk_add_f32 v[178:179], v[178:179], v[246:247] op_sel_hi:[1,0]
v_pk_add_f32 v[180:181], v[180:181], v[246:247] op_sel_hi:[1,0]
v_pk_add_f32 v[182:183], v[182:183], v[246:247] op_sel_hi:[1,0]
v_pk_add_f32 v[184:185], v[184:185], v[248:249] op_sel_hi:[1,0]
v_pk_add_f32 v[186:187], v[186:187], v[248:249] op_sel_hi:[1,0]
v_pk_add_f32 v[188:189], v[188:189], v[248:249] op_sel_hi:[1,0]
v_pk_add_f32 v[190:191], v[190:191], v[248:249] op_sel_hi:[1,0]
v_pk_mul_f32 v[176:177], v[176:177], v[112:113]
v_pk_mul_f32 v[178:179], v[178:179], v[114:115]
v_pk_mul_f32 v[180:181], v[180:181], v[116:117]
v_pk_mul_f32 v[182:183], v[182:183], v[118:119]
v_pk_mul_f32 v[184:185], v[184:185], v[120:121]
v_pk_mul_f32 v[186:187], v[186:187], v[122:123]
v_pk_mul_f32 v[188:189], v[188:189], v[124:125]
v_pk_mul_f32 v[190:191], v[190:191], v[126:127]
v_cvt_pk_bf16_f32 v176, v176, v177
v_cvt_pk_bf16_f32 v177, v178, v179
v_cvt_pk_bf16_f32 v178, v180, v181
v_cvt_pk_bf16_f32 v179, v182, v183
v_cvt_pk_bf16_f32 v180, v184, v185
v_cvt_pk_bf16_f32 v181, v186, v187
v_cvt_pk_bf16_f32 v182, v188, v189
v_cvt_pk_bf16_f32 v183, v190, v191
s_add_u32 s26, s32, 114688
buffer_store_dwordx4 v[176:179], v11, s[52:55], s26 offen offset:0 sc0 sc1
buffer_store_dwordx4 v[180:183], v11, s[52:55], s26 offen offset:1024 sc0 sc1
s_barrier
v_pk_add_f32 v[192:193], v[192:193], v[242:243] op_sel_hi:[1,0]
v_pk_add_f32 v[194:195], v[194:195], v[242:243] op_sel_hi:[1,0]
v_pk_add_f32 v[196:197], v[196:197], v[242:243] op_sel_hi:[1,0]
v_pk_add_f32 v[198:199], v[198:199], v[242:243] op_sel_hi:[1,0]
v_pk_add_f32 v[200:201], v[200:201], v[244:245] op_sel_hi:[1,0]
v_pk_add_f32 v[202:203], v[202:203], v[244:245] op_sel_hi:[1,0]
v_pk_add_f32 v[204:205], v[204:205], v[244:245] op_sel_hi:[1,0]
v_pk_add_f32 v[206:207], v[206:207], v[244:245] op_sel_hi:[1,0]
v_pk_mul_f32 v[192:193], v[192:193], v[128:129]
v_pk_mul_f32 v[194:195], v[194:195], v[130:131]
v_pk_mul_f32 v[196:197], v[196:197], v[132:133]
v_pk_mul_f32 v[198:199], v[198:199], v[134:135]
v_pk_mul_f32 v[200:201], v[200:201], v[136:137]
v_pk_mul_f32 v[202:203], v[202:203], v[138:139]
v_pk_mul_f32 v[204:205], v[204:205], v[140:141]
v_pk_mul_f32 v[206:207], v[206:207], v[142:143]
v_cvt_pk_bf16_f32 v192, v192, v193
v_cvt_pk_bf16_f32 v193, v194, v195
v_cvt_pk_bf16_f32 v194, v196, v197
v_cvt_pk_bf16_f32 v195, v198, v199
v_cvt_pk_bf16_f32 v196, v200, v201
v_cvt_pk_bf16_f32 v197, v202, v203
v_cvt_pk_bf16_f32 v198, v204, v205
v_cvt_pk_bf16_f32 v199, v206, v207
s_add_u32 s26, s32, 2048
buffer_store_dwordx4 v[192:195], v11, s[52:55], s26 offen offset:0 sc0 sc1
buffer_store_dwordx4 v[196:199], v11, s[52:55], s26 offen offset:1024 sc0 sc1
v_pk_add_f32 v[208:209], v[208:209], v[246:247] op_sel_hi:[1,0]
v_pk_add_f32 v[210:211], v[210:211], v[246:247] op_sel_hi:[1,0]
v_pk_add_f32 v[212:213], v[212:213], v[246:247] op_sel_hi:[1,0]
v_pk_add_f32 v[214:215], v[214:215], v[246:247] op_sel_hi:[1,0]
v_pk_add_f32 v[216:217], v[216:217], v[248:249] op_sel_hi:[1,0]
v_pk_add_f32 v[218:219], v[218:219], v[248:249] op_sel_hi:[1,0]
v_pk_add_f32 v[220:221], v[220:221], v[248:249] op_sel_hi:[1,0]
v_pk_add_f32 v[222:223], v[222:223], v[248:249] op_sel_hi:[1,0]
v_pk_mul_f32 v[208:209], v[208:209], v[144:145]
v_pk_mul_f32 v[210:211], v[210:211], v[146:147]
v_pk_mul_f32 v[212:213], v[212:213], v[148:149]
v_pk_mul_f32 v[214:215], v[214:215], v[150:151]
v_pk_mul_f32 v[216:217], v[216:217], v[152:153]
v_pk_mul_f32 v[218:219], v[218:219], v[154:155]
v_pk_mul_f32 v[220:221], v[220:221], v[156:157]
v_pk_mul_f32 v[222:223], v[222:223], v[158:159]
v_cvt_pk_bf16_f32 v208, v208, v209
v_cvt_pk_bf16_f32 v209, v210, v211
v_cvt_pk_bf16_f32 v210, v212, v213
v_cvt_pk_bf16_f32 v211, v214, v215
v_cvt_pk_bf16_f32 v212, v216, v217
v_cvt_pk_bf16_f32 v213, v218, v219
v_cvt_pk_bf16_f32 v214, v220, v221
v_cvt_pk_bf16_f32 v215, v222, v223
s_add_u32 s26, s32, 116736
buffer_store_dwordx4 v[208:211], v11, s[52:55], s26 offen offset:0 sc0 sc1
buffer_store_dwordx4 v[212:215], v11, s[52:55], s26 offen offset:1024 sc0 sc1
s_add_u32 m0, s41, 114688
s_add_u32 s58, s57, 1835008
buffer_load_dwordx4 v16, s[12:15], s58 offen offset:0 lds
buffer_load_dwordx4 v17, s[12:15], s58 offen offset:1024 lds
buffer_load_dwordx4 v18, s[12:15], s58 offen offset:2048 lds
buffer_load_dwordx4 v19, s[12:15], s58 offen offset:3072 lds
s_barrier
s_barrier
s_waitcnt vmcnt(4)
s_barrier
s_lshl_b32 s30, s64, 1
s_add_u32 s30, s30, s75
s_lshl_b32 s30, s30, 8
s_add_u32 s30, s30, 40960
s_cmp_lg_u32 s25, 7
s_cbranch_scc1 L_c_pb
s_mov_b64 exec, 3
v_mov_b32 v14, 1
v_lshlrev_b32 v15, 7, v0
buffer_atomic_add v14, v15, s[48:51], s30 offen sc1
s_mov_b64 exec, -1
L_c_pb:
L_gC:
s_lshl_b32 s30, s64, 1
s_add_u32 s30, s30, s75
s_lshl_b32 s30, s30, 1
s_and_b32 s26, s34, 1
s_add_u32 s30, s30, s26
s_lshl_b32 s30, s30, 7
s_add_u32 s30, s30, 40960
s_xor_b32 s35, s30, 256
s_lshr_b32 s31, s64, 1
s_lshl_b32 s31, s31, 3
s_and_b32 s26, s34, 7
s_add_u32 s31, s31, s26
s_lshl_b32 s31, s31, 7
s_add_u32 s31, s31, 32768
s_mov_b32 s52, s72
s_mov_b32 s53, s73
s_mov_b32 s54, 0x400000
s_mov_b32 s55, 0x20000
s_lshl_b32 s32, s43, 16
s_add_u32 s32, s32, s59
s_add_u32 s33, s32, 32768
buffer_load_dwordx4 v[224:227], v28, s[52:55], s32 offen offset:0
buffer_load_dwordx4 v[228:231], v28, s[52:55], s32 offen offset:64
buffer_load_dwordx4 v[232:235], v28, s[52:55], s33 offen offset:0
buffer_load_dwordx4 v[236:239], v28, s[52:55], s33 offen offset:64
s_mul_i32 s26, s43, 114688
s_add_u32 s26, s26, 0x2c00000
s_add_u32 s8, s4, s26
s_addc_u32 s9, s5, 0
s_mov_b32 s10, 0x1c000
s_mov_b32 s11, 0x20000
s_mul_i32 s24, s75, 57344
s_lshl_b32 s26, s43, 16
s_add_u32 s26, s26, 0x2800000
s_add_u32 s16, s4, s26
s_addc_u32 s17, s5, 0
s_mov_b32 s18, 0x10000
s_mov_b32 s19, 0x20000
s_sub_u32 s26, 0x200000, s59
s_add_u32 s20, s66, s59
s_addc_u32 s21, s67, 0
s_mov_b32 s22, s26
s_mov_b32 s23, 0x20000
s_mov_b32 s52, s70
s_mov_b32 s53, s71
s_mov_b32 s54, 0x400000
s_mov_b32 s55, 0x20000
s_mov_b32 s26, 0x3030306
s_mov_b32 s27, 0x1a000000
s_lshl_b32 s28, s34, 3
s_lshr_b64 s[26:27], s[26:27], s28
s_and_b32 s47, s26, 0xff
s_cbranch_scc0 L_c_ex0
L_c_ex:
s_barrier
s_sub_u32 s47, s47, 1
s_cmp_lg_u32 s47, 0
s_cbranch_scc1 L_c_ex
L_c_ex0:
s_barrier
s_cmp_lg_u32 s25, 7
s_cbranch_scc1 L_c_ak
s_mov_b64 exec, 1
v_mov_b32 v12, 0
buffer_load_dword v15, v12, s[48:51], s30 offen sc1
s_mov_b64 exec, -1
L_c_ak:
s_barrier
s_barrier
s_cmp_lg_u32 s25, 7
s_cbranch_scc1 L_c_ck
s_mov_b64 exec, 1
s_mov_b32 s27, 0x40000
L_c_ck_l:
s_waitcnt vmcnt(0)
L_c_ck_k:
v_readfirstlane_b32 s26, v15
s_sub_u32 s27, s27, 1
s_cmp_ge_u32 s26, 7
s_cbranch_scc1 L_c_ck_g
s_sleep 1
buffer_load_dword v15, v12, s[48:51], s30 offen sc1
s_cmp_lg_u32 s27, 0
s_cbranch_scc1 L_c_ck_l
L_c_ck_g:
s_mov_b64 exec, -1
L_c_ck:
s_barrier
buffer_load_dwordx4 v[32:35], v20, s[8:11], s24 offen offset:0
buffer_load_dwordx4 v[36:39], v20, s[8:11], s24 offen offset:1024
buffer_load_dwordx4 v[40:43], v20, s[8:11], s24 offen offset:2048
buffer_load_dwordx4 v[44:47], v20, s[8:11], s24 offen offset:3072
buffer_load_dwordx4 v[48:51], v21, s[8:11], s24 offen offset:0
buffer_load_dwordx4 v[52:55], v21, s[8:11], s24 offen offset:1024
buffer_load_dwordx4 v[56:59], v21, s[8:11], s24 offen offset:2048
buffer_load_dwordx4 v[60:63], v21, s[8:11], s24 offen offset:3072
s_add_u32 s24, s24, 8192
s_barrier
buffer_load_dwordx4 v[64:67], v20, s[8:11], s24 offen offset:0
buffer_load_dwordx4 v[68:71], v20, s[8:11], s24 offen offset:1024
buffer_load_dwordx4 v[72:75], v20, s[8:11], s24 offen offset:2048
buffer_load_dwordx4 v[76:79], v20, s[8:11], s24 offen offset:3072
buffer_load_dwordx4 v[80:83], v21, s[8:11], s24 offen offset:0
buffer_load_dwordx4 v[84:87], v21, s[8:11], s24 offen offset:1024
buffer_load_dwordx4 v[88:91], v21, s[8:11], s24 offen offset:2048
buffer_load_dwordx4 v[92:95], v21, s[8:11], s24 offen offset:3072
s_add_u32 s24, s24, 8192
buffer_load_dwordx4 v[96:99], v20, s[8:11], s24 offen offset:0
buffer_load_dwordx4 v[100:103], v20, s[8:11], s24 offen offset:1024
buffer_load_dwordx4 v[104:107], v20, s[8:11], s24 offen offset:2048
buffer_load_dwordx4 v[108:111], v20, s[8:11], s24 offen offset:3072
buffer_load_dwordx4 v[112:115], v21, s[8:11], s24 offen offset:0
buffer_load_dwordx4 v[116:119], v21, s[8:11], s24 offen offset:1024
buffer_load_dwordx4 v[120:123], v21, s[8:11], s24 offen offset:2048
buffer_load_dwordx4 v[124:127], v21, s[8:11], s24 offen offset:3072
s_add_u32 s24, s24, 8192
s_waitcnt vmcnt(16)
s_barrier
ds_read_b64_tr_b16 v[160:161], v22 offset:0
ds_read_b64_tr_b16 v[162:163], v22 offset:2048
ds_read_b64_tr_b16 v[176:177], v22 offset:4096
ds_read_b64_tr_b16 v[178:179], v22 offset:6144
ds_read_b64_tr_b16 v[164:165], v22 offset:256
ds_read_b64_tr_b16 v[166:167], v22 offset:2304
ds_read_b64_tr_b16 v[180:181], v22 offset:4352
ds_read_b64_tr_b16 v[182:183], v22 offset:6400
s_waitcnt lgkmcnt(6)
v_mfma_f32_16x16x32_bf16 v[192:195], v[160:163], v[32:35], 0
ds_read_b64_tr_b16 v[168:169], v22 offset:512
buffer_load_dwordx4 v[128:131], v20, s[8:11], s24 offen offset:0
s_waitcnt lgkmcnt(5)
v_mfma_f32_16x16x32_bf16 v[192:195], v[176:179], v[40:43], v[192:195]
ds_read_b64_tr_b16 v[170:171], v22 offset:2560
v_mfma_f32_16x16x32_bf16 v[208:211], v[176:179], v[44:47], 0
ds_read_b64_tr_b16 v[184:185], v22 offset:4608
v_mfma_f32_16x16x32_bf16 v[208:211], v[160:163], v[36:39], v[208:211]
ds_read_b64_tr_b16 v[186:187], v22 offset:6656
buffer_load_dwordx4 v[132:135], v20, s[8:11], s24 offen offset:1024
s_waitcnt lgkmcnt(6)
v_mfma_f32_16x16x32_bf16 v[212:215], v[164:167], v[36:39], 0
ds_read_b64_tr_b16 v[172:173], v22 offset:768
s_waitcnt lgkmcnt(5)
v_mfma_f32_16x16x32_bf16 v[212:215], v[180:183], v[44:47], v[212:215]
ds_read_b64_tr_b16 v[174:175], v22 offset:2816
v_mfma_f32_16x16x32_bf16 v[196:199], v[180:183], v[40:43], 0
ds_read_b64_tr_b16 v[188:189], v22 offset:4864
buffer_load_dwordx4 v[136:139], v20, s[8:11], s24 offen offset:2048
v_mfma_f32_16x16x32_bf16 v[196:199], v[164:167], v[32:35], v[196:199]
ds_read_b64_tr_b16 v[190:191], v22 offset:6912
s_waitcnt lgkmcnt(6)
v_mfma_f32_16x16x32_bf16 v[200:203], v[168:171], v[32:35], 0
ds_read_b64_tr_b16 v[160:161], v22 offset:8192
s_waitcnt lgkmcnt(5)
v_mfma_f32_16x16x32_bf16 v[200:203], v[184:187], v[40:43], v[200:203]
ds_read_b64_tr_b16 v[162:163], v22 offset:10240
buffer_load_dwordx4 v[140:143], v20, s[8:11], s24 offen offset:3072
v_mfma_f32_16x16x32_bf16 v[216:219], v[184:187], v[44:47], 0
ds_read_b64_tr_b16 v[176:177], v22 offset:12288
v_mfma_f32_16x16x32_bf16 v[216:219], v[168:171], v[36:39], v[216:219]
ds_read_b64_tr_b16 v[178:179], v22 offset:14336
s_waitcnt lgkmcnt(6)
v_mfma_f32_16x16x32_bf16 v[220:223], v[172:175], v[36:39], 0
ds_read_b64_tr_b16 v[164:165], v22 offset:8448
buffer_load_dwordx4 v[144:147], v21, s[8:11], s24 offen offset:0
s_waitcnt lgkmcnt(5)
v_mfma_f32_16x16x32_bf16 v[220:223], v[188:191], v[44:47], v[220:223]
ds_read_b64_tr_b16 v[166:167], v22 offset:10496
v_mfma_f32_16x16x32_bf16 v[204:207], v[188:191], v[40:43], 0
ds_read_b64_tr_b16 v[180:181], v22 offset:12544
v_mfma_f32_16x16x32_bf16 v[204:207], v[172:175], v[32:35], v[204:207]
ds_read_b64_tr_b16 v[182:183], v22 offset:14592
buffer_load_dwordx4 v[148:151], v21, s[8:11], s24 offen offset:1024
s_waitcnt lgkmcnt(6)
v_mfma_f32_16x16x32_bf16 v[192:195], v[160:163], v[48:51], v[192:195]
ds_read_b64_tr_b16 v[168:169], v22 offset:8704
s_waitcnt lgkmcnt(5)
v_mfma_f32_16x16x32_bf16 v[192:195], v[176:179], v[56:59], v[192:195]
ds_read_b64_tr_b16 v[170:171], v22 offset:10752
v_mfma_f32_16x16x32_bf16 v[208:211], v[176:179], v[60:63], v[208:211]
ds_read_b64_tr_b16 v[184:185], v22 offset:12800
buffer_load_dwordx4 v[152:155], v21, s[8:11], s24 offen offset:2048
v_mfma_f32_16x16x32_bf16 v[208:211], v[160:163], v[52:55], v[208:211]
ds_read_b64_tr_b16 v[186:187], v22 offset:14848
s_waitcnt lgkmcnt(6)
v_mfma_f32_16x16x32_bf16 v[212:215], v[164:167], v[52:55], v[212:215]
ds_read_b64_tr_b16 v[172:173], v22 offset:8960
s_waitcnt lgkmcnt(5)
v_mfma_f32_16x16x32_bf16 v[212:215], v[180:183], v[60:63], v[212:215]
ds_read_b64_tr_b16 v[174:175], v22 offset:11008
buffer_load_dwordx4 v[156:159], v21, s[8:11], s24 offen offset:3072
s_add_u32 s24, s24, 8192
v_mfma_f32_16x16x32_bf16 v[196:199], v[180:183], v[56:59], v[196:199]
ds_read_b64_tr_b16 v[188:189], v22 offset:13056
v_mfma_f32_16x16x32_bf16 v[196:199], v[164:167], v[48:51], v[196:199]
s_waitcnt vmcnt(16)
s_barrier
ds_read_b64_tr_b16 v[190:191], v22 offset:15104
s_waitcnt lgkmcnt(6)
v_mfma_f32_16x16x32_bf16 v[200:203], v[168:171], v[48:51], v[200:203]
ds_read_b64_tr_b16 v[160:161], v22 offset:16384
s_waitcnt lgkmcnt(5)
v_mfma_f32_16x16x32_bf16 v[200:203], v[184:187], v[56:59], v[200:203]
ds_read_b64_tr_b16 v[162:163], v22 offset:18432
v_mfma_f32_16x16x32_bf16 v[216:219], v[184:187], v[60:63], v[216:219]
ds_read_b64_tr_b16 v[176:177], v22 offset:20480
v_mfma_f32_16x16x32_bf16 v[216:219], v[168:171], v[52:55], v[216:219]
ds_read_b64_tr_b16 v[178:179], v22 offset:22528
s_waitcnt lgkmcnt(6)
v_mfma_f32_16x16x32_bf16 v[220:223], v[172:175], v[52:55], v[220:223]
ds_read_b64_tr_b16 v[164:165], v22 offset:16640
s_waitcnt lgkmcnt(5)
v_mfma_f32_16x16x32_bf16 v[220:223], v[188:191], v[60:63], v[220:223]
ds_read_b64_tr_b16 v[166:167], v22 offset:18688
v_mfma_f32_16x16x32_bf16 v[204:207], v[188:191], v[56:59], v[204:207]
ds_read_b64_tr_b16 v[180:181], v22 offset:20736
v_mfma_f32_16x16x32_bf16 v[204:207], v[172:175], v[48:51], v[204:207]
ds_read_b64_tr_b16 v[182:183], v22 offset:22784
s_waitcnt lgkmcnt(6)
v_mfma_f32_16x16x32_bf16 v[192:195], v[160:163], v[64:67], v[192:195]
ds_read_b64_tr_b16 v[168:169], v22 offset:16896
buffer_load_dwordx4 v[32:35], v20, s[8:11], s24 offen offset:0
s_waitcnt lgkmcnt(5)
v_mfma_f32_16x16x32_bf16 v[192:195], v[176:179], v[72:75], v[192:195]
ds_read_b64_tr_b16 v[170:171], v22 offset:18944
v_mfma_f32_16x16x32_bf16 v[208:211], v[176:179], v[76:79], v[208:211]
ds_read_b64_tr_b16 v[184:185], v22 offset:20992
v_mfma_f32_16x16x32_bf16 v[208:211], v[160:163], v[68:71], v[208:211]
ds_read_b64_tr_b16 v[186:187], v22 offset:23040
buffer_load_dwordx4 v[36:39], v20, s[8:11], s24 offen offset:1024
s_waitcnt lgkmcnt(6)
v_mfma_f32_16x16x32_bf16 v[212:215], v[164:167], v[68:71], v[212:215]
ds_read_b64_tr_b16 v[172:173], v22 offset:17152
s_waitcnt lgkmcnt(5)
v_mfma_f32_16x16x32_bf16 v[212:215], v[180:183], v[76:79], v[212:215]
ds_read_b64_tr_b16 v[174:175], v22 offset:19200
v_mfma_f32_16x16x32_bf16 v[196:199], v[180:183], v[72:75], v[196:199]
ds_read_b64_tr_b16 v[188:189], v22 offset:21248
buffer_load_dwordx4 v[40:43], v20, s[8:11], s24 offen offset:2048
v_mfma_f32_16x16x32_bf16 v[196:199], v[164:167], v[64:67], v[196:199]
ds_read_b64_tr_b16 v[190:191], v22 offset:23296
s_waitcnt lgkmcnt(6)
v_mfma_f32_16x16x32_bf16 v[200:203], v[168:171], v[64:67], v[200:203]
ds_read_b64_tr_b16 v[160:161], v22 offset:24576
s_waitcnt lgkmcnt(5)
v_mfma_f32_16x16x32_bf16 v[200:203], v[184:187], v[72:75], v[200:203]
ds_read_b64_tr_b16 v[162:163], v22 offset:26624
buffer_load_dwordx4 v[44:47], v20, s[8:11], s24 offen offset:3072
v_mfma_f32_16x16x32_bf16 v[216:219], v[184:187], v[76:79], v[216:219]
ds_read_b64_tr_b16 v[176:177], v22 offset:28672
v_mfma_f32_16x16x32_bf16 v[216:219], v[168:171], v[68:71], v[216:219]
ds_read_b64_tr_b16 v[178:179], v22 offset:30720
s_waitcnt lgkmcnt(6)
v_mfma_f32_16x16x32_bf16 v[220:223], v[172:175], v[68:71], v[220:223]
ds_read_b64_tr_b16 v[164:165], v22 offset:24832
buffer_load_dwordx4 v[48:51], v21, s[8:11], s24 offen offset:0
s_waitcnt lgkmcnt(5)
v_mfma_f32_16x16x32_bf16 v[220:223], v[188:191], v[76:79], v[220:223]
ds_read_b64_tr_b16 v[166:167], v22 offset:26880
v_mfma_f32_16x16x32_bf16 v[204:207], v[188:191], v[72:75], v[204:207]
ds_read_b64_tr_b16 v[180:181], v22 offset:28928
v_mfma_f32_16x16x32_bf16 v[204:207], v[172:175], v[64:67], v[204:207]
ds_read_b64_tr_b16 v[182:183], v22 offset:30976
buffer_load_dwordx4 v[52:55], v21, s[8:11], s24 offen offset:1024
s_waitcnt lgkmcnt(6)
v_mfma_f32_16x16x32_bf16 v[192:195], v[160:163], v[80:83], v[192:195]
ds_read_b64_tr_b16 v[168:169], v22 offset:25088
s_waitcnt lgkmcnt(5)
v_mfma_f32_16x16x32_bf16 v[192:195], v[176:179], v[88:91], v[192:195]
ds_read_b64_tr_b16 v[170:171], v22 offset:27136
v_mfma_f32_16x16x32_bf16 v[208:211], v[176:179], v[92:95], v[208:211]
ds_read_b64_tr_b16 v[184:185], v22 offset:29184
buffer_load_dwordx4 v[56:59], v21, s[8:11], s24 offen offset:2048
v_mfma_f32_16x16x32_bf16 v[208:211], v[160:163], v[84:87], v[208:211]
ds_read_b64_tr_b16 v[186:187], v22 offset:31232
s_waitcnt lgkmcnt(6)
v_mfma_f32_16x16x32_bf16 v[212:215], v[164:167], v[84:87], v[212:215]
ds_read_b64_tr_b16 v[172:173], v22 offset:25344
s_waitcnt lgkmcnt(5)
v_mfma_f32_16x16x32_bf16 v[212:215], v[180:183], v[92:95], v[212:215]
ds_read_b64_tr_b16 v[174:175], v22 offset:27392
buffer_load_dwordx4 v[60:63], v21, s[8:11], s24 offen offset:3072
s_add_u32 s24, s24, 8192
v_mfma_f32_16x16x32_bf16 v[196:199], v[180:183], v[88:91], v[196:199]
ds_read_b64_tr_b16 v[188:189], v22 offset:29440
v_mfma_f32_16x16x32_bf16 v[196:199], v[164:167], v[80:83], v[196:199]
s_waitcnt vmcnt(16)
s_barrier
s_cmp_lg_u32 s25, 7
s_cbranch_scc1 L_d_ak
s_mov_b64 exec, 1
v_mov_b32 v12, 0
buffer_load_dword v15, v12, s[48:51], s35 offen sc1
s_mov_b64 exec, -1
L_d_ak:
s_add_u32 m0, s41, 0
s_add_u32 s58, s57, 2097152
ds_read_b64_tr_b16 v[190:191], v22 offset:31488
s_waitcnt lgkmcnt(6)
v_mfma_f32_16x16x32_bf16 v[200:203], v[168:171], v[80:83], v[200:203]
ds_read_b64_tr_b16 v[160:161], v22 offset:32768
buffer_load_dwordx4 v16, s[12:15], s58 offen offset:0 lds
s_waitcnt lgkmcnt(5)
v_mfma_f32_16x16x32_bf16 v[200:203], v[184:187], v[88:91], v[200:203]
ds_read_b64_tr_b16 v[162:163], v22 offset:34816
v_mfma_f32_16x16x32_bf16 v[216:219], v[184:187], v[92:95], v[216:219]
ds_read_b64_tr_b16 v[176:177], v22 offset:36864
buffer_load_dwordx4 v17, s[12:15], s58 offen offset:1024 lds
v_mfma_f32_16x16x32_bf16 v[216:219], v[168:171], v[84:87], v[216:219]
ds_read_b64_tr_b16 v[178:179], v22 offset:38912
s_waitcnt lgkmcnt(6)
v_mfma_f32_16x16x32_bf16 v[220:223], v[172:175], v[84:87], v[220:223]
ds_read_b64_tr_b16 v[164:165], v22 offset:33024
buffer_load_dwordx4 v18, s[12:15], s58 offen offset:2048 lds
s_waitcnt lgkmcnt(5)
v_mfma_f32_16x16x32_bf16 v[220:223], v[188:191], v[92:95], v[220:223]
ds_read_b64_tr_b16 v[166:167], v22 offset:35072
v_mfma_f32_16x16x32_bf16 v[204:207], v[188:191], v[88:91], v[204:207]
ds_read_b64_tr_b16 v[180:181], v22 offset:37120
buffer_load_dwordx4 v19, s[12:15], s58 offen offset:3072 lds
v_mfma_f32_16x16x32_bf16 v[204:207], v[172:175], v[80:83], v[204:207]
ds_read_b64_tr_b16 v[182:183], v22 offset:39168
s_waitcnt lgkmcnt(6)
v_mfma_f32_16x16x32_bf16 v[192:195], v[160:163], v[96:99], v[192:195]
ds_read_b64_tr_b16 v[168:169], v22 offset:33280
buffer_load_dwordx4 v[64:67], v20, s[8:11], s24 offen offset:0
s_waitcnt lgkmcnt(5)
v_mfma_f32_16x16x32_bf16 v[192:195], v[176:179], v[104:107], v[192:195]
ds_read_b64_tr_b16 v[170:171], v22 offset:35328
v_mfma_f32_16x16x32_bf16 v[208:211], v[176:179], v[108:111], v[208:211]
ds_read_b64_tr_b16 v[184:185], v22 offset:37376
v_mfma_f32_16x16x32_bf16 v[208:211], v[160:163], v[100:103], v[208:211]
ds_read_b64_tr_b16 v[186:187], v22 offset:39424
buffer_load_dwordx4 v[68:71], v20, s[8:11], s24 offen offset:1024
s_waitcnt lgkmcnt(6)
v_mfma_f32_16x16x32_bf16 v[212:215], v[164:167], v[100:103], v[212:215]
ds_read_b64_tr_b16 v[172:173], v22 offset:33536
s_waitcnt lgkmcnt(5)
v_mfma_f32_16x16x32_bf16 v[212:215], v[180:183], v[108:111], v[212:215]
ds_read_b64_tr_b16 v[174:175], v22 offset:35584
v_mfma_f32_16x16x32_bf16 v[196:199], v[180:183], v[104:107], v[196:199]
ds_read_b64_tr_b16 v[188:189], v22 offset:37632
buffer_load_dwordx4 v[72:75], v20, s[8:11], s24 offen offset:2048
v_mfma_f32_16x16x32_bf16 v[196:199], v[164:167], v[96:99], v[196:199]
ds_read_b64_tr_b16 v[190:191], v22 offset:39680
s_waitcnt lgkmcnt(6)
v_mfma_f32_16x16x32_bf16 v[200:203], v[168:171], v[96:99], v[200:203]
ds_read_b64_tr_b16 v[160:161], v22 offset:40960
s_waitcnt lgkmcnt(5)
v_mfma_f32_16x16x32_bf16 v[200:203], v[184:187], v[104:107], v[200:203]
ds_read_b64_tr_b16 v[162:163], v22 offset:43008
buffer_load_dwordx4 v[76:79], v20, s[8:11], s24 offen offset:3072
v_mfma_f32_16x16x32_bf16 v[216:219], v[184:187], v[108:111], v[216:219]
ds_read_b64_tr_b16 v[176:177], v22 offset:45056
v_mfma_f32_16x16x32_bf16 v[216:219], v[168:171], v[100:103], v[216:219]
ds_read_b64_tr_b16 v[178:179], v22 offset:47104
s_waitcnt lgkmcnt(6)
v_mfma_f32_16x16x32_bf16 v[220:223], v[172:175], v[100:103], v[220:223]
ds_read_b64_tr_b16 v[164:165], v22 offset:41216
buffer_load_dwordx4 v[80:83], v21, s[8:11], s24 offen offset:0
s_waitcnt lgkmcnt(5)
v_mfma_f32_16x16x32_bf16 v[220:223], v[188:191], v[108:111], v[220:223]
ds_read_b64_tr_b16 v[166:167], v22 offset:43264
v_mfma_f32_16x16x32_bf16 v[204:207], v[188:191], v[104:107], v[204:207]
ds_read_b64_tr_b16 v[180:181], v22 offset:45312
v_mfma_f32_16x16x32_bf16 v[204:207], v[172:175], v[96:99], v[204:207]
ds_read_b64_tr_b16 v[182:183], v22 offset:47360
buffer_load_dwordx4 v[84:87], v21, s[8:11], s24 offen offset:1024
s_waitcnt lgkmcnt(6)
v_mfma_f32_16x16x32_bf16 v[192:195], v[160:163], v[112:115], v[192:195]
ds_read_b64_tr_b16 v[168:169], v22 offset:41472
s_waitcnt lgkmcnt(5)
v_mfma_f32_16x16x32_bf16 v[192:195], v[176:179], v[120:123], v[192:195]
ds_read_b64_tr_b16 v[170:171], v22 offset:43520
v_mfma_f32_16x16x32_bf16 v[208:211], v[176:179], v[124:127], v[208:211]
ds_read_b64_tr_b16 v[184:185], v22 offset:45568
buffer_load_dwordx4 v[88:91], v21, s[8:11], s24 offen offset:2048
v_mfma_f32_16x16x32_bf16 v[208:211], v[160:163], v[116:119], v[208:211]
ds_read_b64_tr_b16 v[186:187], v22 offset:47616
s_waitcnt lgkmcnt(6)
v_mfma_f32_16x16x32_bf16 v[212:215], v[164:167], v[116:119], v[212:215]
ds_read_b64_tr_b16 v[172:173], v22 offset:41728
s_waitcnt lgkmcnt(5)
v_mfma_f32_16x16x32_bf16 v[212:215], v[180:183], v[124:127], v[212:215]
ds_read_b64_tr_b16 v[174:175], v22 offset:43776
buffer_load_dwordx4 v[92:95], v21, s[8:11], s24 offen offset:3072
s_add_u32 s24, s24, 8192
v_mfma_f32_16x16x32_bf16 v[196:199], v[180:183], v[120:123], v[196:199]
ds_read_b64_tr_b16 v[188:189], v22 offset:45824
v_mfma_f32_16x16x32_bf16 v[196:199], v[164:167], v[112:115], v[196:199]
s_waitcnt vmcnt(20)
s_barrier
s_add_u32 m0, s41, 16384
s_add_u32 s58, s57, 2359296
ds_read_b64_tr_b16 v[190:191], v22 offset:47872
s_waitcnt lgkmcnt(6)
v_mfma_f32_16x16x32_bf16 v[200:203], v[168:171], v[112:115], v[200:203]
ds_read_b64_tr_b16 v[160:161], v22 offset:49152
buffer_load_dwordx4 v16, s[12:15], s58 offen offset:0 lds
s_waitcnt lgkmcnt(5)
v_mfma_f32_16x16x32_bf16 v[200:203], v[184:187], v[120:123], v[200:203]
ds_read_b64_tr_b16 v[162:163], v22 offset:51200
v_mfma_f32_16x16x32_bf16 v[216:219], v[184:187], v[124:127], v[216:219]
ds_read_b64_tr_b16 v[176:177], v22 offset:53248
buffer_load_dwordx4 v17, s[12:15], s58 offen offset:1024 lds
v_mfma_f32_16x16x32_bf16 v[216:219], v[168:171], v[116:119], v[216:219]
ds_read_b64_tr_b16 v[178:179], v22 offset:55296
s_waitcnt lgkmcnt(6)
v_mfma_f32_16x16x32_bf16 v[220:223], v[172:175], v[116:119], v[220:223]
ds_read_b64_tr_b16 v[164:165], v22 offset:49408
buffer_load_dwordx4 v18, s[12:15], s58 offen offset:2048 lds
s_waitcnt lgkmcnt(5)
v_mfma_f32_16x16x32_bf16 v[220:223], v[188:191], v[124:127], v[220:223]
ds_read_b64_tr_b16 v[166:167], v22 offset:51456
v_mfma_f32_16x16x32_bf16 v[204:207], v[188:191], v[120:123], v[204:207]
ds_read_b64_tr_b16 v[180:181], v22 offset:53504
buffer_load_dwordx4 v19, s[12:15], s58 offen offset:3072 lds
v_mfma_f32_16x16x32_bf16 v[204:207], v[172:175], v[112:115], v[204:207]
ds_read_b64_tr_b16 v[182:183], v22 offset:55552
s_waitcnt lgkmcnt(6)
v_mfma_f32_16x16x32_bf16 v[192:195], v[160:163], v[128:131], v[192:195]
ds_read_b64_tr_b16 v[168:169], v22 offset:49664
buffer_load_dwordx4 v[96:99], v20, s[8:11], s24 offen offset:0
s_waitcnt lgkmcnt(5)
v_mfma_f32_16x16x32_bf16 v[192:195], v[176:179], v[136:139], v[192:195]
ds_read_b64_tr_b16 v[170:171], v22 offset:51712
v_mfma_f32_16x16x32_bf16 v[208:211], v[176:179], v[140:143], v[208:211]
ds_read_b64_tr_b16 v[184:185], v22 offset:53760
v_mfma_f32_16x16x32_bf16 v[208:211], v[160:163], v[132:135], v[208:211]
ds_read_b64_tr_b16 v[186:187], v22 offset:55808
buffer_load_dwordx4 v[100:103], v20, s[8:11], s24 offen offset:1024
s_waitcnt lgkmcnt(6)
v_mfma_f32_16x16x32_bf16 v[212:215], v[164:167], v[132:135], v[212:215]
ds_read_b64_tr_b16 v[172:173], v22 offset:49920
s_waitcnt lgkmcnt(5)
v_mfma_f32_16x16x32_bf16 v[212:215], v[180:183], v[140:143], v[212:215]
ds_read_b64_tr_b16 v[174:175], v22 offset:51968
v_mfma_f32_16x16x32_bf16 v[196:199], v[180:183], v[136:139], v[196:199]
ds_read_b64_tr_b16 v[188:189], v22 offset:54016
buffer_load_dwordx4 v[104:107], v20, s[8:11], s24 offen offset:2048
v_mfma_f32_16x16x32_bf16 v[196:199], v[164:167], v[128:131], v[196:199]
ds_read_b64_tr_b16 v[190:191], v22 offset:56064
s_waitcnt lgkmcnt(6)
v_mfma_f32_16x16x32_bf16 v[200:203], v[168:171], v[128:131], v[200:203]
ds_read_b64_tr_b16 v[160:161], v22 offset:57344
s_waitcnt lgkmcnt(5)
v_mfma_f32_16x16x32_bf16 v[200:203], v[184:187], v[136:139], v[200:203]
ds_read_b64_tr_b16 v[162:163], v22 offset:59392
buffer_load_dwordx4 v[108:111], v20, s[8:11], s24 offen offset:3072
v_mfma_f32_16x16x32_bf16 v[216:219], v[184:187], v[140:143], v[216:219]
ds_read_b64_tr_b16 v[176:177], v22 offset:61440
v_mfma_f32_16x16x32_bf16 v[216:219], v[168:171], v[132:135], v[216:219]
ds_read_b64_tr_b16 v[178:179], v22 offset:63488
s_waitcnt lgkmcnt(6)
v_mfma_f32_16x16x32_bf16 v[220:223], v[172:175], v[132:135], v[220:223]
ds_read_b64_tr_b16 v[164:165], v22 offset:57600
buffer_load_dwordx4 v[112:115], v21, s[8:11], s24 offen offset:0
s_waitcnt lgkmcnt(5)
v_mfma_f32_16x16x32_bf16 v[220:223], v[188:191], v[140:143], v[220:223]
ds_read_b64_tr_b16 v[166:167], v22 offset:59648
v_mfma_f32_16x16x32_bf16 v[204:207], v[188:191], v[136:139], v[204:207]
ds_read_b64_tr_b16 v[180:181], v22 offset:61696
v_mfma_f32_16x16x32_bf16 v[204:207], v[172:175], v[128:131], v[204:207]
ds_read_b64_tr_b16 v[182:183], v22 offset:63744
buffer_load_dwordx4 v[116:119], v21, s[8:11], s24 offen offset:1024
s_waitcnt lgkmcnt(6)
v_mfma_f32_16x16x32_bf16 v[192:195], v[160:163], v[144:147], v[192:195]
ds_read_b64_tr_b16 v[168:169], v22 offset:57856
s_waitcnt lgkmcnt(5)
v_mfma_f32_16x16x32_bf16 v[192:195], v[176:179], v[152:155], v[192:195]
ds_read_b64_tr_b16 v[170:171], v22 offset:59904
v_mfma_f32_16x16x32_bf16 v[208:211], v[176:179], v[156:159], v[208:211]
ds_read_b64_tr_b16 v[184:185], v22 offset:61952
buffer_load_dwordx4 v[120:123], v21, s[8:11], s24 offen offset:2048
v_mfma_f32_16x16x32_bf16 v[208:211], v[160:163], v[148:151], v[208:211]
ds_read_b64_tr_b16 v[186:187], v22 offset:64000
s_waitcnt lgkmcnt(6)
v_mfma_f32_16x16x32_bf16 v[212:215], v[164:167], v[148:151], v[212:215]
ds_read_b64_tr_b16 v[172:173], v22 offset:58112
s_waitcnt lgkmcnt(5)
v_mfma_f32_16x16x32_bf16 v[212:215], v[180:183], v[156:159], v[212:215]
ds_read_b64_tr_b16 v[174:175], v22 offset:60160
buffer_load_dwordx4 v[124:127], v21, s[8:11], s24 offen offset:3072
s_add_u32 s24, s24, 8192
v_mfma_f32_16x16x32_bf16 v[196:199], v[180:183], v[152:155], v[196:199]
ds_read_b64_tr_b16 v[188:189], v22 offset:62208
v_mfma_f32_16x16x32_bf16 v[196:199], v[164:167], v[144:147], v[196:199]
s_waitcnt vmcnt(24)
s_cmp_lg_u32 s25, 7
s_cbranch_scc1 L_d_ck
s_mov_b64 exec, 1
s_mov_b32 s27, 0x40000
s_branch L_d_ck_k
L_d_ck_l:
s_waitcnt vmcnt(0)
L_d_ck_k:
v_readfirstlane_b32 s26, v15
s_sub_u32 s27, s27, 1
s_cmp_ge_u32 s26, 7
s_cbranch_scc1 L_d_ck_g
s_sleep 1
buffer_load_dword v15, v12, s[48:51], s35 offen sc1
s_cmp_lg_u32 s27, 0
s_cbranch_scc1 L_d_ck_l
L_d_ck_g:
s_mov_b64 exec, -1
L_d_ck:
s_barrier
s_xor_b32 s24, s75, 1
s_mul_i32 s24, s24, 57344
s_add_u32 m0, s41, 32768
s_add_u32 s58, s57, 2621440
ds_read_b64_tr_b16 v[190:191], v22 offset:64256
s_waitcnt lgkmcnt(6)
v_mfma_f32_16x16x32_bf16 v[200:203], v[168:171], v[144:147], v[200:203]
ds_read_b64_tr_b16 v[160:161], v23 offset:0
buffer_load_dwordx4 v16, s[12:15], s58 offen offset:0 lds
s_waitcnt lgkmcnt(5)
v_mfma_f32_16x16x32_bf16 v[200:203], v[184:187], v[152:155], v[200:203]
ds_read_b64_tr_b16 v[162:163], v23 offset:2048
v_mfma_f32_16x16x32_bf16 v[216:219], v[184:187], v[156:159], v[216:219]
ds_read_b64_tr_b16 v[176:177], v23 offset:4096
buffer_load_dwordx4 v17, s[12:15], s58 offen offset:1024 lds
v_mfma_f32_16x16x32_bf16 v[216:219], v[168:171], v[148:151], v[216:219]
ds_read_b64_tr_b16 v[178:179], v23 offset:6144
s_waitcnt lgkmcnt(6)
v_mfma_f32_16x16x32_bf16 v[220:223], v[172:175], v[148:151], v[220:223]
ds_read_b64_tr_b16 v[164:165], v23 offset:256
buffer_load_dwordx4 v18, s[12:15], s58 offen offset:2048 lds
s_waitcnt lgkmcnt(5)
v_mfma_f32_16x16x32_bf16 v[220:223], v[188:191], v[156:159], v[220:223]
ds_read_b64_tr_b16 v[166:167], v23 offset:2304
v_mfma_f32_16x16x32_bf16 v[204:207], v[188:191], v[152:155], v[204:207]
ds_read_b64_tr_b16 v[180:181], v23 offset:4352
buffer_load_dwordx4 v19, s[12:15], s58 offen offset:3072 lds
v_mfma_f32_16x16x32_bf16 v[204:207], v[172:175], v[144:147], v[204:207]
ds_read_b64_tr_b16 v[182:183], v23 offset:6400
s_waitcnt lgkmcnt(6)
v_mfma_f32_16x16x32_bf16 v[192:195], v[160:163], v[32:35], v[192:195]
ds_read_b64_tr_b16 v[168:169], v23 offset:512
buffer_load_dwordx4 v[128:131], v20, s[8:11], s24 offen offset:0
s_waitcnt lgkmcnt(5)
v_mfma_f32_16x16x32_bf16 v[192:195], v[176:179], v[40:43], v[192:195]
ds_read_b64_tr_b16 v[170:171], v23 offset:2560
v_mfma_f32_16x16x32_bf16 v[208:211], v[176:179], v[44:47], v[208:211]
ds_read_b64_tr_b16 v[184:185], v23 offset:4608
v_mfma_f32_16x16x32_bf16 v[208:211], v[160:163], v[36:39], v[208:211]
ds_read_b64_tr_b16 v[186:187], v23 offset:6656
buffer_load_dwordx4 v[132:135], v20, s[8:11], s24 offen offset:1024
s_waitcnt lgkmcnt(6)
v_mfma_f32_16x16x32_bf16 v[212:215], v[164:167], v[36:39], v[212:215]
ds_read_b64_tr_b16 v[172:173], v23 offset:768
s_waitcnt lgkmcnt(5)
v_mfma_f32_16x16x32_bf16 v[212:215], v[180:183], v[44:47], v[212:215]
ds_read_b64_tr_b16 v[174:175], v23 offset:2816
v_mfma_f32_16x16x32_bf16 v[196:199], v[180:183], v[40:43], v[196:199]
ds_read_b64_tr_b16 v[188:189], v23 offset:4864
buffer_load_dwordx4 v[136:139], v20, s[8:11], s24 offen offset:2048
v_mfma_f32_16x16x32_bf16 v[196:199], v[164:167], v[32:35], v[196:199]
ds_read_b64_tr_b16 v[190:191], v23 offset:6912
s_waitcnt lgkmcnt(6)
v_mfma_f32_16x16x32_bf16 v[200:203], v[168:171], v[32:35], v[200:203]
ds_read_b64_tr_b16 v[160:161], v23 offset:8192
s_waitcnt lgkmcnt(5)
v_mfma_f32_16x16x32_bf16 v[200:203], v[184:187], v[40:43], v[200:203]
ds_read_b64_tr_b16 v[162:163], v23 offset:10240
buffer_load_dwordx4 v[140:143], v20, s[8:11], s24 offen offset:3072
v_mfma_f32_16x16x32_bf16 v[216:219], v[184:187], v[44:47], v[216:219]
ds_read_b64_tr_b16 v[176:177], v23 offset:12288
v_mfma_f32_16x16x32_bf16 v[216:219], v[168:171], v[36:39], v[216:219]
ds_read_b64_tr_b16 v[178:179], v23 offset:14336
s_waitcnt lgkmcnt(6)
v_mfma_f32_16x16x32_bf16 v[220:223], v[172:175], v[36:39], v[220:223]
ds_read_b64_tr_b16 v[164:165], v23 offset:8448
buffer_load_dwordx4 v[144:147], v21, s[8:11], s24 offen offset:0
s_waitcnt lgkmcnt(5)
v_mfma_f32_16x16x32_bf16 v[220:223], v[188:191], v[44:47], v[220:223]
ds_read_b64_tr_b16 v[166:167], v23 offset:10496
v_mfma_f32_16x16x32_bf16 v[204:207], v[188:191], v[40:43], v[204:207]
ds_read_b64_tr_b16 v[180:181], v23 offset:12544
v_mfma_f32_16x16x32_bf16 v[204:207], v[172:175], v[32:35], v[204:207]
ds_read_b64_tr_b16 v[182:183], v23 offset:14592
buffer_load_dwordx4 v[148:151], v21, s[8:11], s24 offen offset:1024
s_waitcnt lgkmcnt(6)
v_mfma_f32_16x16x32_bf16 v[192:195], v[160:163], v[48:51], v[192:195]
ds_read_b64_tr_b16 v[168:169], v23 offset:8704
s_waitcnt lgkmcnt(5)
v_mfma_f32_16x16x32_bf16 v[192:195], v[176:179], v[56:59], v[192:195]
ds_read_b64_tr_b16 v[170:171], v23 offset:10752
v_mfma_f32_16x16x32_bf16 v[208:211], v[176:179], v[60:63], v[208:211]
ds_read_b64_tr_b16 v[184:185], v23 offset:12800
buffer_load_dwordx4 v[152:155], v21, s[8:11], s24 offen offset:2048
v_mfma_f32_16x16x32_bf16 v[208:211], v[160:163], v[52:55], v[208:211]
ds_read_b64_tr_b16 v[186:187], v23 offset:14848
s_waitcnt lgkmcnt(6)
v_mfma_f32_16x16x32_bf16 v[212:215], v[164:167], v[52:55], v[212:215]
ds_read_b64_tr_b16 v[172:173], v23 offset:8960
s_waitcnt lgkmcnt(5)
v_mfma_f32_16x16x32_bf16 v[212:215], v[180:183], v[60:63], v[212:215]
ds_read_b64_tr_b16 v[174:175], v23 offset:11008
buffer_load_dwordx4 v[156:159], v21, s[8:11], s24 offen offset:3072
s_add_u32 s24, s24, 8192
v_mfma_f32_16x16x32_bf16 v[196:199], v[180:183], v[56:59], v[196:199]
ds_read_b64_tr_b16 v[188:189], v23 offset:13056
v_mfma_f32_16x16x32_bf16 v[196:199], v[164:167], v[48:51], v[196:199]
s_waitcnt vmcnt(24)
s_barrier
s_add_u32 m0, s41, 49152
s_add_u32 s58, s57, 2883584
ds_read_b64_tr_b16 v[190:191], v23 offset:15104
s_waitcnt lgkmcnt(6)
v_mfma_f32_16x16x32_bf16 v[200:203], v[168:171], v[48:51], v[200:203]
ds_read_b64_tr_b16 v[160:161], v23 offset:16384
buffer_load_dwordx4 v16, s[12:15], s58 offen offset:0 lds
s_waitcnt lgkmcnt(5)
v_mfma_f32_16x16x32_bf16 v[200:203], v[184:187], v[56:59], v[200:203]
ds_read_b64_tr_b16 v[162:163], v23 offset:18432
v_mfma_f32_16x16x32_bf16 v[216:219], v[184:187], v[60:63], v[216:219]
ds_read_b64_tr_b16 v[176:177], v23 offset:20480
buffer_load_dwordx4 v17, s[12:15], s58 offen offset:1024 lds
v_mfma_f32_16x16x32_bf16 v[216:219], v[168:171], v[52:55], v[216:219]
ds_read_b64_tr_b16 v[178:179], v23 offset:22528
s_waitcnt lgkmcnt(6)
v_mfma_f32_16x16x32_bf16 v[220:223], v[172:175], v[52:55], v[220:223]
ds_read_b64_tr_b16 v[164:165], v23 offset:16640
buffer_load_dwordx4 v18, s[12:15], s58 offen offset:2048 lds
s_waitcnt lgkmcnt(5)
v_mfma_f32_16x16x32_bf16 v[220:223], v[188:191], v[60:63], v[220:223]
ds_read_b64_tr_b16 v[166:167], v23 offset:18688
v_mfma_f32_16x16x32_bf16 v[204:207], v[188:191], v[56:59], v[204:207]
ds_read_b64_tr_b16 v[180:181], v23 offset:20736
buffer_load_dwordx4 v19, s[12:15], s58 offen offset:3072 lds
v_mfma_f32_16x16x32_bf16 v[204:207], v[172:175], v[48:51], v[204:207]
ds_read_b64_tr_b16 v[182:183], v23 offset:22784
s_waitcnt lgkmcnt(6)
v_mfma_f32_16x16x32_bf16 v[192:195], v[160:163], v[64:67], v[192:195]
ds_read_b64_tr_b16 v[168:169], v23 offset:16896
buffer_load_dwordx4 v[32:35], v20, s[8:11], s24 offen offset:0
s_waitcnt lgkmcnt(5)
v_mfma_f32_16x16x32_bf16 v[192:195], v[176:179], v[72:75], v[192:195]
ds_read_b64_tr_b16 v[170:171], v23 offset:18944
v_mfma_f32_16x16x32_bf16 v[208:211], v[176:179], v[76:79], v[208:211]
ds_read_b64_tr_b16 v[184:185], v23 offset:20992
v_mfma_f32_16x16x32_bf16 v[208:211], v[160:163], v[68:71], v[208:211]
ds_read_b64_tr_b16 v[186:187], v23 offset:23040
buffer_load_dwordx4 v[36:39], v20, s[8:11], s24 offen offset:1024
s_waitcnt lgkmcnt(6)
v_mfma_f32_16x16x32_bf16 v[212:215], v[164:167], v[68:71], v[212:215]
ds_read_b64_tr_b16 v[172:173], v23 offset:17152
s_waitcnt lgkmcnt(5)
v_mfma_f32_16x16x32_bf16 v[212:215], v[180:183], v[76:79], v[212:215]
ds_read_b64_tr_b16 v[174:175], v23 offset:19200
v_mfma_f32_16x16x32_bf16 v[196:199], v[180:183], v[72:75], v[196:199]
ds_read_b64_tr_b16 v[188:189], v23 offset:21248
buffer_load_dwordx4 v[40:43], v20, s[8:11], s24 offen offset:2048
v_mfma_f32_16x16x32_bf16 v[196:199], v[164:167], v[64:67], v[196:199]
ds_read_b64_tr_b16 v[190:191], v23 offset:23296
s_waitcnt lgkmcnt(6)
v_mfma_f32_16x16x32_bf16 v[200:203], v[168:171], v[64:67], v[200:203]
ds_read_b64_tr_b16 v[160:161], v23 offset:24576
s_waitcnt lgkmcnt(5)
v_mfma_f32_16x16x32_bf16 v[200:203], v[184:187], v[72:75], v[200:203]
ds_read_b64_tr_b16 v[162:163], v23 offset:26624
buffer_load_dwordx4 v[44:47], v20, s[8:11], s24 offen offset:3072
v_mfma_f32_16x16x32_bf16 v[216:219], v[184:187], v[76:79], v[216:219]
ds_read_b64_tr_b16 v[176:177], v23 offset:28672
v_mfma_f32_16x16x32_bf16 v[216:219], v[168:171], v[68:71], v[216:219]
ds_read_b64_tr_b16 v[178:179], v23 offset:30720
s_waitcnt lgkmcnt(6)
v_mfma_f32_16x16x32_bf16 v[220:223], v[172:175], v[68:71], v[220:223]
ds_read_b64_tr_b16 v[164:165], v23 offset:24832
buffer_load_dwordx4 v[48:51], v21, s[8:11], s24 offen offset:0
s_waitcnt lgkmcnt(5)
v_mfma_f32_16x16x32_bf16 v[220:223], v[188:191], v[76:79], v[220:223]
ds_read_b64_tr_b16 v[166:167], v23 offset:26880
v_mfma_f32_16x16x32_bf16 v[204:207], v[188:191], v[72:75], v[204:207]
ds_read_b64_tr_b16 v[180:181], v23 offset:28928
v_mfma_f32_16x16x32_bf16 v[204:207], v[172:175], v[64:67], v[204:207]
ds_read_b64_tr_b16 v[182:183], v23 offset:30976
buffer_load_dwordx4 v[52:55], v21, s[8:11], s24 offen offset:1024
s_waitcnt lgkmcnt(6)
v_mfma_f32_16x16x32_bf16 v[192:195], v[160:163], v[80:83], v[192:195]
ds_read_b64_tr_b16 v[168:169], v23 offset:25088
s_waitcnt lgkmcnt(5)
v_mfma_f32_16x16x32_bf16 v[192:195], v[176:179], v[88:91], v[192:195]
ds_read_b64_tr_b16 v[170:171], v23 offset:27136
v_mfma_f32_16x16x32_bf16 v[208:211], v[176:179], v[92:95], v[208:211]
ds_read_b64_tr_b16 v[184:185], v23 offset:29184
buffer_load_dwordx4 v[56:59], v21, s[8:11], s24 offen offset:2048
v_mfma_f32_16x16x32_bf16 v[208:211], v[160:163], v[84:87], v[208:211]
ds_read_b64_tr_b16 v[186:187], v23 offset:31232
s_waitcnt lgkmcnt(6)
v_mfma_f32_16x16x32_bf16 v[212:215], v[164:167], v[84:87], v[212:215]
ds_read_b64_tr_b16 v[172:173], v23 offset:25344
s_waitcnt lgkmcnt(5)
v_mfma_f32_16x16x32_bf16 v[212:215], v[180:183], v[92:95], v[212:215]
ds_read_b64_tr_b16 v[174:175], v23 offset:27392
buffer_load_dwordx4 v[60:63], v21, s[8:11], s24 offen offset:3072
s_add_u32 s24, s24, 8192
v_mfma_f32_16x16x32_bf16 v[196:199], v[180:183], v[88:91], v[196:199]
ds_read_b64_tr_b16 v[188:189], v23 offset:29440
v_mfma_f32_16x16x32_bf16 v[196:199], v[164:167], v[80:83], v[196:199]
s_waitcnt vmcnt(24)
s_barrier
s_add_u32 m0, s41, 65536
s_add_u32 s58, s57, 3145728
ds_read_b64_tr_b16 v[190:191], v23 offset:31488
s_waitcnt lgkmcnt(6)
v_mfma_f32_16x16x32_bf16 v[200:203], v[168:171], v[80:83], v[200:203]
ds_read_b64_tr_b16 v[160:161], v23 offset:32768
buffer_load_dwordx4 v16, s[12:15], s58 offen offset:0 lds
s_waitcnt lgkmcnt(5)
v_mfma_f32_16x16x32_bf16 v[200:203], v[184:187], v[88:91], v[200:203]
ds_read_b64_tr_b16 v[162:163], v23 offset:34816
v_mfma_f32_16x16x32_bf16 v[216:219], v[184:187], v[92:95], v[216:219]
ds_read_b64_tr_b16 v[176:177], v23 offset:36864
buffer_load_dwordx4 v17, s[12:15], s58 offen offset:1024 lds
v_mfma_f32_16x16x32_bf16 v[216:219], v[168:171], v[84:87], v[216:219]
ds_read_b64_tr_b16 v[178:179], v23 offset:38912
s_waitcnt lgkmcnt(6)
v_mfma_f32_16x16x32_bf16 v[220:223], v[172:175], v[84:87], v[220:223]
ds_read_b64_tr_b16 v[164:165], v23 offset:33024
buffer_load_dwordx4 v18, s[12:15], s58 offen offset:2048 lds
s_waitcnt lgkmcnt(5)
v_mfma_f32_16x16x32_bf16 v[220:223], v[188:191], v[92:95], v[220:223]
ds_read_b64_tr_b16 v[166:167], v23 offset:35072
v_mfma_f32_16x16x32_bf16 v[204:207], v[188:191], v[88:91], v[204:207]
ds_read_b64_tr_b16 v[180:181], v23 offset:37120
buffer_load_dwordx4 v19, s[12:15], s58 offen offset:3072 lds
v_mfma_f32_16x16x32_bf16 v[204:207], v[172:175], v[80:83], v[204:207]
ds_read_b64_tr_b16 v[182:183], v23 offset:39168
s_waitcnt lgkmcnt(6)
v_mfma_f32_16x16x32_bf16 v[192:195], v[160:163], v[96:99], v[192:195]
ds_read_b64_tr_b16 v[168:169], v23 offset:33280
buffer_load_dwordx4 v[64:67], v20, s[8:11], s24 offen offset:0
s_waitcnt lgkmcnt(5)
v_mfma_f32_16x16x32_bf16 v[192:195], v[176:179], v[104:107], v[192:195]
ds_read_b64_tr_b16 v[170:171], v23 offset:35328
v_mfma_f32_16x16x32_bf16 v[208:211], v[176:179], v[108:111], v[208:211]
ds_read_b64_tr_b16 v[184:185], v23 offset:37376
v_mfma_f32_16x16x32_bf16 v[208:211], v[160:163], v[100:103], v[208:211]
ds_read_b64_tr_b16 v[186:187], v23 offset:39424
buffer_load_dwordx4 v[68:71], v20, s[8:11], s24 offen offset:1024
s_waitcnt lgkmcnt(6)
v_mfma_f32_16x16x32_bf16 v[212:215], v[164:167], v[100:103], v[212:215]
ds_read_b64_tr_b16 v[172:173], v23 offset:33536
s_waitcnt lgkmcnt(5)
v_mfma_f32_16x16x32_bf16 v[212:215], v[180:183], v[108:111], v[212:215]
ds_read_b64_tr_b16 v[174:175], v23 offset:35584
v_mfma_f32_16x16x32_bf16 v[196:199], v[180:183], v[104:107], v[196:199]
ds_read_b64_tr_b16 v[188:189], v23 offset:37632
buffer_load_dwordx4 v[72:75], v20, s[8:11], s24 offen offset:2048
v_mfma_f32_16x16x32_bf16 v[196:199], v[164:167], v[96:99], v[196:199]
ds_read_b64_tr_b16 v[190:191], v23 offset:39680
s_waitcnt lgkmcnt(6)
v_mfma_f32_16x16x32_bf16 v[200:203], v[168:171], v[96:99], v[200:203]
ds_read_b64_tr_b16 v[160:161], v23 offset:40960
s_waitcnt lgkmcnt(5)
v_mfma_f32_16x16x32_bf16 v[200:203], v[184:187], v[104:107], v[200:203]
ds_read_b64_tr_b16 v[162:163], v23 offset:43008
buffer_load_dwordx4 v[76:79], v20, s[8:11], s24 offen offset:3072
v_mfma_f32_16x16x32_bf16 v[216:219], v[184:187], v[108:111], v[216:219]
ds_read_b64_tr_b16 v[176:177], v23 offset:45056
v_mfma_f32_16x16x32_bf16 v[216:219], v[168:171], v[100:103], v[216:219]
ds_read_b64_tr_b16 v[178:179], v23 offset:47104
s_waitcnt lgkmcnt(6)
v_mfma_f32_16x16x32_bf16 v[220:223], v[172:175], v[100:103], v[220:223]
ds_read_b64_tr_b16 v[164:165], v23 offset:41216
buffer_load_dwordx4 v[80:83], v21, s[8:11], s24 offen offset:0
s_waitcnt lgkmcnt(5)
v_mfma_f32_16x16x32_bf16 v[220:223], v[188:191], v[108:111], v[220:223]
ds_read_b64_tr_b16 v[166:167], v23 offset:43264
v_mfma_f32_16x16x32_bf16 v[204:207], v[188:191], v[104:107], v[204:207]
ds_read_b64_tr_b16 v[180:181], v23 offset:45312
v_mfma_f32_16x16x32_bf16 v[204:207], v[172:175], v[96:99], v[204:207]
ds_read_b64_tr_b16 v[182:183], v23 offset:47360
buffer_load_dwordx4 v[84:87], v21, s[8:11], s24 offen offset:1024
s_waitcnt lgkmcnt(6)
v_mfma_f32_16x16x32_bf16 v[192:195], v[160:163], v[112:115], v[192:195]
ds_read_b64_tr_b16 v[168:169], v23 offset:41472
s_waitcnt lgkmcnt(5)
v_mfma_f32_16x16x32_bf16 v[192:195], v[176:179], v[120:123], v[192:195]
ds_read_b64_tr_b16 v[170:171], v23 offset:43520
v_mfma_f32_16x16x32_bf16 v[208:211], v[176:179], v[124:127], v[208:211]
ds_read_b64_tr_b16 v[184:185], v23 offset:45568
buffer_load_dwordx4 v[88:91], v21, s[8:11], s24 offen offset:2048
v_mfma_f32_16x16x32_bf16 v[208:211], v[160:163], v[116:119], v[208:211]
ds_read_b64_tr_b16 v[186:187], v23 offset:47616
s_waitcnt lgkmcnt(6)
v_mfma_f32_16x16x32_bf16 v[212:215], v[164:167], v[116:119], v[212:215]
ds_read_b64_tr_b16 v[172:173], v23 offset:41728
s_waitcnt lgkmcnt(5)
v_mfma_f32_16x16x32_bf16 v[212:215], v[180:183], v[124:127], v[212:215]
ds_read_b64_tr_b16 v[174:175], v23 offset:43776
buffer_load_dwordx4 v[92:95], v21, s[8:11], s24 offen offset:3072
s_add_u32 s24, s24, 8192
v_mfma_f32_16x16x32_bf16 v[196:199], v[180:183], v[120:123], v[196:199]
ds_read_b64_tr_b16 v[188:189], v23 offset:45824
v_mfma_f32_16x16x32_bf16 v[196:199], v[164:167], v[112:115], v[196:199]
s_waitcnt vmcnt(24)
s_barrier
s_add_u32 m0, s41, 81920
s_add_u32 s58, s57, 3407872
ds_read_b64_tr_b16 v[190:191], v23 offset:47872
s_waitcnt lgkmcnt(6)
v_mfma_f32_16x16x32_bf16 v[200:203], v[168:171], v[112:115], v[200:203]
ds_read_b64_tr_b16 v[160:161], v23 offset:49152
buffer_load_dwordx4 v16, s[12:15], s58 offen offset:0 lds
s_waitcnt lgkmcnt(5)
v_mfma_f32_16x16x32_bf16 v[200:203], v[184:187], v[120:123], v[200:203]
ds_read_b64_tr_b16 v[162:163], v23 offset:51200
v_mfma_f32_16x16x32_bf16 v[216:219], v[184:187], v[124:127], v[216:219]
ds_read_b64_tr_b16 v[176:177], v23 offset:53248
buffer_load_dwordx4 v17, s[12:15], s58 offen offset:1024 lds
v_mfma_f32_16x16x32_bf16 v[216:219], v[168:171], v[116:119], v[216:219]
ds_read_b64_tr_b16 v[178:179], v23 offset:55296
s_waitcnt lgkmcnt(6)
v_mfma_f32_16x16x32_bf16 v[220:223], v[172:175], v[116:119], v[220:223]
ds_read_b64_tr_b16 v[164:165], v23 offset:49408
buffer_load_dwordx4 v18, s[12:15], s58 offen offset:2048 lds
s_waitcnt lgkmcnt(5)
v_mfma_f32_16x16x32_bf16 v[220:223], v[188:191], v[124:127], v[220:223]
ds_read_b64_tr_b16 v[166:167], v23 offset:51456
v_mfma_f32_16x16x32_bf16 v[204:207], v[188:191], v[120:123], v[204:207]
ds_read_b64_tr_b16 v[180:181], v23 offset:53504
buffer_load_dwordx4 v19, s[12:15], s58 offen offset:3072 lds
v_mfma_f32_16x16x32_bf16 v[204:207], v[172:175], v[112:115], v[204:207]
ds_read_b64_tr_b16 v[182:183], v23 offset:55552
s_waitcnt lgkmcnt(6)
v_mfma_f32_16x16x32_bf16 v[192:195], v[160:163], v[128:131], v[192:195]
ds_read_b64_tr_b16 v[168:169], v23 offset:49664
buffer_load_dwordx4 v[96:99], v20, s[8:11], s24 offen offset:0
s_waitcnt lgkmcnt(5)
v_mfma_f32_16x16x32_bf16 v[192:195], v[176:179], v[136:139], v[192:195]
ds_read_b64_tr_b16 v[170:171], v23 offset:51712
v_mfma_f32_16x16x32_bf16 v[208:211], v[176:179], v[140:143], v[208:211]
ds_read_b64_tr_b16 v[184:185], v23 offset:53760
v_mfma_f32_16x16x32_bf16 v[208:211], v[160:163], v[132:135], v[208:211]
ds_read_b64_tr_b16 v[186:187], v23 offset:55808
buffer_load_dwordx4 v[100:103], v20, s[8:11], s24 offen offset:1024
s_waitcnt lgkmcnt(6)
v_mfma_f32_16x16x32_bf16 v[212:215], v[164:167], v[132:135], v[212:215]
ds_read_b64_tr_b16 v[172:173], v23 offset:49920
s_waitcnt lgkmcnt(5)
v_mfma_f32_16x16x32_bf16 v[212:215], v[180:183], v[140:143], v[212:215]
ds_read_b64_tr_b16 v[174:175], v23 offset:51968
v_mfma_f32_16x16x32_bf16 v[196:199], v[180:183], v[136:139], v[196:199]
ds_read_b64_tr_b16 v[188:189], v23 offset:54016
buffer_load_dwordx4 v[104:107], v20, s[8:11], s24 offen offset:2048
v_mfma_f32_16x16x32_bf16 v[196:199], v[164:167], v[128:131], v[196:199]
ds_read_b64_tr_b16 v[190:191], v23 offset:56064
s_waitcnt lgkmcnt(6)
v_mfma_f32_16x16x32_bf16 v[200:203], v[168:171], v[128:131], v[200:203]
ds_read_b64_tr_b16 v[160:161], v23 offset:57344
s_waitcnt lgkmcnt(5)
v_mfma_f32_16x16x32_bf16 v[200:203], v[184:187], v[136:139], v[200:203]
ds_read_b64_tr_b16 v[162:163], v23 offset:59392
buffer_load_dwordx4 v[108:111], v20, s[8:11], s24 offen offset:3072
v_mfma_f32_16x16x32_bf16 v[216:219], v[184:187], v[140:143], v[216:219]
ds_read_b64_tr_b16 v[176:177], v23 offset:61440
v_mfma_f32_16x16x32_bf16 v[216:219], v[168:171], v[132:135], v[216:219]
ds_read_b64_tr_b16 v[178:179], v23 offset:63488
s_waitcnt lgkmcnt(6)
v_mfma_f32_16x16x32_bf16 v[220:223], v[172:175], v[132:135], v[220:223]
ds_read_b64_tr_b16 v[164:165], v23 offset:57600
buffer_load_dwordx4 v[112:115], v21, s[8:11], s24 offen offset:0
s_waitcnt lgkmcnt(5)
v_mfma_f32_16x16x32_bf16 v[220:223], v[188:191], v[140:143], v[220:223]
ds_read_b64_tr_b16 v[166:167], v23 offset:59648
v_mfma_f32_16x16x32_bf16 v[204:207], v[188:191], v[136:139], v[204:207]
ds_read_b64_tr_b16 v[180:181], v23 offset:61696
v_mfma_f32_16x16x32_bf16 v[204:207], v[172:175], v[128:131], v[204:207]
ds_read_b64_tr_b16 v[182:183], v23 offset:63744
buffer_load_dwordx4 v[116:119], v21, s[8:11], s24 offen offset:1024
s_waitcnt lgkmcnt(6)
v_mfma_f32_16x16x32_bf16 v[192:195], v[160:163], v[144:147], v[192:195]
ds_read_b64_tr_b16 v[168:169], v23 offset:57856
s_waitcnt lgkmcnt(5)
v_mfma_f32_16x16x32_bf16 v[192:195], v[176:179], v[152:155], v[192:195]
ds_read_b64_tr_b16 v[170:171], v23 offset:59904
v_mfma_f32_16x16x32_bf16 v[208:211], v[176:179], v[156:159], v[208:211]
ds_read_b64_tr_b16 v[184:185], v23 offset:61952
buffer_load_dwordx4 v[120:123], v21, s[8:11], s24 offen offset:2048
v_mfma_f32_16x16x32_bf16 v[208:211], v[160:163], v[148:151], v[208:211]
ds_read_b64_tr_b16 v[186:187], v23 offset:64000
s_waitcnt lgkmcnt(6)
v_mfma_f32_16x16x32_bf16 v[212:215], v[164:167], v[148:151], v[212:215]
ds_read_b64_tr_b16 v[172:173], v23 offset:58112
s_waitcnt lgkmcnt(5)
v_mfma_f32_16x16x32_bf16 v[212:215], v[180:183], v[156:159], v[212:215]
ds_read_b64_tr_b16 v[174:175], v23 offset:60160
buffer_load_dwordx4 v[124:127], v21, s[8:11], s24 offen offset:3072
s_add_u32 s24, s24, 8192
v_mfma_f32_16x16x32_bf16 v[196:199], v[180:183], v[152:155], v[196:199]
ds_read_b64_tr_b16 v[188:189], v23 offset:62208
v_mfma_f32_16x16x32_bf16 v[196:199], v[164:167], v[144:147], v[196:199]
s_waitcnt vmcnt(24)
s_barrier
s_mov_b64 s[12:13], s[20:21]
s_mov_b32 s14, s22
s_add_u32 m0, s41, 98304
s_mov_b32 s58, 0
ds_read_b64_tr_b16 v[190:191], v23 offset:64256
s_waitcnt lgkmcnt(6)
v_mfma_f32_16x16x32_bf16 v[200:203], v[168:171], v[144:147], v[200:203]
ds_read_b64_tr_b16 v[160:161], v22 offset:0
buffer_load_dwordx4 v16, s[12:15], s58 offen offset:0 lds
s_waitcnt lgkmcnt(5)
v_mfma_f32_16x16x32_bf16 v[200:203], v[184:187], v[152:155], v[200:203]
ds_read_b64_tr_b16 v[162:163], v22 offset:2048
v_mfma_f32_16x16x32_bf16 v[216:219], v[184:187], v[156:159], v[216:219]
ds_read_b64_tr_b16 v[176:177], v22 offset:4096
buffer_load_dwordx4 v17, s[12:15], s58 offen offset:1024 lds
v_mfma_f32_16x16x32_bf16 v[216:219], v[168:171], v[148:151], v[216:219]
ds_read_b64_tr_b16 v[178:179], v22 offset:6144
s_waitcnt lgkmcnt(6)
v_mfma_f32_16x16x32_bf16 v[220:223], v[172:175], v[148:151], v[220:223]
ds_read_b64_tr_b16 v[164:165], v22 offset:256
buffer_load_dwordx4 v18, s[12:15], s58 offen offset:2048 lds
s_waitcnt lgkmcnt(5)
v_mfma_f32_16x16x32_bf16 v[220:223], v[188:191], v[156:159], v[220:223]
ds_read_b64_tr_b16 v[166:167], v22 offset:2304
v_mfma_f32_16x16x32_bf16 v[204:207], v[188:191], v[152:155], v[204:207]
ds_read_b64_tr_b16 v[180:181], v22 offset:4352
buffer_load_dwordx4 v19, s[12:15], s58 offen offset:3072 lds
v_mfma_f32_16x16x32_bf16 v[204:207], v[172:175], v[144:147], v[204:207]
ds_read_b64_tr_b16 v[182:183], v22 offset:6400
s_waitcnt lgkmcnt(6)
v_mfma_f32_16x16x32_bf16 v[192:195], v[160:163], v[32:35], v[192:195]
ds_read_b64_tr_b16 v[168:169], v22 offset:512
buffer_load_dwordx4 v[128:131], v20, s[8:11], s24 offen offset:0
s_waitcnt lgkmcnt(5)
v_mfma_f32_16x16x32_bf16 v[192:195], v[176:179], v[40:43], v[192:195]
ds_read_b64_tr_b16 v[170:171], v22 offset:2560
v_mfma_f32_16x16x32_bf16 v[208:211], v[176:179], v[44:47], v[208:211]
ds_read_b64_tr_b16 v[184:185], v22 offset:4608
v_mfma_f32_16x16x32_bf16 v[208:211], v[160:163], v[36:39], v[208:211]
ds_read_b64_tr_b16 v[186:187], v22 offset:6656
buffer_load_dwordx4 v[132:135], v20, s[8:11], s24 offen offset:1024
s_waitcnt lgkmcnt(6)
v_mfma_f32_16x16x32_bf16 v[212:215], v[164:167], v[36:39], v[212:215]
ds_read_b64_tr_b16 v[172:173], v22 offset:768
s_waitcnt lgkmcnt(5)
v_mfma_f32_16x16x32_bf16 v[212:215], v[180:183], v[44:47], v[212:215]
ds_read_b64_tr_b16 v[174:175], v22 offset:2816
v_mfma_f32_16x16x32_bf16 v[196:199], v[180:183], v[40:43], v[196:199]
ds_read_b64_tr_b16 v[188:189], v22 offset:4864
buffer_load_dwordx4 v[136:139], v20, s[8:11], s24 offen offset:2048
v_mfma_f32_16x16x32_bf16 v[196:199], v[164:167], v[32:35], v[196:199]
ds_read_b64_tr_b16 v[190:191], v22 offset:6912
s_waitcnt lgkmcnt(6)
v_mfma_f32_16x16x32_bf16 v[200:203], v[168:171], v[32:35], v[200:203]
ds_read_b64_tr_b16 v[160:161], v22 offset:8192
s_waitcnt lgkmcnt(5)
v_mfma_f32_16x16x32_bf16 v[200:203], v[184:187], v[40:43], v[200:203]
ds_read_b64_tr_b16 v[162:163], v22 offset:10240
buffer_load_dwordx4 v[140:143], v20, s[8:11], s24 offen offset:3072
v_mfma_f32_16x16x32_bf16 v[216:219], v[184:187], v[44:47], v[216:219]
ds_read_b64_tr_b16 v[176:177], v22 offset:12288
v_mfma_f32_16x16x32_bf16 v[216:219], v[168:171], v[36:39], v[216:219]
ds_read_b64_tr_b16 v[178:179], v22 offset:14336
s_waitcnt lgkmcnt(6)
v_mfma_f32_16x16x32_bf16 v[220:223], v[172:175], v[36:39], v[220:223]
ds_read_b64_tr_b16 v[164:165], v22 offset:8448
buffer_load_dwordx4 v[144:147], v21, s[8:11], s24 offen offset:0
s_waitcnt lgkmcnt(5)
v_mfma_f32_16x16x32_bf16 v[220:223], v[188:191], v[44:47], v[220:223]
ds_read_b64_tr_b16 v[166:167], v22 offset:10496
v_mfma_f32_16x16x32_bf16 v[204:207], v[188:191], v[40:43], v[204:207]
ds_read_b64_tr_b16 v[180:181], v22 offset:12544
v_mfma_f32_16x16x32_bf16 v[204:207], v[172:175], v[32:35], v[204:207]
ds_read_b64_tr_b16 v[182:183], v22 offset:14592
buffer_load_dwordx4 v[148:151], v21, s[8:11], s24 offen offset:1024
s_waitcnt lgkmcnt(6)
v_mfma_f32_16x16x32_bf16 v[192:195], v[160:163], v[48:51], v[192:195]
ds_read_b64_tr_b16 v[168:169], v22 offset:8704
s_waitcnt lgkmcnt(5)
v_mfma_f32_16x16x32_bf16 v[192:195], v[176:179], v[56:59], v[192:195]
ds_read_b64_tr_b16 v[170:171], v22 offset:10752
v_mfma_f32_16x16x32_bf16 v[208:211], v[176:179], v[60:63], v[208:211]
ds_read_b64_tr_b16 v[184:185], v22 offset:12800
buffer_load_dwordx4 v[152:155], v21, s[8:11], s24 offen offset:2048
v_mfma_f32_16x16x32_bf16 v[208:211], v[160:163], v[52:55], v[208:211]
ds_read_b64_tr_b16 v[186:187], v22 offset:14848
s_waitcnt lgkmcnt(6)
v_mfma_f32_16x16x32_bf16 v[212:215], v[164:167], v[52:55], v[212:215]
ds_read_b64_tr_b16 v[172:173], v22 offset:8960
s_waitcnt lgkmcnt(5)
v_mfma_f32_16x16x32_bf16 v[212:215], v[180:183], v[60:63], v[212:215]
ds_read_b64_tr_b16 v[174:175], v22 offset:11008
buffer_load_dwordx4 v[156:159], v21, s[8:11], s24 offen offset:3072
s_add_u32 s24, s24, 8192
v_mfma_f32_16x16x32_bf16 v[196:199], v[180:183], v[56:59], v[196:199]
ds_read_b64_tr_b16 v[188:189], v22 offset:13056
v_mfma_f32_16x16x32_bf16 v[196:199], v[164:167], v[48:51], v[196:199]
s_waitcnt vmcnt(24)
s_barrier
s_add_u32 m0, s41, 114688
s_mov_b32 s58, 262144
ds_read_b64_tr_b16 v[190:191], v22 offset:15104
s_waitcnt lgkmcnt(6)
v_mfma_f32_16x16x32_bf16 v[200:203], v[168:171], v[48:51], v[200:203]
ds_read_b64_tr_b16 v[160:161], v22 offset:16384
buffer_load_dwordx4 v16, s[12:15], s58 offen offset:0 lds
s_waitcnt lgkmcnt(5)
v_mfma_f32_16x16x32_bf16 v[200:203], v[184:187], v[56:59], v[200:203]
ds_read_b64_tr_b16 v[162:163], v22 offset:18432
v_mfma_f32_16x16x32_bf16 v[216:219], v[184:187], v[60:63], v[216:219]
ds_read_b64_tr_b16 v[176:177], v22 offset:20480
buffer_load_dwordx4 v17, s[12:15], s58 offen offset:1024 lds
v_mfma_f32_16x16x32_bf16 v[216:219], v[168:171], v[52:55], v[216:219]
ds_read_b64_tr_b16 v[178:179], v22 offset:22528
s_waitcnt lgkmcnt(6)
v_mfma_f32_16x16x32_bf16 v[220:223], v[172:175], v[52:55], v[220:223]
ds_read_b64_tr_b16 v[164:165], v22 offset:16640
buffer_load_dwordx4 v18, s[12:15], s58 offen offset:2048 lds
s_waitcnt lgkmcnt(5)
v_mfma_f32_16x16x32_bf16 v[220:223], v[188:191], v[60:63], v[220:223]
ds_read_b64_tr_b16 v[166:167], v22 offset:18688
v_mfma_f32_16x16x32_bf16 v[204:207], v[188:191], v[56:59], v[204:207]
ds_read_b64_tr_b16 v[180:181], v22 offset:20736
buffer_load_dwordx4 v19, s[12:15], s58 offen offset:3072 lds
v_mfma_f32_16x16x32_bf16 v[204:207], v[172:175], v[48:51], v[204:207]
ds_read_b64_tr_b16 v[182:183], v22 offset:22784
s_waitcnt lgkmcnt(6)
v_mfma_f32_16x16x32_bf16 v[192:195], v[160:163], v[64:67], v[192:195]
ds_read_b64_tr_b16 v[168:169], v22 offset:16896
buffer_load_dwordx4 v[32:35], v20, s[8:11], s24 offen offset:0
s_waitcnt lgkmcnt(5)
v_mfma_f32_16x16x32_bf16 v[192:195], v[176:179], v[72:75], v[192:195]
ds_read_b64_tr_b16 v[170:171], v22 offset:18944
v_mfma_f32_16x16x32_bf16 v[208:211], v[176:179], v[76:79], v[208:211]
ds_read_b64_tr_b16 v[184:185], v22 offset:20992
v_mfma_f32_16x16x32_bf16 v[208:211], v[160:163], v[68:71], v[208:211]
ds_read_b64_tr_b16 v[186:187], v22 offset:23040
buffer_load_dwordx4 v[36:39], v20, s[8:11], s24 offen offset:1024
s_waitcnt lgkmcnt(6)
v_mfma_f32_16x16x32_bf16 v[212:215], v[164:167], v[68:71], v[212:215]
ds_read_b64_tr_b16 v[172:173], v22 offset:17152
s_waitcnt lgkmcnt(5)
v_mfma_f32_16x16x32_bf16 v[212:215], v[180:183], v[76:79], v[212:215]
ds_read_b64_tr_b16 v[174:175], v22 offset:19200
v_mfma_f32_16x16x32_bf16 v[196:199], v[180:183], v[72:75], v[196:199]
ds_read_b64_tr_b16 v[188:189], v22 offset:21248
buffer_load_dwordx4 v[40:43], v20, s[8:11], s24 offen offset:2048
v_mfma_f32_16x16x32_bf16 v[196:199], v[164:167], v[64:67], v[196:199]
ds_read_b64_tr_b16 v[190:191], v22 offset:23296
s_waitcnt lgkmcnt(6)
v_mfma_f32_16x16x32_bf16 v[200:203], v[168:171], v[64:67], v[200:203]
ds_read_b64_tr_b16 v[160:161], v22 offset:24576
s_waitcnt lgkmcnt(5)
v_mfma_f32_16x16x32_bf16 v[200:203], v[184:187], v[72:75], v[200:203]
ds_read_b64_tr_b16 v[162:163], v22 offset:26624
buffer_load_dwordx4 v[44:47], v20, s[8:11], s24 offen offset:3072
v_mfma_f32_16x16x32_bf16 v[216:219], v[184:187], v[76:79], v[216:219]
ds_read_b64_tr_b16 v[176:177], v22 offset:28672
v_mfma_f32_16x16x32_bf16 v[216:219], v[168:171], v[68:71], v[216:219]
ds_read_b64_tr_b16 v[178:179], v22 offset:30720
s_waitcnt lgkmcnt(6)
v_mfma_f32_16x16x32_bf16 v[220:223], v[172:175], v[68:71], v[220:223]
ds_read_b64_tr_b16 v[164:165], v22 offset:24832
buffer_load_dwordx4 v[48:51], v21, s[8:11], s24 offen offset:0
s_waitcnt lgkmcnt(5)
v_mfma_f32_16x16x32_bf16 v[220:223], v[188:191], v[76:79], v[220:223]
ds_read_b64_tr_b16 v[166:167], v22 offset:26880
v_mfma_f32_16x16x32_bf16 v[204:207], v[188:191], v[72:75], v[204:207]
ds_read_b64_tr_b16 v[180:181], v22 offset:28928
v_mfma_f32_16x16x32_bf16 v[204:207], v[172:175], v[64:67], v[204:207]
ds_read_b64_tr_b16 v[182:183], v22 offset:30976
buffer_load_dwordx4 v[52:55], v21, s[8:11], s24 offen offset:1024
s_waitcnt lgkmcnt(6)
v_mfma_f32_16x16x32_bf16 v[192:195], v[160:163], v[80:83], v[192:195]
ds_read_b64_tr_b16 v[168:169], v22 offset:25088
s_waitcnt lgkmcnt(5)
v_mfma_f32_16x16x32_bf16 v[192:195], v[176:179], v[88:91], v[192:195]
ds_read_b64_tr_b16 v[170:171], v22 offset:27136
v_mfma_f32_16x16x32_bf16 v[208:211], v[176:179], v[92:95], v[208:211]
ds_read_b64_tr_b16 v[184:185], v22 offset:29184
buffer_load_dwordx4 v[56:59], v21, s[8:11], s24 offen offset:2048
v_mfma_f32_16x16x32_bf16 v[208:211], v[160:163], v[84:87], v[208:211]
ds_read_b64_tr_b16 v[186:187], v22 offset:31232
s_waitcnt lgkmcnt(6)
v_mfma_f32_16x16x32_bf16 v[212:215], v[164:167], v[84:87], v[212:215]
ds_read_b64_tr_b16 v[172:173], v22 offset:25344
s_waitcnt lgkmcnt(5)
v_mfma_f32_16x16x32_bf16 v[212:215], v[180:183], v[92:95], v[212:215]
ds_read_b64_tr_b16 v[174:175], v22 offset:27392
buffer_load_dwordx4 v[60:63], v21, s[8:11], s24 offen offset:3072
s_add_u32 s24, s24, 8192
v_mfma_f32_16x16x32_bf16 v[196:199], v[180:183], v[88:91], v[196:199]
ds_read_b64_tr_b16 v[188:189], v22 offset:29440
v_mfma_f32_16x16x32_bf16 v[196:199], v[164:167], v[80:83], v[196:199]
s_waitcnt vmcnt(24)
s_barrier
s_add_u32 m0, s41, 0
s_mov_b32 s58, 524288
ds_read_b64_tr_b16 v[190:191], v22 offset:31488
s_waitcnt lgkmcnt(6)
v_mfma_f32_16x16x32_bf16 v[200:203], v[168:171], v[80:83], v[200:203]
ds_read_b64_tr_b16 v[160:161], v22 offset:32768
buffer_load_dwordx4 v16, s[12:15], s58 offen offset:0 lds
s_waitcnt lgkmcnt(5)
v_mfma_f32_16x16x32_bf16 v[200:203], v[184:187], v[88:91], v[200:203]
ds_read_b64_tr_b16 v[162:163], v22 offset:34816
v_mfma_f32_16x16x32_bf16 v[216:219], v[184:187], v[92:95], v[216:219]
ds_read_b64_tr_b16 v[176:177], v22 offset:36864
buffer_load_dwordx4 v17, s[12:15], s58 offen offset:1024 lds
v_mfma_f32_16x16x32_bf16 v[216:219], v[168:171], v[84:87], v[216:219]
ds_read_b64_tr_b16 v[178:179], v22 offset:38912
s_waitcnt lgkmcnt(6)
v_mfma_f32_16x16x32_bf16 v[220:223], v[172:175], v[84:87], v[220:223]
ds_read_b64_tr_b16 v[164:165], v22 offset:33024
buffer_load_dwordx4 v18, s[12:15], s58 offen offset:2048 lds
s_waitcnt lgkmcnt(5)
v_mfma_f32_16x16x32_bf16 v[220:223], v[188:191], v[92:95], v[220:223]
ds_read_b64_tr_b16 v[166:167], v22 offset:35072
v_mfma_f32_16x16x32_bf16 v[204:207], v[188:191], v[88:91], v[204:207]
ds_read_b64_tr_b16 v[180:181], v22 offset:37120
buffer_load_dwordx4 v19, s[12:15], s58 offen offset:3072 lds
v_mfma_f32_16x16x32_bf16 v[204:207], v[172:175], v[80:83], v[204:207]
ds_read_b64_tr_b16 v[182:183], v22 offset:39168
s_waitcnt lgkmcnt(6)
v_mfma_f32_16x16x32_bf16 v[192:195], v[160:163], v[96:99], v[192:195]
ds_read_b64_tr_b16 v[168:169], v22 offset:33280
buffer_load_dwordx4 v[64:67], v20, s[8:11], s24 offen offset:0
s_waitcnt lgkmcnt(5)
v_mfma_f32_16x16x32_bf16 v[192:195], v[176:179], v[104:107], v[192:195]
ds_read_b64_tr_b16 v[170:171], v22 offset:35328
v_mfma_f32_16x16x32_bf16 v[208:211], v[176:179], v[108:111], v[208:211]
ds_read_b64_tr_b16 v[184:185], v22 offset:37376
v_mfma_f32_16x16x32_bf16 v[208:211], v[160:163], v[100:103], v[208:211]
ds_read_b64_tr_b16 v[186:187], v22 offset:39424
buffer_load_dwordx4 v[68:71], v20, s[8:11], s24 offen offset:1024
s_waitcnt lgkmcnt(6)
v_mfma_f32_16x16x32_bf16 v[212:215], v[164:167], v[100:103], v[212:215]
ds_read_b64_tr_b16 v[172:173], v22 offset:33536
s_waitcnt lgkmcnt(5)
v_mfma_f32_16x16x32_bf16 v[212:215], v[180:183], v[108:111], v[212:215]
ds_read_b64_tr_b16 v[174:175], v22 offset:35584
v_mfma_f32_16x16x32_bf16 v[196:199], v[180:183], v[104:107], v[196:199]
ds_read_b64_tr_b16 v[188:189], v22 offset:37632
buffer_load_dwordx4 v[72:75], v20, s[8:11], s24 offen offset:2048
v_mfma_f32_16x16x32_bf16 v[196:199], v[164:167], v[96:99], v[196:199]
ds_read_b64_tr_b16 v[190:191], v22 offset:39680
s_waitcnt lgkmcnt(6)
v_mfma_f32_16x16x32_bf16 v[200:203], v[168:171], v[96:99], v[200:203]
ds_read_b64_tr_b16 v[160:161], v22 offset:40960
s_waitcnt lgkmcnt(5)
v_mfma_f32_16x16x32_bf16 v[200:203], v[184:187], v[104:107], v[200:203]
ds_read_b64_tr_b16 v[162:163], v22 offset:43008
buffer_load_dwordx4 v[76:79], v20, s[8:11], s24 offen offset:3072
v_mfma_f32_16x16x32_bf16 v[216:219], v[184:187], v[108:111], v[216:219]
ds_read_b64_tr_b16 v[176:177], v22 offset:45056
v_mfma_f32_16x16x32_bf16 v[216:219], v[168:171], v[100:103], v[216:219]
ds_read_b64_tr_b16 v[178:179], v22 offset:47104
s_waitcnt lgkmcnt(6)
v_mfma_f32_16x16x32_bf16 v[220:223], v[172:175], v[100:103], v[220:223]
ds_read_b64_tr_b16 v[164:165], v22 offset:41216
buffer_load_dwordx4 v[80:83], v21, s[8:11], s24 offen offset:0
s_waitcnt lgkmcnt(5)
v_mfma_f32_16x16x32_bf16 v[220:223], v[188:191], v[108:111], v[220:223]
ds_read_b64_tr_b16 v[166:167], v22 offset:43264
v_mfma_f32_16x16x32_bf16 v[204:207], v[188:191], v[104:107], v[204:207]
ds_read_b64_tr_b16 v[180:181], v22 offset:45312
v_mfma_f32_16x16x32_bf16 v[204:207], v[172:175], v[96:99], v[204:207]
ds_read_b64_tr_b16 v[182:183], v22 offset:47360
buffer_load_dwordx4 v[84:87], v21, s[8:11], s24 offen offset:1024
s_waitcnt lgkmcnt(6)
v_mfma_f32_16x16x32_bf16 v[192:195], v[160:163], v[112:115], v[192:195]
ds_read_b64_tr_b16 v[168:169], v22 offset:41472
s_waitcnt lgkmcnt(5)
v_mfma_f32_16x16x32_bf16 v[192:195], v[176:179], v[120:123], v[192:195]
ds_read_b64_tr_b16 v[170:171], v22 offset:43520
v_mfma_f32_16x16x32_bf16 v[208:211], v[176:179], v[124:127], v[208:211]
ds_read_b64_tr_b16 v[184:185], v22 offset:45568
buffer_load_dwordx4 v[88:91], v21, s[8:11], s24 offen offset:2048
v_mfma_f32_16x16x32_bf16 v[208:211], v[160:163], v[116:119], v[208:211]
ds_read_b64_tr_b16 v[186:187], v22 offset:47616
s_waitcnt lgkmcnt(6)
v_mfma_f32_16x16x32_bf16 v[212:215], v[164:167], v[116:119], v[212:215]
ds_read_b64_tr_b16 v[172:173], v22 offset:41728
s_waitcnt lgkmcnt(5)
v_mfma_f32_16x16x32_bf16 v[212:215], v[180:183], v[124:127], v[212:215]
ds_read_b64_tr_b16 v[174:175], v22 offset:43776
buffer_load_dwordx4 v[92:95], v21, s[8:11], s24 offen offset:3072
s_add_u32 s24, s24, 8192
v_mfma_f32_16x16x32_bf16 v[196:199], v[180:183], v[120:123], v[196:199]
ds_read_b64_tr_b16 v[188:189], v22 offset:45824
v_mfma_f32_16x16x32_bf16 v[196:199], v[164:167], v[112:115], v[196:199]
s_waitcnt vmcnt(24)
s_barrier
s_add_u32 m0, s41, 16384
s_mov_b32 s58, 786432
ds_read_b64_tr_b16 v[190:191], v22 offset:47872
s_waitcnt lgkmcnt(6)
v_mfma_f32_16x16x32_bf16 v[200:203], v[168:171], v[112:115], v[200:203]
ds_read_b64_tr_b16 v[160:161], v22 offset:49152
buffer_load_dwordx4 v16, s[12:15], s58 offen offset:0 lds
s_waitcnt lgkmcnt(5)
v_mfma_f32_16x16x32_bf16 v[200:203], v[184:187], v[120:123], v[200:203]
ds_read_b64_tr_b16 v[162:163], v22 offset:51200
v_mfma_f32_16x16x32_bf16 v[216:219], v[184:187], v[124:127], v[216:219]
ds_read_b64_tr_b16 v[176:177], v22 offset:53248
buffer_load_dwordx4 v17, s[12:15], s58 offen offset:1024 lds
v_mfma_f32_16x16x32_bf16 v[216:219], v[168:171], v[116:119], v[216:219]
ds_read_b64_tr_b16 v[178:179], v22 offset:55296
s_waitcnt lgkmcnt(6)
v_mfma_f32_16x16x32_bf16 v[220:223], v[172:175], v[116:119], v[220:223]
ds_read_b64_tr_b16 v[164:165], v22 offset:49408
buffer_load_dwordx4 v18, s[12:15], s58 offen offset:2048 lds
s_waitcnt lgkmcnt(5)
v_mfma_f32_16x16x32_bf16 v[220:223], v[188:191], v[124:127], v[220:223]
ds_read_b64_tr_b16 v[166:167], v22 offset:51456
v_mfma_f32_16x16x32_bf16 v[204:207], v[188:191], v[120:123], v[204:207]
ds_read_b64_tr_b16 v[180:181], v22 offset:53504
buffer_load_dwordx4 v19, s[12:15], s58 offen offset:3072 lds
v_mfma_f32_16x16x32_bf16 v[204:207], v[172:175], v[112:115], v[204:207]
ds_read_b64_tr_b16 v[182:183], v22 offset:55552
s_waitcnt lgkmcnt(6)
v_mfma_f32_16x16x32_bf16 v[192:195], v[160:163], v[128:131], v[192:195]
ds_read_b64_tr_b16 v[168:169], v22 offset:49664
s_waitcnt lgkmcnt(5)
v_mfma_f32_16x16x32_bf16 v[192:195], v[176:179], v[136:139], v[192:195]
ds_read_b64_tr_b16 v[170:171], v22 offset:51712
v_mfma_f32_16x16x32_bf16 v[208:211], v[176:179], v[140:143], v[208:211]
ds_read_b64_tr_b16 v[184:185], v22 offset:53760
v_mfma_f32_16x16x32_bf16 v[208:211], v[160:163], v[132:135], v[208:211]
ds_read_b64_tr_b16 v[186:187], v22 offset:55808
s_waitcnt lgkmcnt(6)
v_mfma_f32_16x16x32_bf16 v[212:215], v[164:167], v[132:135], v[212:215]
ds_read_b64_tr_b16 v[172:173], v22 offset:49920
s_waitcnt lgkmcnt(5)
v_mfma_f32_16x16x32_bf16 v[212:215], v[180:183], v[140:143], v[212:215]
ds_read_b64_tr_b16 v[174:175], v22 offset:51968
v_mfma_f32_16x16x32_bf16 v[196:199], v[180:183], v[136:139], v[196:199]
ds_read_b64_tr_b16 v[188:189], v22 offset:54016
v_mfma_f32_16x16x32_bf16 v[196:199], v[164:167], v[128:131], v[196:199]
ds_read_b64_tr_b16 v[190:191], v22 offset:56064
s_waitcnt lgkmcnt(6)
v_mfma_f32_16x16x32_bf16 v[200:203], v[168:171], v[128:131], v[200:203]
ds_read_b64_tr_b16 v[160:161], v22 offset:57344
s_waitcnt lgkmcnt(5)
v_mfma_f32_16x16x32_bf16 v[200:203], v[184:187], v[136:139], v[200:203]
ds_read_b64_tr_b16 v[162:163], v22 offset:59392
v_mfma_f32_16x16x32_bf16 v[216:219], v[184:187], v[140:143], v[216:219]
ds_read_b64_tr_b16 v[176:177], v22 offset:61440
v_mfma_f32_16x16x32_bf16 v[216:219], v[168:171], v[132:135], v[216:219]
ds_read_b64_tr_b16 v[178:179], v22 offset:63488
s_waitcnt lgkmcnt(6)
v_mfma_f32_16x16x32_bf16 v[220:223], v[172:175], v[132:135], v[220:223]
ds_read_b64_tr_b16 v[164:165], v22 offset:57600
s_waitcnt lgkmcnt(5)
v_mfma_f32_16x16x32_bf16 v[220:223], v[188:191], v[140:143], v[220:223]
ds_read_b64_tr_b16 v[166:167], v22 offset:59648
v_mfma_f32_16x16x32_bf16 v[204:207], v[188:191], v[136:139], v[204:207]
ds_read_b64_tr_b16 v[180:181], v22 offset:61696
v_mfma_f32_16x16x32_bf16 v[204:207], v[172:175], v[128:131], v[204:207]
ds_read_b64_tr_b16 v[182:183], v22 offset:63744
s_waitcnt lgkmcnt(6)
v_mfma_f32_16x16x32_bf16 v[192:195], v[160:163], v[144:147], v[192:195]
ds_read_b64_tr_b16 v[168:169], v22 offset:57856
s_waitcnt lgkmcnt(5)
v_mfma_f32_16x16x32_bf16 v[192:195], v[176:179], v[152:155], v[192:195]
ds_read_b64_tr_b16 v[170:171], v22 offset:59904
v_mfma_f32_16x16x32_bf16 v[208:211], v[176:179], v[156:159], v[208:211]
ds_read_b64_tr_b16 v[184:185], v22 offset:61952
v_mfma_f32_16x16x32_bf16 v[208:211], v[160:163], v[148:151], v[208:211]
ds_read_b64_tr_b16 v[186:187], v22 offset:64000
s_waitcnt lgkmcnt(6)
v_mfma_f32_16x16x32_bf16 v[212:215], v[164:167], v[148:151], v[212:215]
ds_read_b64_tr_b16 v[172:173], v22 offset:58112
s_waitcnt lgkmcnt(5)
v_mfma_f32_16x16x32_bf16 v[212:215], v[180:183], v[156:159], v[212:215]
ds_read_b64_tr_b16 v[174:175], v22 offset:60160
v_mfma_f32_16x16x32_bf16 v[196:199], v[180:183], v[152:155], v[196:199]
ds_read_b64_tr_b16 v[188:189], v22 offset:62208
v_mfma_f32_16x16x32_bf16 v[196:199], v[164:167], v[144:147], v[196:199]
s_waitcnt vmcnt(16)
s_barrier
s_add_u32 m0, s41, 32768
s_mov_b32 s58, 1048576
ds_read_b64_tr_b16 v[190:191], v22 offset:64256
s_waitcnt lgkmcnt(6)
v_mfma_f32_16x16x32_bf16 v[200:203], v[168:171], v[144:147], v[200:203]
ds_read_b64_tr_b16 v[160:161], v23 offset:0
buffer_load_dwordx4 v16, s[12:15], s58 offen offset:0 lds
s_waitcnt lgkmcnt(5)
v_mfma_f32_16x16x32_bf16 v[200:203], v[184:187], v[152:155], v[200:203]
ds_read_b64_tr_b16 v[162:163], v23 offset:2048
v_mfma_f32_16x16x32_bf16 v[216:219], v[184:187], v[156:159], v[216:219]
ds_read_b64_tr_b16 v[176:177], v23 offset:4096
buffer_load_dwordx4 v17, s[12:15], s58 offen offset:1024 lds
v_mfma_f32_16x16x32_bf16 v[216:219], v[168:171], v[148:151], v[216:219]
ds_read_b64_tr_b16 v[178:179], v23 offset:6144
s_waitcnt lgkmcnt(6)
v_mfma_f32_16x16x32_bf16 v[220:223], v[172:175], v[148:151], v[220:223]
ds_read_b64_tr_b16 v[164:165], v23 offset:256
buffer_load_dwordx4 v18, s[12:15], s58 offen offset:2048 lds
s_waitcnt lgkmcnt(5)
v_mfma_f32_16x16x32_bf16 v[220:223], v[188:191], v[156:159], v[220:223]
ds_read_b64_tr_b16 v[166:167], v23 offset:2304
v_mfma_f32_16x16x32_bf16 v[204:207], v[188:191], v[152:155], v[204:207]
ds_read_b64_tr_b16 v[180:181], v23 offset:4352
buffer_load_dwordx4 v19, s[12:15], s58 offen offset:3072 lds
v_mfma_f32_16x16x32_bf16 v[204:207], v[172:175], v[144:147], v[204:207]
ds_read_b64_tr_b16 v[182:183], v23 offset:6400
s_waitcnt lgkmcnt(6)
v_mfma_f32_16x16x32_bf16 v[192:195], v[160:163], v[32:35], v[192:195]
ds_read_b64_tr_b16 v[168:169], v23 offset:512
s_waitcnt lgkmcnt(5)
v_mfma_f32_16x16x32_bf16 v[192:195], v[176:179], v[40:43], v[192:195]
ds_read_b64_tr_b16 v[170:171], v23 offset:2560
v_mfma_f32_16x16x32_bf16 v[208:211], v[176:179], v[44:47], v[208:211]
ds_read_b64_tr_b16 v[184:185], v23 offset:4608
v_mfma_f32_16x16x32_bf16 v[208:211], v[160:163], v[36:39], v[208:211]
ds_read_b64_tr_b16 v[186:187], v23 offset:6656
s_waitcnt lgkmcnt(6)
v_mfma_f32_16x16x32_bf16 v[212:215], v[164:167], v[36:39], v[212:215]
ds_read_b64_tr_b16 v[172:173], v23 offset:768
s_waitcnt lgkmcnt(5)
v_mfma_f32_16x16x32_bf16 v[212:215], v[180:183], v[44:47], v[212:215]
ds_read_b64_tr_b16 v[174:175], v23 offset:2816
v_mfma_f32_16x16x32_bf16 v[196:199], v[180:183], v[40:43], v[196:199]
ds_read_b64_tr_b16 v[188:189], v23 offset:4864
v_mfma_f32_16x16x32_bf16 v[196:199], v[164:167], v[32:35], v[196:199]
ds_read_b64_tr_b16 v[190:191], v23 offset:6912
s_waitcnt lgkmcnt(6)
v_mfma_f32_16x16x32_bf16 v[200:203], v[168:171], v[32:35], v[200:203]
ds_read_b64_tr_b16 v[160:161], v23 offset:8192
s_waitcnt lgkmcnt(5)
v_mfma_f32_16x16x32_bf16 v[200:203], v[184:187], v[40:43], v[200:203]
ds_read_b64_tr_b16 v[162:163], v23 offset:10240
v_mfma_f32_16x16x32_bf16 v[216:219], v[184:187], v[44:47], v[216:219]
ds_read_b64_tr_b16 v[176:177], v23 offset:12288
v_mfma_f32_16x16x32_bf16 v[216:219], v[168:171], v[36:39], v[216:219]
ds_read_b64_tr_b16 v[178:179], v23 offset:14336
s_waitcnt lgkmcnt(6)
v_mfma_f32_16x16x32_bf16 v[220:223], v[172:175], v[36:39], v[220:223]
ds_read_b64_tr_b16 v[164:165], v23 offset:8448
s_waitcnt lgkmcnt(5)
v_mfma_f32_16x16x32_bf16 v[220:223], v[188:191], v[44:47], v[220:223]
ds_read_b64_tr_b16 v[166:167], v23 offset:10496
v_mfma_f32_16x16x32_bf16 v[204:207], v[188:191], v[40:43], v[204:207]
ds_read_b64_tr_b16 v[180:181], v23 offset:12544
v_mfma_f32_16x16x32_bf16 v[204:207], v[172:175], v[32:35], v[204:207]
ds_read_b64_tr_b16 v[182:183], v23 offset:14592
s_waitcnt lgkmcnt(6)
v_mfma_f32_16x16x32_bf16 v[192:195], v[160:163], v[48:51], v[192:195]
ds_read_b64_tr_b16 v[168:169], v23 offset:8704
s_waitcnt lgkmcnt(5)
v_mfma_f32_16x16x32_bf16 v[192:195], v[176:179], v[56:59], v[192:195]
ds_read_b64_tr_b16 v[170:171], v23 offset:10752
v_mfma_f32_16x16x32_bf16 v[208:211], v[176:179], v[60:63], v[208:211]
ds_read_b64_tr_b16 v[184:185], v23 offset:12800
v_mfma_f32_16x16x32_bf16 v[208:211], v[160:163], v[52:55], v[208:211]
ds_read_b64_tr_b16 v[186:187], v23 offset:14848
s_waitcnt lgkmcnt(6)
v_mfma_f32_16x16x32_bf16 v[212:215], v[164:167], v[52:55], v[212:215]
ds_read_b64_tr_b16 v[172:173], v23 offset:8960
s_waitcnt lgkmcnt(5)
v_mfma_f32_16x16x32_bf16 v[212:215], v[180:183], v[60:63], v[212:215]
ds_read_b64_tr_b16 v[174:175], v23 offset:11008
v_mfma_f32_16x16x32_bf16 v[196:199], v[180:183], v[56:59], v[196:199]
ds_read_b64_tr_b16 v[188:189], v23 offset:13056
v_mfma_f32_16x16x32_bf16 v[196:199], v[164:167], v[48:51], v[196:199]
s_waitcnt vmcnt(8)
s_barrier
s_add_u32 m0, s41, 49152
s_mov_b32 s58, 1310720
ds_read_b64_tr_b16 v[190:191], v23 offset:15104
s_waitcnt lgkmcnt(6)
v_mfma_f32_16x16x32_bf16 v[200:203], v[168:171], v[48:51], v[200:203]
ds_read_b64_tr_b16 v[160:161], v23 offset:16384
buffer_load_dwordx4 v16, s[12:15], s58 offen offset:0 lds
s_waitcnt lgkmcnt(5)
v_mfma_f32_16x16x32_bf16 v[200:203], v[184:187], v[56:59], v[200:203]
ds_read_b64_tr_b16 v[162:163], v23 offset:18432
v_mfma_f32_16x16x32_bf16 v[216:219], v[184:187], v[60:63], v[216:219]
ds_read_b64_tr_b16 v[176:177], v23 offset:20480
buffer_load_dwordx4 v17, s[12:15], s58 offen offset:1024 lds
v_mfma_f32_16x16x32_bf16 v[216:219], v[168:171], v[52:55], v[216:219]
ds_read_b64_tr_b16 v[178:179], v23 offset:22528
s_waitcnt lgkmcnt(6)
v_mfma_f32_16x16x32_bf16 v[220:223], v[172:175], v[52:55], v[220:223]
ds_read_b64_tr_b16 v[164:165], v23 offset:16640
buffer_load_dwordx4 v18, s[12:15], s58 offen offset:2048 lds
s_waitcnt lgkmcnt(5)
v_mfma_f32_16x16x32_bf16 v[220:223], v[188:191], v[60:63], v[220:223]
ds_read_b64_tr_b16 v[166:167], v23 offset:18688
v_mfma_f32_16x16x32_bf16 v[204:207], v[188:191], v[56:59], v[204:207]
ds_read_b64_tr_b16 v[180:181], v23 offset:20736
buffer_load_dwordx4 v19, s[12:15], s58 offen offset:3072 lds
v_mfma_f32_16x16x32_bf16 v[204:207], v[172:175], v[48:51], v[204:207]
ds_read_b64_tr_b16 v[182:183], v23 offset:22784
s_waitcnt lgkmcnt(6)
v_mfma_f32_16x16x32_bf16 v[192:195], v[160:163], v[64:67], v[192:195]
ds_read_b64_tr_b16 v[168:169], v23 offset:16896
s_waitcnt lgkmcnt(5)
v_mfma_f32_16x16x32_bf16 v[192:195], v[176:179], v[72:75], v[192:195]
ds_read_b64_tr_b16 v[170:171], v23 offset:18944
v_mfma_f32_16x16x32_bf16 v[208:211], v[176:179], v[76:79], v[208:211]
ds_read_b64_tr_b16 v[184:185], v23 offset:20992
v_mfma_f32_16x16x32_bf16 v[208:211], v[160:163], v[68:71], v[208:211]
ds_read_b64_tr_b16 v[186:187], v23 offset:23040
s_waitcnt lgkmcnt(6)
v_mfma_f32_16x16x32_bf16 v[212:215], v[164:167], v[68:71], v[212:215]
ds_read_b64_tr_b16 v[172:173], v23 offset:17152
s_waitcnt lgkmcnt(5)
v_mfma_f32_16x16x32_bf16 v[212:215], v[180:183], v[76:79], v[212:215]
ds_read_b64_tr_b16 v[174:175], v23 offset:19200
v_mfma_f32_16x16x32_bf16 v[196:199], v[180:183], v[72:75], v[196:199]
ds_read_b64_tr_b16 v[188:189], v23 offset:21248
v_mfma_f32_16x16x32_bf16 v[196:199], v[164:167], v[64:67], v[196:199]
ds_read_b64_tr_b16 v[190:191], v23 offset:23296
s_waitcnt lgkmcnt(6)
v_mfma_f32_16x16x32_bf16 v[200:203], v[168:171], v[64:67], v[200:203]
ds_read_b64_tr_b16 v[160:161], v23 offset:24576
s_waitcnt lgkmcnt(5)
v_mfma_f32_16x16x32_bf16 v[200:203], v[184:187], v[72:75], v[200:203]
ds_read_b64_tr_b16 v[162:163], v23 offset:26624
v_mfma_f32_16x16x32_bf16 v[216:219], v[184:187], v[76:79], v[216:219]
ds_read_b64_tr_b16 v[176:177], v23 offset:28672
v_mfma_f32_16x16x32_bf16 v[216:219], v[168:171], v[68:71], v[216:219]
ds_read_b64_tr_b16 v[178:179], v23 offset:30720
s_waitcnt lgkmcnt(6)
v_mfma_f32_16x16x32_bf16 v[220:223], v[172:175], v[68:71], v[220:223]
ds_read_b64_tr_b16 v[164:165], v23 offset:24832
s_waitcnt lgkmcnt(5)
v_mfma_f32_16x16x32_bf16 v[220:223], v[188:191], v[76:79], v[220:223]
ds_read_b64_tr_b16 v[166:167], v23 offset:26880
v_mfma_f32_16x16x32_bf16 v[204:207], v[188:191], v[72:75], v[204:207]
ds_read_b64_tr_b16 v[180:181], v23 offset:28928
v_mfma_f32_16x16x32_bf16 v[204:207], v[172:175], v[64:67], v[204:207]
ds_read_b64_tr_b16 v[182:183], v23 offset:30976
s_waitcnt lgkmcnt(6)
v_mfma_f32_16x16x32_bf16 v[192:195], v[160:163], v[80:83], v[192:195]
ds_read_b64_tr_b16 v[168:169], v23 offset:25088
s_waitcnt lgkmcnt(5)
v_mfma_f32_16x16x32_bf16 v[192:195], v[176:179], v[88:91], v[192:195]
ds_read_b64_tr_b16 v[170:171], v23 offset:27136
v_mfma_f32_16x16x32_bf16 v[208:211], v[176:179], v[92:95], v[208:211]
ds_read_b64_tr_b16 v[184:185], v23 offset:29184
v_mfma_f32_16x16x32_bf16 v[208:211], v[160:163], v[84:87], v[208:211]
ds_read_b64_tr_b16 v[186:187], v23 offset:31232
s_waitcnt lgkmcnt(6)
v_mfma_f32_16x16x32_bf16 v[212:215], v[164:167], v[84:87], v[212:215]
ds_read_b64_tr_b16 v[172:173], v23 offset:25344
s_waitcnt lgkmcnt(5)
v_mfma_f32_16x16x32_bf16 v[212:215], v[180:183], v[92:95], v[212:215]
ds_read_b64_tr_b16 v[174:175], v23 offset:27392
v_mfma_f32_16x16x32_bf16 v[196:199], v[180:183], v[88:91], v[196:199]
ds_read_b64_tr_b16 v[188:189], v23 offset:29440
v_mfma_f32_16x16x32_bf16 v[196:199], v[164:167], v[80:83], v[196:199]
s_waitcnt vmcnt(63)
s_barrier
s_add_u32 m0, s41, 65536
s_mov_b32 s58, 1572864
ds_read_b64_tr_b16 v[190:191], v23 offset:31488
s_waitcnt lgkmcnt(6)
v_mfma_f32_16x16x32_bf16 v[200:203], v[168:171], v[80:83], v[200:203]
buffer_load_dwordx4 v16, s[12:15], s58 offen offset:0 lds
s_waitcnt lgkmcnt(4)
v_mfma_f32_16x16x32_bf16 v[200:203], v[184:187], v[88:91], v[200:203]
v_mfma_f32_16x16x32_bf16 v[216:219], v[184:187], v[92:95], v[216:219]
buffer_load_dwordx4 v17, s[12:15], s58 offen offset:1024 lds
v_mfma_f32_16x16x32_bf16 v[216:219], v[168:171], v[84:87], v[216:219]
s_waitcnt lgkmcnt(2)
v_mfma_f32_16x16x32_bf16 v[220:223], v[172:175], v[84:87], v[220:223]
buffer_load_dwordx4 v18, s[12:15], s58 offen offset:2048 lds
s_waitcnt lgkmcnt(0)
v_mfma_f32_16x16x32_bf16 v[220:223], v[188:191], v[92:95], v[220:223]
v_mfma_f32_16x16x32_bf16 v[204:207], v[188:191], v[88:91], v[204:207]
buffer_load_dwordx4 v19, s[12:15], s58 offen offset:3072 lds
v_mfma_f32_16x16x32_bf16 v[204:207], v[172:175], v[80:83], v[204:207]
s_waitcnt lgkmcnt(0)
s_barrier
s_add_u32 m0, s41, 81920
s_mov_b32 s58, 1835008
buffer_load_dwordx4 v16, s[12:15], s58 offen offset:0 lds
buffer_load_dwordx4 v17, s[12:15], s58 offen offset:1024 lds
buffer_load_dwordx4 v18, s[12:15], s58 offen offset:2048 lds
buffer_load_dwordx4 v19, s[12:15], s58 offen offset:3072 lds
s_mov_b64 s[8:9], s[16:17]
s_mov_b32 s10, s18
s_mov_b32 s44, 0
s_mov_b32 s45, 0
v_lshlrev_b32 v14, 2, v0
s_mov_b64 exec, 0xff
buffer_load_dword v15, v14, s[48:51], s31 offen sc1
s_mov_b64 exec, -1
s_mov_b32 s28, 0xbfb8aa3b
s_mov_b32 s29, s28
v_pk_mul_f32 v[176:177], v[192:193], s[28:29]
v_pk_mul_f32 v[178:179], v[194:195], s[28:29]
v_pk_mul_f32 v[180:181], v[196:197], s[28:29]
v_pk_mul_f32 v[182:183], v[198:199], s[28:29]
v_pk_mul_f32 v[184:185], v[200:201], s[28:29]
v_pk_mul_f32 v[186:187], v[202:203], s[28:29]
v_pk_mul_f32 v[188:189], v[204:205], s[28:29]
v_pk_mul_f32 v[190:191], v[206:207], s[28:29]
v_exp_f32 v176, v176
v_exp_f32 v177, v177
v_exp_f32 v178, v178
v_exp_f32 v179, v179
v_exp_f32 v180, v180
v_exp_f32 v181, v181
v_exp_f32 v182, v182
v_exp_f32 v183, v183
v_exp_f32 v184, v184
v_exp_f32 v185, v185
v_exp_f32 v186, v186
v_exp_f32 v187, v187
v_exp_f32 v188, v188
v_exp_f32 v189, v189
v_exp_f32 v190, v190
v_exp_f32 v191, v191
v_pk_add_f32 v[176:177], v[176:177], 1.0 op_sel_hi:[1,0]
v_pk_add_f32 v[178:179], v[178:179], 1.0 op_sel_hi:[1,0]
v_pk_add_f32 v[180:181], v[180:181], 1.0 op_sel_hi:[1,0]
v_pk_add_f32 v[182:183], v[182:183], 1.0 op_sel_hi:[1,0]
v_pk_add_f32 v[184:185], v[184:185], 1.0 op_sel_hi:[1,0]
v_pk_add_f32 v[186:187], v[186:187], 1.0 op_sel_hi:[1,0]
v_pk_add_f32 v[188:189], v[188:189], 1.0 op_sel_hi:[1,0]
v_pk_add_f32 v[190:191], v[190:191], 1.0 op_sel_hi:[1,0]
v_rcp_f32 v176, v176
v_rcp_f32 v177, v177
v_rcp_f32 v178, v178
v_rcp_f32 v179, v179
v_rcp_f32 v180, v180
v_rcp_f32 v181, v181
v_rcp_f32 v182, v182
v_rcp_f32 v183, v183
v_rcp_f32 v184, v184
v_rcp_f32 v185, v185
v_rcp_f32 v186, v186
v_rcp_f32 v187, v187
v_rcp_f32 v188, v188
v_rcp_f32 v189, v189
v_rcp_f32 v190, v190
v_rcp_f32 v191, v191
v_pk_mul_f32 v[192:193], v[192:193], v[176:177]
v_pk_mul_f32 v[194:195], v[194:195], v[178:179]
v_pk_mul_f32 v[196:197], v[196:197], v[180:181]
v_pk_mul_f32 v[198:199], v[198:199], v[182:183]
v_pk_mul_f32 v[200:201], v[200:201], v[184:185]
v_pk_mul_f32 v[202:203], v[202:203], v[186:187]
v_pk_mul_f32 v[204:205], v[204:205], v[188:189]
v_pk_mul_f32 v[206:207], v[206:207], v[190:191]
v_pk_mul_f32 v[176:177], v[208:209], s[28:29]
v_pk_mul_f32 v[178:179], v[210:211], s[28:29]
v_pk_mul_f32 v[180:181], v[212:213], s[28:29]
v_pk_mul_f32 v[182:183], v[214:215], s[28:29]
v_pk_mul_f32 v[184:185], v[216:217], s[28:29]
v_pk_mul_f32 v[186:187], v[218:219], s[28:29]
v_pk_mul_f32 v[188:189], v[220:221], s[28:29]
v_pk_mul_f32 v[190:191], v[222:223], s[28:29]
v_exp_f32 v176, v176
v_exp_f32 v177, v177
v_exp_f32 v178, v178
v_exp_f32 v179, v179
v_exp_f32 v180, v180
v_exp_f32 v181, v181
v_exp_f32 v182, v182
v_exp_f32 v183, v183
v_exp_f32 v184, v184
v_exp_f32 v185, v185
v_exp_f32 v186, v186
v_exp_f32 v187, v187
v_exp_f32 v188, v188
v_exp_f32 v189, v189
v_exp_f32 v190, v190
v_exp_f32 v191, v191
v_pk_add_f32 v[176:177], v[176:177], 1.0 op_sel_hi:[1,0]
v_pk_add_f32 v[178:179], v[178:179], 1.0 op_sel_hi:[1,0]
v_pk_add_f32 v[180:181], v[180:181], 1.0 op_sel_hi:[1,0]
v_pk_add_f32 v[182:183], v[182:183], 1.0 op_sel_hi:[1,0]
v_pk_add_f32 v[184:185], v[184:185], 1.0 op_sel_hi:[1,0]
v_pk_add_f32 v[186:187], v[186:187], 1.0 op_sel_hi:[1,0]
v_pk_add_f32 v[188:189], v[188:189], 1.0 op_sel_hi:[1,0]
v_pk_add_f32 v[190:191], v[190:191], 1.0 op_sel_hi:[1,0]
v_rcp_f32 v176, v176
v_rcp_f32 v177, v177
v_rcp_f32 v178, v178
v_rcp_f32 v179, v179
v_rcp_f32 v180, v180
v_rcp_f32 v181, v181
v_rcp_f32 v182, v182
v_rcp_f32 v183, v183
v_rcp_f32 v184, v184
v_rcp_f32 v185, v185
v_rcp_f32 v186, v186
v_rcp_f32 v187, v187
v_rcp_f32 v188, v188
v_rcp_f32 v189, v189
v_rcp_f32 v190, v190
v_rcp_f32 v191, v191
v_pk_mul_f32 v[208:209], v[208:209], v[176:177]
v_pk_mul_f32 v[210:211], v[210:211], v[178:179]
v_pk_mul_f32 v[212:213], v[212:213], v[180:181]
v_pk_mul_f32 v[214:215], v[214:215], v[182:183]
v_pk_mul_f32 v[216:217], v[216:217], v[184:185]
v_pk_mul_f32 v[218:219], v[218:219], v[186:187]
v_pk_mul_f32 v[220:221], v[220:221], v[188:189]
v_pk_mul_f32 v[222:223], v[222:223], v[190:191]
v_permlane16_swap_b32 v224, v226
v_permlane16_swap_b32 v225, v227
v_permlane16_swap_b32 v228, v230
v_permlane16_swap_b32 v229, v231
v_permlane16_swap_b32 v232, v234
v_permlane16_swap_b32 v233, v235
v_permlane16_swap_b32 v236, v238
v_permlane16_swap_b32 v237, v239
v_and_b32 v255, 0xffff0000, v239
v_lshlrev_b32 v254, 16, v239
v_and_b32 v253, 0xffff0000, v238
v_lshlrev_b32 v252, 16, v238
v_and_b32 v251, 0xffff0000, v237
v_lshlrev_b32 v250, 16, v237
v_and_b32 v249, 0xffff0000, v236
v_lshlrev_b32 v248, 16, v236
v_and_b32 v247, 0xffff0000, v235
v_lshlrev_b32 v246, 16, v235
v_and_b32 v245, 0xffff0000, v234
v_lshlrev_b32 v244, 16, v234
v_and_b32 v243, 0xffff0000, v233
v_lshlrev_b32 v242, 16, v233
v_and_b32 v241, 0xffff0000, v232
v_lshlrev_b32 v240, 16, v232
v_and_b32 v239, 0xffff0000, v231
v_lshlrev_b32 v238, 16, v231
v_and_b32 v237, 0xffff0000, v230
v_lshlrev_b32 v236, 16, v230
v_and_b32 v235, 0xffff0000, v229
v_lshlrev_b32 v234, 16, v229
v_and_b32 v233, 0xffff0000, v228
v_lshlrev_b32 v232, 16, v228
v_and_b32 v231, 0xffff0000, v227
v_lshlrev_b32 v230, 16, v227
v_and_b32 v229, 0xffff0000, v226
v_lshlrev_b32 v228, 16, v226
v_and_b32 v227, 0xffff0000, v225
v_lshlrev_b32 v226, 16, v225
v_and_b32 v225, 0xffff0000, v224
v_lshlrev_b32 v224, 16, v224
s_waitcnt vmcnt(0)
s_barrier
s_andn2_b32 s26, s44, s45
s_cbranch_scc1 L_e0_h
s_waitcnt vmcnt(0)
s_mov_b32 s47, 0x40000
L_e0_l:
v_cmp_le_u32 vcc, 4, v15
s_sub_u32 s47, s47, 1
s_cselect_b32 s26, 0xff, 0
s_or_b32 s26, s26, vcc_lo
s_and_b32 s44, s26, 0xff
s_andn2_b32 s26, s44, s45
s_cbranch_scc1 L_e0_h
s_sleep 2
s_mov_b64 exec, 0xff
buffer_load_dword v15, v14, s[48:51], s31 offen sc1
s_mov_b64 exec, -1
s_waitcnt vmcnt(0)
s_branch L_e0_l
L_e0_h:
s_ff1_i32_b32 s46, s26
s_bitset1_b32 s45, s46
s_lshl_b32 s24, s46, 13
s_add_u32 s26, s46, 6
s_and_b32 s26, s26, 7
s_lshl_b32 s36, s26, 14
s_mov_b64 exec, 0xff
buffer_load_dword v15, v14, s[48:51], s31 offen sc1
s_mov_b64 exec, -1
buffer_load_dwordx4 v[32:35], v20, s[8:11], s24 offen offset:0
buffer_load_dwordx4 v[36:39], v20, s[8:11], s24 offen offset:1024
buffer_load_dwordx4 v[40:43], v20, s[8:11], s24 offen offset:2048
buffer_load_dwordx4 v[44:47], v20, s[8:11], s24 offen offset:3072
buffer_load_dwordx4 v[48:51], v21, s[8:11], s24 offen offset:0
buffer_load_dwordx4 v[52:55], v21, s[8:11], s24 offen offset:1024
buffer_load_dwordx4 v[56:59], v21, s[8:11], s24 offen offset:2048
buffer_load_dwordx4 v[60:63], v21, s[8:11], s24 offen offset:3072
s_add_u32 s24, s24, 8192
s_andn2_b32 s26, s44, s45
s_cbranch_scc1 L_e1_h
s_waitcnt vmcnt(8)
s_mov_b32 s47, 0x40000
L_e1_l:
v_cmp_le_u32 vcc, 4, v15
s_sub_u32 s47, s47, 1
s_cselect_b32 s26, 0xff, 0
s_or_b32 s26, s26, vcc_lo
s_and_b32 s44, s26, 0xff
s_andn2_b32 s26, s44, s45
s_cbranch_scc1 L_e1_h
s_sleep 2
s_mov_b64 exec, 0xff
buffer_load_dword v15, v14, s[48:51], s31 offen sc1
s_mov_b64 exec, -1
s_waitcnt vmcnt(0)
s_branch L_e1_l
L_e1_h:
s_ff1_i32_b32 s46, s26
s_bitset1_b32 s45, s46
s_lshl_b32 s24, s46, 13
s_add_u32 s26, s46, 6
s_and_b32 s26, s26, 7
s_lshl_b32 s37, s26, 14
s_mov_b64 exec, 0xff
buffer_load_dword v15, v14, s[48:51], s31 offen sc1
s_mov_b64 exec, -1
buffer_load_dwordx4 v[64:67], v20, s[8:11], s24 offen offset:0
buffer_load_dwordx4 v[68:71], v20, s[8:11], s24 offen offset:1024
buffer_load_dwordx4 v[72:75], v20, s[8:11], s24 offen offset:2048
buffer_load_dwordx4 v[76:79], v20, s[8:11], s24 offen offset:3072
buffer_load_dwordx4 v[80:83], v21, s[8:11], s24 offen offset:0
buffer_load_dwordx4 v[84:87], v21, s[8:11], s24 offen offset:1024
buffer_load_dwordx4 v[88:91], v21, s[8:11], s24 offen offset:2048
buffer_load_dwordx4 v[92:95], v21, s[8:11], s24 offen offset:3072
s_add_u32 s24, s24, 8192
v_add_u32 v24, s36, v22
ds_read_b64_tr_b16 v[160:161], v24 offset:0
ds_read_b64_tr_b16 v[162:163], v24 offset:2048
ds_read_b64_tr_b16 v[176:177], v24 offset:4096
ds_read_b64_tr_b16 v[178:179], v24 offset:6144
ds_read_b64_tr_b16 v[164:165], v24 offset:256
ds_read_b64_tr_b16 v[166:167], v24 offset:2304
ds_read_b64_tr_b16 v[180:181], v24 offset:4352
ds_read_b64_tr_b16 v[182:183], v24 offset:6400
s_waitcnt vmcnt(9)
s_waitcnt lgkmcnt(6)
v_mfma_f32_16x16x32_bf16 v[128:131], v[160:163], v[32:35], 0
ds_read_b64_tr_b16 v[168:169], v24 offset:512
v_add_u32 v25, s37, v22
s_waitcnt lgkmcnt(5)
v_mfma_f32_16x16x32_bf16 v[128:131], v[176:179], v[40:43], v[128:131]
ds_read_b64_tr_b16 v[170:171], v24 offset:2560
v_mfma_f32_16x16x32_bf16 v[144:147], v[176:179], v[44:47], 0
ds_read_b64_tr_b16 v[184:185], v24 offset:4608
v_mfma_f32_16x16x32_bf16 v[144:147], v[160:163], v[36:39], v[144:147]
ds_read_b64_tr_b16 v[186:187], v24 offset:6656
s_waitcnt lgkmcnt(6)
v_mfma_f32_16x16x32_bf16 v[148:151], v[164:167], v[36:39], 0
ds_read_b64_tr_b16 v[172:173], v24 offset:768
s_waitcnt lgkmcnt(5)
v_mfma_f32_16x16x32_bf16 v[148:151], v[180:183], v[44:47], v[148:151]
ds_read_b64_tr_b16 v[174:175], v24 offset:2816
v_mfma_f32_16x16x32_bf16 v[132:135], v[180:183], v[40:43], 0
ds_read_b64_tr_b16 v[188:189], v24 offset:4864
v_mfma_f32_16x16x32_bf16 v[132:135], v[164:167], v[32:35], v[132:135]
ds_read_b64_tr_b16 v[190:191], v24 offset:6912
s_waitcnt lgkmcnt(6)
v_mfma_f32_16x16x32_bf16 v[136:139], v[168:171], v[32:35], 0
ds_read_b64_tr_b16 v[160:161], v24 offset:8192
s_waitcnt lgkmcnt(5)
v_mfma_f32_16x16x32_bf16 v[136:139], v[184:187], v[40:43], v[136:139]
ds_read_b64_tr_b16 v[162:163], v24 offset:10240
v_mfma_f32_16x16x32_bf16 v[152:155], v[184:187], v[44:47], 0
ds_read_b64_tr_b16 v[176:177], v24 offset:12288
v_mfma_f32_16x16x32_bf16 v[152:155], v[168:171], v[36:39], v[152:155]
ds_read_b64_tr_b16 v[178:179], v24 offset:14336
s_waitcnt lgkmcnt(6)
v_mfma_f32_16x16x32_bf16 v[156:159], v[172:175], v[36:39], 0
ds_read_b64_tr_b16 v[164:165], v24 offset:8448
s_waitcnt lgkmcnt(5)
v_mfma_f32_16x16x32_bf16 v[156:159], v[188:191], v[44:47], v[156:159]
ds_read_b64_tr_b16 v[166:167], v24 offset:10496
v_mfma_f32_16x16x32_bf16 v[140:143], v[188:191], v[40:43], 0
ds_read_b64_tr_b16 v[180:181], v24 offset:12544
v_mfma_f32_16x16x32_bf16 v[140:143], v[172:175], v[32:35], v[140:143]
ds_read_b64_tr_b16 v[182:183], v24 offset:14592
s_waitcnt lgkmcnt(6)
v_mfma_f32_16x16x32_bf16 v[128:131], v[160:163], v[48:51], v[128:131]
ds_read_b64_tr_b16 v[168:169], v24 offset:8704
s_waitcnt lgkmcnt(5)
v_mfma_f32_16x16x32_bf16 v[128:131], v[176:179], v[56:59], v[128:131]
ds_read_b64_tr_b16 v[170:171], v24 offset:10752
v_mfma_f32_16x16x32_bf16 v[144:147], v[176:179], v[60:63], v[144:147]
ds_read_b64_tr_b16 v[184:185], v24 offset:12800
v_mfma_f32_16x16x32_bf16 v[144:147], v[160:163], v[52:55], v[144:147]
ds_read_b64_tr_b16 v[186:187], v24 offset:14848
s_waitcnt lgkmcnt(6)
v_mfma_f32_16x16x32_bf16 v[148:151], v[164:167], v[52:55], v[148:151]
ds_read_b64_tr_b16 v[172:173], v24 offset:8960
s_waitcnt lgkmcnt(5)
v_mfma_f32_16x16x32_bf16 v[148:151], v[180:183], v[60:63], v[148:151]
ds_read_b64_tr_b16 v[174:175], v24 offset:11008
v_mfma_f32_16x16x32_bf16 v[132:135], v[180:183], v[56:59], v[132:135]
ds_read_b64_tr_b16 v[188:189], v24 offset:13056
v_mfma_f32_16x16x32_bf16 v[132:135], v[164:167], v[48:51], v[132:135]
ds_read_b64_tr_b16 v[190:191], v24 offset:15104
s_waitcnt lgkmcnt(6)
v_mfma_f32_16x16x32_bf16 v[136:139], v[168:171], v[48:51], v[136:139]
ds_read_b64_tr_b16 v[160:161], v25 offset:0
s_waitcnt lgkmcnt(5)
v_mfma_f32_16x16x32_bf16 v[136:139], v[184:187], v[56:59], v[136:139]
ds_read_b64_tr_b16 v[162:163], v25 offset:2048
v_mfma_f32_16x16x32_bf16 v[152:155], v[184:187], v[60:63], v[152:155]
ds_read_b64_tr_b16 v[176:177], v25 offset:4096
v_mfma_f32_16x16x32_bf16 v[152:155], v[168:171], v[52:55], v[152:155]
ds_read_b64_tr_b16 v[178:179], v25 offset:6144
s_waitcnt lgkmcnt(6)
v_mfma_f32_16x16x32_bf16 v[156:159], v[172:175], v[52:55], v[156:159]
ds_read_b64_tr_b16 v[164:165], v25 offset:256
s_waitcnt lgkmcnt(5)
v_mfma_f32_16x16x32_bf16 v[156:159], v[188:191], v[60:63], v[156:159]
ds_read_b64_tr_b16 v[166:167], v25 offset:2304
v_mfma_f32_16x16x32_bf16 v[140:143], v[188:191], v[56:59], v[140:143]
ds_read_b64_tr_b16 v[180:181], v25 offset:4352
v_mfma_f32_16x16x32_bf16 v[140:143], v[172:175], v[48:51], v[140:143]
ds_read_b64_tr_b16 v[182:183], v25 offset:6400
s_andn2_b32 s26, s44, s45
s_cbranch_scc1 L_e2_h
s_waitcnt vmcnt(8)
s_mov_b32 s47, 0x40000
L_e2_l:
v_cmp_le_u32 vcc, 4, v15
s_sub_u32 s47, s47, 1
s_cselect_b32 s26, 0xff, 0
s_or_b32 s26, s26, vcc_lo
s_and_b32 s44, s26, 0xff
s_andn2_b32 s26, s44, s45
s_cbranch_scc1 L_e2_h
s_sleep 2
s_mov_b64 exec, 0xff
buffer_load_dword v15, v14, s[48:51], s31 offen sc1
s_mov_b64 exec, -1
s_waitcnt vmcnt(0)
s_branch L_e2_l
L_e2_h:
s_ff1_i32_b32 s46, s26
s_bitset1_b32 s45, s46
s_lshl_b32 s24, s46, 13
s_add_u32 s26, s46, 6
s_and_b32 s26, s26, 7
s_lshl_b32 s38, s26, 14
s_mov_b64 exec, 0xff
buffer_load_dword v15, v14, s[48:51], s31 offen sc1
s_mov_b64 exec, -1
buffer_load_dwordx4 v[96:99], v20, s[8:11], s24 offen offset:0
buffer_load_dwordx4 v[100:103], v20, s[8:11], s24 offen offset:1024
buffer_load_dwordx4 v[104:107], v20, s[8:11], s24 offen offset:2048
buffer_load_dwordx4 v[108:111], v20, s[8:11], s24 offen offset:3072
buffer_load_dwordx4 v[112:115], v21, s[8:11], s24 offen offset:0
buffer_load_dwordx4 v[116:119], v21, s[8:11], s24 offen offset:1024
buffer_load_dwordx4 v[120:123], v21, s[8:11], s24 offen offset:2048
buffer_load_dwordx4 v[124:127], v21, s[8:11], s24 offen offset:3072
s_add_u32 s24, s24, 8192
s_waitcnt vmcnt(9)
s_waitcnt lgkmcnt(6)
v_mfma_f32_16x16x32_bf16 v[128:131], v[160:163], v[64:67], v[128:131]
ds_read_b64_tr_b16 v[168:169], v25 offset:512
v_add_u32 v24, s38, v22
s_waitcnt lgkmcnt(5)
v_mfma_f32_16x16x32_bf16 v[128:131], v[176:179], v[72:75], v[128:131]
ds_read_b64_tr_b16 v[170:171], v25 offset:2560
v_mfma_f32_16x16x32_bf16 v[144:147], v[176:179], v[76:79], v[144:147]
ds_read_b64_tr_b16 v[184:185], v25 offset:4608
v_mfma_f32_16x16x32_bf16 v[144:147], v[160:163], v[68:71], v[144:147]
ds_read_b64_tr_b16 v[186:187], v25 offset:6656
s_waitcnt lgkmcnt(6)
v_mfma_f32_16x16x32_bf16 v[148:151], v[164:167], v[68:71], v[148:151]
ds_read_b64_tr_b16 v[172:173], v25 offset:768
s_waitcnt lgkmcnt(5)
v_mfma_f32_16x16x32_bf16 v[148:151], v[180:183], v[76:79], v[148:151]
ds_read_b64_tr_b16 v[174:175], v25 offset:2816
v_mfma_f32_16x16x32_bf16 v[132:135], v[180:183], v[72:75], v[132:135]
ds_read_b64_tr_b16 v[188:189], v25 offset:4864
v_mfma_f32_16x16x32_bf16 v[132:135], v[164:167], v[64:67], v[132:135]
ds_read_b64_tr_b16 v[190:191], v25 offset:6912
s_waitcnt lgkmcnt(6)
v_mfma_f32_16x16x32_bf16 v[136:139], v[168:171], v[64:67], v[136:139]
ds_read_b64_tr_b16 v[160:161], v25 offset:8192
s_waitcnt lgkmcnt(5)
v_mfma_f32_16x16x32_bf16 v[136:139], v[184:187], v[72:75], v[136:139]
ds_read_b64_tr_b16 v[162:163], v25 offset:10240
v_mfma_f32_16x16x32_bf16 v[152:155], v[184:187], v[76:79], v[152:155]
ds_read_b64_tr_b16 v[176:177], v25 offset:12288
v_mfma_f32_16x16x32_bf16 v[152:155], v[168:171], v[68:71], v[152:155]
ds_read_b64_tr_b16 v[178:179], v25 offset:14336
s_waitcnt lgkmcnt(6)
v_mfma_f32_16x16x32_bf16 v[156:159], v[172:175], v[68:71], v[156:159]
ds_read_b64_tr_b16 v[164:165], v25 offset:8448
s_waitcnt lgkmcnt(5)
v_mfma_f32_16x16x32_bf16 v[156:159], v[188:191], v[76:79], v[156:159]
ds_read_b64_tr_b16 v[166:167], v25 offset:10496
v_mfma_f32_16x16x32_bf16 v[140:143], v[188:191], v[72:75], v[140:143]
ds_read_b64_tr_b16 v[180:181], v25 offset:12544
v_mfma_f32_16x16x32_bf16 v[140:143], v[172:175], v[64:67], v[140:143]
ds_read_b64_tr_b16 v[182:183], v25 offset:14592
s_waitcnt lgkmcnt(6)
v_mfma_f32_16x16x32_bf16 v[128:131], v[160:163], v[80:83], v[128:131]
ds_read_b64_tr_b16 v[168:169], v25 offset:8704
s_waitcnt lgkmcnt(5)
v_mfma_f32_16x16x32_bf16 v[128:131], v[176:179], v[88:91], v[128:131]
ds_read_b64_tr_b16 v[170:171], v25 offset:10752
v_mfma_f32_16x16x32_bf16 v[144:147], v[176:179], v[92:95], v[144:147]
ds_read_b64_tr_b16 v[184:185], v25 offset:12800
v_mfma_f32_16x16x32_bf16 v[144:147], v[160:163], v[84:87], v[144:147]
ds_read_b64_tr_b16 v[186:187], v25 offset:14848
s_waitcnt lgkmcnt(6)
v_mfma_f32_16x16x32_bf16 v[148:151], v[164:167], v[84:87], v[148:151]
ds_read_b64_tr_b16 v[172:173], v25 offset:8960
s_waitcnt lgkmcnt(5)
v_mfma_f32_16x16x32_bf16 v[148:151], v[180:183], v[92:95], v[148:151]
ds_read_b64_tr_b16 v[174:175], v25 offset:11008
v_mfma_f32_16x16x32_bf16 v[132:135], v[180:183], v[88:91], v[132:135]
ds_read_b64_tr_b16 v[188:189], v25 offset:13056
v_mfma_f32_16x16x32_bf16 v[132:135], v[164:167], v[80:83], v[132:135]
ds_read_b64_tr_b16 v[190:191], v25 offset:15104
s_waitcnt lgkmcnt(6)
v_mfma_f32_16x16x32_bf16 v[136:139], v[168:171], v[80:83], v[136:139]
ds_read_b64_tr_b16 v[160:161], v24 offset:0
s_waitcnt lgkmcnt(5)
v_mfma_f32_16x16x32_bf16 v[136:139], v[184:187], v[88:91], v[136:139]
ds_read_b64_tr_b16 v[162:163], v24 offset:2048
v_mfma_f32_16x16x32_bf16 v[152:155], v[184:187], v[92:95], v[152:155]
ds_read_b64_tr_b16 v[176:177], v24 offset:4096
v_mfma_f32_16x16x32_bf16 v[152:155], v[168:171], v[84:87], v[152:155]
ds_read_b64_tr_b16 v[178:179], v24 offset:6144
s_waitcnt lgkmcnt(6)
v_mfma_f32_16x16x32_bf16 v[156:159], v[172:175], v[84:87], v[156:159]
ds_read_b64_tr_b16 v[164:165], v24 offset:256
s_waitcnt lgkmcnt(5)
v_mfma_f32_16x16x32_bf16 v[156:159], v[188:191], v[92:95], v[156:159]
ds_read_b64_tr_b16 v[166:167], v24 offset:2304
v_mfma_f32_16x16x32_bf16 v[140:143], v[188:191], v[88:91], v[140:143]
ds_read_b64_tr_b16 v[180:181], v24 offset:4352
v_mfma_f32_16x16x32_bf16 v[140:143], v[172:175], v[80:83], v[140:143]
ds_read_b64_tr_b16 v[182:183], v24 offset:6400
s_andn2_b32 s26, s44, s45
s_cbranch_scc1 L_e3_h
s_waitcnt vmcnt(8)
s_mov_b32 s47, 0x40000
L_e3_l:
v_cmp_le_u32 vcc, 4, v15
s_sub_u32 s47, s47, 1
s_cselect_b32 s26, 0xff, 0
s_or_b32 s26, s26, vcc_lo
s_and_b32 s44, s26, 0xff
s_andn2_b32 s26, s44, s45
s_cbranch_scc1 L_e3_h
s_sleep 2
s_mov_b64 exec, 0xff
buffer_load_dword v15, v14, s[48:51], s31 offen sc1
s_mov_b64 exec, -1
s_waitcnt vmcnt(0)
s_branch L_e3_l
L_e3_h:
s_ff1_i32_b32 s46, s26
s_bitset1_b32 s45, s46
s_lshl_b32 s24, s46, 13
s_add_u32 s26, s46, 6
s_and_b32 s26, s26, 7
s_lshl_b32 s39, s26, 14
s_mov_b64 exec, 0xff
buffer_load_dword v15, v14, s[48:51], s31 offen sc1
s_mov_b64 exec, -1
buffer_load_dwordx4 v[32:35], v20, s[8:11], s24 offen offset:0
buffer_load_dwordx4 v[36:39], v20, s[8:11], s24 offen offset:1024
buffer_load_dwordx4 v[40:43], v20, s[8:11], s24 offen offset:2048
buffer_load_dwordx4 v[44:47], v20, s[8:11], s24 offen offset:3072
buffer_load_dwordx4 v[48:51], v21, s[8:11], s24 offen offset:0
buffer_load_dwordx4 v[52:55], v21, s[8:11], s24 offen offset:1024
buffer_load_dwordx4 v[56:59], v21, s[8:11], s24 offen offset:2048
buffer_load_dwordx4 v[60:63], v21, s[8:11], s24 offen offset:3072
s_add_u32 s24, s24, 8192
s_waitcnt vmcnt(9)
s_waitcnt lgkmcnt(6)
v_mfma_f32_16x16x32_bf16 v[128:131], v[160:163], v[96:99], v[128:131]
ds_read_b64_tr_b16 v[168:169], v24 offset:512
v_add_u32 v25, s39, v22
s_waitcnt lgkmcnt(5)
v_mfma_f32_16x16x32_bf16 v[128:131], v[176:179], v[104:107], v[128:131]
ds_read_b64_tr_b16 v[170:171], v24 offset:2560
v_mfma_f32_16x16x32_bf16 v[144:147], v[176:179], v[108:111], v[144:147]
ds_read_b64_tr_b16 v[184:185], v24 offset:4608
v_mfma_f32_16x16x32_bf16 v[144:147], v[160:163], v[100:103], v[144:147]
ds_read_b64_tr_b16 v[186:187], v24 offset:6656
s_waitcnt lgkmcnt(6)
v_mfma_f32_16x16x32_bf16 v[148:151], v[164:167], v[100:103], v[148:151]
ds_read_b64_tr_b16 v[172:173], v24 offset:768
s_waitcnt lgkmcnt(5)
v_mfma_f32_16x16x32_bf16 v[148:151], v[180:183], v[108:111], v[148:151]
ds_read_b64_tr_b16 v[174:175], v24 offset:2816
v_mfma_f32_16x16x32_bf16 v[132:135], v[180:183], v[104:107], v[132:135]
ds_read_b64_tr_b16 v[188:189], v24 offset:4864
v_mfma_f32_16x16x32_bf16 v[132:135], v[164:167], v[96:99], v[132:135]
ds_read_b64_tr_b16 v[190:191], v24 offset:6912
s_waitcnt lgkmcnt(6)
v_mfma_f32_16x16x32_bf16 v[136:139], v[168:171], v[96:99], v[136:139]
ds_read_b64_tr_b16 v[160:161], v24 offset:8192
s_waitcnt lgkmcnt(5)
v_mfma_f32_16x16x32_bf16 v[136:139], v[184:187], v[104:107], v[136:139]
ds_read_b64_tr_b16 v[162:163], v24 offset:10240
v_mfma_f32_16x16x32_bf16 v[152:155], v[184:187], v[108:111], v[152:155]
ds_read_b64_tr_b16 v[176:177], v24 offset:12288
v_mfma_f32_16x16x32_bf16 v[152:155], v[168:171], v[100:103], v[152:155]
ds_read_b64_tr_b16 v[178:179], v24 offset:14336
s_waitcnt lgkmcnt(6)
v_mfma_f32_16x16x32_bf16 v[156:159], v[172:175], v[100:103], v[156:159]
ds_read_b64_tr_b16 v[164:165], v24 offset:8448
s_waitcnt lgkmcnt(5)
v_mfma_f32_16x16x32_bf16 v[156:159], v[188:191], v[108:111], v[156:159]
ds_read_b64_tr_b16 v[166:167], v24 offset:10496
v_mfma_f32_16x16x32_bf16 v[140:143], v[188:191], v[104:107], v[140:143]
ds_read_b64_tr_b16 v[180:181], v24 offset:12544
v_mfma_f32_16x16x32_bf16 v[140:143], v[172:175], v[96:99], v[140:143]
ds_read_b64_tr_b16 v[182:183], v24 offset:14592
s_waitcnt lgkmcnt(6)
v_mfma_f32_16x16x32_bf16 v[128:131], v[160:163], v[112:115], v[128:131]
ds_read_b64_tr_b16 v[168:169], v24 offset:8704
s_waitcnt lgkmcnt(5)
v_mfma_f32_16x16x32_bf16 v[128:131], v[176:179], v[120:123], v[128:131]
ds_read_b64_tr_b16 v[170:171], v24 offset:10752
v_mfma_f32_16x16x32_bf16 v[144:147], v[176:179], v[124:127], v[144:147]
ds_read_b64_tr_b16 v[184:185], v24 offset:12800
v_mfma_f32_16x16x32_bf16 v[144:147], v[160:163], v[116:119], v[144:147]
ds_read_b64_tr_b16 v[186:187], v24 offset:14848
s_waitcnt lgkmcnt(6)
v_mfma_f32_16x16x32_bf16 v[148:151], v[164:167], v[116:119], v[148:151]
ds_read_b64_tr_b16 v[172:173], v24 offset:8960
s_waitcnt lgkmcnt(5)
v_mfma_f32_16x16x32_bf16 v[148:151], v[180:183], v[124:127], v[148:151]
ds_read_b64_tr_b16 v[174:175], v24 offset:11008
v_mfma_f32_16x16x32_bf16 v[132:135], v[180:183], v[120:123], v[132:135]
ds_read_b64_tr_b16 v[188:189], v24 offset:13056
v_mfma_f32_16x16x32_bf16 v[132:135], v[164:167], v[112:115], v[132:135]
ds_read_b64_tr_b16 v[190:191], v24 offset:15104
s_waitcnt lgkmcnt(6)
v_mfma_f32_16x16x32_bf16 v[136:139], v[168:171], v[112:115], v[136:139]
ds_read_b64_tr_b16 v[160:161], v25 offset:0
s_waitcnt lgkmcnt(5)
v_mfma_f32_16x16x32_bf16 v[136:139], v[184:187], v[120:123], v[136:139]
ds_read_b64_tr_b16 v[162:163], v25 offset:2048
v_mfma_f32_16x16x32_bf16 v[152:155], v[184:187], v[124:127], v[152:155]
ds_read_b64_tr_b16 v[176:177], v25 offset:4096
v_mfma_f32_16x16x32_bf16 v[152:155], v[168:171], v[116:119], v[152:155]
ds_read_b64_tr_b16 v[178:179], v25 offset:6144
s_waitcnt lgkmcnt(6)
v_mfma_f32_16x16x32_bf16 v[156:159], v[172:175], v[116:119], v[156:159]
ds_read_b64_tr_b16 v[164:165], v25 offset:256
s_waitcnt lgkmcnt(5)
v_mfma_f32_16x16x32_bf16 v[156:159], v[188:191], v[124:127], v[156:159]
ds_read_b64_tr_b16 v[166:167], v25 offset:2304
v_mfma_f32_16x16x32_bf16 v[140:143], v[188:191], v[120:123], v[140:143]
ds_read_b64_tr_b16 v[180:181], v25 offset:4352
v_mfma_f32_16x16x32_bf16 v[140:143], v[172:175], v[112:115], v[140:143]
ds_read_b64_tr_b16 v[182:183], v25 offset:6400
s_andn2_b32 s26, s44, s45
s_cbranch_scc1 L_e4_h
s_waitcnt vmcnt(8)
s_mov_b32 s47, 0x40000
L_e4_l:
v_cmp_le_u32 vcc, 4, v15
s_sub_u32 s47, s47, 1
s_cselect_b32 s26, 0xff, 0
s_or_b32 s26, s26, vcc_lo
s_and_b32 s44, s26, 0xff
s_andn2_b32 s26, s44, s45
s_cbranch_scc1 L_e4_h
s_sleep 2
s_mov_b64 exec, 0xff
buffer_load_dword v15, v14, s[48:51], s31 offen sc1
s_mov_b64 exec, -1
s_waitcnt vmcnt(0)
s_branch L_e4_l
L_e4_h:
s_ff1_i32_b32 s46, s26
s_bitset1_b32 s45, s46
s_lshl_b32 s24, s46, 13
s_add_u32 s26, s46, 6
s_and_b32 s26, s26, 7
s_lshl_b32 s36, s26, 14
s_mov_b64 exec, 0xff
buffer_load_dword v15, v14, s[48:51], s31 offen sc1
s_mov_b64 exec, -1
buffer_load_dwordx4 v[64:67], v20, s[8:11], s24 offen offset:0
buffer_load_dwordx4 v[68:71], v20, s[8:11], s24 offen offset:1024
buffer_load_dwordx4 v[72:75], v20, s[8:11], s24 offen offset:2048
buffer_load_dwordx4 v[76:79], v20, s[8:11], s24 offen offset:3072
buffer_load_dwordx4 v[80:83], v21, s[8:11], s24 offen offset:0
buffer_load_dwordx4 v[84:87], v21, s[8:11], s24 offen offset:1024
buffer_load_dwordx4 v[88:91], v21, s[8:11], s24 offen offset:2048
buffer_load_dwordx4 v[92:95], v21, s[8:11], s24 offen offset:3072
s_add_u32 s24, s24, 8192
s_waitcnt vmcnt(9)
s_waitcnt lgkmcnt(6)
v_mfma_f32_16x16x32_bf16 v[128:131], v[160:163], v[32:35], v[128:131]
ds_read_b64_tr_b16 v[168:169], v25 offset:512
v_add_u32 v24, s36, v22
s_waitcnt lgkmcnt(5)
v_mfma_f32_16x16x32_bf16 v[128:131], v[176:179], v[40:43], v[128:131]
ds_read_b64_tr_b16 v[170:171], v25 offset:2560
v_mfma_f32_16x16x32_bf16 v[144:147], v[176:179], v[44:47], v[144:147]
ds_read_b64_tr_b16 v[184:185], v25 offset:4608
v_mfma_f32_16x16x32_bf16 v[144:147], v[160:163], v[36:39], v[144:147]
ds_read_b64_tr_b16 v[186:187], v25 offset:6656
s_waitcnt lgkmcnt(6)
v_mfma_f32_16x16x32_bf16 v[148:151], v[164:167], v[36:39], v[148:151]
ds_read_b64_tr_b16 v[172:173], v25 offset:768
s_waitcnt lgkmcnt(5)
v_mfma_f32_16x16x32_bf16 v[148:151], v[180:183], v[44:47], v[148:151]
ds_read_b64_tr_b16 v[174:175], v25 offset:2816
v_mfma_f32_16x16x32_bf16 v[132:135], v[180:183], v[40:43], v[132:135]
ds_read_b64_tr_b16 v[188:189], v25 offset:4864
v_mfma_f32_16x16x32_bf16 v[132:135], v[164:167], v[32:35], v[132:135]
ds_read_b64_tr_b16 v[190:191], v25 offset:6912
s_waitcnt lgkmcnt(6)
v_mfma_f32_16x16x32_bf16 v[136:139], v[168:171], v[32:35], v[136:139]
ds_read_b64_tr_b16 v[160:161], v25 offset:8192
s_waitcnt lgkmcnt(5)
v_mfma_f32_16x16x32_bf16 v[136:139], v[184:187], v[40:43], v[136:139]
ds_read_b64_tr_b16 v[162:163], v25 offset:10240
v_mfma_f32_16x16x32_bf16 v[152:155], v[184:187], v[44:47], v[152:155]
ds_read_b64_tr_b16 v[176:177], v25 offset:12288
v_mfma_f32_16x16x32_bf16 v[152:155], v[168:171], v[36:39], v[152:155]
ds_read_b64_tr_b16 v[178:179], v25 offset:14336
s_waitcnt lgkmcnt(6)
v_mfma_f32_16x16x32_bf16 v[156:159], v[172:175], v[36:39], v[156:159]
ds_read_b64_tr_b16 v[164:165], v25 offset:8448
s_waitcnt lgkmcnt(5)
v_mfma_f32_16x16x32_bf16 v[156:159], v[188:191], v[44:47], v[156:159]
ds_read_b64_tr_b16 v[166:167], v25 offset:10496
v_mfma_f32_16x16x32_bf16 v[140:143], v[188:191], v[40:43], v[140:143]
ds_read_b64_tr_b16 v[180:181], v25 offset:12544
v_mfma_f32_16x16x32_bf16 v[140:143], v[172:175], v[32:35], v[140:143]
ds_read_b64_tr_b16 v[182:183], v25 offset:14592
s_waitcnt lgkmcnt(6)
v_mfma_f32_16x16x32_bf16 v[128:131], v[160:163], v[48:51], v[128:131]
ds_read_b64_tr_b16 v[168:169], v25 offset:8704
s_waitcnt lgkmcnt(5)
v_mfma_f32_16x16x32_bf16 v[128:131], v[176:179], v[56:59], v[128:131]
ds_read_b64_tr_b16 v[170:171], v25 offset:10752
v_mfma_f32_16x16x32_bf16 v[144:147], v[176:179], v[60:63], v[144:147]
ds_read_b64_tr_b16 v[184:185], v25 offset:12800
v_mfma_f32_16x16x32_bf16 v[144:147], v[160:163], v[52:55], v[144:147]
ds_read_b64_tr_b16 v[186:187], v25 offset:14848
s_waitcnt lgkmcnt(6)
v_mfma_f32_16x16x32_bf16 v[148:151], v[164:167], v[52:55], v[148:151]
ds_read_b64_tr_b16 v[172:173], v25 offset:8960
s_waitcnt lgkmcnt(5)
v_mfma_f32_16x16x32_bf16 v[148:151], v[180:183], v[60:63], v[148:151]
ds_read_b64_tr_b16 v[174:175], v25 offset:11008
v_mfma_f32_16x16x32_bf16 v[132:135], v[180:183], v[56:59], v[132:135]
ds_read_b64_tr_b16 v[188:189], v25 offset:13056
v_mfma_f32_16x16x32_bf16 v[132:135], v[164:167], v[48:51], v[132:135]
ds_read_b64_tr_b16 v[190:191], v25 offset:15104
s_waitcnt lgkmcnt(6)
v_mfma_f32_16x16x32_bf16 v[136:139], v[168:171], v[48:51], v[136:139]
ds_read_b64_tr_b16 v[160:161], v24 offset:0
s_waitcnt lgkmcnt(5)
v_mfma_f32_16x16x32_bf16 v[136:139], v[184:187], v[56:59], v[136:139]
ds_read_b64_tr_b16 v[162:163], v24 offset:2048
v_mfma_f32_16x16x32_bf16 v[152:155], v[184:187], v[60:63], v[152:155]
ds_read_b64_tr_b16 v[176:177], v24 offset:4096
v_mfma_f32_16x16x32_bf16 v[152:155], v[168:171], v[52:55], v[152:155]
ds_read_b64_tr_b16 v[178:179], v24 offset:6144
s_waitcnt lgkmcnt(6)
v_mfma_f32_16x16x32_bf16 v[156:159], v[172:175], v[52:55], v[156:159]
ds_read_b64_tr_b16 v[164:165], v24 offset:256
s_waitcnt lgkmcnt(5)
v_mfma_f32_16x16x32_bf16 v[156:159], v[188:191], v[60:63], v[156:159]
ds_read_b64_tr_b16 v[166:167], v24 offset:2304
v_mfma_f32_16x16x32_bf16 v[140:143], v[188:191], v[56:59], v[140:143]
ds_read_b64_tr_b16 v[180:181], v24 offset:4352
v_mfma_f32_16x16x32_bf16 v[140:143], v[172:175], v[48:51], v[140:143]
ds_read_b64_tr_b16 v[182:183], v24 offset:6400
s_andn2_b32 s26, s44, s45
s_cbranch_scc1 L_e5_h
s_waitcnt vmcnt(8)
s_mov_b32 s47, 0x40000
L_e5_l:
v_cmp_le_u32 vcc, 4, v15
s_sub_u32 s47, s47, 1
s_cselect_b32 s26, 0xff, 0
s_or_b32 s26, s26, vcc_lo
s_and_b32 s44, s26, 0xff
s_andn2_b32 s26, s44, s45
s_cbranch_scc1 L_e5_h
s_sleep 2
s_mov_b64 exec, 0xff
buffer_load_dword v15, v14, s[48:51], s31 offen sc1
s_mov_b64 exec, -1
s_waitcnt vmcnt(0)
s_branch L_e5_l
L_e5_h:
s_ff1_i32_b32 s46, s26
s_bitset1_b32 s45, s46
s_lshl_b32 s24, s46, 13
s_add_u32 s26, s46, 6
s_and_b32 s26, s26, 7
s_lshl_b32 s37, s26, 14
s_mov_b64 exec, 0xff
buffer_load_dword v15, v14, s[48:51], s31 offen sc1
s_mov_b64 exec, -1
buffer_load_dwordx4 v[96:99], v20, s[8:11], s24 offen offset:0
buffer_load_dwordx4 v[100:103], v20, s[8:11], s24 offen offset:1024
buffer_load_dwordx4 v[104:107], v20, s[8:11], s24 offen offset:2048
buffer_load_dwordx4 v[108:111], v20, s[8:11], s24 offen offset:3072
buffer_load_dwordx4 v[112:115], v21, s[8:11], s24 offen offset:0
buffer_load_dwordx4 v[116:119], v21, s[8:11], s24 offen offset:1024
buffer_load_dwordx4 v[120:123], v21, s[8:11], s24 offen offset:2048
buffer_load_dwordx4 v[124:127], v21, s[8:11], s24 offen offset:3072
s_add_u32 s24, s24, 8192
s_waitcnt vmcnt(9)
s_waitcnt lgkmcnt(6)
v_mfma_f32_16x16x32_bf16 v[128:131], v[160:163], v[64:67], v[128:131]
ds_read_b64_tr_b16 v[168:169], v24 offset:512
v_add_u32 v25, s37, v22
s_waitcnt lgkmcnt(5)
v_mfma_f32_16x16x32_bf16 v[128:131], v[176:179], v[72:75], v[128:131]
ds_read_b64_tr_b16 v[170:171], v24 offset:2560
v_mfma_f32_16x16x32_bf16 v[144:147], v[176:179], v[76:79], v[144:147]
ds_read_b64_tr_b16 v[184:185], v24 offset:4608
v_mfma_f32_16x16x32_bf16 v[144:147], v[160:163], v[68:71], v[144:147]
ds_read_b64_tr_b16 v[186:187], v24 offset:6656
s_waitcnt lgkmcnt(6)
v_mfma_f32_16x16x32_bf16 v[148:151], v[164:167], v[68:71], v[148:151]
ds_read_b64_tr_b16 v[172:173], v24 offset:768
s_waitcnt lgkmcnt(5)
v_mfma_f32_16x16x32_bf16 v[148:151], v[180:183], v[76:79], v[148:151]
ds_read_b64_tr_b16 v[174:175], v24 offset:2816
v_mfma_f32_16x16x32_bf16 v[132:135], v[180:183], v[72:75], v[132:135]
ds_read_b64_tr_b16 v[188:189], v24 offset:4864
v_mfma_f32_16x16x32_bf16 v[132:135], v[164:167], v[64:67], v[132:135]
ds_read_b64_tr_b16 v[190:191], v24 offset:6912
s_waitcnt lgkmcnt(6)
v_mfma_f32_16x16x32_bf16 v[136:139], v[168:171], v[64:67], v[136:139]
ds_read_b64_tr_b16 v[160:161], v24 offset:8192
s_waitcnt lgkmcnt(5)
v_mfma_f32_16x16x32_bf16 v[136:139], v[184:187], v[72:75], v[136:139]
ds_read_b64_tr_b16 v[162:163], v24 offset:10240
v_mfma_f32_16x16x32_bf16 v[152:155], v[184:187], v[76:79], v[152:155]
ds_read_b64_tr_b16 v[176:177], v24 offset:12288
v_mfma_f32_16x16x32_bf16 v[152:155], v[168:171], v[68:71], v[152:155]
ds_read_b64_tr_b16 v[178:179], v24 offset:14336
s_waitcnt lgkmcnt(6)
v_mfma_f32_16x16x32_bf16 v[156:159], v[172:175], v[68:71], v[156:159]
ds_read_b64_tr_b16 v[164:165], v24 offset:8448
s_waitcnt lgkmcnt(5)
v_mfma_f32_16x16x32_bf16 v[156:159], v[188:191], v[76:79], v[156:159]
ds_read_b64_tr_b16 v[166:167], v24 offset:10496
v_mfma_f32_16x16x32_bf16 v[140:143], v[188:191], v[72:75], v[140:143]
ds_read_b64_tr_b16 v[180:181], v24 offset:12544
v_mfma_f32_16x16x32_bf16 v[140:143], v[172:175], v[64:67], v[140:143]
ds_read_b64_tr_b16 v[182:183], v24 offset:14592
s_waitcnt lgkmcnt(6)
v_mfma_f32_16x16x32_bf16 v[128:131], v[160:163], v[80:83], v[128:131]
ds_read_b64_tr_b16 v[168:169], v24 offset:8704
s_waitcnt lgkmcnt(5)
v_mfma_f32_16x16x32_bf16 v[128:131], v[176:179], v[88:91], v[128:131]
ds_read_b64_tr_b16 v[170:171], v24 offset:10752
v_mfma_f32_16x16x32_bf16 v[144:147], v[176:179], v[92:95], v[144:147]
ds_read_b64_tr_b16 v[184:185], v24 offset:12800
v_mfma_f32_16x16x32_bf16 v[144:147], v[160:163], v[84:87], v[144:147]
ds_read_b64_tr_b16 v[186:187], v24 offset:14848
s_waitcnt lgkmcnt(6)
v_mfma_f32_16x16x32_bf16 v[148:151], v[164:167], v[84:87], v[148:151]
ds_read_b64_tr_b16 v[172:173], v24 offset:8960
s_waitcnt lgkmcnt(5)
v_mfma_f32_16x16x32_bf16 v[148:151], v[180:183], v[92:95], v[148:151]
ds_read_b64_tr_b16 v[174:175], v24 offset:11008
v_mfma_f32_16x16x32_bf16 v[132:135], v[180:183], v[88:91], v[132:135]
ds_read_b64_tr_b16 v[188:189], v24 offset:13056
v_mfma_f32_16x16x32_bf16 v[132:135], v[164:167], v[80:83], v[132:135]
ds_read_b64_tr_b16 v[190:191], v24 offset:15104
s_waitcnt lgkmcnt(6)
v_mfma_f32_16x16x32_bf16 v[136:139], v[168:171], v[80:83], v[136:139]
ds_read_b64_tr_b16 v[160:161], v25 offset:0
s_waitcnt lgkmcnt(5)
v_mfma_f32_16x16x32_bf16 v[136:139], v[184:187], v[88:91], v[136:139]
ds_read_b64_tr_b16 v[162:163], v25 offset:2048
v_mfma_f32_16x16x32_bf16 v[152:155], v[184:187], v[92:95], v[152:155]
ds_read_b64_tr_b16 v[176:177], v25 offset:4096
v_mfma_f32_16x16x32_bf16 v[152:155], v[168:171], v[84:87], v[152:155]
ds_read_b64_tr_b16 v[178:179], v25 offset:6144
s_waitcnt lgkmcnt(6)
v_mfma_f32_16x16x32_bf16 v[156:159], v[172:175], v[84:87], v[156:159]
ds_read_b64_tr_b16 v[164:165], v25 offset:256
s_waitcnt lgkmcnt(5)
v_mfma_f32_16x16x32_bf16 v[156:159], v[188:191], v[92:95], v[156:159]
ds_read_b64_tr_b16 v[166:167], v25 offset:2304
v_mfma_f32_16x16x32_bf16 v[140:143], v[188:191], v[88:91], v[140:143]
ds_read_b64_tr_b16 v[180:181], v25 offset:4352
v_mfma_f32_16x16x32_bf16 v[140:143], v[172:175], v[80:83], v[140:143]
ds_read_b64_tr_b16 v[182:183], v25 offset:6400
s_andn2_b32 s26, s44, s45
s_cbranch_scc1 L_e6_h
s_waitcnt vmcnt(8)
s_mov_b32 s47, 0x40000
L_e6_l:
v_cmp_le_u32 vcc, 4, v15
s_sub_u32 s47, s47, 1
s_cselect_b32 s26, 0xff, 0
s_or_b32 s26, s26, vcc_lo
s_and_b32 s44, s26, 0xff
s_andn2_b32 s26, s44, s45
s_cbranch_scc1 L_e6_h
s_sleep 2
s_mov_b64 exec, 0xff
buffer_load_dword v15, v14, s[48:51], s31 offen sc1
s_mov_b64 exec, -1
s_waitcnt vmcnt(0)
s_branch L_e6_l
L_e6_h:
s_ff1_i32_b32 s46, s26
s_bitset1_b32 s45, s46
s_lshl_b32 s24, s46, 13
s_add_u32 s26, s46, 6
s_and_b32 s26, s26, 7
s_lshl_b32 s38, s26, 14
s_mov_b64 exec, 0xff
buffer_load_dword v15, v14, s[48:51], s31 offen sc1
s_mov_b64 exec, -1
buffer_load_dwordx4 v[32:35], v20, s[8:11], s24 offen offset:0
buffer_load_dwordx4 v[36:39], v20, s[8:11], s24 offen offset:1024
buffer_load_dwordx4 v[40:43], v20, s[8:11], s24 offen offset:2048
buffer_load_dwordx4 v[44:47], v20, s[8:11], s24 offen offset:3072
buffer_load_dwordx4 v[48:51], v21, s[8:11], s24 offen offset:0
buffer_load_dwordx4 v[52:55], v21, s[8:11], s24 offen offset:1024
buffer_load_dwordx4 v[56:59], v21, s[8:11], s24 offen offset:2048
buffer_load_dwordx4 v[60:63], v21, s[8:11], s24 offen offset:3072
s_add_u32 s24, s24, 8192
s_waitcnt vmcnt(9)
s_waitcnt lgkmcnt(6)
v_mfma_f32_16x16x32_bf16 v[128:131], v[160:163], v[96:99], v[128:131]
ds_read_b64_tr_b16 v[168:169], v25 offset:512
v_add_u32 v24, s38, v22
s_waitcnt lgkmcnt(5)
v_mfma_f32_16x16x32_bf16 v[128:131], v[176:179], v[104:107], v[128:131]
ds_read_b64_tr_b16 v[170:171], v25 offset:2560
v_mfma_f32_16x16x32_bf16 v[144:147], v[176:179], v[108:111], v[144:147]
ds_read_b64_tr_b16 v[184:185], v25 offset:4608
v_mfma_f32_16x16x32_bf16 v[144:147], v[160:163], v[100:103], v[144:147]
ds_read_b64_tr_b16 v[186:187], v25 offset:6656
s_waitcnt lgkmcnt(6)
v_mfma_f32_16x16x32_bf16 v[148:151], v[164:167], v[100:103], v[148:151]
ds_read_b64_tr_b16 v[172:173], v25 offset:768
s_waitcnt lgkmcnt(5)
v_mfma_f32_16x16x32_bf16 v[148:151], v[180:183], v[108:111], v[148:151]
ds_read_b64_tr_b16 v[174:175], v25 offset:2816
v_mfma_f32_16x16x32_bf16 v[132:135], v[180:183], v[104:107], v[132:135]
ds_read_b64_tr_b16 v[188:189], v25 offset:4864
v_mfma_f32_16x16x32_bf16 v[132:135], v[164:167], v[96:99], v[132:135]
ds_read_b64_tr_b16 v[190:191], v25 offset:6912
s_waitcnt lgkmcnt(6)
v_mfma_f32_16x16x32_bf16 v[136:139], v[168:171], v[96:99], v[136:139]
ds_read_b64_tr_b16 v[160:161], v25 offset:8192
s_waitcnt lgkmcnt(5)
v_mfma_f32_16x16x32_bf16 v[136:139], v[184:187], v[104:107], v[136:139]
ds_read_b64_tr_b16 v[162:163], v25 offset:10240
v_mfma_f32_16x16x32_bf16 v[152:155], v[184:187], v[108:111], v[152:155]
ds_read_b64_tr_b16 v[176:177], v25 offset:12288
v_mfma_f32_16x16x32_bf16 v[152:155], v[168:171], v[100:103], v[152:155]
ds_read_b64_tr_b16 v[178:179], v25 offset:14336
s_waitcnt lgkmcnt(6)
v_mfma_f32_16x16x32_bf16 v[156:159], v[172:175], v[100:103], v[156:159]
ds_read_b64_tr_b16 v[164:165], v25 offset:8448
s_waitcnt lgkmcnt(5)
v_mfma_f32_16x16x32_bf16 v[156:159], v[188:191], v[108:111], v[156:159]
ds_read_b64_tr_b16 v[166:167], v25 offset:10496
v_mfma_f32_16x16x32_bf16 v[140:143], v[188:191], v[104:107], v[140:143]
ds_read_b64_tr_b16 v[180:181], v25 offset:12544
v_mfma_f32_16x16x32_bf16 v[140:143], v[172:175], v[96:99], v[140:143]
ds_read_b64_tr_b16 v[182:183], v25 offset:14592
s_waitcnt lgkmcnt(6)
v_mfma_f32_16x16x32_bf16 v[128:131], v[160:163], v[112:115], v[128:131]
ds_read_b64_tr_b16 v[168:169], v25 offset:8704
s_waitcnt lgkmcnt(5)
v_mfma_f32_16x16x32_bf16 v[128:131], v[176:179], v[120:123], v[128:131]
ds_read_b64_tr_b16 v[170:171], v25 offset:10752
v_mfma_f32_16x16x32_bf16 v[144:147], v[176:179], v[124:127], v[144:147]
ds_read_b64_tr_b16 v[184:185], v25 offset:12800
v_mfma_f32_16x16x32_bf16 v[144:147], v[160:163], v[116:119], v[144:147]
ds_read_b64_tr_b16 v[186:187], v25 offset:14848
s_waitcnt lgkmcnt(6)
v_mfma_f32_16x16x32_bf16 v[148:151], v[164:167], v[116:119], v[148:151]
ds_read_b64_tr_b16 v[172:173], v25 offset:8960
s_waitcnt lgkmcnt(5)
v_mfma_f32_16x16x32_bf16 v[148:151], v[180:183], v[124:127], v[148:151]
ds_read_b64_tr_b16 v[174:175], v25 offset:11008
v_mfma_f32_16x16x32_bf16 v[132:135], v[180:183], v[120:123], v[132:135]
ds_read_b64_tr_b16 v[188:189], v25 offset:13056
v_mfma_f32_16x16x32_bf16 v[132:135], v[164:167], v[112:115], v[132:135]
ds_read_b64_tr_b16 v[190:191], v25 offset:15104
s_waitcnt lgkmcnt(6)
v_mfma_f32_16x16x32_bf16 v[136:139], v[168:171], v[112:115], v[136:139]
ds_read_b64_tr_b16 v[160:161], v24 offset:0
s_waitcnt lgkmcnt(5)
v_mfma_f32_16x16x32_bf16 v[136:139], v[184:187], v[120:123], v[136:139]
ds_read_b64_tr_b16 v[162:163], v24 offset:2048
v_mfma_f32_16x16x32_bf16 v[152:155], v[184:187], v[124:127], v[152:155]
ds_read_b64_tr_b16 v[176:177], v24 offset:4096
v_mfma_f32_16x16x32_bf16 v[152:155], v[168:171], v[116:119], v[152:155]
ds_read_b64_tr_b16 v[178:179], v24 offset:6144
s_waitcnt lgkmcnt(6)
v_mfma_f32_16x16x32_bf16 v[156:159], v[172:175], v[116:119], v[156:159]
ds_read_b64_tr_b16 v[164:165], v24 offset:256
s_waitcnt lgkmcnt(5)
v_mfma_f32_16x16x32_bf16 v[156:159], v[188:191], v[124:127], v[156:159]
ds_read_b64_tr_b16 v[166:167], v24 offset:2304
v_mfma_f32_16x16x32_bf16 v[140:143], v[188:191], v[120:123], v[140:143]
ds_read_b64_tr_b16 v[180:181], v24 offset:4352
v_mfma_f32_16x16x32_bf16 v[140:143], v[172:175], v[112:115], v[140:143]
ds_read_b64_tr_b16 v[182:183], v24 offset:6400
s_andn2_b32 s26, s44, s45
s_cbranch_scc1 L_e7_h
s_waitcnt vmcnt(8)
s_mov_b32 s47, 0x40000
L_e7_l:
v_cmp_le_u32 vcc, 4, v15
s_sub_u32 s47, s47, 1
s_cselect_b32 s26, 0xff, 0
s_or_b32 s26, s26, vcc_lo
s_and_b32 s44, s26, 0xff
s_andn2_b32 s26, s44, s45
s_cbranch_scc1 L_e7_h
s_sleep 2
s_mov_b64 exec, 0xff
buffer_load_dword v15, v14, s[48:51], s31 offen sc1
s_mov_b64 exec, -1
s_waitcnt vmcnt(0)
s_branch L_e7_l
L_e7_h:
s_ff1_i32_b32 s46, s26
s_bitset1_b32 s45, s46
s_lshl_b32 s24, s46, 13
s_add_u32 s26, s46, 6
s_and_b32 s26, s26, 7
s_lshl_b32 s39, s26, 14
buffer_load_dwordx4 v[64:67], v20, s[8:11], s24 offen offset:0
buffer_load_dwordx4 v[68:71], v20, s[8:11], s24 offen offset:1024
buffer_load_dwordx4 v[72:75], v20, s[8:11], s24 offen offset:2048
buffer_load_dwordx4 v[76:79], v20, s[8:11], s24 offen offset:3072
buffer_load_dwordx4 v[80:83], v21, s[8:11], s24 offen offset:0
buffer_load_dwordx4 v[84:87], v21, s[8:11], s24 offen offset:1024
buffer_load_dwordx4 v[88:91], v21, s[8:11], s24 offen offset:2048
buffer_load_dwordx4 v[92:95], v21, s[8:11], s24 offen offset:3072
s_add_u32 s24, s24, 8192
s_waitcnt vmcnt(8)
s_waitcnt lgkmcnt(6)
v_mfma_f32_16x16x32_bf16 v[128:131], v[160:163], v[32:35], v[128:131]
ds_read_b64_tr_b16 v[168:169], v24 offset:512
v_add_u32 v25, s39, v22
s_waitcnt lgkmcnt(5)
v_mfma_f32_16x16x32_bf16 v[128:131], v[176:179], v[40:43], v[128:131]
ds_read_b64_tr_b16 v[170:171], v24 offset:2560
v_mfma_f32_16x16x32_bf16 v[144:147], v[176:179], v[44:47], v[144:147]
ds_read_b64_tr_b16 v[184:185], v24 offset:4608
v_mfma_f32_16x16x32_bf16 v[144:147], v[160:163], v[36:39], v[144:147]
ds_read_b64_tr_b16 v[186:187], v24 offset:6656
s_waitcnt lgkmcnt(6)
v_mfma_f32_16x16x32_bf16 v[148:151], v[164:167], v[36:39], v[148:151]
ds_read_b64_tr_b16 v[172:173], v24 offset:768
s_waitcnt lgkmcnt(5)
v_mfma_f32_16x16x32_bf16 v[148:151], v[180:183], v[44:47], v[148:151]
ds_read_b64_tr_b16 v[174:175], v24 offset:2816
v_mfma_f32_16x16x32_bf16 v[132:135], v[180:183], v[40:43], v[132:135]
ds_read_b64_tr_b16 v[188:189], v24 offset:4864
v_mfma_f32_16x16x32_bf16 v[132:135], v[164:167], v[32:35], v[132:135]
ds_read_b64_tr_b16 v[190:191], v24 offset:6912
s_waitcnt lgkmcnt(6)
v_mfma_f32_16x16x32_bf16 v[136:139], v[168:171], v[32:35], v[136:139]
ds_read_b64_tr_b16 v[160:161], v24 offset:8192
s_waitcnt lgkmcnt(5)
v_mfma_f32_16x16x32_bf16 v[136:139], v[184:187], v[40:43], v[136:139]
ds_read_b64_tr_b16 v[162:163], v24 offset:10240
v_mfma_f32_16x16x32_bf16 v[152:155], v[184:187], v[44:47], v[152:155]
ds_read_b64_tr_b16 v[176:177], v24 offset:12288
v_mfma_f32_16x16x32_bf16 v[152:155], v[168:171], v[36:39], v[152:155]
ds_read_b64_tr_b16 v[178:179], v24 offset:14336
s_waitcnt lgkmcnt(6)
v_mfma_f32_16x16x32_bf16 v[156:159], v[172:175], v[36:39], v[156:159]
ds_read_b64_tr_b16 v[164:165], v24 offset:8448
s_waitcnt lgkmcnt(5)
v_mfma_f32_16x16x32_bf16 v[156:159], v[188:191], v[44:47], v[156:159]
ds_read_b64_tr_b16 v[166:167], v24 offset:10496
v_mfma_f32_16x16x32_bf16 v[140:143], v[188:191], v[40:43], v[140:143]
ds_read_b64_tr_b16 v[180:181], v24 offset:12544
v_mfma_f32_16x16x32_bf16 v[140:143], v[172:175], v[32:35], v[140:143]
ds_read_b64_tr_b16 v[182:183], v24 offset:14592
s_waitcnt lgkmcnt(6)
v_mfma_f32_16x16x32_bf16 v[128:131], v[160:163], v[48:51], v[128:131]
ds_read_b64_tr_b16 v[168:169], v24 offset:8704
s_waitcnt lgkmcnt(5)
v_mfma_f32_16x16x32_bf16 v[128:131], v[176:179], v[56:59], v[128:131]
ds_read_b64_tr_b16 v[170:171], v24 offset:10752
v_mfma_f32_16x16x32_bf16 v[144:147], v[176:179], v[60:63], v[144:147]
ds_read_b64_tr_b16 v[184:185], v24 offset:12800
v_mfma_f32_16x16x32_bf16 v[144:147], v[160:163], v[52:55], v[144:147]
ds_read_b64_tr_b16 v[186:187], v24 offset:14848
s_waitcnt lgkmcnt(6)
v_mfma_f32_16x16x32_bf16 v[148:151], v[164:167], v[52:55], v[148:151]
ds_read_b64_tr_b16 v[172:173], v24 offset:8960
s_waitcnt lgkmcnt(5)
v_mfma_f32_16x16x32_bf16 v[148:151], v[180:183], v[60:63], v[148:151]
ds_read_b64_tr_b16 v[174:175], v24 offset:11008
v_mfma_f32_16x16x32_bf16 v[132:135], v[180:183], v[56:59], v[132:135]
ds_read_b64_tr_b16 v[188:189], v24 offset:13056
v_mfma_f32_16x16x32_bf16 v[132:135], v[164:167], v[48:51], v[132:135]
ds_read_b64_tr_b16 v[190:191], v24 offset:15104
s_waitcnt lgkmcnt(6)
v_mfma_f32_16x16x32_bf16 v[136:139], v[168:171], v[48:51], v[136:139]
ds_read_b64_tr_b16 v[160:161], v25 offset:0
s_waitcnt lgkmcnt(5)
v_mfma_f32_16x16x32_bf16 v[136:139], v[184:187], v[56:59], v[136:139]
ds_read_b64_tr_b16 v[162:163], v25 offset:2048
v_mfma_f32_16x16x32_bf16 v[152:155], v[184:187], v[60:63], v[152:155]
ds_read_b64_tr_b16 v[176:177], v25 offset:4096
v_mfma_f32_16x16x32_bf16 v[152:155], v[168:171], v[52:55], v[152:155]
ds_read_b64_tr_b16 v[178:179], v25 offset:6144
s_waitcnt lgkmcnt(6)
v_mfma_f32_16x16x32_bf16 v[156:159], v[172:175], v[52:55], v[156:159]
ds_read_b64_tr_b16 v[164:165], v25 offset:256
s_waitcnt lgkmcnt(5)
v_mfma_f32_16x16x32_bf16 v[156:159], v[188:191], v[60:63], v[156:159]
ds_read_b64_tr_b16 v[166:167], v25 offset:2304
v_mfma_f32_16x16x32_bf16 v[140:143], v[188:191], v[56:59], v[140:143]
ds_read_b64_tr_b16 v[180:181], v25 offset:4352
v_mfma_f32_16x16x32_bf16 v[140:143], v[172:175], v[48:51], v[140:143]
ds_read_b64_tr_b16 v[182:183], v25 offset:6400
s_waitcnt vmcnt(0)
s_waitcnt lgkmcnt(6)
v_mfma_f32_16x16x32_bf16 v[128:131], v[160:163], v[64:67], v[128:131]
ds_read_b64_tr_b16 v[168:169], v25 offset:512
s_waitcnt lgkmcnt(5)
v_mfma_f32_16x16x32_bf16 v[128:131], v[176:179], v[72:75], v[128:131]
ds_read_b64_tr_b16 v[170:171], v25 offset:2560
v_mfma_f32_16x16x32_bf16 v[144:147], v[176:179], v[76:79], v[144:147]
ds_read_b64_tr_b16 v[184:185], v25 offset:4608
v_mfma_f32_16x16x32_bf16 v[144:147], v[160:163], v[68:71], v[144:147]
ds_read_b64_tr_b16 v[186:187], v25 offset:6656
s_waitcnt lgkmcnt(6)
v_mfma_f32_16x16x32_bf16 v[148:151], v[164:167], v[68:71], v[148:151]
ds_read_b64_tr_b16 v[172:173], v25 offset:768
s_waitcnt lgkmcnt(5)
v_mfma_f32_16x16x32_bf16 v[148:151], v[180:183], v[76:79], v[148:151]
ds_read_b64_tr_b16 v[174:175], v25 offset:2816
v_mfma_f32_16x16x32_bf16 v[132:135], v[180:183], v[72:75], v[132:135]
ds_read_b64_tr_b16 v[188:189], v25 offset:4864
v_mfma_f32_16x16x32_bf16 v[132:135], v[164:167], v[64:67], v[132:135]
ds_read_b64_tr_b16 v[190:191], v25 offset:6912
s_waitcnt lgkmcnt(6)
v_mfma_f32_16x16x32_bf16 v[136:139], v[168:171], v[64:67], v[136:139]
ds_read_b64_tr_b16 v[160:161], v25 offset:8192
s_waitcnt lgkmcnt(5)
v_mfma_f32_16x16x32_bf16 v[136:139], v[184:187], v[72:75], v[136:139]
ds_read_b64_tr_b16 v[162:163], v25 offset:10240
v_mfma_f32_16x16x32_bf16 v[152:155], v[184:187], v[76:79], v[152:155]
ds_read_b64_tr_b16 v[176:177], v25 offset:12288
v_mfma_f32_16x16x32_bf16 v[152:155], v[168:171], v[68:71], v[152:155]
ds_read_b64_tr_b16 v[178:179], v25 offset:14336
s_waitcnt lgkmcnt(6)
v_mfma_f32_16x16x32_bf16 v[156:159], v[172:175], v[68:71], v[156:159]
ds_read_b64_tr_b16 v[164:165], v25 offset:8448
s_waitcnt lgkmcnt(5)
v_mfma_f32_16x16x32_bf16 v[156:159], v[188:191], v[76:79], v[156:159]
ds_read_b64_tr_b16 v[166:167], v25 offset:10496
v_mfma_f32_16x16x32_bf16 v[140:143], v[188:191], v[72:75], v[140:143]
ds_read_b64_tr_b16 v[180:181], v25 offset:12544
v_mfma_f32_16x16x32_bf16 v[140:143], v[172:175], v[64:67], v[140:143]
ds_read_b64_tr_b16 v[182:183], v25 offset:14592
s_waitcnt lgkmcnt(6)
v_mfma_f32_16x16x32_bf16 v[128:131], v[160:163], v[80:83], v[128:131]
ds_read_b64_tr_b16 v[168:169], v25 offset:8704
s_waitcnt lgkmcnt(5)
v_mfma_f32_16x16x32_bf16 v[128:131], v[176:179], v[88:91], v[128:131]
ds_read_b64_tr_b16 v[170:171], v25 offset:10752
v_mfma_f32_16x16x32_bf16 v[144:147], v[176:179], v[92:95], v[144:147]
ds_read_b64_tr_b16 v[184:185], v25 offset:12800
v_mfma_f32_16x16x32_bf16 v[144:147], v[160:163], v[84:87], v[144:147]
ds_read_b64_tr_b16 v[186:187], v25 offset:14848
s_waitcnt lgkmcnt(6)
v_mfma_f32_16x16x32_bf16 v[148:151], v[164:167], v[84:87], v[148:151]
ds_read_b64_tr_b16 v[172:173], v25 offset:8960
s_waitcnt lgkmcnt(5)
v_mfma_f32_16x16x32_bf16 v[148:151], v[180:183], v[92:95], v[148:151]
ds_read_b64_tr_b16 v[174:175], v25 offset:11008
v_mfma_f32_16x16x32_bf16 v[132:135], v[180:183], v[88:91], v[132:135]
ds_read_b64_tr_b16 v[188:189], v25 offset:13056
v_mfma_f32_16x16x32_bf16 v[132:135], v[164:167], v[80:83], v[132:135]
ds_read_b64_tr_b16 v[190:191], v25 offset:15104
s_waitcnt lgkmcnt(6)
v_mfma_f32_16x16x32_bf16 v[136:139], v[168:171], v[80:83], v[136:139]
s_waitcnt lgkmcnt(4)
v_mfma_f32_16x16x32_bf16 v[136:139], v[184:187], v[88:91], v[136:139]
v_mfma_f32_16x16x32_bf16 v[152:155], v[184:187], v[92:95], v[152:155]
v_mfma_f32_16x16x32_bf16 v[152:155], v[168:171], v[84:87], v[152:155]
s_waitcnt lgkmcnt(2)
v_mfma_f32_16x16x32_bf16 v[156:159], v[172:175], v[84:87], v[156:159]
s_waitcnt lgkmcnt(0)
v_mfma_f32_16x16x32_bf16 v[156:159], v[188:191], v[92:95], v[156:159]
v_mfma_f32_16x16x32_bf16 v[140:143], v[188:191], v[88:91], v[140:143]
v_mfma_f32_16x16x32_bf16 v[140:143], v[172:175], v[80:83], v[140:143]
v_pk_fma_f32 v[128:129], v[128:129], v[192:193], v[224:225]
v_pk_fma_f32 v[130:131], v[130:131], v[194:195], v[226:227]
v_pk_fma_f32 v[132:133], v[132:133], v[196:197], v[228:229]
v_pk_fma_f32 v[134:135], v[134:135], v[198:199], v[230:231]
v_pk_fma_f32 v[136:137], v[136:137], v[200:201], v[232:233]
v_pk_fma_f32 v[138:139], v[138:139], v[202:203], v[234:235]
s_nop 1
v_pk_fma_f32 v[140:141], v[140:141], v[204:205], v[236:237]
v_pk_fma_f32 v[142:143], v[142:143], v[206:207], v[238:239]
v_cvt_pk_bf16_f32 v128, v128, v129
v_cvt_pk_bf16_f32 v129, v130, v131
v_cvt_pk_bf16_f32 v130, v132, v133
v_cvt_pk_bf16_f32 v131, v134, v135
v_cvt_pk_bf16_f32 v132, v136, v137
v_cvt_pk_bf16_f32 v133, v138, v139
v_cvt_pk_bf16_f32 v134, v140, v141
v_cvt_pk_bf16_f32 v135, v142, v143
v_permlane16_swap_b32 v128, v130
v_permlane16_swap_b32 v129, v131
v_permlane16_swap_b32 v132, v134
v_permlane16_swap_b32 v133, v135
buffer_store_dwordx4 v[128:131], v28, s[52:55], s32 offen offset:0
buffer_store_dwordx4 v[132:135], v28, s[52:55], s32 offen offset:64
v_pk_fma_f32 v[144:145], v[144:145], v[208:209], v[240:241]
v_pk_fma_f32 v[146:147], v[146:147], v[210:211], v[242:243]
v_pk_fma_f32 v[148:149], v[148:149], v[212:213], v[244:245]
v_pk_fma_f32 v[150:151], v[150:151], v[214:215], v[246:247]
v_pk_fma_f32 v[152:153], v[152:153], v[216:217], v[248:249]
v_pk_fma_f32 v[154:155], v[154:155], v[218:219], v[250:251]
v_pk_fma_f32 v[156:157], v[156:157], v[220:221], v[252:253]
v_pk_fma_f32 v[158:159], v[158:159], v[222:223], v[254:255]
v_cvt_pk_bf16_f32 v144, v144, v145
v_cvt_pk_bf16_f32 v145, v146, v147
v_cvt_pk_bf16_f32 v146, v148, v149
v_cvt_pk_bf16_f32 v147, v150, v151
v_cvt_pk_bf16_f32 v148, v152, v153
v_cvt_pk_bf16_f32 v149, v154, v155
v_cvt_pk_bf16_f32 v150, v156, v157
v_cvt_pk_bf16_f32 v151, v158, v159
v_permlane16_swap_b32 v144, v146
v_permlane16_swap_b32 v145, v147
v_permlane16_swap_b32 v148, v150
v_permlane16_swap_b32 v149, v151
buffer_store_dwordx4 v[144:147], v28, s[52:55], s33 offen offset:0
buffer_store_dwordx4 v[148:151], v28, s[52:55], s33 offen offset:64
L_fin:
L_end:
s_endpgm
L_g_idle:
s_lshr_b32 s34, s2, 5
s_add_u32 s52, s4, 0x2c00000
s_addc_u32 s53, s5, 0
s_mov_b32 s54, 0x700000
s_mov_b32 s55, 0x20000
s_bfe_u32 s26, s2, 0x10002
s_lshl_b32 s26, s26, 3
s_add_u32 s59, s26, s34
s_lshl_b32 s59, s59, 7
v_bfe_u32 v10, v0, 3, 1
v_bfe_u32 v12, v0, 1, 2
v_lshl_add_u32 v10, v10, 4, v12
s_lshl_b32 s26, s42, 5
v_add_u32 v10, s26, v10
v_lshlrev_b32 v10, 11, v10
v_lshrrev_b32 v13, 4, v0
v_lshl_add_u32 v10, v13, 5, v10
v_and_b32 v12, 1, v0
v_lshl_add_u32 v16, v12, 4, v10
v_add_u32 v17, 7168, v16
v_add_u32 v18, 14336, v16
v_add_u32 v19, 21504, v16
v_and_b32 v10, 15, v0
v_lshlrev_b32 v10, 11, v10
v_lshrrev_b32 v12, 5, v0
v_lshl_add_u32 v10, v12, 4, v10
v_bfe_u32 v12, v0, 4, 1
v_lshl_add_u32 v28, v12, 5, v10
v_lshrrev_b32 v13, 5, v0
v_and_b32 v12, 31, v0
v_lshlrev_b32 v12, 3, v12
v_lshl_add_u32 v22, v13, 10, v12
v_add_u32 v23, 65536, v22
v_mov_b32 v20, v11
v_add_u32 v21, 4096, v11
s_lshl_b32 s43, s64, 2
s_add_u32 s43, s43, s42
s_bfe_u32 s75, s2, 0x10002
s_mul_i32 s56, s75, 1835008
s_sub_u32 s57, 0, s56
s_sub_u32 s26, 0x380000, s59
s_add_u32 s12, s68, s59
s_addc_u32 s13, s69, 0
s_mov_b32 s14, s26
s_mov_b32 s15, 0x20000
s_barrier
s_barrier
v_mov_b32 v13, 159748
v_mov_b32 v14, 1
v_lshlrev_b32 v15, 7, v0
s_mov_b64 exec, 1
s_waitcnt vmcnt(0)
ds_add_rtn_u32 v13, v13, v14
s_waitcnt lgkmcnt(0)
v_readfirstlane_b32 s26, v13
s_mov_b64 exec, 15
s_cmp_lg_u32 s26, 3
s_cbranch_scc1 L_t_pi
buffer_atomic_add v14, v15, s[48:51], s74 offen sc1
L_t_pi:
s_mov_b64 exec, -1
s_barrier
s_barrier
s_barrier
s_barrier
s_barrier
s_barrier
v_lshlrev_b32 v12, 7, v0
s_sub_u32 s26, s2, 224
s_lshl_b32 s26, s26, 2
s_add_u32 s26, s26, s42
s_lshl_b32 s26, s26, 13
s_mov_b32 s8, s66
s_mov_b32 s9, s67
s_mov_b32 s10, 0x200000
s_mov_b32 s11, 0x20000
s_mov_b32 s20, s68
s_mov_b32 s21, s69
s_mov_b32 s22, 0x380000
s_mov_b32 s23, 0x20000
s_add_u32 s27, s26, 0
buffer_load_dword v13, v12, s[8:11], s27 offen
s_add_u32 s27, s26, 1048576
buffer_load_dword v13, v12, s[8:11], s27 offen
s_add_u32 s27, s26, 0
buffer_load_dword v13, v12, s[20:23], s27 offen
s_add_u32 s27, s26, 1048576
buffer_load_dword v13, v12, s[20:23], s27 offen
s_add_u32 s27, s26, 2097152
buffer_load_dword v13, v12, s[20:23], s27 offen
s_add_u32 s27, s26, 3145728
buffer_load_dword v13, v12, s[20:23], s27 offen
s_barrier
s_add_u32 m0, s41, 0
s_add_u32 s58, s56, 0
buffer_load_dwordx4 v16, s[12:15], s58 offen offset:0 lds
buffer_load_dwordx4 v17, s[12:15], s58 offen offset:1024 lds
buffer_load_dwordx4 v18, s[12:15], s58 offen offset:2048 lds
buffer_load_dwordx4 v19, s[12:15], s58 offen offset:3072 lds
s_barrier
s_add_u32 m0, s41, 16384
s_add_u32 s58, s56, 262144
buffer_load_dwordx4 v16, s[12:15], s58 offen offset:0 lds
buffer_load_dwordx4 v17, s[12:15], s58 offen offset:1024 lds
buffer_load_dwordx4 v18, s[12:15], s58 offen offset:2048 lds
buffer_load_dwordx4 v19, s[12:15], s58 offen offset:3072 lds
s_barrier
s_add_u32 m0, s41, 32768
s_add_u32 s58, s56, 524288
buffer_load_dwordx4 v16, s[12:15], s58 offen offset:0 lds
buffer_load_dwordx4 v17, s[12:15], s58 offen offset:1024 lds
buffer_load_dwordx4 v18, s[12:15], s58 offen offset:2048 lds
buffer_load_dwordx4 v19, s[12:15], s58 offen offset:3072 lds
s_barrier
s_add_u32 m0, s41, 49152
s_add_u32 s58, s56, 786432
buffer_load_dwordx4 v16, s[12:15], s58 offen offset:0 lds
buffer_load_dwordx4 v17, s[12:15], s58 offen offset:1024 lds
buffer_load_dwordx4 v18, s[12:15], s58 offen offset:2048 lds
buffer_load_dwordx4 v19, s[12:15], s58 offen offset:3072 lds
s_barrier
s_add_u32 m0, s41, 65536
s_add_u32 s58, s56, 1048576
buffer_load_dwordx4 v16, s[12:15], s58 offen offset:0 lds
buffer_load_dwordx4 v17, s[12:15], s58 offen offset:1024 lds
buffer_load_dwordx4 v18, s[12:15], s58 offen offset:2048 lds
buffer_load_dwordx4 v19, s[12:15], s58 offen offset:3072 lds
s_barrier
s_add_u32 m0, s41, 81920
s_add_u32 s58, s56, 1310720
buffer_load_dwordx4 v16, s[12:15], s58 offen offset:0 lds
buffer_load_dwordx4 v17, s[12:15], s58 offen offset:1024 lds
buffer_load_dwordx4 v18, s[12:15], s58 offen offset:2048 lds
buffer_load_dwordx4 v19, s[12:15], s58 offen offset:3072 lds
s_barrier
s_add_u32 m0, s41, 98304
s_add_u32 s58, s56, 1572864
buffer_load_dwordx4 v16, s[12:15], s58 offen offset:0 lds
buffer_load_dwordx4 v17, s[12:15], s58 offen offset:1024 lds
buffer_load_dwordx4 v18, s[12:15], s58 offen offset:2048 lds
buffer_load_dwordx4 v19, s[12:15], s58 offen offset:3072 lds
s_barrier
s_add_u32 m0, s41, 114688
s_add_u32 s58, s57, 1835008
buffer_load_dwordx4 v16, s[12:15], s58 offen offset:0 lds
buffer_load_dwordx4 v17, s[12:15], s58 offen offset:1024 lds
buffer_load_dwordx4 v18, s[12:15], s58 offen offset:2048 lds
buffer_load_dwordx4 v19, s[12:15], s58 offen offset:3072 lds
s_mov_b32 s47, 38
L_g_idl:
s_barrier
s_sub_u32 s47, s47, 1
s_cmp_lg_u32 s47, 0
s_cbranch_scc1 L_g_idl
s_branch L_gC
L_cw1:
.section .rodata,"a"
.p2align 6
.amdhsa_kernel recurrent_scan__softmax_full_mha__mixer_gmlp__prompt_kernel
  .amdhsa_next_free_vgpr 256
  .amdhsa_next_free_sgpr 102
  .amdhsa_accum_offset 256
  .amdhsa_group_segment_fixed_size 0
  .amdhsa_kernarg_size 88
  .amdhsa_user_sgpr_count 2
  .amdhsa_user_sgpr_kernarg_segment_ptr 1
  .amdhsa_system_sgpr_workgroup_id_x 1
.end_amdhsa_kernel
```
